```python
import torch

def _softmax(x, axis=-1):
    return torch.softmax(x, dim=axis)
def _gelu(x):
    return torch.nn.functional.gelu(x, approximate="tanh")
def _silu(x):
    return torch.nn.functional.silu(x)
def _sigmoid(x):
    return torch.sigmoid(x)
def _layernorm(x, axis=-1, eps=1e-5):
    m = x.mean(dim=axis, keepdim=True)
    v = x.var(dim=axis, keepdim=True, unbiased=False)
    return (x - m) / torch.sqrt(v + eps)
def _scatter_add(tgt, idx, src, axis=0):
    return tgt.clone().index_add_(axis, idx, src)
def _segment_sum(src, seg, n):
    out = torch.zeros((n,) + src.shape[1:], dtype=src.dtype)
    return out.index_add_(0, seg, src)
def _pad(x, pw):
    flat = tuple(v for pair in reversed(pw) for v in pair)
    return torch.nn.functional.pad(x, flat)

kernel_name = 'concat_heads__mha_block_cached__gqa_block_cached__near_ridge'

def setup_inputs():

    _w = (lambda a: (lambda t: t.to(torch.bfloat16) if t.is_floating_point() else t)(torch.as_tensor(a)))
    def _A_setup():
        B, Sq, D = 16, 96, 576
        H, Sk, Dh = 32, 512, 128
        return {
            "x": _w((lambda *s: torch.randn(*s, dtype=torch.bfloat16) * 0.8)(B, Sq, D)),
            "k_cache": _w((lambda *s: torch.randn(*s, dtype=torch.bfloat16) * 0.8)(B, H, Sk, Dh)),
            "v_cache": _w((lambda *s: torch.randn(*s, dtype=torch.bfloat16) * 0.05)(B, H, Sk, Dh)),
            "wq": _w((lambda *s: torch.randn(*s, dtype=torch.bfloat16) * 0.8)(D, H * Dh) * (D ** -0.5)),
            "wo": _w((lambda *s: torch.randn(*s, dtype=torch.bfloat16) * 0.05)(H * Dh, D) * ((H * Dh) ** -0.5)),
        }
    _A_in = _A_setup()

    def _B_setup():
        B, Sq, D = 16, 96, 576
        Hq, Hkv, Sk, Dh = 32, 32, 512, 128
        assert Hq % Hkv == 0, (Hq, Hkv)
        return {
            "x": _w((lambda *s: torch.randn(*s, dtype=torch.bfloat16) * 0.8)(B, Sq, D)),
            "k_cache": _w((lambda *s: torch.randn(*s, dtype=torch.bfloat16) * 0.8)(B, Hkv, Sk, Dh)),
            "v_cache": _w((lambda *s: torch.randn(*s, dtype=torch.bfloat16) * 0.05)(B, Hkv, Sk, Dh)),
            "wq": _w((lambda *s: torch.randn(*s, dtype=torch.bfloat16) * 0.8)(D, Hq * Dh) * (D ** -0.5)),
            "wo": _w((lambda *s: torch.randn(*s, dtype=torch.bfloat16) * 0.05)(Hq * Dh, D) * ((Hq * Dh) ** -0.5)),
        }
    _B_in = _B_setup()

    return {
        "A_x": _A_in["x"],
        "A_k_cache": _A_in["k_cache"],
        "A_v_cache": _A_in["v_cache"],
        "A_wq": _A_in["wq"],
        "A_wo": _A_in["wo"],
        "B_x": _B_in["x"],
        "B_k_cache": _B_in["k_cache"],
        "B_v_cache": _B_in["v_cache"],
        "B_wq": _B_in["wq"],
        "B_wo": _B_in["wo"],
    }

def reference(A_x, A_k_cache, A_v_cache, A_wq, A_wo, B_x, B_k_cache, B_v_cache, B_wq, B_wo):
    def _A_ref(x, k_cache, v_cache, wq, wo):
        B, Sq, D = x.shape
        H, Dh = 32, 128
        q = (lambda x, *d: x.permute(*d))((x @ wq).reshape(B, Sq, H, Dh), 0, 2, 1, 3)
        scores = torch.einsum("bhqd,bhkd->bhqk", q, k_cache) * (Dh ** -0.5)
        p = _softmax(scores, axis=-1)
        o = torch.einsum("bhqk,bhkd->bhqd", p, v_cache)
        return (lambda x, *d: x.permute(*d))(o, 0, 2, 1, 3).reshape(B, Sq, H * Dh) @ wo

    def _B_ref(x, k_cache, v_cache, wq, wo):
        B, Sq, D = x.shape
        Hq, Dh = 32, 128
        Hkv = k_cache.shape[1]
        rep = Hq // Hkv
        q = (lambda x, *d: x.permute(*d))((x @ wq).reshape(B, Sq, Hq, Dh), 0, 2, 1, 3)
        k = (lambda x, n, axis: torch.repeat_interleave(x, n, dim=axis))(k_cache, rep, axis=1)
        v = (lambda x, n, axis: torch.repeat_interleave(x, n, dim=axis))(v_cache, rep, axis=1)
        scores = torch.einsum("bhqd,bhkd->bhqk", q, k) * (Dh ** -0.5)
        p = _softmax(scores, axis=-1)
        o = torch.einsum("bhqk,bhkd->bhqd", p, v)
        return (lambda x, *d: x.permute(*d))(o, 0, 2, 1, 3).reshape(B, Sq, Hq * Dh) @ wo

    a = _A_ref(A_x, A_k_cache, A_v_cache, A_wq, A_wo)
    b = _B_ref(B_x, B_k_cache, B_v_cache, B_wq, B_wo)
    return torch.concatenate([a, b], axis=-1)
```

```asm
; @launch grid=(256,1,1) block=(256,1,1) lds=163840
.amdgcn_target "amdgcn-amd-amdhsa--gfx950"
.text
.globl concat_heads__mha_block_cached__gqa_block_cached__near_ridge_kernel
.p2align 8
.type concat_heads__mha_block_cached__gqa_block_cached__near_ridge_kernel,@function
concat_heads__mha_block_cached__gqa_block_cached__near_ridge_kernel:
    s_cmp_ge_u32 s2, 256
    s_cbranch_scc1 L_exit
    s_load_dwordx16 s[56:71], s[0:1], 0
    s_load_dwordx4 s[72:75], s[0:1], 64
    s_load_dwordx2 s[20:21], s[0:1], 96
    s_getpc_b64 s[76:77]
L_pcref:
    s_mov_b32 s78, L_exit-L_pcref
    s_mov_b32 s79, 0x20000
    v_lshlrev_b32 v114, 4, v0
    s_lshr_b32 s48, s2, 3
    s_lshl_b32 s48, s48, 12
    s_mov_b32 m0, 130560
    s_nop 0
    buffer_load_dwordx4 v114, s[76:79], s48 offen lds
    v_lshrrev_b32 v10, 6, v0
    v_and_b32 v100, 63, v0
    v_readfirstlane_b32 s3, v10
    v_lshlrev_b32 v114, 4, v100
    s_and_b32 s48, s2, 7
    s_lshr_b32 s45, s48, 2
    s_and_b32 s44, s48, 3
    s_lshr_b32 s49, s2, 3
    s_lshr_b32 s43, s49, 1
    v_lshrrev_b32 v10, 4, v100
    v_and_b32 v106, 15, v100
    v_xor_b32 v107, v106, v10
    v_lshlrev_b32 v107, 4, v107
    v_mul_u32_u24 v105, 1152, v10
    v_add_u32 v105, v105, v107
    s_mul_i32 s48, s3, 9216
    v_add_u32 v105, s48, v105
    s_mul_i32 s42, s3, 2176
    s_mul_i32 s36, s43, 110592
    s_mul_i32 s37, s3, 1056
    s_and_b32 s49, s49, 1
    s_lshl_b32 s44, s44, 1
    s_add_u32 s44, s44, s49
    s_lshl_b32 s49, s49, 4
    s_lshr_b32 s31, s44, 1
    s_add_u32 s31, s31, s49
    s_and_b32 s48, s43, 1
    s_lshl_b32 s48, s48, 4
    s_mov_b32 s41, 0x3213210
    s_bitcmp1_b32 s43, 1
    s_cselect_b32 s41, 0x21031032, s41
    s_lshr_b32 s41, s41, s48
    s_and_b32 s41, s41, 0xffff
    s_mov_b32 s28, 0
    s_lshr_b32 s48, s41, 0
    s_and_b32 s48, s48, 3
    s_lshl_b32 s49, s44, 2
    s_add_u32 s48, s48, s49
    s_lshl_b32 s29, s48, 8
    v_and_b32 v108, 7, v100
    v_lshlrev_b32 v113, 4, v108
    v_lshrrev_b32 v108, 5, v100
    v_lshl_add_u32 v113, v108, 17, v113
    v_bfe_u32 v108, v100, 3, 1
    v_lshl_add_u32 v113, v108, 16, v113
    v_lshl_add_u32 v112, v108, 31, v105
    v_bfe_u32 v108, v100, 4, 1
    v_lshl_add_u32 v113, v108, 15, v113
    s_lshl_b32 s48, s3, 13
    v_add_u32 v113, s48, v113
    s_mov_b32 s26, 1769472
    s_mov_b32 s27, 0x20000
    s_mov_b32 s18, 4718592
    s_mov_b32 s19, 0x20000
    s_waitcnt lgkmcnt(0)
    s_cmp_eq_u32 s45, 0
    s_cselect_b32 s24, s56, s66
    s_cselect_b32 s25, s57, s67
    s_cselect_b32 s16, s62, s72
    s_cselect_b32 s17, s63, s73
    s_cselect_b32 s4, s58, s68
    s_cselect_b32 s5, s59, s69
    s_cselect_b32 s8, s60, s70
    s_cselect_b32 s9, s61, s71
    s_cselect_b32 s12, s64, s74
    s_cselect_b32 s13, s65, s75
    s_add_u32 m0, s42, 26112
    s_add_u32 s50, s36, 0
    buffer_load_dwordx4 v105, s[24:27], s50 offen  lds
    s_add_u32 m0, s42, 27200
    s_add_u32 s50, s36, 4608
    buffer_load_dwordx4 v105, s[24:27], s50 offen  lds
    s_add_u32 m0, s42, 34816
    s_add_u32 s50, s36, 36864
    buffer_load_dwordx4 v105, s[24:27], s50 offen  lds
    s_add_u32 m0, s42, 35904
    s_add_u32 s50, s36, 41472
    buffer_load_dwordx4 v105, s[24:27], s50 offen  lds
    s_add_u32 m0, s42, 43520
    s_add_u32 s50, s36, 73728
    buffer_load_dwordx4 v105, s[24:27], s50 offen  lds
    s_add_u32 m0, s42, 44608
    s_add_u32 s50, s36, 78336
    buffer_load_dwordx4 v105, s[24:27], s50 offen  lds
    s_add_u32 m0, s37, 0
    s_nop 0
    buffer_load_dwordx4 v113, s[16:19], s29 offen  lds
    s_add_u32 m0, s37, 4096
    s_nop 0
    buffer_load_dwordx4 v113, s[16:19], s29 offen offset:128  lds
    s_add_u32 m0, s37, 8448
    s_add_u32 s29, s29, 262144
    buffer_load_dwordx4 v113, s[16:19], s29 offen  lds
    s_add_u32 m0, s37, 12544
    s_nop 0
    buffer_load_dwordx4 v113, s[16:19], s29 offen offset:128  lds
    s_add_u32 m0, s37, 16896
    s_add_u32 s29, s29, 262144
    buffer_load_dwordx4 v113, s[16:19], s29 offen  lds
    s_add_u32 m0, s37, 20992
    s_nop 0
    buffer_load_dwordx4 v113, s[16:19], s29 offen offset:128  lds
    s_add_u32 m0, s37, 113152
    s_add_u32 s29, s29, 262144
    buffer_load_dwordx4 v113, s[16:19], s29 offen  lds
    s_add_u32 m0, s37, 117248
    s_nop 0
    buffer_load_dwordx4 v113, s[16:19], s29 offen offset:128  lds
    s_add_u32 s29, s29, 262144
    s_add_u32 m0, s42, 52224
    s_add_u32 s50, s36, 256
    buffer_load_dwordx4 v105, s[24:27], s50 offen  lds
    s_add_u32 m0, s42, 53312
    s_add_u32 s50, s36, 4864
    buffer_load_dwordx4 v105, s[24:27], s50 offen  lds
    s_add_u32 m0, s42, 60928
    s_add_u32 s50, s36, 37120
    buffer_load_dwordx4 v105, s[24:27], s50 offen  lds
    s_add_u32 m0, s42, 62016
    s_add_u32 s50, s36, 41728
    buffer_load_dwordx4 v105, s[24:27], s50 offen  lds
    s_add_u32 m0, s42, 69632
    s_add_u32 s50, s36, 73984
    buffer_load_dwordx4 v105, s[24:27], s50 offen  lds
    s_add_u32 m0, s42, 70720
    s_add_u32 s50, s36, 78592
    buffer_load_dwordx4 v105, s[24:27], s50 offen  lds
    s_lshl_b32 s55, s45, 4
    s_add_u32 s55, s55, s43
    s_mov_b32 s46, 0x41200000
    s_mov_b32 s47, 0x3e0293ee
    s_mul_i32 s40, s3, 2176
    s_mul_i32 s39, s3, 2112
    v_lshlrev_b32 v8, 11, v10
    v_lshl_add_u32 v8, v106, 4, v8
    v_lshl_add_u32 v7, v10, 8, v107
    s_mul_i32 s48, s3, 2048
    v_add_u32 v7, s48, v7
    s_mul_i32 s48, s3, 512
    v_add_u32 v8, s48, v8
    v_lshrrev_b32 v10, 3, v100
    v_mul_u32_u24 v9, 9216, v10
    v_and_b32 v10, 7, v100
    v_lshl_add_u32 v9, v10, 4, v9
    s_mul_i32 s48, s3, 2304
    v_add_u32 v9, s48, v9
    v_bfe_u32 v10, v100, 2, 2
    v_mul_u32_u24 v101, 1088, v10
    v_and_b32 v10, 3, v100
    v_lshl_add_u32 v101, v10, 8, v101
    v_lshrrev_b32 v106, 4, v100
    v_xor_b32 v106, v106, v10
    v_lshl_add_u32 v101, v106, 4, v101
    v_bfe_u32 v106, v100, 2, 3
    v_mul_u32_u24 v102, 1056, v106
    v_lshl_add_u32 v102, v10, 3, v102
    v_lshrrev_b32 v106, 5, v100
    v_lshl_add_u32 v103, v106, 7, v102
    v_lshl_add_u32 v102, v106, 8, v102
    v_lshlrev_b32 v104, 3, v10
    v_lshl_add_u32 v104, v106, 9, v104
    v_bfe_u32 v106, v100, 4, 1
    v_lshl_add_u32 v104, v106, 7, v104
    v_bfe_u32 v106, v100, 2, 2
    v_mul_u32_u24 v106, 1056, v106
    v_add_u32 v104, v104, v106
    s_mov_b32 s6, 67108864
    s_mov_b32 s7, 0x20000
    s_mov_b32 s10, 67108864
    s_mov_b32 s11, 0x20000
    s_mov_b32 s14, 0
    s_mov_b32 s15, 0x20000
    s_mov_b32 s22, 28377088
    s_mov_b32 s23, 0x20000
    s_mov_b32 s76, s12
    s_mov_b32 s77, s13
    s_mov_b32 s78, 4718592
    s_mov_b32 s79, 0x20000
    s_lshr_b32 s48, s44, 1
    s_mul_i32 s48, s48, 1179648
    s_lshr_b32 s49, s2, 3
    s_lshl_b32 s49, s49, 2
    s_add_u32 s49, s49, s3
    s_mul_i32 s49, s49, 9216
    s_add_u32 s66, s48, s49
    s_mov_b32 s34, 73728
    s_mov_b32 s30, 0
    s_mov_b32 s73, 0
    s_lshl_b32 s48, s30, 2
    s_lshr_b32 s48, s41, s48
    s_and_b32 s48, s48, 3
    s_lshl_b32 s49, s44, 2
    s_add_u32 s48, s48, s49
    s_lshl_b32 s49, s43, 5
    s_add_u32 s48, s48, s49
    s_lshl_b32 s74, s48, 17
    s_mov_b32 s32, s74
    s_add_u32 s30, s30, 1
    s_mov_b32 s33, s74
    s_cmp_eq_u32 s3, 3
    s_cbranch_scc1 L_qwave
    s_lshl_b32 s48, s3, 13
    s_add_u32 s48, s48, 113152
    v_add_u32 v0, s48, v114
    s_mul_i32 s48, s55, 27
    s_mul_i32 s49, s3, 9
    s_add_u32 s48, s48, s49
    s_lshl_b32 s48, s48, 3
    s_add_u32 s48, s48, s44
    s_lshl_b32 s54, s48, 12
    v_add_u32 v1, 26112, v101
    v_add_u32 v2, 26112, v102
    v_add_u32 v3, 26112, v103
    v_add_u32 v4, 69632, v101
    v_add_u32 v5, 69632, v102
    v_add_u32 v6, 69632, v103
    v_add_u32 v108, 61440, v104
    v_add_u32 v109, 122880, v104
    s_mul_i32 s49, s3, 8704
    s_add_u32 s48, s49, 26112
    v_add_u32 v110, s48, v101
    s_add_u32 s48, s49, 137728
    v_add_u32 v111, s48, v101
    v_accvgpr_write_b32 a144, 0
    v_accvgpr_write_b32 a145, 0
    v_accvgpr_write_b32 a146, 0
    v_accvgpr_write_b32 a147, 0
    v_accvgpr_write_b32 a148, 0
    v_accvgpr_write_b32 a149, 0
    v_accvgpr_write_b32 a150, 0
    v_accvgpr_write_b32 a151, 0
    v_accvgpr_write_b32 a152, 0
    v_accvgpr_write_b32 a153, 0
    v_accvgpr_write_b32 a154, 0
    v_accvgpr_write_b32 a155, 0
    v_accvgpr_write_b32 a156, 0
    v_accvgpr_write_b32 a157, 0
    v_accvgpr_write_b32 a158, 0
    v_accvgpr_write_b32 a159, 0
    v_accvgpr_write_b32 a160, 0
    v_accvgpr_write_b32 a161, 0
    v_accvgpr_write_b32 a162, 0
    v_accvgpr_write_b32 a163, 0
    v_accvgpr_write_b32 a164, 0
    v_accvgpr_write_b32 a165, 0
    v_accvgpr_write_b32 a166, 0
    v_accvgpr_write_b32 a167, 0
    v_accvgpr_write_b32 a168, 0
    v_accvgpr_write_b32 a169, 0
    v_accvgpr_write_b32 a170, 0
    v_accvgpr_write_b32 a171, 0
    v_accvgpr_write_b32 a172, 0
    v_accvgpr_write_b32 a173, 0
    v_accvgpr_write_b32 a174, 0
    v_accvgpr_write_b32 a175, 0
    v_accvgpr_write_b32 a176, 0
    v_accvgpr_write_b32 a177, 0
    v_accvgpr_write_b32 a178, 0
    v_accvgpr_write_b32 a179, 0
    v_accvgpr_write_b32 a180, 0
    v_accvgpr_write_b32 a181, 0
    v_accvgpr_write_b32 a182, 0
    v_accvgpr_write_b32 a183, 0
    v_accvgpr_write_b32 a184, 0
    v_accvgpr_write_b32 a185, 0
    v_accvgpr_write_b32 a186, 0
    v_accvgpr_write_b32 a187, 0
    v_accvgpr_write_b32 a188, 0
    v_accvgpr_write_b32 a189, 0
    v_accvgpr_write_b32 a190, 0
    v_accvgpr_write_b32 a191, 0
    v_accvgpr_write_b32 a192, 0
    v_accvgpr_write_b32 a193, 0
    v_accvgpr_write_b32 a194, 0
    v_accvgpr_write_b32 a195, 0
    v_accvgpr_write_b32 a196, 0
    v_accvgpr_write_b32 a197, 0
    v_accvgpr_write_b32 a198, 0
    v_accvgpr_write_b32 a199, 0
    v_accvgpr_write_b32 a200, 0
    v_accvgpr_write_b32 a201, 0
    v_accvgpr_write_b32 a202, 0
    v_accvgpr_write_b32 a203, 0
    v_accvgpr_write_b32 a204, 0
    v_accvgpr_write_b32 a205, 0
    v_accvgpr_write_b32 a206, 0
    v_accvgpr_write_b32 a207, 0
    v_accvgpr_write_b32 a208, 0
    v_accvgpr_write_b32 a209, 0
    v_accvgpr_write_b32 a210, 0
    v_accvgpr_write_b32 a211, 0
    v_accvgpr_write_b32 a212, 0
    v_accvgpr_write_b32 a213, 0
    v_accvgpr_write_b32 a214, 0
    v_accvgpr_write_b32 a215, 0
    v_accvgpr_write_b32 a216, 0
    v_accvgpr_write_b32 a217, 0
    v_accvgpr_write_b32 a218, 0
    v_accvgpr_write_b32 a219, 0
    v_accvgpr_write_b32 a220, 0
    v_accvgpr_write_b32 a221, 0
    v_accvgpr_write_b32 a222, 0
    v_accvgpr_write_b32 a223, 0
    v_accvgpr_write_b32 a224, 0
    v_accvgpr_write_b32 a225, 0
    v_accvgpr_write_b32 a226, 0
    v_accvgpr_write_b32 a227, 0
    v_accvgpr_write_b32 a228, 0
    v_accvgpr_write_b32 a229, 0
    v_accvgpr_write_b32 a230, 0
    v_accvgpr_write_b32 a231, 0
    v_accvgpr_write_b32 a232, 0
    v_accvgpr_write_b32 a233, 0
    v_accvgpr_write_b32 a234, 0
    v_accvgpr_write_b32 a235, 0
    v_accvgpr_write_b32 a236, 0
    v_accvgpr_write_b32 a237, 0
    v_accvgpr_write_b32 a238, 0
    v_accvgpr_write_b32 a239, 0
    v_accvgpr_write_b32 a240, 0
    v_accvgpr_write_b32 a241, 0
    v_accvgpr_write_b32 a242, 0
    v_accvgpr_write_b32 a243, 0
    v_accvgpr_write_b32 a244, 0
    v_accvgpr_write_b32 a245, 0
    v_accvgpr_write_b32 a246, 0
    v_accvgpr_write_b32 a247, 0
    v_accvgpr_write_b32 a248, 0
    v_accvgpr_write_b32 a249, 0
    v_accvgpr_write_b32 a250, 0
    v_accvgpr_write_b32 a251, 0
    v_accvgpr_write_b32 a252, 0
    v_accvgpr_write_b32 a253, 0
    v_accvgpr_write_b32 a254, 0
    v_accvgpr_write_b32 a255, 0
    v_mov_b32 v224, 0
    v_mov_b32 v225, 0
    v_mov_b32 v226, 0
    v_mov_b32 v227, 0
    v_mov_b32 v228, 0
    v_mov_b32 v229, 0
    v_mov_b32 v230, 0
    v_mov_b32 v231, 0
    v_mov_b32 v232, 0
    v_mov_b32 v233, 0
    v_mov_b32 v234, 0
    v_mov_b32 v235, 0
    v_mov_b32 v236, 0
    v_mov_b32 v237, 0
    v_mov_b32 v238, 0
    v_mov_b32 v239, 0
    v_mov_b32 v240, 0
    v_mov_b32 v241, 0
    v_mov_b32 v242, 0
    v_mov_b32 v243, 0
    v_mov_b32 v244, 0
    v_mov_b32 v245, 0
    v_mov_b32 v246, 0
    v_mov_b32 v247, 0
    v_mov_b32 v248, 0
    v_mov_b32 v249, 0
    v_mov_b32 v250, 0
    v_mov_b32 v251, 0
    v_mov_b32 v252, 0
    v_mov_b32 v253, 0
    v_mov_b32 v254, 0
    v_mov_b32 v255, 0
    s_waitcnt vmcnt(12) lgkmcnt(0)
    s_barrier
    ds_read_b128 a[0:3], v110 offset:0
    ds_read_b128 a[4:7], v110 offset:4352
    ds_read_b128 a[8:11], v110 offset:64
    ds_read_b128 a[12:15], v110 offset:4416
    ds_read_b128 a[16:19], v110 offset:128
    ds_read_b128 a[20:23], v110 offset:4480
    ds_read_b128 a[24:27], v110 offset:192
    ds_read_b128 a[28:31], v110 offset:4544
    ds_read_b64_tr_b16 v[16:17], v104 offset:0
    ds_read_b64_tr_b16 v[18:19], v104 offset:256
    ds_read_b64_tr_b16 v[20:21], v104 offset:32
    ds_read_b64_tr_b16 v[22:23], v104 offset:288
    ds_read_b64_tr_b16 v[24:25], v104 offset:64
    ds_read_b64_tr_b16 v[26:27], v104 offset:320
    ds_read_b64_tr_b16 v[28:29], v104 offset:96
    ds_read_b64_tr_b16 v[30:31], v104 offset:352
    ds_read_b64_tr_b16 v[32:33], v104 offset:4224
    ds_read_b64_tr_b16 v[34:35], v104 offset:4480
    ds_read_b64_tr_b16 v[36:37], v104 offset:4256
    ds_read_b64_tr_b16 v[38:39], v104 offset:4512
    ds_read_b64_tr_b16 v[40:41], v104 offset:4288
    ds_read_b64_tr_b16 v[42:43], v104 offset:4544
    ds_read_b64_tr_b16 v[44:45], v104 offset:4320
    ds_read_b64_tr_b16 v[46:47], v104 offset:4576
    s_add_u32 m0, s37, 121600
    s_nop 0
    buffer_load_dwordx4 v113, s[16:19], s29 offen  lds
    s_add_u32 m0, s37, 125696
    s_nop 0
    buffer_load_dwordx4 v113, s[16:19], s29 offen offset:128  lds
    s_add_u32 m0, s37, 78336
    s_add_u32 s29, s29, 262144
    buffer_load_dwordx4 v113, s[16:19], s29 offen  lds
    s_add_u32 m0, s37, 82432
    s_nop 0
    buffer_load_dwordx4 v113, s[16:19], s29 offen offset:128  lds
    s_add_u32 s29, s29, 262144
    s_waitcnt vmcnt(14) lgkmcnt(0)
    s_barrier
    v_mfma_f32_16x16x32_bf16 v[160:163], v[16:19], a[0:3], 0
    ds_read_b64_tr_b16 v[64:65], v104 offset:8448
    ds_read_b64_tr_b16 v[66:67], v104 offset:8704
    v_mfma_f32_16x16x32_bf16 v[192:195], v[16:19], a[4:7], 0
    ds_read_b64_tr_b16 v[68:69], v104 offset:8480
    ds_read_b64_tr_b16 v[70:71], v104 offset:8736
    v_mfma_f32_16x16x32_bf16 v[164:167], v[20:23], a[0:3], 0
    ds_read_b64_tr_b16 v[72:73], v104 offset:8512
    ds_read_b64_tr_b16 v[74:75], v104 offset:8768
    v_mfma_f32_16x16x32_bf16 v[196:199], v[20:23], a[4:7], 0
    ds_read_b64_tr_b16 v[76:77], v104 offset:8544
    ds_read_b64_tr_b16 v[78:79], v104 offset:8800
    v_mfma_f32_16x16x32_bf16 v[168:171], v[24:27], a[0:3], 0
    ds_read_b64_tr_b16 v[80:81], v104 offset:12672
    ds_read_b64_tr_b16 v[82:83], v104 offset:12928
    v_mfma_f32_16x16x32_bf16 v[200:203], v[24:27], a[4:7], 0
    ds_read_b64_tr_b16 v[84:85], v104 offset:12704
    ds_read_b64_tr_b16 v[86:87], v104 offset:12960
    v_mfma_f32_16x16x32_bf16 v[172:175], v[28:31], a[0:3], 0
    ds_read_b64_tr_b16 v[88:89], v104 offset:12736
    ds_read_b64_tr_b16 v[90:91], v104 offset:12992
    v_mfma_f32_16x16x32_bf16 v[204:207], v[28:31], a[4:7], 0
    ds_read_b64_tr_b16 v[92:93], v104 offset:12768
    ds_read_b64_tr_b16 v[94:95], v104 offset:13024
    s_add_u32 m0, s37, 87040
    v_mfma_f32_16x16x32_bf16 v[176:179], v[32:35], a[0:3], 0
    buffer_load_dwordx4 v113, s[16:19], s29 offen  lds
    s_add_u32 m0, s37, 91136
    v_mfma_f32_16x16x32_bf16 v[208:211], v[32:35], a[4:7], 0
    buffer_load_dwordx4 v113, s[16:19], s29 offen offset:128  lds
    s_add_u32 s29, s29, 262144
    v_mfma_f32_16x16x32_bf16 v[180:183], v[36:39], a[0:3], 0
    s_add_u32 m0, s42, 26112
    s_add_u32 s50, s36, 512
    buffer_load_dwordx4 v105, s[24:27], s50 offen  lds
    v_mfma_f32_16x16x32_bf16 v[212:215], v[36:39], a[4:7], 0
    s_add_u32 m0, s42, 27200
    s_add_u32 s50, s36, 5120
    buffer_load_dwordx4 v105, s[24:27], s50 offen  lds
    v_mfma_f32_16x16x32_bf16 v[184:187], v[40:43], a[0:3], 0
    s_add_u32 m0, s42, 34816
    s_add_u32 s50, s36, 37376
    buffer_load_dwordx4 v105, s[24:27], s50 offen  lds
    v_mfma_f32_16x16x32_bf16 v[216:219], v[40:43], a[4:7], 0
    s_add_u32 m0, s42, 35904
    s_add_u32 s50, s36, 41984
    buffer_load_dwordx4 v105, s[24:27], s50 offen  lds
    v_mfma_f32_16x16x32_bf16 v[188:191], v[44:47], a[0:3], 0
    s_add_u32 m0, s42, 43520
    s_add_u32 s50, s36, 74240
    buffer_load_dwordx4 v105, s[24:27], s50 offen  lds
    v_mfma_f32_16x16x32_bf16 v[220:223], v[44:47], a[4:7], 0
    s_add_u32 m0, s42, 44608
    s_add_u32 s50, s36, 78848
    buffer_load_dwordx4 v105, s[24:27], s50 offen  lds
    s_waitcnt vmcnt(20) lgkmcnt(0)
    s_barrier
    v_mfma_f32_16x16x32_bf16 v[160:163], v[64:67], a[8:11], v[160:163]
    ds_read_b64_tr_b16 v[16:17], v104 offset:16896
    ds_read_b64_tr_b16 v[18:19], v104 offset:17152
    v_mfma_f32_16x16x32_bf16 v[192:195], v[64:67], a[12:15], v[192:195]
    ds_read_b64_tr_b16 v[20:21], v104 offset:16928
    ds_read_b64_tr_b16 v[22:23], v104 offset:17184
    v_mfma_f32_16x16x32_bf16 v[164:167], v[68:71], a[8:11], v[164:167]
    ds_read_b64_tr_b16 v[24:25], v104 offset:16960
    ds_read_b64_tr_b16 v[26:27], v104 offset:17216
    v_mfma_f32_16x16x32_bf16 v[196:199], v[68:71], a[12:15], v[196:199]
    ds_read_b64_tr_b16 v[28:29], v104 offset:16992
    ds_read_b64_tr_b16 v[30:31], v104 offset:17248
    v_mfma_f32_16x16x32_bf16 v[168:171], v[72:75], a[8:11], v[168:171]
    ds_read_b64_tr_b16 v[32:33], v104 offset:21120
    ds_read_b64_tr_b16 v[34:35], v104 offset:21376
    v_mfma_f32_16x16x32_bf16 v[200:203], v[72:75], a[12:15], v[200:203]
    ds_read_b64_tr_b16 v[36:37], v104 offset:21152
    ds_read_b64_tr_b16 v[38:39], v104 offset:21408
    v_mfma_f32_16x16x32_bf16 v[172:175], v[76:79], a[8:11], v[172:175]
    ds_read_b64_tr_b16 v[40:41], v104 offset:21184
    ds_read_b64_tr_b16 v[42:43], v104 offset:21440
    v_mfma_f32_16x16x32_bf16 v[204:207], v[76:79], a[12:15], v[204:207]
    ds_read_b64_tr_b16 v[44:45], v104 offset:21216
    ds_read_b64_tr_b16 v[46:47], v104 offset:21472
    s_add_u32 m0, s37, 95744
    v_mfma_f32_16x16x32_bf16 v[176:179], v[80:83], a[8:11], v[176:179]
    buffer_load_dwordx4 v113, s[16:19], s29 offen  lds
    s_add_u32 m0, s37, 99840
    v_mfma_f32_16x16x32_bf16 v[208:211], v[80:83], a[12:15], v[208:211]
    buffer_load_dwordx4 v113, s[16:19], s29 offen offset:128  lds
    s_add_u32 s29, s29, 262144
    v_accvgpr_write_b32 a0, 0
    v_mfma_f32_16x16x32_bf16 v[180:183], v[84:87], a[8:11], v[180:183]
    v_accvgpr_write_b32 a1, 0
    v_accvgpr_write_b32 a2, 0
    v_mfma_f32_16x16x32_bf16 v[212:215], v[84:87], a[12:15], v[212:215]
    v_accvgpr_write_b32 a3, 0
    v_accvgpr_write_b32 a4, 0
    v_mfma_f32_16x16x32_bf16 v[184:187], v[88:91], a[8:11], v[184:187]
    v_accvgpr_write_b32 a5, 0
    v_accvgpr_write_b32 a6, 0
    v_mfma_f32_16x16x32_bf16 v[216:219], v[88:91], a[12:15], v[216:219]
    v_accvgpr_write_b32 a7, 0
    v_mfma_f32_16x16x32_bf16 v[188:191], v[92:95], a[8:11], v[188:191]
    v_mfma_f32_16x16x32_bf16 v[220:223], v[92:95], a[12:15], v[220:223]
    s_waitcnt vmcnt(20) lgkmcnt(0)
    s_barrier
    v_mfma_f32_16x16x32_bf16 v[160:163], v[16:19], a[16:19], v[160:163]
    ds_read_b64_tr_b16 v[64:65], v108 offset:51712
    ds_read_b64_tr_b16 v[66:67], v108 offset:51968
    v_mfma_f32_16x16x32_bf16 v[192:195], v[16:19], a[20:23], v[192:195]
    ds_read_b64_tr_b16 v[68:69], v108 offset:51744
    ds_read_b64_tr_b16 v[70:71], v108 offset:52000
    v_mfma_f32_16x16x32_bf16 v[164:167], v[20:23], a[16:19], v[164:167]
    ds_read_b64_tr_b16 v[72:73], v108 offset:51776
    ds_read_b64_tr_b16 v[74:75], v108 offset:52032
    v_mfma_f32_16x16x32_bf16 v[196:199], v[20:23], a[20:23], v[196:199]
    ds_read_b64_tr_b16 v[76:77], v108 offset:51808
    ds_read_b64_tr_b16 v[78:79], v108 offset:52064
    v_mfma_f32_16x16x32_bf16 v[168:171], v[24:27], a[16:19], v[168:171]
    ds_read_b64_tr_b16 v[80:81], v108 offset:55936
    ds_read_b64_tr_b16 v[82:83], v108 offset:56192
    v_mfma_f32_16x16x32_bf16 v[200:203], v[24:27], a[20:23], v[200:203]
    ds_read_b64_tr_b16 v[84:85], v108 offset:55968
    ds_read_b64_tr_b16 v[86:87], v108 offset:56224
    v_mfma_f32_16x16x32_bf16 v[172:175], v[28:31], a[16:19], v[172:175]
    ds_read_b64_tr_b16 v[88:89], v108 offset:56000
    ds_read_b64_tr_b16 v[90:91], v108 offset:56256
    v_mfma_f32_16x16x32_bf16 v[204:207], v[28:31], a[20:23], v[204:207]
    ds_read_b64_tr_b16 v[92:93], v108 offset:56032
    ds_read_b64_tr_b16 v[94:95], v108 offset:56288
    s_add_u32 m0, s37, 104448
    v_mfma_f32_16x16x32_bf16 v[176:179], v[32:35], a[16:19], v[176:179]
    buffer_load_dwordx4 v113, s[16:19], s29 offen  lds
    s_add_u32 m0, s37, 108544
    v_mfma_f32_16x16x32_bf16 v[208:211], v[32:35], a[20:23], v[208:211]
    buffer_load_dwordx4 v113, s[16:19], s29 offen offset:128  lds
    v_mfma_f32_16x16x32_bf16 v[180:183], v[36:39], a[16:19], v[180:183]
    s_add_u32 m0, s37, 0
    s_add_u32 s29, s29, 262144
    buffer_load_dwordx4 v113, s[16:19], s29 offen  lds
    s_add_u32 m0, s37, 4096
    v_mfma_f32_16x16x32_bf16 v[212:215], v[36:39], a[20:23], v[212:215]
    buffer_load_dwordx4 v113, s[16:19], s29 offen offset:128  lds
    s_add_u32 s29, s29, 262144
    v_accvgpr_write_b32 a8, 0
    v_mfma_f32_16x16x32_bf16 v[184:187], v[40:43], a[16:19], v[184:187]
    v_accvgpr_write_b32 a9, 0
    v_accvgpr_write_b32 a10, 0
    v_mfma_f32_16x16x32_bf16 v[216:219], v[40:43], a[20:23], v[216:219]
    v_accvgpr_write_b32 a11, 0
    v_accvgpr_write_b32 a12, 0
    v_mfma_f32_16x16x32_bf16 v[188:191], v[44:47], a[16:19], v[188:191]
    v_accvgpr_write_b32 a13, 0
    v_accvgpr_write_b32 a14, 0
    v_mfma_f32_16x16x32_bf16 v[220:223], v[44:47], a[20:23], v[220:223]
    v_accvgpr_write_b32 a15, 0
    s_waitcnt vmcnt(16) lgkmcnt(0)
    s_barrier
    v_mfma_f32_16x16x32_bf16 v[160:163], v[64:67], a[24:27], v[160:163]
    ds_read_b64_tr_b16 v[16:17], v108 offset:60160
    ds_read_b64_tr_b16 v[18:19], v108 offset:60416
    v_mfma_f32_16x16x32_bf16 v[192:195], v[64:67], a[28:31], v[192:195]
    ds_read_b64_tr_b16 v[20:21], v108 offset:60192
    ds_read_b64_tr_b16 v[22:23], v108 offset:60448
    v_mfma_f32_16x16x32_bf16 v[164:167], v[68:71], a[24:27], v[164:167]
    ds_read_b64_tr_b16 v[24:25], v108 offset:60224
    ds_read_b64_tr_b16 v[26:27], v108 offset:60480
    ds_read_b64_tr_b16 v[28:29], v108 offset:60256
    v_mfma_f32_16x16x32_bf16 v[196:199], v[68:71], a[28:31], v[196:199]
    ds_read_b64_tr_b16 v[30:31], v108 offset:60512
    ds_read_b64_tr_b16 v[32:33], v108 offset:64384
    v_mfma_f32_16x16x32_bf16 v[168:171], v[72:75], a[24:27], v[168:171]
    ds_read_b64_tr_b16 v[34:35], v108 offset:64640
    ds_read_b64_tr_b16 v[36:37], v108 offset:64416
    v_mfma_f32_16x16x32_bf16 v[200:203], v[72:75], a[28:31], v[200:203]
    ds_read_b64_tr_b16 v[38:39], v108 offset:64672
    ds_read_b64_tr_b16 v[40:41], v108 offset:64448
    v_mfma_f32_16x16x32_bf16 v[172:175], v[76:79], a[24:27], v[172:175]
    ds_read_b64_tr_b16 v[42:43], v108 offset:64704
    ds_read_b64_tr_b16 v[44:45], v108 offset:64480
    v_mfma_f32_16x16x32_bf16 v[204:207], v[76:79], a[28:31], v[204:207]
    ds_read_b64_tr_b16 v[46:47], v108 offset:64736
    ds_read_b128 a[32:35], v110 offset:26112
    ds_read_b128 a[36:39], v110 offset:30464
    v_mfma_f32_16x16x32_bf16 v[176:179], v[80:83], a[24:27], v[176:179]
    ds_read_b128 a[40:43], v110 offset:26176
    ds_read_b128 a[44:47], v110 offset:30528
    v_mfma_f32_16x16x32_bf16 v[208:211], v[80:83], a[28:31], v[208:211]
    ds_read_b128 a[48:51], v110 offset:26240
    ds_read_b128 a[52:55], v110 offset:30592
    v_mfma_f32_16x16x32_bf16 v[180:183], v[84:87], a[24:27], v[180:183]
    ds_read_b128 a[56:59], v110 offset:26304
    ds_read_b128 a[60:63], v110 offset:30656
    s_add_u32 m0, s37, 8448
    v_mfma_f32_16x16x32_bf16 v[212:215], v[84:87], a[28:31], v[212:215]
    buffer_load_dwordx4 v113, s[16:19], s29 offen  lds
    s_add_u32 m0, s37, 12544
    v_mfma_f32_16x16x32_bf16 v[184:187], v[88:91], a[24:27], v[184:187]
    buffer_load_dwordx4 v113, s[16:19], s29 offen offset:128  lds
    s_add_u32 s29, s29, 262144
    v_accvgpr_write_b32 a16, 0
    v_mfma_f32_16x16x32_bf16 v[216:219], v[88:91], a[28:31], v[216:219]
    v_accvgpr_write_b32 a17, 0
    v_accvgpr_write_b32 a18, 0
    v_mfma_f32_16x16x32_bf16 v[188:191], v[92:95], a[24:27], v[188:191]
    v_accvgpr_write_b32 a19, 0
    v_accvgpr_write_b32 a20, 0
    v_accvgpr_write_b32 a21, 0
    v_mfma_f32_16x16x32_bf16 v[220:223], v[92:95], a[28:31], v[220:223]
    v_accvgpr_write_b32 a22, 0
    v_accvgpr_write_b32 a23, 0
    s_waitcnt vmcnt(16) lgkmcnt(0)
    s_barrier
    v_mfma_f32_16x16x32_bf16 v[160:163], v[16:19], a[32:35], v[160:163]
    ds_read_b64_tr_b16 v[64:65], v108 offset:16896
    ds_read_b64_tr_b16 v[66:67], v108 offset:17152
    ds_read_b64_tr_b16 v[68:69], v108 offset:16928
    v_mfma_f32_16x16x32_bf16 v[192:195], v[16:19], a[36:39], v[192:195]
    ds_read_b64_tr_b16 v[70:71], v108 offset:17184
    ds_read_b64_tr_b16 v[72:73], v108 offset:16960
    v_mfma_f32_16x16x32_bf16 v[164:167], v[20:23], a[32:35], v[164:167]
    ds_read_b64_tr_b16 v[74:75], v108 offset:17216
    ds_read_b64_tr_b16 v[76:77], v108 offset:16992
    ds_read_b64_tr_b16 v[78:79], v108 offset:17248
    v_mfma_f32_16x16x32_bf16 v[196:199], v[20:23], a[36:39], v[196:199]
    ds_read_b64_tr_b16 v[80:81], v108 offset:21120
    ds_read_b64_tr_b16 v[82:83], v108 offset:21376
    v_mfma_f32_16x16x32_bf16 v[168:171], v[24:27], a[32:35], v[168:171]
    ds_read_b64_tr_b16 v[84:85], v108 offset:21152
    ds_read_b64_tr_b16 v[86:87], v108 offset:21408
    ds_read_b64_tr_b16 v[88:89], v108 offset:21184
    v_mfma_f32_16x16x32_bf16 v[200:203], v[24:27], a[36:39], v[200:203]
    ds_read_b64_tr_b16 v[90:91], v108 offset:21440
    ds_read_b64_tr_b16 v[92:93], v108 offset:21216
    v_mfma_f32_16x16x32_bf16 v[172:175], v[28:31], a[32:35], v[172:175]
    ds_read_b64_tr_b16 v[94:95], v108 offset:21472
    s_add_u32 m0, s42, 52224
    s_add_u32 s50, s36, 768
    buffer_load_dwordx4 v112, s[24:27], s50 offen  lds
    v_mfma_f32_16x16x32_bf16 v[204:207], v[28:31], a[36:39], v[204:207]
    s_add_u32 m0, s42, 53312
    s_add_u32 s50, s36, 5376
    buffer_load_dwordx4 v112, s[24:27], s50 offen  lds
    v_mfma_f32_16x16x32_bf16 v[176:179], v[32:35], a[32:35], v[176:179]
    s_add_u32 m0, s42, 60928
    s_add_u32 s50, s36, 37632
    buffer_load_dwordx4 v112, s[24:27], s50 offen  lds
    v_mfma_f32_16x16x32_bf16 v[208:211], v[32:35], a[36:39], v[208:211]
    s_add_u32 m0, s42, 62016
    s_add_u32 s50, s36, 42240
    buffer_load_dwordx4 v112, s[24:27], s50 offen  lds
    v_mfma_f32_16x16x32_bf16 v[180:183], v[36:39], a[32:35], v[180:183]
    s_add_u32 m0, s42, 69632
    s_add_u32 s50, s36, 74496
    buffer_load_dwordx4 v112, s[24:27], s50 offen  lds
    v_mfma_f32_16x16x32_bf16 v[212:215], v[36:39], a[36:39], v[212:215]
    s_add_u32 m0, s42, 70720
    s_add_u32 s50, s36, 79104
    buffer_load_dwordx4 v112, s[24:27], s50 offen  lds
    s_add_u32 m0, s37, 16896
    s_nop 0
    buffer_load_dwordx4 v113, s[16:19], s29 offen  lds
    s_add_u32 m0, s37, 20992
    v_mfma_f32_16x16x32_bf16 v[184:187], v[40:43], a[32:35], v[184:187]
    buffer_load_dwordx4 v113, s[16:19], s29 offen offset:128  lds
    s_add_u32 s29, s29, 262144
    v_mfma_f32_16x16x32_bf16 v[216:219], v[40:43], a[36:39], v[216:219]
    v_accvgpr_write_b32 a24, 0
    v_accvgpr_write_b32 a25, 0
    v_accvgpr_write_b32 a26, 0
    v_mfma_f32_16x16x32_bf16 v[188:191], v[44:47], a[32:35], v[188:191]
    v_accvgpr_write_b32 a27, 0
    v_accvgpr_write_b32 a28, 0
    v_mfma_f32_16x16x32_bf16 v[220:223], v[44:47], a[36:39], v[220:223]
    v_accvgpr_write_b32 a29, 0
    v_accvgpr_write_b32 a30, 0
    v_accvgpr_write_b32 a31, 0
    s_waitcnt vmcnt(22) lgkmcnt(0)
    s_barrier
    v_mfma_f32_16x16x32_bf16 v[160:163], v[64:67], a[40:43], v[160:163]
    ds_read_b64_tr_b16 v[16:17], v108 offset:25600
    ds_read_b64_tr_b16 v[18:19], v108 offset:25856
    ds_read_b64_tr_b16 v[20:21], v108 offset:25632
    v_mfma_f32_16x16x32_bf16 v[192:195], v[64:67], a[44:47], v[192:195]
    ds_read_b64_tr_b16 v[22:23], v108 offset:25888
    ds_read_b64_tr_b16 v[24:25], v108 offset:25664
    v_mfma_f32_16x16x32_bf16 v[164:167], v[68:71], a[40:43], v[164:167]
    ds_read_b64_tr_b16 v[26:27], v108 offset:25920
    ds_read_b64_tr_b16 v[28:29], v108 offset:25696
    ds_read_b64_tr_b16 v[30:31], v108 offset:25952
    v_mfma_f32_16x16x32_bf16 v[196:199], v[68:71], a[44:47], v[196:199]
    ds_read_b64_tr_b16 v[32:33], v108 offset:29824
    ds_read_b64_tr_b16 v[34:35], v108 offset:30080
    ds_read_b64_tr_b16 v[36:37], v108 offset:29856
    v_mfma_f32_16x16x32_bf16 v[168:171], v[72:75], a[40:43], v[168:171]
    ds_read_b64_tr_b16 v[38:39], v108 offset:30112
    ds_read_b64_tr_b16 v[40:41], v108 offset:29888
    v_mfma_f32_16x16x32_bf16 v[200:203], v[72:75], a[44:47], v[200:203]
    ds_read_b64_tr_b16 v[42:43], v108 offset:30144
    ds_read_b64_tr_b16 v[44:45], v108 offset:29920
    ds_read_b64_tr_b16 v[46:47], v108 offset:30176
    s_add_u32 m0, s37, 113152
    v_mfma_f32_16x16x32_bf16 v[172:175], v[76:79], a[40:43], v[172:175]
    buffer_load_dwordx4 v113, s[16:19], s29 offen  lds
    s_add_u32 m0, s37, 117248
    s_nop 0
    buffer_load_dwordx4 v113, s[16:19], s29 offen offset:128  lds
    v_mfma_f32_16x16x32_bf16 v[204:207], v[76:79], a[44:47], v[204:207]
    s_add_u32 s29, s29, 262144
    s_add_u32 m0, s42, 137728
    s_add_u32 s50, s36, 896
    buffer_load_dwordx4 v105, s[24:27], s50 offen  lds
    v_mfma_f32_16x16x32_bf16 v[176:179], v[80:83], a[40:43], v[176:179]
    s_add_u32 m0, s42, 138816
    s_add_u32 s50, s36, 5504
    buffer_load_dwordx4 v105, s[24:27], s50 offen  lds
    v_mfma_f32_16x16x32_bf16 v[208:211], v[80:83], a[44:47], v[208:211]
    s_add_u32 m0, s42, 146432
    s_add_u32 s50, s36, 37760
    buffer_load_dwordx4 v105, s[24:27], s50 offen  lds
    v_mfma_f32_16x16x32_bf16 v[180:183], v[84:87], a[40:43], v[180:183]
    s_add_u32 m0, s42, 147520
    s_add_u32 s50, s36, 42368
    buffer_load_dwordx4 v105, s[24:27], s50 offen  lds
    v_mfma_f32_16x16x32_bf16 v[212:215], v[84:87], a[44:47], v[212:215]
    s_add_u32 m0, s42, 155136
    s_add_u32 s50, s36, 74624
    buffer_load_dwordx4 v105, s[24:27], s50 offen  lds
    v_mfma_f32_16x16x32_bf16 v[184:187], v[88:91], a[40:43], v[184:187]
    s_add_u32 m0, s42, 156224
    s_add_u32 s50, s36, 79232
    buffer_load_dwordx4 v105, s[24:27], s50 offen  lds
    v_accvgpr_write_b32 a32, 0
    v_accvgpr_write_b32 a33, 0
    v_mfma_f32_16x16x32_bf16 v[216:219], v[88:91], a[44:47], v[216:219]
    v_accvgpr_write_b32 a34, 0
    v_accvgpr_write_b32 a35, 0
    v_mfma_f32_16x16x32_bf16 v[188:191], v[92:95], a[40:43], v[188:191]
    v_accvgpr_write_b32 a36, 0
    v_accvgpr_write_b32 a37, 0
    v_accvgpr_write_b32 a38, 0
    v_mfma_f32_16x16x32_bf16 v[220:223], v[92:95], a[44:47], v[220:223]
    v_accvgpr_write_b32 a39, 0
    s_waitcnt vmcnt(22) lgkmcnt(0)
    s_barrier
    v_mfma_f32_16x16x32_bf16 v[160:163], v[16:19], a[48:51], v[160:163]
    ds_read_b64_tr_b16 v[64:65], v108 offset:34304
    ds_read_b64_tr_b16 v[66:67], v108 offset:34560
    v_mfma_f32_16x16x32_bf16 v[192:195], v[16:19], a[52:55], v[192:195]
    ds_read_b64_tr_b16 v[68:69], v108 offset:34336
    ds_read_b64_tr_b16 v[70:71], v108 offset:34592
    v_mfma_f32_16x16x32_bf16 v[164:167], v[20:23], a[48:51], v[164:167]
    ds_read_b64_tr_b16 v[72:73], v108 offset:34368
    ds_read_b64_tr_b16 v[74:75], v108 offset:34624
    v_mfma_f32_16x16x32_bf16 v[196:199], v[20:23], a[52:55], v[196:199]
    ds_read_b64_tr_b16 v[76:77], v108 offset:34400
    ds_read_b64_tr_b16 v[78:79], v108 offset:34656
    v_mfma_f32_16x16x32_bf16 v[168:171], v[24:27], a[48:51], v[168:171]
    ds_read_b64_tr_b16 v[80:81], v108 offset:38528
    ds_read_b64_tr_b16 v[82:83], v108 offset:38784
    v_mfma_f32_16x16x32_bf16 v[200:203], v[24:27], a[52:55], v[200:203]
    ds_read_b64_tr_b16 v[84:85], v108 offset:38560
    ds_read_b64_tr_b16 v[86:87], v108 offset:38816
    v_mfma_f32_16x16x32_bf16 v[172:175], v[28:31], a[48:51], v[172:175]
    ds_read_b64_tr_b16 v[88:89], v108 offset:38592
    ds_read_b64_tr_b16 v[90:91], v108 offset:38848
    v_mfma_f32_16x16x32_bf16 v[204:207], v[28:31], a[52:55], v[204:207]
    ds_read_b64_tr_b16 v[92:93], v108 offset:38624
    ds_read_b64_tr_b16 v[94:95], v108 offset:38880
    s_add_u32 m0, s37, 121600
    v_mfma_f32_16x16x32_bf16 v[176:179], v[32:35], a[48:51], v[176:179]
    buffer_load_dwordx4 v113, s[16:19], s29 offen  lds
    s_add_u32 m0, s37, 125696
    v_mfma_f32_16x16x32_bf16 v[208:211], v[32:35], a[52:55], v[208:211]
    buffer_load_dwordx4 v113, s[16:19], s29 offen offset:128  lds
    s_add_u32 s29, s29, 262144
    v_accvgpr_write_b32 a40, 0
    v_mfma_f32_16x16x32_bf16 v[180:183], v[36:39], a[48:51], v[180:183]
    v_accvgpr_write_b32 a41, 0
    v_accvgpr_write_b32 a42, 0
    v_mfma_f32_16x16x32_bf16 v[212:215], v[36:39], a[52:55], v[212:215]
    v_accvgpr_write_b32 a43, 0
    v_accvgpr_write_b32 a44, 0
    v_mfma_f32_16x16x32_bf16 v[184:187], v[40:43], a[48:51], v[184:187]
    v_accvgpr_write_b32 a45, 0
    v_accvgpr_write_b32 a46, 0
    v_mfma_f32_16x16x32_bf16 v[216:219], v[40:43], a[52:55], v[216:219]
    v_accvgpr_write_b32 a47, 0
    v_mfma_f32_16x16x32_bf16 v[188:191], v[44:47], a[48:51], v[188:191]
    v_mfma_f32_16x16x32_bf16 v[220:223], v[44:47], a[52:55], v[220:223]
    s_waitcnt vmcnt(22) lgkmcnt(0)
    s_barrier
    v_mfma_f32_16x16x32_bf16 v[160:163], v[64:67], a[56:59], v[160:163]
    ds_read_b64_tr_b16 v[16:17], v108 offset:43008
    ds_read_b64_tr_b16 v[18:19], v108 offset:43264
    v_mfma_f32_16x16x32_bf16 v[192:195], v[64:67], a[60:63], v[192:195]
    ds_read_b64_tr_b16 v[20:21], v108 offset:43040
    ds_read_b64_tr_b16 v[22:23], v108 offset:43296
    v_mfma_f32_16x16x32_bf16 v[164:167], v[68:71], a[56:59], v[164:167]
    ds_read_b64_tr_b16 v[24:25], v108 offset:43072
    ds_read_b64_tr_b16 v[26:27], v108 offset:43328
    ds_read_b64_tr_b16 v[28:29], v108 offset:43104
    v_mfma_f32_16x16x32_bf16 v[196:199], v[68:71], a[60:63], v[196:199]
    ds_read_b64_tr_b16 v[30:31], v108 offset:43360
    ds_read_b64_tr_b16 v[32:33], v108 offset:47232
    v_mfma_f32_16x16x32_bf16 v[168:171], v[72:75], a[56:59], v[168:171]
    ds_read_b64_tr_b16 v[34:35], v108 offset:47488
    ds_read_b64_tr_b16 v[36:37], v108 offset:47264
    v_mfma_f32_16x16x32_bf16 v[200:203], v[72:75], a[60:63], v[200:203]
    ds_read_b64_tr_b16 v[38:39], v108 offset:47520
    ds_read_b64_tr_b16 v[40:41], v108 offset:47296
    v_mfma_f32_16x16x32_bf16 v[172:175], v[76:79], a[56:59], v[172:175]
    ds_read_b64_tr_b16 v[42:43], v108 offset:47552
    ds_read_b64_tr_b16 v[44:45], v108 offset:47328
    v_mfma_f32_16x16x32_bf16 v[204:207], v[76:79], a[60:63], v[204:207]
    ds_read_b64_tr_b16 v[46:47], v108 offset:47584
    ds_read_b128 a[64:67], v110 offset:0
    ds_read_b128 a[68:71], v110 offset:4352
    v_mfma_f32_16x16x32_bf16 v[176:179], v[80:83], a[56:59], v[176:179]
    ds_read_b128 a[72:75], v110 offset:64
    ds_read_b128 a[76:79], v110 offset:4416
    v_mfma_f32_16x16x32_bf16 v[208:211], v[80:83], a[60:63], v[208:211]
    ds_read_b128 a[80:83], v110 offset:128
    ds_read_b128 a[84:87], v110 offset:4480
    v_mfma_f32_16x16x32_bf16 v[180:183], v[84:87], a[56:59], v[180:183]
    ds_read_b128 a[88:91], v110 offset:192
    ds_read_b128 a[92:95], v110 offset:4544
    s_add_u32 m0, s37, 87040
    v_mfma_f32_16x16x32_bf16 v[212:215], v[84:87], a[60:63], v[212:215]
    buffer_load_dwordx4 v113, s[16:19], s29 offen  lds
    s_add_u32 m0, s37, 91136
    v_mfma_f32_16x16x32_bf16 v[184:187], v[88:91], a[56:59], v[184:187]
    buffer_load_dwordx4 v113, s[16:19], s29 offen offset:128  lds
    s_add_u32 s29, s29, 262144
    v_accvgpr_write_b32 a48, 0
    v_mfma_f32_16x16x32_bf16 v[216:219], v[88:91], a[60:63], v[216:219]
    v_accvgpr_write_b32 a49, 0
    v_accvgpr_write_b32 a50, 0
    v_mfma_f32_16x16x32_bf16 v[188:191], v[92:95], a[56:59], v[188:191]
    v_accvgpr_write_b32 a51, 0
    v_accvgpr_write_b32 a52, 0
    v_accvgpr_write_b32 a53, 0
    v_mfma_f32_16x16x32_bf16 v[220:223], v[92:95], a[60:63], v[220:223]
    v_accvgpr_write_b32 a54, 0
    v_accvgpr_write_b32 a55, 0
    s_waitcnt vmcnt(22) lgkmcnt(0)
    s_barrier
    v_mfma_f32_16x16x32_bf16 v[160:163], v[16:19], a[64:67], v[160:163]
    ds_read_b64_tr_b16 v[64:65], v104 offset:0
    ds_read_b64_tr_b16 v[66:67], v104 offset:256
    v_mfma_f32_16x16x32_bf16 v[192:195], v[16:19], a[68:71], v[192:195]
    ds_read_b64_tr_b16 v[68:69], v104 offset:32
    ds_read_b64_tr_b16 v[70:71], v104 offset:288
    v_mfma_f32_16x16x32_bf16 v[164:167], v[20:23], a[64:67], v[164:167]
    ds_read_b64_tr_b16 v[72:73], v104 offset:64
    ds_read_b64_tr_b16 v[74:75], v104 offset:320
    v_mfma_f32_16x16x32_bf16 v[196:199], v[20:23], a[68:71], v[196:199]
    ds_read_b64_tr_b16 v[76:77], v104 offset:96
    ds_read_b64_tr_b16 v[78:79], v104 offset:352
    v_mfma_f32_16x16x32_bf16 v[168:171], v[24:27], a[64:67], v[168:171]
    ds_read_b64_tr_b16 v[80:81], v104 offset:4224
    ds_read_b64_tr_b16 v[82:83], v104 offset:4480
    v_mfma_f32_16x16x32_bf16 v[200:203], v[24:27], a[68:71], v[200:203]
    ds_read_b64_tr_b16 v[84:85], v104 offset:4256
    ds_read_b64_tr_b16 v[86:87], v104 offset:4512
    v_mfma_f32_16x16x32_bf16 v[172:175], v[28:31], a[64:67], v[172:175]
    ds_read_b64_tr_b16 v[88:89], v104 offset:4288
    ds_read_b64_tr_b16 v[90:91], v104 offset:4544
    v_mfma_f32_16x16x32_bf16 v[204:207], v[28:31], a[68:71], v[204:207]
    ds_read_b64_tr_b16 v[92:93], v104 offset:4320
    ds_read_b64_tr_b16 v[94:95], v104 offset:4576
    s_add_u32 m0, s37, 104448
    v_mfma_f32_16x16x32_bf16 v[176:179], v[32:35], a[64:67], v[176:179]
    buffer_load_dwordx4 v113, s[16:19], s29 offen  lds
    s_add_u32 m0, s37, 108544
    v_mfma_f32_16x16x32_bf16 v[208:211], v[32:35], a[68:71], v[208:211]
    buffer_load_dwordx4 v113, s[16:19], s29 offen offset:128  lds
    v_mfma_f32_16x16x32_bf16 v[180:183], v[36:39], a[64:67], v[180:183]
    s_add_u32 m0, s37, 34816
    s_add_u32 s29, s29, 262144
    buffer_load_dwordx4 v113, s[16:19], s29 offen  lds
    s_add_u32 m0, s37, 38912
    v_mfma_f32_16x16x32_bf16 v[212:215], v[36:39], a[68:71], v[212:215]
    buffer_load_dwordx4 v113, s[16:19], s29 offen offset:128  lds
    s_add_u32 s29, s29, 262144
    v_accvgpr_write_b32 a56, 0
    v_mfma_f32_16x16x32_bf16 v[184:187], v[40:43], a[64:67], v[184:187]
    v_accvgpr_write_b32 a57, 0
    v_accvgpr_write_b32 a58, 0
    v_mfma_f32_16x16x32_bf16 v[216:219], v[40:43], a[68:71], v[216:219]
    v_accvgpr_write_b32 a59, 0
    v_accvgpr_write_b32 a60, 0
    v_mfma_f32_16x16x32_bf16 v[188:191], v[44:47], a[64:67], v[188:191]
    v_accvgpr_write_b32 a61, 0
    v_accvgpr_write_b32 a62, 0
    v_mfma_f32_16x16x32_bf16 v[220:223], v[44:47], a[68:71], v[220:223]
    v_accvgpr_write_b32 a63, 0
    s_waitcnt vmcnt(24) lgkmcnt(0)
    s_barrier
    v_mfma_f32_16x16x32_bf16 v[160:163], v[64:67], a[72:75], v[160:163]
    ds_read_b64_tr_b16 v[16:17], v104 offset:8448
    ds_read_b64_tr_b16 v[18:19], v104 offset:8704
    v_mfma_f32_16x16x32_bf16 v[192:195], v[64:67], a[76:79], v[192:195]
    ds_read_b64_tr_b16 v[20:21], v104 offset:8480
    ds_read_b64_tr_b16 v[22:23], v104 offset:8736
    v_mfma_f32_16x16x32_bf16 v[164:167], v[68:71], a[72:75], v[164:167]
    ds_read_b64_tr_b16 v[24:25], v104 offset:8512
    ds_read_b64_tr_b16 v[26:27], v104 offset:8768
    v_mfma_f32_16x16x32_bf16 v[196:199], v[68:71], a[76:79], v[196:199]
    ds_read_b64_tr_b16 v[28:29], v104 offset:8544
    ds_read_b64_tr_b16 v[30:31], v104 offset:8800
    v_mfma_f32_16x16x32_bf16 v[168:171], v[72:75], a[72:75], v[168:171]
    ds_read_b64_tr_b16 v[32:33], v104 offset:12672
    ds_read_b64_tr_b16 v[34:35], v104 offset:12928
    v_mfma_f32_16x16x32_bf16 v[200:203], v[72:75], a[76:79], v[200:203]
    ds_read_b64_tr_b16 v[36:37], v104 offset:12704
    ds_read_b64_tr_b16 v[38:39], v104 offset:12960
    v_mfma_f32_16x16x32_bf16 v[172:175], v[76:79], a[72:75], v[172:175]
    ds_read_b64_tr_b16 v[40:41], v104 offset:12736
    ds_read_b64_tr_b16 v[42:43], v104 offset:12992
    v_mfma_f32_16x16x32_bf16 v[204:207], v[76:79], a[76:79], v[204:207]
    ds_read_b64_tr_b16 v[44:45], v104 offset:12768
    ds_read_b64_tr_b16 v[46:47], v104 offset:13024
    s_add_u32 m0, s37, 95744
    v_mfma_f32_16x16x32_bf16 v[176:179], v[80:83], a[72:75], v[176:179]
    buffer_load_dwordx4 v113, s[16:19], s29 offen  lds
    s_add_u32 m0, s37, 99840
    v_mfma_f32_16x16x32_bf16 v[208:211], v[80:83], a[76:79], v[208:211]
    buffer_load_dwordx4 v113, s[16:19], s29 offen offset:128  lds
    v_mfma_f32_16x16x32_bf16 v[180:183], v[84:87], a[72:75], v[180:183]
    s_add_u32 m0, s40, 26112
    s_add_u32 s29, s29, 262144
    buffer_load_dwordx4 v7, s[4:7], s32 offen nt lds
    s_add_u32 m0, s40, 26176
    v_mfma_f32_16x16x32_bf16 v[212:215], v[84:87], a[76:79], v[212:215]
    buffer_load_dwordx4 v7, s[4:7], s32 offen offset:1024 nt lds
    s_add_u32 s32, s32, 8192
    v_accvgpr_write_b32 a64, 0
    v_mfma_f32_16x16x32_bf16 v[184:187], v[88:91], a[72:75], v[184:187]
    v_accvgpr_write_b32 a65, 0
    v_accvgpr_write_b32 a66, 0
    v_mfma_f32_16x16x32_bf16 v[216:219], v[88:91], a[76:79], v[216:219]
    v_accvgpr_write_b32 a67, 0
    v_accvgpr_write_b32 a68, 0
    v_mfma_f32_16x16x32_bf16 v[188:191], v[92:95], a[72:75], v[188:191]
    v_accvgpr_write_b32 a69, 0
    v_accvgpr_write_b32 a70, 0
    v_mfma_f32_16x16x32_bf16 v[220:223], v[92:95], a[76:79], v[220:223]
    v_accvgpr_write_b32 a71, 0
    s_waitcnt vmcnt(20) lgkmcnt(0)
    s_barrier
    v_mfma_f32_16x16x32_bf16 v[160:163], v[16:19], a[80:83], v[160:163]
    ds_read_b64_tr_b16 v[64:65], v104 offset:16896
    ds_read_b64_tr_b16 v[66:67], v104 offset:17152
    v_mfma_f32_16x16x32_bf16 v[192:195], v[16:19], a[84:87], v[192:195]
    ds_read_b64_tr_b16 v[68:69], v104 offset:16928
    ds_read_b64_tr_b16 v[70:71], v104 offset:17184
    v_mfma_f32_16x16x32_bf16 v[164:167], v[20:23], a[80:83], v[164:167]
    ds_read_b64_tr_b16 v[72:73], v104 offset:16960
    ds_read_b64_tr_b16 v[74:75], v104 offset:17216
    v_mfma_f32_16x16x32_bf16 v[196:199], v[20:23], a[84:87], v[196:199]
    ds_read_b64_tr_b16 v[76:77], v104 offset:16992
    ds_read_b64_tr_b16 v[78:79], v104 offset:17248
    v_mfma_f32_16x16x32_bf16 v[168:171], v[24:27], a[80:83], v[168:171]
    ds_read_b64_tr_b16 v[80:81], v104 offset:21120
    ds_read_b64_tr_b16 v[82:83], v104 offset:21376
    v_mfma_f32_16x16x32_bf16 v[200:203], v[24:27], a[84:87], v[200:203]
    ds_read_b64_tr_b16 v[84:85], v104 offset:21152
    ds_read_b64_tr_b16 v[86:87], v104 offset:21408
    v_mfma_f32_16x16x32_bf16 v[172:175], v[28:31], a[80:83], v[172:175]
    ds_read_b64_tr_b16 v[88:89], v104 offset:21184
    ds_read_b64_tr_b16 v[90:91], v104 offset:21440
    v_mfma_f32_16x16x32_bf16 v[204:207], v[28:31], a[84:87], v[204:207]
    ds_read_b64_tr_b16 v[92:93], v104 offset:21216
    ds_read_b64_tr_b16 v[94:95], v104 offset:21472
    v_mfma_f32_16x16x32_bf16 v[176:179], v[32:35], a[80:83], v[176:179]
    v_accvgpr_write_b32 a72, 0
    v_accvgpr_write_b32 a73, 0
    v_mfma_f32_16x16x32_bf16 v[208:211], v[32:35], a[84:87], v[208:211]
    v_accvgpr_write_b32 a74, 0
    v_accvgpr_write_b32 a75, 0
    v_mfma_f32_16x16x32_bf16 v[180:183], v[36:39], a[80:83], v[180:183]
    v_accvgpr_write_b32 a76, 0
    v_accvgpr_write_b32 a77, 0
    v_mfma_f32_16x16x32_bf16 v[212:215], v[36:39], a[84:87], v[212:215]
    v_accvgpr_write_b32 a78, 0
    v_accvgpr_write_b32 a79, 0
    v_mfma_f32_16x16x32_bf16 v[184:187], v[40:43], a[80:83], v[184:187]
    v_mfma_f32_16x16x32_bf16 v[216:219], v[40:43], a[84:87], v[216:219]
    v_mfma_f32_16x16x32_bf16 v[188:191], v[44:47], a[80:83], v[188:191]
    v_mfma_f32_16x16x32_bf16 v[220:223], v[44:47], a[84:87], v[220:223]
    s_waitcnt vmcnt(18) lgkmcnt(0)
    s_barrier
    v_mfma_f32_16x16x32_bf16 v[160:163], v[64:67], a[88:91], v[160:163]
    ds_read_b64_tr_b16 v[16:17], v108 offset:51712
    ds_read_b64_tr_b16 v[18:19], v108 offset:51968
    v_mfma_f32_16x16x32_bf16 v[192:195], v[64:67], a[92:95], v[192:195]
    ds_read_b64_tr_b16 v[20:21], v108 offset:51744
    ds_read_b64_tr_b16 v[22:23], v108 offset:52000
    v_mfma_f32_16x16x32_bf16 v[164:167], v[68:71], a[88:91], v[164:167]
    ds_read_b64_tr_b16 v[24:25], v108 offset:51776
    ds_read_b64_tr_b16 v[26:27], v108 offset:52032
    v_mfma_f32_16x16x32_bf16 v[196:199], v[68:71], a[92:95], v[196:199]
    ds_read_b64_tr_b16 v[28:29], v108 offset:51808
    ds_read_b64_tr_b16 v[30:31], v108 offset:52064
    v_mfma_f32_16x16x32_bf16 v[168:171], v[72:75], a[88:91], v[168:171]
    ds_read_b64_tr_b16 v[32:33], v108 offset:55936
    ds_read_b64_tr_b16 v[34:35], v108 offset:56192
    v_mfma_f32_16x16x32_bf16 v[200:203], v[72:75], a[92:95], v[200:203]
    ds_read_b64_tr_b16 v[36:37], v108 offset:55968
    ds_read_b64_tr_b16 v[38:39], v108 offset:56224
    v_mfma_f32_16x16x32_bf16 v[172:175], v[76:79], a[88:91], v[172:175]
    ds_read_b64_tr_b16 v[40:41], v108 offset:56000
    ds_read_b64_tr_b16 v[42:43], v108 offset:56256
    v_mfma_f32_16x16x32_bf16 v[204:207], v[76:79], a[92:95], v[204:207]
    ds_read_b64_tr_b16 v[44:45], v108 offset:56032
    ds_read_b64_tr_b16 v[46:47], v108 offset:56288
    v_mfma_f32_16x16x32_bf16 v[176:179], v[80:83], a[88:91], v[176:179]
    ds_read_b128 a[96:99], v110 offset:26112
    ds_read_b128 a[100:103], v110 offset:30464
    v_mfma_f32_16x16x32_bf16 v[208:211], v[80:83], a[92:95], v[208:211]
    ds_read_b128 a[104:107], v110 offset:26176
    ds_read_b128 a[108:111], v110 offset:30528
    v_mfma_f32_16x16x32_bf16 v[180:183], v[84:87], a[88:91], v[180:183]
    v_accvgpr_write_b32 a80, 0
    v_accvgpr_write_b32 a81, 0
    v_mfma_f32_16x16x32_bf16 v[212:215], v[84:87], a[92:95], v[212:215]
    v_accvgpr_write_b32 a82, 0
    v_accvgpr_write_b32 a83, 0
    v_mfma_f32_16x16x32_bf16 v[184:187], v[88:91], a[88:91], v[184:187]
    v_accvgpr_write_b32 a84, 0
    v_accvgpr_write_b32 a85, 0
    v_mfma_f32_16x16x32_bf16 v[216:219], v[88:91], a[92:95], v[216:219]
    v_accvgpr_write_b32 a86, 0
    v_accvgpr_write_b32 a87, 0
    v_mfma_f32_16x16x32_bf16 v[188:191], v[92:95], a[88:91], v[188:191]
    v_mfma_f32_16x16x32_bf16 v[220:223], v[92:95], a[92:95], v[220:223]
    s_waitcnt vmcnt(10) lgkmcnt(0)
    s_barrier
    v_mfma_f32_16x16x32_bf16 v[160:163], v[16:19], a[96:99], v[160:163]
    ds_read_b64_tr_b16 v[64:65], v108 offset:60160
    ds_read_b64_tr_b16 v[66:67], v108 offset:60416
    v_mfma_f32_16x16x32_bf16 v[192:195], v[16:19], a[100:103], v[192:195]
    ds_read_b64_tr_b16 v[68:69], v108 offset:60192
    ds_read_b64_tr_b16 v[70:71], v108 offset:60448
    v_mfma_f32_16x16x32_bf16 v[164:167], v[20:23], a[96:99], v[164:167]
    ds_read_b64_tr_b16 v[72:73], v108 offset:60224
    ds_read_b64_tr_b16 v[74:75], v108 offset:60480
    v_mfma_f32_16x16x32_bf16 v[196:199], v[20:23], a[100:103], v[196:199]
    ds_read_b64_tr_b16 v[76:77], v108 offset:60256
    ds_read_b64_tr_b16 v[78:79], v108 offset:60512
    v_mfma_f32_16x16x32_bf16 v[168:171], v[24:27], a[96:99], v[168:171]
    ds_read_b64_tr_b16 v[80:81], v108 offset:64384
    ds_read_b64_tr_b16 v[82:83], v108 offset:64640
    v_mfma_f32_16x16x32_bf16 v[200:203], v[24:27], a[100:103], v[200:203]
    ds_read_b64_tr_b16 v[84:85], v108 offset:64416
    ds_read_b64_tr_b16 v[86:87], v108 offset:64672
    v_mfma_f32_16x16x32_bf16 v[172:175], v[28:31], a[96:99], v[172:175]
    ds_read_b64_tr_b16 v[88:89], v108 offset:64448
    ds_read_b64_tr_b16 v[90:91], v108 offset:64704
    v_mfma_f32_16x16x32_bf16 v[204:207], v[28:31], a[100:103], v[204:207]
    ds_read_b64_tr_b16 v[92:93], v108 offset:64480
    ds_read_b64_tr_b16 v[94:95], v108 offset:64736
    s_add_u32 m0, s40, 52224
    v_mfma_f32_16x16x32_bf16 v[176:179], v[32:35], a[96:99], v[176:179]
    buffer_load_dwordx4 v7, s[4:7], s32 offen nt lds
    s_add_u32 m0, s40, 52288
    v_mfma_f32_16x16x32_bf16 v[208:211], v[32:35], a[100:103], v[208:211]
    buffer_load_dwordx4 v7, s[4:7], s32 offen offset:1024 nt lds
    s_add_u32 s32, s32, 8192
    v_mfma_f32_16x16x32_bf16 v[180:183], v[36:39], a[96:99], v[180:183]
    s_add_u32 m0, s39, 69632
    s_nop 0
    buffer_load_dwordx4 v8, s[8:11], s33 offen nt lds
    s_add_u32 m0, s39, 70432
    s_nop 0
    buffer_load_dwordx4 v8, s[8:11], s33 offen offset:256 nt lds
    v_mfma_f32_16x16x32_bf16 v[212:215], v[36:39], a[100:103], v[212:215]
    s_add_u32 s33, s33, 8192
    v_accvgpr_write_b32 a88, 0
    v_accvgpr_write_b32 a89, 0
    v_mfma_f32_16x16x32_bf16 v[184:187], v[40:43], a[96:99], v[184:187]
    v_accvgpr_write_b32 a90, 0
    v_accvgpr_write_b32 a91, 0
    v_mfma_f32_16x16x32_bf16 v[216:219], v[40:43], a[100:103], v[216:219]
    v_accvgpr_write_b32 a92, 0
    v_accvgpr_write_b32 a93, 0
    v_mfma_f32_16x16x32_bf16 v[188:191], v[44:47], a[96:99], v[188:191]
    v_accvgpr_write_b32 a94, 0
    v_accvgpr_write_b32 a95, 0
    v_mfma_f32_16x16x32_bf16 v[220:223], v[44:47], a[100:103], v[220:223]
    s_waitcnt vmcnt(12) lgkmcnt(0)
    s_barrier
    v_mfma_f32_16x16x32_bf16 v[160:163], v[64:67], a[104:107], v[160:163]
    ds_read_b64_tr_b16 v[16:17], v108 offset:25600
    ds_read_b64_tr_b16 v[18:19], v108 offset:25856
    v_mfma_f32_16x16x32_bf16 v[192:195], v[64:67], a[108:111], v[192:195]
    ds_read_b64_tr_b16 v[20:21], v108 offset:25632
    ds_read_b64_tr_b16 v[22:23], v108 offset:25888
    v_mfma_f32_16x16x32_bf16 v[164:167], v[68:71], a[104:107], v[164:167]
    ds_read_b64_tr_b16 v[24:25], v108 offset:25664
    ds_read_b64_tr_b16 v[26:27], v108 offset:25920
    ds_read_b64_tr_b16 v[28:29], v108 offset:25696
    v_mfma_f32_16x16x32_bf16 v[196:199], v[68:71], a[108:111], v[196:199]
    ds_read_b64_tr_b16 v[30:31], v108 offset:25952
    ds_read_b64_tr_b16 v[32:33], v108 offset:29824
    v_mfma_f32_16x16x32_bf16 v[168:171], v[72:75], a[104:107], v[168:171]
    ds_read_b64_tr_b16 v[34:35], v108 offset:30080
    ds_read_b64_tr_b16 v[36:37], v108 offset:29856
    v_mfma_f32_16x16x32_bf16 v[200:203], v[72:75], a[108:111], v[200:203]
    ds_read_b64_tr_b16 v[38:39], v108 offset:30112
    ds_read_b64_tr_b16 v[40:41], v108 offset:29888
    v_mfma_f32_16x16x32_bf16 v[172:175], v[76:79], a[104:107], v[172:175]
    ds_read_b64_tr_b16 v[42:43], v108 offset:30144
    ds_read_b64_tr_b16 v[44:45], v108 offset:29920
    v_mfma_f32_16x16x32_bf16 v[204:207], v[76:79], a[108:111], v[204:207]
    ds_read_b64_tr_b16 v[46:47], v108 offset:30176
    ds_read_b128 a[112:115], v111 offset:0
    ds_read_b128 a[116:119], v111 offset:4352
    v_mfma_f32_16x16x32_bf16 v[176:179], v[80:83], a[104:107], v[176:179]
    ds_read_b128 a[120:123], v111 offset:64
    ds_read_b128 a[124:127], v111 offset:4416
    v_mfma_f32_16x16x32_bf16 v[208:211], v[80:83], a[108:111], v[208:211]
    ds_read_b128 a[128:131], v111 offset:128
    ds_read_b128 a[132:135], v111 offset:4480
    v_mfma_f32_16x16x32_bf16 v[180:183], v[84:87], a[104:107], v[180:183]
    ds_read_b128 a[136:139], v111 offset:192
    ds_read_b128 a[140:143], v111 offset:4544
    s_add_u32 m0, s40, 78336
    v_mfma_f32_16x16x32_bf16 v[212:215], v[84:87], a[108:111], v[212:215]
    buffer_load_dwordx4 v7, s[4:7], s32 offen nt lds
    s_add_u32 m0, s40, 78400
    v_mfma_f32_16x16x32_bf16 v[184:187], v[88:91], a[104:107], v[184:187]
    buffer_load_dwordx4 v7, s[4:7], s32 offen offset:1024 nt lds
    s_add_u32 s32, s32, 8192
    v_accvgpr_write_b32 a96, 0
    v_mfma_f32_16x16x32_bf16 v[216:219], v[88:91], a[108:111], v[216:219]
    v_accvgpr_write_b32 a97, 0
    v_accvgpr_write_b32 a98, 0
    v_mfma_f32_16x16x32_bf16 v[188:191], v[92:95], a[104:107], v[188:191]
    v_accvgpr_write_b32 a99, 0
    v_accvgpr_write_b32 a100, 0
    v_accvgpr_write_b32 a101, 0
    v_mfma_f32_16x16x32_bf16 v[220:223], v[92:95], a[108:111], v[220:223]
    v_accvgpr_write_b32 a102, 0
    v_accvgpr_write_b32 a103, 0
    s_waitcnt vmcnt(12) lgkmcnt(0)
    s_barrier
    v_mfma_f32_16x16x32_bf16 v[160:163], v[16:19], a[112:115], v[160:163]
    ds_read_b64_tr_b16 v[64:65], v108 offset:43008
    ds_read_b64_tr_b16 v[66:67], v108 offset:43264
    v_mfma_f32_16x16x32_bf16 v[192:195], v[16:19], a[116:119], v[192:195]
    ds_read_b64_tr_b16 v[68:69], v108 offset:43040
    ds_read_b64_tr_b16 v[70:71], v108 offset:43296
    v_mfma_f32_16x16x32_bf16 v[164:167], v[20:23], a[112:115], v[164:167]
    ds_read_b64_tr_b16 v[72:73], v108 offset:43072
    ds_read_b64_tr_b16 v[74:75], v108 offset:43328
    v_mfma_f32_16x16x32_bf16 v[196:199], v[20:23], a[116:119], v[196:199]
    ds_read_b64_tr_b16 v[76:77], v108 offset:43104
    ds_read_b64_tr_b16 v[78:79], v108 offset:43360
    v_mfma_f32_16x16x32_bf16 v[168:171], v[24:27], a[112:115], v[168:171]
    ds_read_b64_tr_b16 v[80:81], v108 offset:47232
    ds_read_b64_tr_b16 v[82:83], v108 offset:47488
    v_mfma_f32_16x16x32_bf16 v[200:203], v[24:27], a[116:119], v[200:203]
    ds_read_b64_tr_b16 v[84:85], v108 offset:47264
    ds_read_b64_tr_b16 v[86:87], v108 offset:47520
    v_mfma_f32_16x16x32_bf16 v[172:175], v[28:31], a[112:115], v[172:175]
    ds_read_b64_tr_b16 v[88:89], v108 offset:47296
    ds_read_b64_tr_b16 v[90:91], v108 offset:47552
    v_mfma_f32_16x16x32_bf16 v[204:207], v[28:31], a[116:119], v[204:207]
    ds_read_b64_tr_b16 v[92:93], v108 offset:47328
    ds_read_b64_tr_b16 v[94:95], v108 offset:47584
    v_mfma_f32_16x16x32_bf16 v[176:179], v[32:35], a[112:115], v[176:179]
    v_accvgpr_write_b32 a104, 0
    v_accvgpr_write_b32 a105, 0
    v_mfma_f32_16x16x32_bf16 v[208:211], v[32:35], a[116:119], v[208:211]
    v_accvgpr_write_b32 a106, 0
    v_accvgpr_write_b32 a107, 0
    v_mfma_f32_16x16x32_bf16 v[180:183], v[36:39], a[112:115], v[180:183]
    v_accvgpr_write_b32 a108, 0
    v_accvgpr_write_b32 a109, 0
    v_mfma_f32_16x16x32_bf16 v[212:215], v[36:39], a[116:119], v[212:215]
    v_accvgpr_write_b32 a110, 0
    v_accvgpr_write_b32 a111, 0
    v_mfma_f32_16x16x32_bf16 v[184:187], v[40:43], a[112:115], v[184:187]
    v_mfma_f32_16x16x32_bf16 v[216:219], v[40:43], a[116:119], v[216:219]
    v_mfma_f32_16x16x32_bf16 v[188:191], v[44:47], a[112:115], v[188:191]
    v_mfma_f32_16x16x32_bf16 v[220:223], v[44:47], a[116:119], v[220:223]
    s_waitcnt vmcnt(10) lgkmcnt(0)
    s_barrier
    v_mfma_f32_16x16x32_bf16 v[160:163], v[64:67], a[120:123], v[160:163]
    ds_read_b64_tr_b16 v[16:17], v104 offset:34816
    ds_read_b64_tr_b16 v[18:19], v104 offset:35072
    v_mfma_f32_16x16x32_bf16 v[192:195], v[64:67], a[124:127], v[192:195]
    ds_read_b64_tr_b16 v[20:21], v104 offset:34848
    ds_read_b64_tr_b16 v[22:23], v104 offset:35104
    v_mfma_f32_16x16x32_bf16 v[164:167], v[68:71], a[120:123], v[164:167]
    ds_read_b64_tr_b16 v[24:25], v104 offset:34880
    ds_read_b64_tr_b16 v[26:27], v104 offset:35136
    v_mfma_f32_16x16x32_bf16 v[196:199], v[68:71], a[124:127], v[196:199]
    ds_read_b64_tr_b16 v[28:29], v104 offset:34912
    ds_read_b64_tr_b16 v[30:31], v104 offset:35168
    v_mfma_f32_16x16x32_bf16 v[168:171], v[72:75], a[120:123], v[168:171]
    ds_read_b64_tr_b16 v[32:33], v104 offset:39040
    ds_read_b64_tr_b16 v[34:35], v104 offset:39296
    v_mfma_f32_16x16x32_bf16 v[200:203], v[72:75], a[124:127], v[200:203]
    ds_read_b64_tr_b16 v[36:37], v104 offset:39072
    ds_read_b64_tr_b16 v[38:39], v104 offset:39328
    v_mfma_f32_16x16x32_bf16 v[172:175], v[76:79], a[120:123], v[172:175]
    ds_read_b64_tr_b16 v[40:41], v104 offset:39104
    ds_read_b64_tr_b16 v[42:43], v104 offset:39360
    v_mfma_f32_16x16x32_bf16 v[204:207], v[76:79], a[124:127], v[204:207]
    ds_read_b64_tr_b16 v[44:45], v104 offset:39136
    ds_read_b64_tr_b16 v[46:47], v104 offset:39392
    v_mfma_f32_16x16x32_bf16 v[176:179], v[80:83], a[120:123], v[176:179]
    v_accvgpr_write_b32 a112, 0
    v_accvgpr_write_b32 a113, 0
    v_mfma_f32_16x16x32_bf16 v[208:211], v[80:83], a[124:127], v[208:211]
    v_accvgpr_write_b32 a114, 0
    v_accvgpr_write_b32 a115, 0
    v_mfma_f32_16x16x32_bf16 v[180:183], v[84:87], a[120:123], v[180:183]
    v_accvgpr_write_b32 a116, 0
    v_accvgpr_write_b32 a117, 0
    v_mfma_f32_16x16x32_bf16 v[212:215], v[84:87], a[124:127], v[212:215]
    v_accvgpr_write_b32 a118, 0
    v_accvgpr_write_b32 a119, 0
    v_mfma_f32_16x16x32_bf16 v[184:187], v[88:91], a[120:123], v[184:187]
    v_mfma_f32_16x16x32_bf16 v[216:219], v[88:91], a[124:127], v[216:219]
    v_mfma_f32_16x16x32_bf16 v[188:191], v[92:95], a[120:123], v[188:191]
    v_mfma_f32_16x16x32_bf16 v[220:223], v[92:95], a[124:127], v[220:223]
    s_waitcnt vmcnt(8) lgkmcnt(0)
    s_barrier
    v_mfma_f32_16x16x32_bf16 v[160:163], v[16:19], a[128:131], v[160:163]
    ds_read_b64_tr_b16 v[64:65], v108 offset:34304
    ds_read_b64_tr_b16 v[66:67], v108 offset:34560
    v_mfma_f32_16x16x32_bf16 v[192:195], v[16:19], a[132:135], v[192:195]
    ds_read_b64_tr_b16 v[68:69], v108 offset:34336
    ds_read_b64_tr_b16 v[70:71], v108 offset:34592
    v_mfma_f32_16x16x32_bf16 v[164:167], v[20:23], a[128:131], v[164:167]
    ds_read_b64_tr_b16 v[72:73], v108 offset:34368
    ds_read_b64_tr_b16 v[74:75], v108 offset:34624
    v_mfma_f32_16x16x32_bf16 v[196:199], v[20:23], a[132:135], v[196:199]
    ds_read_b64_tr_b16 v[76:77], v108 offset:34400
    ds_read_b64_tr_b16 v[78:79], v108 offset:34656
    v_mfma_f32_16x16x32_bf16 v[168:171], v[24:27], a[128:131], v[168:171]
    ds_read_b64_tr_b16 v[80:81], v108 offset:38528
    ds_read_b64_tr_b16 v[82:83], v108 offset:38784
    v_mfma_f32_16x16x32_bf16 v[200:203], v[24:27], a[132:135], v[200:203]
    ds_read_b64_tr_b16 v[84:85], v108 offset:38560
    ds_read_b64_tr_b16 v[86:87], v108 offset:38816
    v_mfma_f32_16x16x32_bf16 v[172:175], v[28:31], a[128:131], v[172:175]
    ds_read_b64_tr_b16 v[88:89], v108 offset:38592
    ds_read_b64_tr_b16 v[90:91], v108 offset:38848
    v_mfma_f32_16x16x32_bf16 v[204:207], v[28:31], a[132:135], v[204:207]
    ds_read_b64_tr_b16 v[92:93], v108 offset:38624
    ds_read_b64_tr_b16 v[94:95], v108 offset:38880
    v_mfma_f32_16x16x32_bf16 v[176:179], v[32:35], a[128:131], v[176:179]
    v_accvgpr_write_b32 a120, 0
    v_accvgpr_write_b32 a121, 0
    v_mfma_f32_16x16x32_bf16 v[208:211], v[32:35], a[132:135], v[208:211]
    v_accvgpr_write_b32 a122, 0
    v_accvgpr_write_b32 a123, 0
    v_mfma_f32_16x16x32_bf16 v[180:183], v[36:39], a[128:131], v[180:183]
    v_accvgpr_write_b32 a124, 0
    v_accvgpr_write_b32 a125, 0
    v_mfma_f32_16x16x32_bf16 v[212:215], v[36:39], a[132:135], v[212:215]
    v_accvgpr_write_b32 a126, 0
    v_accvgpr_write_b32 a127, 0
    v_mfma_f32_16x16x32_bf16 v[184:187], v[40:43], a[128:131], v[184:187]
    v_mfma_f32_16x16x32_bf16 v[216:219], v[40:43], a[132:135], v[216:219]
    v_mfma_f32_16x16x32_bf16 v[188:191], v[44:47], a[128:131], v[188:191]
    v_mfma_f32_16x16x32_bf16 v[220:223], v[44:47], a[132:135], v[220:223]
    s_waitcnt vmcnt(6) lgkmcnt(0)
    s_barrier
    v_mfma_f32_16x16x32_bf16 v[160:163], v[64:67], a[136:139], v[160:163]
    ds_read_b128 v[16:19], v1 offset:0
    ds_read_b128 v[20:23], v1 offset:64
    v_mfma_f32_16x16x32_bf16 v[192:195], v[64:67], a[140:143], v[192:195]
    ds_read_b128 v[24:27], v1 offset:128
    ds_read_b128 v[28:31], v1 offset:192
    v_mfma_f32_16x16x32_bf16 v[164:167], v[68:71], a[136:139], v[164:167]
    ds_read_b128 v[32:35], v1 offset:4352
    ds_read_b128 v[36:39], v1 offset:4416
    v_mfma_f32_16x16x32_bf16 v[196:199], v[68:71], a[140:143], v[196:199]
    ds_read_b128 v[40:43], v1 offset:4480
    ds_read_b128 v[44:47], v1 offset:4544
    v_mfma_f32_16x16x32_bf16 v[168:171], v[72:75], a[136:139], v[168:171]
    s_add_u32 m0, s39, 95744
    s_nop 0
    buffer_load_dwordx4 v8, s[8:11], s33 offen nt lds
    s_add_u32 m0, s39, 96544
    v_mfma_f32_16x16x32_bf16 v[200:203], v[72:75], a[140:143], v[200:203]
    buffer_load_dwordx4 v8, s[8:11], s33 offen offset:256 nt lds
    v_mfma_f32_16x16x32_bf16 v[172:175], v[76:79], a[136:139], v[172:175]
    s_add_u32 m0, s40, 104448
    s_add_u32 s33, s33, 8192
    buffer_load_dwordx4 v7, s[4:7], s32 offen nt lds
    v_accvgpr_write_b32 a128, 0
    v_mfma_f32_16x16x32_bf16 v[204:207], v[76:79], a[140:143], v[204:207]
    v_accvgpr_write_b32 a129, 0
    v_accvgpr_write_b32 a130, 0
    v_mfma_f32_16x16x32_bf16 v[176:179], v[80:83], a[136:139], v[176:179]
    v_accvgpr_write_b32 a131, 0
    v_accvgpr_write_b32 a132, 0
    v_mfma_f32_16x16x32_bf16 v[208:211], v[80:83], a[140:143], v[208:211]
    v_accvgpr_write_b32 a133, 0
    v_accvgpr_write_b32 a134, 0
    v_mfma_f32_16x16x32_bf16 v[180:183], v[84:87], a[136:139], v[180:183]
    v_accvgpr_write_b32 a135, 0
    v_mfma_f32_16x16x32_bf16 v[212:215], v[84:87], a[140:143], v[212:215]
    v_mfma_f32_16x16x32_bf16 v[184:187], v[88:91], a[136:139], v[184:187]
    v_mfma_f32_16x16x32_bf16 v[216:219], v[88:91], a[140:143], v[216:219]
    v_mfma_f32_16x16x32_bf16 v[188:191], v[92:95], a[136:139], v[188:191]
    v_mfma_f32_16x16x32_bf16 v[220:223], v[92:95], a[140:143], v[220:223]
    v_accvgpr_write_b32 a136, 0
    v_accvgpr_write_b32 a137, 0
    v_accvgpr_write_b32 a138, 0
    v_accvgpr_write_b32 a139, 0
    v_accvgpr_write_b32 a140, 0
    v_accvgpr_write_b32 a141, 0
    v_accvgpr_write_b32 a142, 0
    v_accvgpr_write_b32 a143, 0
    v_mul_f32 v160, s47, v160
    v_mul_f32 v161, s47, v161
    v_mul_f32 v162, s47, v162
    v_mul_f32 v163, s47, v163
    v_mul_f32 v164, s47, v164
    v_mul_f32 v165, s47, v165
    v_mul_f32 v166, s47, v166
    v_mul_f32 v167, s47, v167
    v_cvt_pk_bf16_f32 v96, v160, v161
    v_cvt_pk_bf16_f32 v97, v162, v163
    v_cvt_pk_bf16_f32 v98, v164, v165
    v_cvt_pk_bf16_f32 v99, v166, v167
    v_mul_f32 v192, s47, v192
    v_mul_f32 v193, s47, v193
    v_mul_f32 v194, s47, v194
    v_mul_f32 v195, s47, v195
    v_mul_f32 v196, s47, v196
    v_mul_f32 v197, s47, v197
    v_mul_f32 v198, s47, v198
    v_mul_f32 v199, s47, v199
    v_cvt_pk_bf16_f32 v100, v192, v193
    v_cvt_pk_bf16_f32 v101, v194, v195
    v_cvt_pk_bf16_f32 v102, v196, v197
    v_cvt_pk_bf16_f32 v103, v198, v199
    s_nop 0
    v_permlane32_swap_b32 v96, v98
    v_permlane32_swap_b32 v97, v99
    v_permlane32_swap_b32 v100, v102
    v_permlane32_swap_b32 v101, v103
    v_permlane16_swap_b32 v96, v98
    v_permlane16_swap_b32 v97, v99
    v_permlane16_swap_b32 v100, v102
    v_permlane16_swap_b32 v101, v103
    v_mul_f32 v168, s47, v168
    v_mul_f32 v169, s47, v169
    v_mul_f32 v170, s47, v170
    v_mul_f32 v171, s47, v171
    v_mul_f32 v172, s47, v172
    v_mul_f32 v173, s47, v173
    v_mul_f32 v174, s47, v174
    v_mul_f32 v175, s47, v175
    v_cvt_pk_bf16_f32 v104, v168, v169
    v_cvt_pk_bf16_f32 v105, v170, v171
    v_cvt_pk_bf16_f32 v106, v172, v173
    v_cvt_pk_bf16_f32 v107, v174, v175
    v_mul_f32 v200, s47, v200
    v_mul_f32 v201, s47, v201
    v_mul_f32 v202, s47, v202
    v_mul_f32 v203, s47, v203
    v_mul_f32 v204, s47, v204
    v_mul_f32 v205, s47, v205
    v_mul_f32 v206, s47, v206
    v_mul_f32 v207, s47, v207
    v_cvt_pk_bf16_f32 v108, v200, v201
    v_cvt_pk_bf16_f32 v109, v202, v203
    v_cvt_pk_bf16_f32 v110, v204, v205
    v_cvt_pk_bf16_f32 v111, v206, v207
    s_nop 0
    v_permlane32_swap_b32 v104, v106
    v_permlane32_swap_b32 v105, v107
    v_permlane32_swap_b32 v108, v110
    v_permlane32_swap_b32 v109, v111
    v_permlane16_swap_b32 v104, v106
    v_permlane16_swap_b32 v105, v107
    v_permlane16_swap_b32 v108, v110
    v_permlane16_swap_b32 v109, v111
    v_mul_f32 v176, s47, v176
    v_mul_f32 v177, s47, v177
    v_mul_f32 v178, s47, v178
    v_mul_f32 v179, s47, v179
    v_mul_f32 v180, s47, v180
    v_mul_f32 v181, s47, v181
    v_mul_f32 v182, s47, v182
    v_mul_f32 v183, s47, v183
    v_cvt_pk_bf16_f32 v112, v176, v177
    v_cvt_pk_bf16_f32 v113, v178, v179
    v_cvt_pk_bf16_f32 v114, v180, v181
    v_cvt_pk_bf16_f32 v115, v182, v183
    v_mul_f32 v208, s47, v208
    v_mul_f32 v209, s47, v209
    v_mul_f32 v210, s47, v210
    v_mul_f32 v211, s47, v211
    v_mul_f32 v212, s47, v212
    v_mul_f32 v213, s47, v213
    v_mul_f32 v214, s47, v214
    v_mul_f32 v215, s47, v215
    v_cvt_pk_bf16_f32 v116, v208, v209
    v_cvt_pk_bf16_f32 v117, v210, v211
    v_cvt_pk_bf16_f32 v118, v212, v213
    v_cvt_pk_bf16_f32 v119, v214, v215
    s_nop 0
    v_permlane32_swap_b32 v112, v114
    v_permlane32_swap_b32 v113, v115
    v_permlane32_swap_b32 v116, v118
    v_permlane32_swap_b32 v117, v119
    v_permlane16_swap_b32 v112, v114
    v_permlane16_swap_b32 v113, v115
    v_permlane16_swap_b32 v116, v118
    v_permlane16_swap_b32 v117, v119
    v_mul_f32 v184, s47, v184
    v_mul_f32 v185, s47, v185
    v_mul_f32 v186, s47, v186
    v_mul_f32 v187, s47, v187
    v_mul_f32 v188, s47, v188
    v_mul_f32 v189, s47, v189
    v_mul_f32 v190, s47, v190
    v_mul_f32 v191, s47, v191
    v_cvt_pk_bf16_f32 v120, v184, v185
    v_cvt_pk_bf16_f32 v121, v186, v187
    v_cvt_pk_bf16_f32 v122, v188, v189
    v_cvt_pk_bf16_f32 v123, v190, v191
    v_mul_f32 v216, s47, v216
    v_mul_f32 v217, s47, v217
    v_mul_f32 v218, s47, v218
    v_mul_f32 v219, s47, v219
    v_mul_f32 v220, s47, v220
    v_mul_f32 v221, s47, v221
    v_mul_f32 v222, s47, v222
    v_mul_f32 v223, s47, v223
    v_cvt_pk_bf16_f32 v124, v216, v217
    v_cvt_pk_bf16_f32 v125, v218, v219
    v_cvt_pk_bf16_f32 v126, v220, v221
    v_cvt_pk_bf16_f32 v127, v222, v223
    s_nop 0
    v_permlane32_swap_b32 v120, v122
    v_permlane32_swap_b32 v121, v123
    v_permlane32_swap_b32 v124, v126
    v_permlane32_swap_b32 v125, v127
    v_permlane16_swap_b32 v120, v122
    v_permlane16_swap_b32 v121, v123
    v_permlane16_swap_b32 v124, v126
    v_permlane16_swap_b32 v125, v127
    s_nop 1
    s_waitcnt lgkmcnt(5)
    s_add_u32 m0, s40, 104512
    v_mfma_f32_16x16x32_bf16 v[64:67], v[16:19], v[96:99], 0
    buffer_load_dwordx4 v7, s[4:7], s32 offen offset:1024 nt lds
    s_add_u32 s32, s32, 8192
    v_mfma_f32_16x16x32_bf16 v[72:75], v[16:19], v[100:103], 0
    v_mov_b32 v11, 0
    v_mov_b32 v12, 0
    v_mfma_f32_16x16x32_bf16 v[64:67], v[20:23], v[104:107], v[64:67]
    v_mfma_f32_16x16x32_bf16 v[72:75], v[20:23], v[108:111], v[72:75]
    v_mfma_f32_16x16x32_bf16 v[64:67], v[24:27], v[112:115], v[64:67]
    v_mfma_f32_16x16x32_bf16 v[72:75], v[24:27], v[116:119], v[72:75]
    s_waitcnt vmcnt(6) lgkmcnt(0)
    s_barrier
    ds_read_b128 v[16:19], v1 offset:26112
    ds_read_b128 v[20:23], v1 offset:26176
    ds_read_b128 v[24:27], v1 offset:26240
    v_mfma_f32_16x16x32_bf16 v[64:67], v[28:31], v[120:123], v[64:67]
    s_add_u32 m0, s39, 34816
    s_nop 0
    buffer_load_dwordx4 v8, s[8:11], s33 offen nt lds
    v_mfma_f32_16x16x32_bf16 v[72:75], v[28:31], v[124:127], v[72:75]
    s_add_u32 m0, s39, 35616
    ds_read_b128 v[28:31], v1 offset:26304
    buffer_load_dwordx4 v8, s[8:11], s33 offen offset:256 nt lds
    v_mfma_f32_16x16x32_bf16 v[68:71], v[32:35], v[96:99], 0
    s_add_u32 m0, s40, 43520
    s_add_u32 s33, s33, 8192
    buffer_load_dwordx4 v7, s[4:7], s32 offen nt lds
    v_mfma_f32_16x16x32_bf16 v[76:79], v[32:35], v[100:103], 0
    ds_read_b128 v[32:35], v1 offset:30464
    v_mfma_f32_16x16x32_bf16 v[68:71], v[36:39], v[104:107], v[68:71]
    v_mfma_f32_16x16x32_bf16 v[76:79], v[36:39], v[108:111], v[76:79]
    ds_read_b128 v[36:39], v1 offset:30528
    v_mfma_f32_16x16x32_bf16 v[68:71], v[40:43], v[112:115], v[68:71]
    v_mfma_f32_16x16x32_bf16 v[76:79], v[40:43], v[116:119], v[76:79]
    ds_read_b128 v[40:43], v1 offset:30592
    v_mfma_f32_16x16x32_bf16 v[68:71], v[44:47], v[120:123], v[68:71]
    v_mfma_f32_16x16x32_bf16 v[76:79], v[44:47], v[124:127], v[76:79]
    ds_read_b128 v[44:47], v1 offset:30656
    s_nop 6
    v_max3_f32 v56, v64, v65, v66
    v_max3_f32 v57, v72, v73, v74
    v_max3_f32 v56, v56, v67, v68
    v_max3_f32 v57, v57, v75, v76
    v_max3_f32 v56, v56, v69, v70
    v_max3_f32 v57, v57, v77, v78
    v_max_f32 v56, v56, v71
    v_max_f32 v57, v57, v79
    v_mov_b32 v10, v56
    v_mov_b32 v58, v57
    s_nop 0
    v_permlane32_swap_b32 v10, v56
    v_permlane32_swap_b32 v58, v57
    v_max_f32 v56, v56, v10
    v_max_f32 v57, v57, v58
    v_mov_b32 v10, v56
    v_mov_b32 v58, v57
    s_nop 0
    v_permlane16_swap_b32 v10, v56
    v_permlane16_swap_b32 v58, v57
    v_max_f32 v56, v56, v10
    v_max_f32 v57, v57, v58
    v_sub_f32 v48, 0, v56
    v_sub_f32 v49, 0, v56
    v_sub_f32 v50, 0, v56
    v_sub_f32 v51, 0, v56
    v_sub_f32 v52, 0, v57
    v_sub_f32 v53, 0, v57
    v_sub_f32 v54, 0, v57
    v_sub_f32 v55, 0, v57
    v_sub_f32 v64, v64, v56
    v_sub_f32 v65, v65, v56
    v_sub_f32 v66, v66, v56
    v_sub_f32 v67, v67, v56
    v_sub_f32 v68, v68, v56
    v_sub_f32 v69, v69, v56
    v_sub_f32 v70, v70, v56
    v_sub_f32 v71, v71, v56
    v_sub_f32 v72, v72, v57
    v_sub_f32 v73, v73, v57
    v_sub_f32 v74, v74, v57
    v_sub_f32 v75, v75, v57
    v_sub_f32 v76, v76, v57
    v_sub_f32 v77, v77, v57
    v_sub_f32 v78, v78, v57
    v_sub_f32 v79, v79, v57
    s_nop 0
    s_waitcnt lgkmcnt(4)
    s_add_u32 m0, s40, 43584
    v_mfma_f32_16x16x32_bf16 v[80:83], v[16:19], v[96:99], v[48:51]
    buffer_load_dwordx4 v7, s[4:7], s32 offen offset:1024 nt lds
    s_add_u32 s32, s32, 8192
    v_exp_f32 v64, v64
    v_mfma_f32_16x16x32_bf16 v[88:91], v[16:19], v[100:103], v[52:55]
    ds_read_b64_tr_b16 v[16:17], v5 offset:0
    ds_read_b64_tr_b16 v[18:19], v5 offset:512
    v_exp_f32 v65, v65
    v_mfma_f32_16x16x32_bf16 v[80:83], v[20:23], v[104:107], v[80:83]
    v_exp_f32 v66, v66
    v_add_f32 v11, v11, v64
    v_add_f32 v11, v11, v65
    v_cvt_pk_bf16_f32 v64, v64, v65
    v_mfma_f32_16x16x32_bf16 v[88:91], v[20:23], v[108:111], v[88:91]
    ds_read_b64_tr_b16 v[20:21], v5 offset:32
    ds_read_b64_tr_b16 v[22:23], v5 offset:544
    v_exp_f32 v67, v67
    v_mfma_f32_16x16x32_bf16 v[80:83], v[24:27], v[112:115], v[80:83]
    v_exp_f32 v68, v68
    v_add_f32 v11, v11, v66
    v_add_f32 v11, v11, v67
    v_cvt_pk_bf16_f32 v65, v66, v67
    v_mfma_f32_16x16x32_bf16 v[88:91], v[24:27], v[116:119], v[88:91]
    ds_read_b64_tr_b16 v[24:25], v5 offset:64
    ds_read_b64_tr_b16 v[26:27], v5 offset:576
    v_exp_f32 v69, v69
    v_mfma_f32_16x16x32_bf16 v[80:83], v[28:31], v[120:123], v[80:83]
    v_exp_f32 v70, v70
    v_cvt_pk_bf16_f32 v66, v68, v69
    v_exp_f32 v71, v71
    v_mfma_f32_16x16x32_bf16 v[88:91], v[28:31], v[124:127], v[88:91]
    ds_read_b64_tr_b16 v[28:29], v5 offset:96
    ds_read_b64_tr_b16 v[30:31], v5 offset:608
    v_add_f32 v11, v11, v68
    v_cvt_pk_bf16_f32 v67, v70, v71
    s_waitcnt lgkmcnt(8)
    v_mfma_f32_16x16x32_bf16 v[84:87], v[32:35], v[96:99], v[48:51]
    v_exp_f32 v72, v72
    v_exp_f32 v73, v73
    v_mfma_f32_16x16x32_bf16 v[92:95], v[32:35], v[100:103], v[52:55]
    ds_read_b64_tr_b16 v[32:33], v5 offset:128
    ds_read_b64_tr_b16 v[34:35], v5 offset:640
    v_exp_f32 v74, v74
    v_add_f32 v12, v12, v72
    v_mfma_f32_16x16x32_bf16 v[84:87], v[36:39], v[104:107], v[84:87]
    v_add_f32 v12, v12, v73
    v_cvt_pk_bf16_f32 v72, v72, v73
    v_exp_f32 v75, v75
    v_mfma_f32_16x16x32_bf16 v[92:95], v[36:39], v[108:111], v[92:95]
    ds_read_b64_tr_b16 v[36:37], v5 offset:160
    ds_read_b64_tr_b16 v[38:39], v5 offset:672
    v_exp_f32 v76, v76
    v_add_f32 v12, v12, v74
    v_mfma_f32_16x16x32_bf16 v[84:87], v[40:43], v[112:115], v[84:87]
    v_add_f32 v12, v12, v75
    v_cvt_pk_bf16_f32 v73, v74, v75
    v_exp_f32 v77, v77
    v_mfma_f32_16x16x32_bf16 v[92:95], v[40:43], v[116:119], v[92:95]
    ds_read_b64_tr_b16 v[40:41], v5 offset:192
    ds_read_b64_tr_b16 v[42:43], v5 offset:704
    v_exp_f32 v78, v78
    v_cvt_pk_bf16_f32 v74, v76, v77
    v_mfma_f32_16x16x32_bf16 v[84:87], v[44:47], v[120:123], v[84:87]
    v_exp_f32 v79, v79
    v_add_f32 v12, v12, v76
    v_cvt_pk_bf16_f32 v75, v78, v79
    v_mfma_f32_16x16x32_bf16 v[92:95], v[44:47], v[124:127], v[92:95]
    ds_read_b64_tr_b16 v[44:45], v5 offset:224
    ds_read_b64_tr_b16 v[46:47], v5 offset:736
    s_waitcnt lgkmcnt(10)
    v_mfma_f32_16x16x32_bf16 v[160:163], v[16:19], v[64:67], 0
    v_mfma_f32_16x16x32_bf16 v[192:195], v[16:19], v[72:75], 0
    v_mfma_f32_16x16x32_bf16 v[164:167], v[20:23], v[64:67], 0
    v_mfma_f32_16x16x32_bf16 v[196:199], v[20:23], v[72:75], 0
    v_add_f32 v11, v11, v69
    v_add_f32 v11, v11, v70
    v_add_f32 v11, v11, v71
    v_add_f32 v12, v12, v77
    v_add_f32 v12, v12, v78
    v_mfma_f32_16x16x32_bf16 v[168:171], v[24:27], v[64:67], 0
    v_add_f32 v12, v12, v79
    v_max3_f32 v13, v80, v81, v82
    v_max3_f32 v13, v13, v83, v84
    v_max3_f32 v13, v13, v85, v86
    v_max3_f32 v13, v13, v87, v88
    v_mfma_f32_16x16x32_bf16 v[200:203], v[24:27], v[72:75], 0
    s_waitcnt vmcnt(6) lgkmcnt(0)
    s_barrier
    ds_read_b128 v[16:19], v4 offset:8704
    ds_read_b128 v[20:23], v4 offset:8768
    ds_read_b128 v[24:27], v4 offset:8832
    v_mfma_f32_16x16x32_bf16 v[172:175], v[28:31], v[64:67], 0
    v_max3_f32 v13, v13, v89, v90
    v_max3_f32 v13, v13, v91, v92
    v_max3_f32 v13, v13, v93, v94
    v_max_f32 v13, v13, v95
    v_cmp_lt_f32 vcc, s46, v13
    v_mfma_f32_16x16x32_bf16 v[204:207], v[28:31], v[72:75], 0
    ds_read_b128 v[28:31], v4 offset:8896
    s_add_u32 m0, s39, 69632
    s_nop 0
    buffer_load_dwordx4 v8, s[8:11], s33 offen nt lds
    v_mfma_f32_16x16x32_bf16 v[176:179], v[32:35], v[64:67], 0
    v_mfma_f32_16x16x32_bf16 v[208:211], v[32:35], v[72:75], 0
    ds_read_b128 v[32:35], v4 offset:13056
    v_mfma_f32_16x16x32_bf16 v[180:183], v[36:39], v[64:67], 0
    v_mfma_f32_16x16x32_bf16 v[212:215], v[36:39], v[72:75], 0
    ds_read_b128 v[36:39], v4 offset:13120
    v_mfma_f32_16x16x32_bf16 v[184:187], v[40:43], v[64:67], 0
    v_mfma_f32_16x16x32_bf16 v[216:219], v[40:43], v[72:75], 0
    ds_read_b128 v[40:43], v4 offset:13184
    v_mfma_f32_16x16x32_bf16 v[188:191], v[44:47], v[64:67], 0
    v_mfma_f32_16x16x32_bf16 v[220:223], v[44:47], v[72:75], 0
    ds_read_b128 v[44:47], v4 offset:13248
    s_cbranch_vccnz L_rare_t1
L_back_t1:
    s_waitcnt lgkmcnt(4)
    s_add_u32 m0, s39, 70432
    v_mfma_f32_16x16x32_bf16 v[64:67], v[16:19], v[96:99], v[48:51]
    buffer_load_dwordx4 v8, s[8:11], s33 offen offset:256 nt lds
    s_add_u32 s33, s33, 8192
    v_exp_f32 v80, v80
    v_mfma_f32_16x16x32_bf16 v[72:75], v[16:19], v[100:103], v[52:55]
    ds_read_b64_tr_b16 v[16:17], v5 offset:26112
    ds_read_b64_tr_b16 v[18:19], v5 offset:26624
    v_exp_f32 v81, v81
    v_mfma_f32_16x16x32_bf16 v[64:67], v[20:23], v[104:107], v[64:67]
    v_exp_f32 v82, v82
    v_add_f32 v11, v11, v80
    v_add_f32 v11, v11, v81
    v_cvt_pk_bf16_f32 v80, v80, v81
    v_mfma_f32_16x16x32_bf16 v[72:75], v[20:23], v[108:111], v[72:75]
    ds_read_b64_tr_b16 v[20:21], v5 offset:26144
    ds_read_b64_tr_b16 v[22:23], v5 offset:26656
    v_exp_f32 v83, v83
    v_mfma_f32_16x16x32_bf16 v[64:67], v[24:27], v[112:115], v[64:67]
    v_exp_f32 v84, v84
    v_add_f32 v11, v11, v82
    v_add_f32 v11, v11, v83
    v_cvt_pk_bf16_f32 v81, v82, v83
    v_mfma_f32_16x16x32_bf16 v[72:75], v[24:27], v[116:119], v[72:75]
    ds_read_b64_tr_b16 v[24:25], v5 offset:26176
    ds_read_b64_tr_b16 v[26:27], v5 offset:26688
    v_exp_f32 v85, v85
    v_mfma_f32_16x16x32_bf16 v[64:67], v[28:31], v[120:123], v[64:67]
    v_exp_f32 v86, v86
    v_cvt_pk_bf16_f32 v82, v84, v85
    v_exp_f32 v87, v87
    v_mfma_f32_16x16x32_bf16 v[72:75], v[28:31], v[124:127], v[72:75]
    ds_read_b64_tr_b16 v[28:29], v5 offset:26208
    ds_read_b64_tr_b16 v[30:31], v5 offset:26720
    v_add_f32 v11, v11, v84
    v_cvt_pk_bf16_f32 v83, v86, v87
    s_waitcnt lgkmcnt(8)
    v_mfma_f32_16x16x32_bf16 v[68:71], v[32:35], v[96:99], v[48:51]
    v_exp_f32 v88, v88
    v_exp_f32 v89, v89
    v_mfma_f32_16x16x32_bf16 v[76:79], v[32:35], v[100:103], v[52:55]
    ds_read_b64_tr_b16 v[32:33], v5 offset:26240
    ds_read_b64_tr_b16 v[34:35], v5 offset:26752
    v_exp_f32 v90, v90
    v_add_f32 v12, v12, v88
    v_mfma_f32_16x16x32_bf16 v[68:71], v[36:39], v[104:107], v[68:71]
    v_add_f32 v12, v12, v89
    v_cvt_pk_bf16_f32 v88, v88, v89
    v_exp_f32 v91, v91
    v_mfma_f32_16x16x32_bf16 v[76:79], v[36:39], v[108:111], v[76:79]
    ds_read_b64_tr_b16 v[36:37], v5 offset:26272
    ds_read_b64_tr_b16 v[38:39], v5 offset:26784
    v_exp_f32 v92, v92
    v_add_f32 v12, v12, v90
    v_mfma_f32_16x16x32_bf16 v[68:71], v[40:43], v[112:115], v[68:71]
    v_add_f32 v12, v12, v91
    v_cvt_pk_bf16_f32 v89, v90, v91
    v_exp_f32 v93, v93
    v_mfma_f32_16x16x32_bf16 v[76:79], v[40:43], v[116:119], v[76:79]
    ds_read_b64_tr_b16 v[40:41], v5 offset:26304
    ds_read_b64_tr_b16 v[42:43], v5 offset:26816
    v_exp_f32 v94, v94
    v_cvt_pk_bf16_f32 v90, v92, v93
    v_mfma_f32_16x16x32_bf16 v[68:71], v[44:47], v[120:123], v[68:71]
    v_exp_f32 v95, v95
    v_add_f32 v12, v12, v92
    v_cvt_pk_bf16_f32 v91, v94, v95
    v_mfma_f32_16x16x32_bf16 v[76:79], v[44:47], v[124:127], v[76:79]
    ds_read_b64_tr_b16 v[44:45], v5 offset:26336
    ds_read_b64_tr_b16 v[46:47], v5 offset:26848
    s_waitcnt lgkmcnt(10)
    v_mfma_f32_16x16x32_bf16 v[160:163], v[16:19], v[80:83], v[160:163]
    v_mfma_f32_16x16x32_bf16 v[192:195], v[16:19], v[88:91], v[192:195]
    v_mfma_f32_16x16x32_bf16 v[164:167], v[20:23], v[80:83], v[164:167]
    v_mfma_f32_16x16x32_bf16 v[196:199], v[20:23], v[88:91], v[196:199]
    v_add_f32 v11, v11, v85
    v_add_f32 v11, v11, v86
    v_add_f32 v11, v11, v87
    v_add_f32 v12, v12, v93
    v_add_f32 v12, v12, v94
    v_mfma_f32_16x16x32_bf16 v[168:171], v[24:27], v[80:83], v[168:171]
    v_add_f32 v12, v12, v95
    v_max3_f32 v13, v64, v65, v66
    v_max3_f32 v13, v13, v67, v68
    v_max3_f32 v13, v13, v69, v70
    v_max3_f32 v13, v13, v71, v72
    v_mfma_f32_16x16x32_bf16 v[200:203], v[24:27], v[88:91], v[200:203]
    s_waitcnt vmcnt(4) lgkmcnt(0)
    s_barrier
    ds_read_b128 v[16:19], v4 offset:34816
    ds_read_b128 v[20:23], v4 offset:34880
    ds_read_b128 v[24:27], v4 offset:34944
    v_mfma_f32_16x16x32_bf16 v[172:175], v[28:31], v[80:83], v[172:175]
    v_max3_f32 v13, v13, v73, v74
    v_max3_f32 v13, v13, v75, v76
    v_max3_f32 v13, v13, v77, v78
    v_max_f32 v13, v13, v79
    v_cmp_lt_f32 vcc, s46, v13
    v_mfma_f32_16x16x32_bf16 v[204:207], v[28:31], v[88:91], v[204:207]
    s_add_u32 m0, s40, 78336
    ds_read_b128 v[28:31], v4 offset:35008
    buffer_load_dwordx4 v7, s[4:7], s32 offen nt lds
    s_add_u32 m0, s40, 78400
    s_nop 0
    buffer_load_dwordx4 v7, s[4:7], s32 offen offset:1024 nt lds
    v_mfma_f32_16x16x32_bf16 v[176:179], v[32:35], v[80:83], v[176:179]
    s_add_u32 s32, s32, 8192
    s_add_u32 m0, s39, 95744
    s_nop 0
    buffer_load_dwordx4 v8, s[8:11], s33 offen nt lds
    v_mfma_f32_16x16x32_bf16 v[208:211], v[32:35], v[88:91], v[208:211]
    ds_read_b128 v[32:35], v4 offset:39168
    v_mfma_f32_16x16x32_bf16 v[180:183], v[36:39], v[80:83], v[180:183]
    v_mfma_f32_16x16x32_bf16 v[212:215], v[36:39], v[88:91], v[212:215]
    ds_read_b128 v[36:39], v4 offset:39232
    v_mfma_f32_16x16x32_bf16 v[184:187], v[40:43], v[80:83], v[184:187]
    v_mfma_f32_16x16x32_bf16 v[216:219], v[40:43], v[88:91], v[216:219]
    ds_read_b128 v[40:43], v4 offset:39296
    v_mfma_f32_16x16x32_bf16 v[188:191], v[44:47], v[80:83], v[188:191]
    v_mfma_f32_16x16x32_bf16 v[220:223], v[44:47], v[88:91], v[220:223]
    ds_read_b128 v[44:47], v4 offset:39360
    s_cbranch_vccnz L_rare_t2
L_back_t2:
    s_waitcnt lgkmcnt(4)
    s_add_u32 m0, s39, 96544
    v_mfma_f32_16x16x32_bf16 v[80:83], v[16:19], v[96:99], v[48:51]
    buffer_load_dwordx4 v8, s[8:11], s33 offen offset:256 nt lds
    s_add_u32 s33, s33, 8192
    v_exp_f32 v64, v64
    v_mfma_f32_16x16x32_bf16 v[88:91], v[16:19], v[100:103], v[52:55]
    ds_read_b64_tr_b16 v[16:17], v2 offset:8704
    ds_read_b64_tr_b16 v[18:19], v2 offset:9216
    v_exp_f32 v65, v65
    v_mfma_f32_16x16x32_bf16 v[80:83], v[20:23], v[104:107], v[80:83]
    v_exp_f32 v66, v66
    v_add_f32 v11, v11, v64
    v_add_f32 v11, v11, v65
    v_cvt_pk_bf16_f32 v64, v64, v65
    v_mfma_f32_16x16x32_bf16 v[88:91], v[20:23], v[108:111], v[88:91]
    ds_read_b64_tr_b16 v[20:21], v2 offset:8736
    ds_read_b64_tr_b16 v[22:23], v2 offset:9248
    v_exp_f32 v67, v67
    v_mfma_f32_16x16x32_bf16 v[80:83], v[24:27], v[112:115], v[80:83]
    v_exp_f32 v68, v68
    v_add_f32 v11, v11, v66
    v_add_f32 v11, v11, v67
    v_cvt_pk_bf16_f32 v65, v66, v67
    v_mfma_f32_16x16x32_bf16 v[88:91], v[24:27], v[116:119], v[88:91]
    ds_read_b64_tr_b16 v[24:25], v2 offset:8768
    ds_read_b64_tr_b16 v[26:27], v2 offset:9280
    v_exp_f32 v69, v69
    v_mfma_f32_16x16x32_bf16 v[80:83], v[28:31], v[120:123], v[80:83]
    v_exp_f32 v70, v70
    v_cvt_pk_bf16_f32 v66, v68, v69
    v_exp_f32 v71, v71
    v_mfma_f32_16x16x32_bf16 v[88:91], v[28:31], v[124:127], v[88:91]
    ds_read_b64_tr_b16 v[28:29], v2 offset:8800
    ds_read_b64_tr_b16 v[30:31], v2 offset:9312
    v_add_f32 v11, v11, v68
    v_cvt_pk_bf16_f32 v67, v70, v71
    s_waitcnt lgkmcnt(8)
    v_mfma_f32_16x16x32_bf16 v[84:87], v[32:35], v[96:99], v[48:51]
    v_exp_f32 v72, v72
    v_exp_f32 v73, v73
    v_mfma_f32_16x16x32_bf16 v[92:95], v[32:35], v[100:103], v[52:55]
    ds_read_b64_tr_b16 v[32:33], v2 offset:8832
    ds_read_b64_tr_b16 v[34:35], v2 offset:9344
    v_exp_f32 v74, v74
    v_add_f32 v12, v12, v72
    v_mfma_f32_16x16x32_bf16 v[84:87], v[36:39], v[104:107], v[84:87]
    v_add_f32 v12, v12, v73
    v_cvt_pk_bf16_f32 v72, v72, v73
    v_exp_f32 v75, v75
    v_mfma_f32_16x16x32_bf16 v[92:95], v[36:39], v[108:111], v[92:95]
    ds_read_b64_tr_b16 v[36:37], v2 offset:8864
    ds_read_b64_tr_b16 v[38:39], v2 offset:9376
    v_exp_f32 v76, v76
    v_add_f32 v12, v12, v74
    v_mfma_f32_16x16x32_bf16 v[84:87], v[40:43], v[112:115], v[84:87]
    v_add_f32 v12, v12, v75
    v_cvt_pk_bf16_f32 v73, v74, v75
    v_exp_f32 v77, v77
    v_mfma_f32_16x16x32_bf16 v[92:95], v[40:43], v[116:119], v[92:95]
    ds_read_b64_tr_b16 v[40:41], v2 offset:8896
    ds_read_b64_tr_b16 v[42:43], v2 offset:9408
    v_exp_f32 v78, v78
    v_cvt_pk_bf16_f32 v74, v76, v77
    v_mfma_f32_16x16x32_bf16 v[84:87], v[44:47], v[120:123], v[84:87]
    v_exp_f32 v79, v79
    v_add_f32 v12, v12, v76
    v_cvt_pk_bf16_f32 v75, v78, v79
    v_mfma_f32_16x16x32_bf16 v[92:95], v[44:47], v[124:127], v[92:95]
    ds_read_b64_tr_b16 v[44:45], v2 offset:8928
    ds_read_b64_tr_b16 v[46:47], v2 offset:9440
    s_waitcnt lgkmcnt(10)
    v_mfma_f32_16x16x32_bf16 v[160:163], v[16:19], v[64:67], v[160:163]
    v_mfma_f32_16x16x32_bf16 v[192:195], v[16:19], v[72:75], v[192:195]
    v_mfma_f32_16x16x32_bf16 v[164:167], v[20:23], v[64:67], v[164:167]
    v_mfma_f32_16x16x32_bf16 v[196:199], v[20:23], v[72:75], v[196:199]
    v_add_f32 v11, v11, v69
    v_add_f32 v11, v11, v70
    v_add_f32 v11, v11, v71
    v_add_f32 v12, v12, v77
    v_add_f32 v12, v12, v78
    v_mfma_f32_16x16x32_bf16 v[168:171], v[24:27], v[64:67], v[168:171]
    v_add_f32 v12, v12, v79
    v_max3_f32 v13, v80, v81, v82
    v_max3_f32 v13, v13, v83, v84
    v_max3_f32 v13, v13, v85, v86
    v_max3_f32 v13, v13, v87, v88
    v_mfma_f32_16x16x32_bf16 v[200:203], v[24:27], v[72:75], v[200:203]
    s_waitcnt vmcnt(4) lgkmcnt(0)
    s_barrier
    ds_read_b128 v[16:19], v1 offset:17408
    ds_read_b128 v[20:23], v1 offset:17472
    ds_read_b128 v[24:27], v1 offset:17536
    v_mfma_f32_16x16x32_bf16 v[172:175], v[28:31], v[64:67], v[172:175]
    v_max3_f32 v13, v13, v89, v90
    v_max3_f32 v13, v13, v91, v92
    v_max3_f32 v13, v13, v93, v94
    v_max_f32 v13, v13, v95
    v_cmp_lt_f32 vcc, s46, v13
    v_mfma_f32_16x16x32_bf16 v[204:207], v[28:31], v[72:75], v[204:207]
    s_add_u32 m0, s40, 104448
    ds_read_b128 v[28:31], v1 offset:17600
    buffer_load_dwordx4 v7, s[4:7], s32 offen nt lds
    s_add_u32 m0, s40, 104512
    s_nop 0
    buffer_load_dwordx4 v7, s[4:7], s32 offen offset:1024 nt lds
    v_mfma_f32_16x16x32_bf16 v[176:179], v[32:35], v[64:67], v[176:179]
    s_add_u32 s32, s32, 8192
    s_add_u32 m0, s39, 34816
    s_nop 0
    buffer_load_dwordx4 v8, s[8:11], s33 offen nt lds
    v_mfma_f32_16x16x32_bf16 v[208:211], v[32:35], v[72:75], v[208:211]
    ds_read_b128 v[32:35], v1 offset:21760
    v_mfma_f32_16x16x32_bf16 v[180:183], v[36:39], v[64:67], v[180:183]
    v_mfma_f32_16x16x32_bf16 v[212:215], v[36:39], v[72:75], v[212:215]
    ds_read_b128 v[36:39], v1 offset:21824
    v_mfma_f32_16x16x32_bf16 v[184:187], v[40:43], v[64:67], v[184:187]
    v_mfma_f32_16x16x32_bf16 v[216:219], v[40:43], v[72:75], v[216:219]
    ds_read_b128 v[40:43], v1 offset:21888
    v_mfma_f32_16x16x32_bf16 v[188:191], v[44:47], v[64:67], v[188:191]
    v_mfma_f32_16x16x32_bf16 v[220:223], v[44:47], v[72:75], v[220:223]
    ds_read_b128 v[44:47], v1 offset:21952
    s_cbranch_vccnz L_rare_t3
L_back_t3:
    s_waitcnt lgkmcnt(4)
    s_add_u32 m0, s39, 35616
    v_mfma_f32_16x16x32_bf16 v[64:67], v[16:19], v[96:99], v[48:51]
    buffer_load_dwordx4 v8, s[8:11], s33 offen offset:256 nt lds
    s_add_u32 s33, s33, 8192
    v_exp_f32 v80, v80
    v_mfma_f32_16x16x32_bf16 v[72:75], v[16:19], v[100:103], v[52:55]
    ds_read_b64_tr_b16 v[16:17], v5 offset:0
    ds_read_b64_tr_b16 v[18:19], v5 offset:512
    v_exp_f32 v81, v81
    v_mfma_f32_16x16x32_bf16 v[64:67], v[20:23], v[104:107], v[64:67]
    v_exp_f32 v82, v82
    v_add_f32 v11, v11, v80
    v_add_f32 v11, v11, v81
    v_cvt_pk_bf16_f32 v80, v80, v81
    v_mfma_f32_16x16x32_bf16 v[72:75], v[20:23], v[108:111], v[72:75]
    ds_read_b64_tr_b16 v[20:21], v5 offset:32
    ds_read_b64_tr_b16 v[22:23], v5 offset:544
    v_exp_f32 v83, v83
    v_mfma_f32_16x16x32_bf16 v[64:67], v[24:27], v[112:115], v[64:67]
    v_exp_f32 v84, v84
    v_add_f32 v11, v11, v82
    v_add_f32 v11, v11, v83
    v_cvt_pk_bf16_f32 v81, v82, v83
    v_mfma_f32_16x16x32_bf16 v[72:75], v[24:27], v[116:119], v[72:75]
    ds_read_b64_tr_b16 v[24:25], v5 offset:64
    ds_read_b64_tr_b16 v[26:27], v5 offset:576
    v_exp_f32 v85, v85
    v_mfma_f32_16x16x32_bf16 v[64:67], v[28:31], v[120:123], v[64:67]
    v_exp_f32 v86, v86
    v_cvt_pk_bf16_f32 v82, v84, v85
    v_exp_f32 v87, v87
    v_mfma_f32_16x16x32_bf16 v[72:75], v[28:31], v[124:127], v[72:75]
    ds_read_b64_tr_b16 v[28:29], v5 offset:96
    ds_read_b64_tr_b16 v[30:31], v5 offset:608
    v_add_f32 v11, v11, v84
    v_cvt_pk_bf16_f32 v83, v86, v87
    s_waitcnt lgkmcnt(8)
    v_mfma_f32_16x16x32_bf16 v[68:71], v[32:35], v[96:99], v[48:51]
    v_exp_f32 v88, v88
    v_exp_f32 v89, v89
    v_mfma_f32_16x16x32_bf16 v[76:79], v[32:35], v[100:103], v[52:55]
    ds_read_b64_tr_b16 v[32:33], v5 offset:128
    ds_read_b64_tr_b16 v[34:35], v5 offset:640
    v_exp_f32 v90, v90
    v_add_f32 v12, v12, v88
    v_mfma_f32_16x16x32_bf16 v[68:71], v[36:39], v[104:107], v[68:71]
    v_add_f32 v12, v12, v89
    v_cvt_pk_bf16_f32 v88, v88, v89
    v_exp_f32 v91, v91
    v_mfma_f32_16x16x32_bf16 v[76:79], v[36:39], v[108:111], v[76:79]
    ds_read_b64_tr_b16 v[36:37], v5 offset:160
    ds_read_b64_tr_b16 v[38:39], v5 offset:672
    v_exp_f32 v92, v92
    v_add_f32 v12, v12, v90
    v_mfma_f32_16x16x32_bf16 v[68:71], v[40:43], v[112:115], v[68:71]
    v_add_f32 v12, v12, v91
    v_cvt_pk_bf16_f32 v89, v90, v91
    v_exp_f32 v93, v93
    v_mfma_f32_16x16x32_bf16 v[76:79], v[40:43], v[116:119], v[76:79]
    ds_read_b64_tr_b16 v[40:41], v5 offset:192
    ds_read_b64_tr_b16 v[42:43], v5 offset:704
    v_exp_f32 v94, v94
    v_cvt_pk_bf16_f32 v90, v92, v93
    v_mfma_f32_16x16x32_bf16 v[68:71], v[44:47], v[120:123], v[68:71]
    v_exp_f32 v95, v95
    v_add_f32 v12, v12, v92
    v_cvt_pk_bf16_f32 v91, v94, v95
    v_mfma_f32_16x16x32_bf16 v[76:79], v[44:47], v[124:127], v[76:79]
    ds_read_b64_tr_b16 v[44:45], v5 offset:224
    ds_read_b64_tr_b16 v[46:47], v5 offset:736
    s_waitcnt lgkmcnt(10)
    v_mfma_f32_16x16x32_bf16 v[160:163], v[16:19], v[80:83], v[160:163]
    v_mfma_f32_16x16x32_bf16 v[192:195], v[16:19], v[88:91], v[192:195]
    v_mfma_f32_16x16x32_bf16 v[164:167], v[20:23], v[80:83], v[164:167]
    v_mfma_f32_16x16x32_bf16 v[196:199], v[20:23], v[88:91], v[196:199]
    v_add_f32 v11, v11, v85
    v_add_f32 v11, v11, v86
    v_add_f32 v11, v11, v87
    v_add_f32 v12, v12, v93
    v_add_f32 v12, v12, v94
    v_mfma_f32_16x16x32_bf16 v[168:171], v[24:27], v[80:83], v[168:171]
    v_add_f32 v12, v12, v95
    v_max3_f32 v13, v64, v65, v66
    v_max3_f32 v13, v13, v67, v68
    v_max3_f32 v13, v13, v69, v70
    v_max3_f32 v13, v13, v71, v72
    v_mfma_f32_16x16x32_bf16 v[200:203], v[24:27], v[88:91], v[200:203]
    s_waitcnt vmcnt(4) lgkmcnt(0)
    s_barrier
    ds_read_b128 v[16:19], v4 offset:8704
    ds_read_b128 v[20:23], v4 offset:8768
    ds_read_b128 v[24:27], v4 offset:8832
    v_mfma_f32_16x16x32_bf16 v[172:175], v[28:31], v[80:83], v[172:175]
    v_max3_f32 v13, v13, v73, v74
    v_max3_f32 v13, v13, v75, v76
    v_max3_f32 v13, v13, v77, v78
    v_max_f32 v13, v13, v79
    v_cmp_lt_f32 vcc, s46, v13
    v_mfma_f32_16x16x32_bf16 v[204:207], v[28:31], v[88:91], v[204:207]
    s_add_u32 m0, s40, 43520
    ds_read_b128 v[28:31], v4 offset:8896
    buffer_load_dwordx4 v7, s[4:7], s32 offen nt lds
    s_add_u32 m0, s40, 43584
    s_nop 0
    buffer_load_dwordx4 v7, s[4:7], s32 offen offset:1024 nt lds
    v_mfma_f32_16x16x32_bf16 v[176:179], v[32:35], v[80:83], v[176:179]
    s_add_u32 s32, s32, 8192
    s_add_u32 m0, s39, 60928
    s_nop 0
    buffer_load_dwordx4 v8, s[8:11], s33 offen nt lds
    s_add_u32 m0, s39, 61728
    s_nop 0
    buffer_load_dwordx4 v8, s[8:11], s33 offen offset:256 nt lds
    v_mfma_f32_16x16x32_bf16 v[208:211], v[32:35], v[88:91], v[208:211]
    ds_read_b128 v[32:35], v4 offset:13056
    v_mfma_f32_16x16x32_bf16 v[180:183], v[36:39], v[80:83], v[180:183]
    v_mfma_f32_16x16x32_bf16 v[212:215], v[36:39], v[88:91], v[212:215]
    ds_read_b128 v[36:39], v4 offset:13120
    v_mfma_f32_16x16x32_bf16 v[184:187], v[40:43], v[80:83], v[184:187]
    v_mfma_f32_16x16x32_bf16 v[216:219], v[40:43], v[88:91], v[216:219]
    ds_read_b128 v[40:43], v4 offset:13184
    v_mfma_f32_16x16x32_bf16 v[188:191], v[44:47], v[80:83], v[188:191]
    v_mfma_f32_16x16x32_bf16 v[220:223], v[44:47], v[88:91], v[220:223]
    ds_read_b128 v[44:47], v4 offset:13248
    s_cbranch_vccnz L_rare_t4
L_back_t4:
    s_waitcnt lgkmcnt(4)
    v_mfma_f32_16x16x32_bf16 v[80:83], v[16:19], v[96:99], v[48:51]
    s_add_u32 m0, s40, 69632
    s_add_u32 s33, s33, 8192
    buffer_load_dwordx4 v7, s[4:7], s32 offen nt lds
    v_exp_f32 v64, v64
    v_mfma_f32_16x16x32_bf16 v[88:91], v[16:19], v[100:103], v[52:55]
    ds_read_b64_tr_b16 v[16:17], v5 offset:26112
    ds_read_b64_tr_b16 v[18:19], v5 offset:26624
    v_exp_f32 v65, v65
    v_mfma_f32_16x16x32_bf16 v[80:83], v[20:23], v[104:107], v[80:83]
    v_exp_f32 v66, v66
    v_add_f32 v11, v11, v64
    v_add_f32 v11, v11, v65
    v_cvt_pk_bf16_f32 v64, v64, v65
    v_mfma_f32_16x16x32_bf16 v[88:91], v[20:23], v[108:111], v[88:91]
    ds_read_b64_tr_b16 v[20:21], v5 offset:26144
    ds_read_b64_tr_b16 v[22:23], v5 offset:26656
    v_exp_f32 v67, v67
    v_mfma_f32_16x16x32_bf16 v[80:83], v[24:27], v[112:115], v[80:83]
    v_exp_f32 v68, v68
    v_add_f32 v11, v11, v66
    v_add_f32 v11, v11, v67
    v_cvt_pk_bf16_f32 v65, v66, v67
    v_mfma_f32_16x16x32_bf16 v[88:91], v[24:27], v[116:119], v[88:91]
    ds_read_b64_tr_b16 v[24:25], v5 offset:26176
    ds_read_b64_tr_b16 v[26:27], v5 offset:26688
    v_exp_f32 v69, v69
    v_mfma_f32_16x16x32_bf16 v[80:83], v[28:31], v[120:123], v[80:83]
    v_exp_f32 v70, v70
    v_cvt_pk_bf16_f32 v66, v68, v69
    v_exp_f32 v71, v71
    v_add_f32 v11, v11, v68
    v_mfma_f32_16x16x32_bf16 v[88:91], v[28:31], v[124:127], v[88:91]
    ds_read_b64_tr_b16 v[28:29], v5 offset:26208
    ds_read_b64_tr_b16 v[30:31], v5 offset:26720
    v_cvt_pk_bf16_f32 v67, v70, v71
    s_waitcnt lgkmcnt(8)
    s_add_u32 m0, s40, 69696
    v_mfma_f32_16x16x32_bf16 v[84:87], v[32:35], v[96:99], v[48:51]
    buffer_load_dwordx4 v7, s[4:7], s32 offen offset:1024 nt lds
    s_add_u32 s32, s32, 8192
    v_exp_f32 v72, v72
    v_exp_f32 v73, v73
    v_mfma_f32_16x16x32_bf16 v[92:95], v[32:35], v[100:103], v[52:55]
    ds_read_b64_tr_b16 v[32:33], v5 offset:26240
    ds_read_b64_tr_b16 v[34:35], v5 offset:26752
    v_exp_f32 v74, v74
    v_mfma_f32_16x16x32_bf16 v[84:87], v[36:39], v[104:107], v[84:87]
    v_add_f32 v12, v12, v72
    v_add_f32 v12, v12, v73
    v_cvt_pk_bf16_f32 v72, v72, v73
    v_exp_f32 v75, v75
    v_mfma_f32_16x16x32_bf16 v[92:95], v[36:39], v[108:111], v[92:95]
    ds_read_b64_tr_b16 v[36:37], v5 offset:26272
    ds_read_b64_tr_b16 v[38:39], v5 offset:26784
    v_exp_f32 v76, v76
    v_mfma_f32_16x16x32_bf16 v[84:87], v[40:43], v[112:115], v[84:87]
    v_add_f32 v12, v12, v74
    v_add_f32 v12, v12, v75
    v_cvt_pk_bf16_f32 v73, v74, v75
    v_exp_f32 v77, v77
    v_mfma_f32_16x16x32_bf16 v[92:95], v[40:43], v[116:119], v[92:95]
    ds_read_b64_tr_b16 v[40:41], v5 offset:26304
    ds_read_b64_tr_b16 v[42:43], v5 offset:26816
    v_exp_f32 v78, v78
    v_mfma_f32_16x16x32_bf16 v[84:87], v[44:47], v[120:123], v[84:87]
    v_cvt_pk_bf16_f32 v74, v76, v77
    v_exp_f32 v79, v79
    v_add_f32 v12, v12, v76
    v_cvt_pk_bf16_f32 v75, v78, v79
    v_mfma_f32_16x16x32_bf16 v[92:95], v[44:47], v[124:127], v[92:95]
    ds_read_b64_tr_b16 v[44:45], v5 offset:26336
    ds_read_b64_tr_b16 v[46:47], v5 offset:26848
    s_waitcnt lgkmcnt(10)
    v_mfma_f32_16x16x32_bf16 v[160:163], v[16:19], v[64:67], v[160:163]
    v_mfma_f32_16x16x32_bf16 v[192:195], v[16:19], v[72:75], v[192:195]
    v_mfma_f32_16x16x32_bf16 v[164:167], v[20:23], v[64:67], v[164:167]
    v_mfma_f32_16x16x32_bf16 v[196:199], v[20:23], v[72:75], v[196:199]
    v_add_f32 v11, v11, v69
    v_add_f32 v11, v11, v70
    v_add_f32 v11, v11, v71
    v_add_f32 v12, v12, v77
    v_add_f32 v12, v12, v78
    v_add_f32 v12, v12, v79
    v_mfma_f32_16x16x32_bf16 v[168:171], v[24:27], v[64:67], v[168:171]
    v_max3_f32 v13, v80, v81, v82
    v_max3_f32 v13, v13, v83, v84
    v_max3_f32 v13, v13, v85, v86
    v_max3_f32 v13, v13, v87, v88
    v_mfma_f32_16x16x32_bf16 v[200:203], v[24:27], v[72:75], v[200:203]
    s_waitcnt vmcnt(6) lgkmcnt(0)
    s_barrier
    ds_read_b128 v[16:19], v4 offset:34816
    ds_read_b128 v[20:23], v4 offset:34880
    ds_read_b128 v[24:27], v4 offset:34944
    v_max3_f32 v13, v13, v89, v90
    v_mfma_f32_16x16x32_bf16 v[172:175], v[28:31], v[64:67], v[172:175]
    v_max3_f32 v13, v13, v91, v92
    v_max3_f32 v13, v13, v93, v94
    v_max_f32 v13, v13, v95
    v_cmp_lt_f32 vcc, s46, v13
    v_mfma_f32_16x16x32_bf16 v[204:207], v[28:31], v[72:75], v[204:207]
    ds_read_b128 v[28:31], v4 offset:35008
    s_add_u32 m0, s39, 95744
    s_nop 0
    buffer_load_dwordx4 v8, s[8:11], s33 offen nt lds
    v_mfma_f32_16x16x32_bf16 v[176:179], v[32:35], v[64:67], v[176:179]
    v_mfma_f32_16x16x32_bf16 v[208:211], v[32:35], v[72:75], v[208:211]
    ds_read_b128 v[32:35], v4 offset:39168
    v_mfma_f32_16x16x32_bf16 v[180:183], v[36:39], v[64:67], v[180:183]
    v_mfma_f32_16x16x32_bf16 v[212:215], v[36:39], v[72:75], v[212:215]
    ds_read_b128 v[36:39], v4 offset:39232
    v_mfma_f32_16x16x32_bf16 v[184:187], v[40:43], v[64:67], v[184:187]
    v_mfma_f32_16x16x32_bf16 v[216:219], v[40:43], v[72:75], v[216:219]
    ds_read_b128 v[40:43], v4 offset:39296
    v_mfma_f32_16x16x32_bf16 v[188:191], v[44:47], v[64:67], v[188:191]
    v_mfma_f32_16x16x32_bf16 v[220:223], v[44:47], v[72:75], v[220:223]
    ds_read_b128 v[44:47], v4 offset:39360
    s_cbranch_vccnz L_rare_t5
L_back_t5:
    s_waitcnt lgkmcnt(4)
    s_add_u32 m0, s39, 96544
    v_mfma_f32_16x16x32_bf16 v[64:67], v[16:19], v[96:99], v[48:51]
    buffer_load_dwordx4 v8, s[8:11], s33 offen offset:256 nt lds
    s_add_u32 s33, s33, 8192
    v_exp_f32 v80, v80
    v_mfma_f32_16x16x32_bf16 v[72:75], v[16:19], v[100:103], v[52:55]
    ds_read_b64_tr_b16 v[16:17], v2 offset:8704
    ds_read_b64_tr_b16 v[18:19], v2 offset:9216
    v_exp_f32 v81, v81
    v_mfma_f32_16x16x32_bf16 v[64:67], v[20:23], v[104:107], v[64:67]
    v_exp_f32 v82, v82
    v_add_f32 v11, v11, v80
    v_add_f32 v11, v11, v81
    v_cvt_pk_bf16_f32 v80, v80, v81
    v_mfma_f32_16x16x32_bf16 v[72:75], v[20:23], v[108:111], v[72:75]
    ds_read_b64_tr_b16 v[20:21], v2 offset:8736
    ds_read_b64_tr_b16 v[22:23], v2 offset:9248
    v_exp_f32 v83, v83
    v_mfma_f32_16x16x32_bf16 v[64:67], v[24:27], v[112:115], v[64:67]
    v_exp_f32 v84, v84
    v_add_f32 v11, v11, v82
    v_add_f32 v11, v11, v83
    v_cvt_pk_bf16_f32 v81, v82, v83
    v_mfma_f32_16x16x32_bf16 v[72:75], v[24:27], v[116:119], v[72:75]
    ds_read_b64_tr_b16 v[24:25], v2 offset:8768
    ds_read_b64_tr_b16 v[26:27], v2 offset:9280
    v_exp_f32 v85, v85
    v_mfma_f32_16x16x32_bf16 v[64:67], v[28:31], v[120:123], v[64:67]
    v_exp_f32 v86, v86
    v_cvt_pk_bf16_f32 v82, v84, v85
    v_exp_f32 v87, v87
    v_mfma_f32_16x16x32_bf16 v[72:75], v[28:31], v[124:127], v[72:75]
    ds_read_b64_tr_b16 v[28:29], v2 offset:8800
    ds_read_b64_tr_b16 v[30:31], v2 offset:9312
    v_add_f32 v11, v11, v84
    v_cvt_pk_bf16_f32 v83, v86, v87
    s_waitcnt lgkmcnt(8)
    v_mfma_f32_16x16x32_bf16 v[68:71], v[32:35], v[96:99], v[48:51]
    v_exp_f32 v88, v88
    v_exp_f32 v89, v89
    v_mfma_f32_16x16x32_bf16 v[76:79], v[32:35], v[100:103], v[52:55]
    ds_read_b64_tr_b16 v[32:33], v2 offset:8832
    ds_read_b64_tr_b16 v[34:35], v2 offset:9344
    v_exp_f32 v90, v90
    v_add_f32 v12, v12, v88
    v_mfma_f32_16x16x32_bf16 v[68:71], v[36:39], v[104:107], v[68:71]
    v_add_f32 v12, v12, v89
    v_cvt_pk_bf16_f32 v88, v88, v89
    v_exp_f32 v91, v91
    v_mfma_f32_16x16x32_bf16 v[76:79], v[36:39], v[108:111], v[76:79]
    ds_read_b64_tr_b16 v[36:37], v2 offset:8864
    ds_read_b64_tr_b16 v[38:39], v2 offset:9376
    v_exp_f32 v92, v92
    v_add_f32 v12, v12, v90
    v_mfma_f32_16x16x32_bf16 v[68:71], v[40:43], v[112:115], v[68:71]
    v_add_f32 v12, v12, v91
    v_cvt_pk_bf16_f32 v89, v90, v91
    v_exp_f32 v93, v93
    v_mfma_f32_16x16x32_bf16 v[76:79], v[40:43], v[116:119], v[76:79]
    ds_read_b64_tr_b16 v[40:41], v2 offset:8896
    ds_read_b64_tr_b16 v[42:43], v2 offset:9408
    v_exp_f32 v94, v94
    v_cvt_pk_bf16_f32 v90, v92, v93
    v_mfma_f32_16x16x32_bf16 v[68:71], v[44:47], v[120:123], v[68:71]
    v_exp_f32 v95, v95
    v_add_f32 v12, v12, v92
    v_cvt_pk_bf16_f32 v91, v94, v95
    v_mfma_f32_16x16x32_bf16 v[76:79], v[44:47], v[124:127], v[76:79]
    ds_read_b64_tr_b16 v[44:45], v2 offset:8928
    ds_read_b64_tr_b16 v[46:47], v2 offset:9440
    s_waitcnt lgkmcnt(10)
    v_mfma_f32_16x16x32_bf16 v[160:163], v[16:19], v[80:83], v[160:163]
    v_mfma_f32_16x16x32_bf16 v[192:195], v[16:19], v[88:91], v[192:195]
    v_mfma_f32_16x16x32_bf16 v[164:167], v[20:23], v[80:83], v[164:167]
    v_mfma_f32_16x16x32_bf16 v[196:199], v[20:23], v[88:91], v[196:199]
    v_add_f32 v11, v11, v85
    v_add_f32 v11, v11, v86
    v_add_f32 v11, v11, v87
    v_add_f32 v12, v12, v93
    v_add_f32 v12, v12, v94
    v_mfma_f32_16x16x32_bf16 v[168:171], v[24:27], v[80:83], v[168:171]
    v_add_f32 v12, v12, v95
    v_max3_f32 v13, v64, v65, v66
    v_max3_f32 v13, v13, v67, v68
    v_max3_f32 v13, v13, v69, v70
    v_max3_f32 v13, v13, v71, v72
    v_mfma_f32_16x16x32_bf16 v[200:203], v[24:27], v[88:91], v[200:203]
    s_waitcnt vmcnt(4) lgkmcnt(0)
    s_barrier
    ds_read_b128 v[16:19], v1 offset:17408
    ds_read_b128 v[20:23], v1 offset:17472
    ds_read_b128 v[24:27], v1 offset:17536
    v_mfma_f32_16x16x32_bf16 v[172:175], v[28:31], v[80:83], v[172:175]
    v_max3_f32 v13, v13, v73, v74
    v_max3_f32 v13, v13, v75, v76
    v_max3_f32 v13, v13, v77, v78
    v_max_f32 v13, v13, v79
    v_cmp_lt_f32 vcc, s46, v13
    v_mfma_f32_16x16x32_bf16 v[204:207], v[28:31], v[88:91], v[204:207]
    s_add_u32 m0, s40, 104448
    ds_read_b128 v[28:31], v1 offset:17600
    buffer_load_dwordx4 v7, s[4:7], s32 offen nt lds
    s_add_u32 m0, s40, 104512
    s_nop 0
    buffer_load_dwordx4 v7, s[4:7], s32 offen offset:1024 nt lds
    v_mfma_f32_16x16x32_bf16 v[176:179], v[32:35], v[80:83], v[176:179]
    s_add_u32 s32, s32, 8192
    s_add_u32 m0, s39, 34816
    s_nop 0
    buffer_load_dwordx4 v8, s[8:11], s33 offen nt lds
    v_mfma_f32_16x16x32_bf16 v[208:211], v[32:35], v[88:91], v[208:211]
    ds_read_b128 v[32:35], v1 offset:21760
    v_mfma_f32_16x16x32_bf16 v[180:183], v[36:39], v[80:83], v[180:183]
    v_mfma_f32_16x16x32_bf16 v[212:215], v[36:39], v[88:91], v[212:215]
    ds_read_b128 v[36:39], v1 offset:21824
    v_mfma_f32_16x16x32_bf16 v[184:187], v[40:43], v[80:83], v[184:187]
    v_mfma_f32_16x16x32_bf16 v[216:219], v[40:43], v[88:91], v[216:219]
    ds_read_b128 v[40:43], v1 offset:21888
    v_mfma_f32_16x16x32_bf16 v[188:191], v[44:47], v[80:83], v[188:191]
    v_mfma_f32_16x16x32_bf16 v[220:223], v[44:47], v[88:91], v[220:223]
    ds_read_b128 v[44:47], v1 offset:21952
    s_cbranch_vccnz L_rare_t6
L_back_t6:
    s_waitcnt lgkmcnt(4)
    s_add_u32 m0, s39, 35616
    v_mfma_f32_16x16x32_bf16 v[80:83], v[16:19], v[96:99], v[48:51]
    buffer_load_dwordx4 v8, s[8:11], s33 offen offset:256 nt lds
    s_add_u32 s33, s33, 8192
    v_exp_f32 v64, v64
    v_mfma_f32_16x16x32_bf16 v[88:91], v[16:19], v[100:103], v[52:55]
    ds_read_b64_tr_b16 v[16:17], v2 offset:34816
    ds_read_b64_tr_b16 v[18:19], v2 offset:35328
    v_exp_f32 v65, v65
    v_mfma_f32_16x16x32_bf16 v[80:83], v[20:23], v[104:107], v[80:83]
    v_exp_f32 v66, v66
    v_add_f32 v11, v11, v64
    v_add_f32 v11, v11, v65
    v_cvt_pk_bf16_f32 v64, v64, v65
    v_mfma_f32_16x16x32_bf16 v[88:91], v[20:23], v[108:111], v[88:91]
    ds_read_b64_tr_b16 v[20:21], v2 offset:34848
    ds_read_b64_tr_b16 v[22:23], v2 offset:35360
    v_exp_f32 v67, v67
    v_mfma_f32_16x16x32_bf16 v[80:83], v[24:27], v[112:115], v[80:83]
    v_exp_f32 v68, v68
    v_add_f32 v11, v11, v66
    v_add_f32 v11, v11, v67
    v_cvt_pk_bf16_f32 v65, v66, v67
    v_mfma_f32_16x16x32_bf16 v[88:91], v[24:27], v[116:119], v[88:91]
    ds_read_b64_tr_b16 v[24:25], v2 offset:34880
    ds_read_b64_tr_b16 v[26:27], v2 offset:35392
    v_exp_f32 v69, v69
    v_mfma_f32_16x16x32_bf16 v[80:83], v[28:31], v[120:123], v[80:83]
    v_exp_f32 v70, v70
    v_cvt_pk_bf16_f32 v66, v68, v69
    v_exp_f32 v71, v71
    v_mfma_f32_16x16x32_bf16 v[88:91], v[28:31], v[124:127], v[88:91]
    ds_read_b64_tr_b16 v[28:29], v2 offset:34912
    ds_read_b64_tr_b16 v[30:31], v2 offset:35424
    v_add_f32 v11, v11, v68
    v_cvt_pk_bf16_f32 v67, v70, v71
    s_waitcnt lgkmcnt(8)
    v_mfma_f32_16x16x32_bf16 v[84:87], v[32:35], v[96:99], v[48:51]
    v_exp_f32 v72, v72
    v_exp_f32 v73, v73
    v_mfma_f32_16x16x32_bf16 v[92:95], v[32:35], v[100:103], v[52:55]
    ds_read_b64_tr_b16 v[32:33], v2 offset:34944
    ds_read_b64_tr_b16 v[34:35], v2 offset:35456
    v_exp_f32 v74, v74
    v_add_f32 v12, v12, v72
    v_mfma_f32_16x16x32_bf16 v[84:87], v[36:39], v[104:107], v[84:87]
    v_add_f32 v12, v12, v73
    v_cvt_pk_bf16_f32 v72, v72, v73
    v_exp_f32 v75, v75
    v_mfma_f32_16x16x32_bf16 v[92:95], v[36:39], v[108:111], v[92:95]
    ds_read_b64_tr_b16 v[36:37], v2 offset:34976
    ds_read_b64_tr_b16 v[38:39], v2 offset:35488
    v_exp_f32 v76, v76
    v_add_f32 v12, v12, v74
    v_mfma_f32_16x16x32_bf16 v[84:87], v[40:43], v[112:115], v[84:87]
    v_add_f32 v12, v12, v75
    v_cvt_pk_bf16_f32 v73, v74, v75
    v_exp_f32 v77, v77
    v_mfma_f32_16x16x32_bf16 v[92:95], v[40:43], v[116:119], v[92:95]
    ds_read_b64_tr_b16 v[40:41], v2 offset:35008
    ds_read_b64_tr_b16 v[42:43], v2 offset:35520
    v_exp_f32 v78, v78
    v_cvt_pk_bf16_f32 v74, v76, v77
    v_mfma_f32_16x16x32_bf16 v[84:87], v[44:47], v[120:123], v[84:87]
    v_exp_f32 v79, v79
    v_add_f32 v12, v12, v76
    v_cvt_pk_bf16_f32 v75, v78, v79
    v_mfma_f32_16x16x32_bf16 v[92:95], v[44:47], v[124:127], v[92:95]
    ds_read_b64_tr_b16 v[44:45], v2 offset:35040
    ds_read_b64_tr_b16 v[46:47], v2 offset:35552
    s_waitcnt lgkmcnt(10)
    v_mfma_f32_16x16x32_bf16 v[160:163], v[16:19], v[64:67], v[160:163]
    v_mfma_f32_16x16x32_bf16 v[192:195], v[16:19], v[72:75], v[192:195]
    v_mfma_f32_16x16x32_bf16 v[164:167], v[20:23], v[64:67], v[164:167]
    v_mfma_f32_16x16x32_bf16 v[196:199], v[20:23], v[72:75], v[196:199]
    v_add_f32 v11, v11, v69
    v_add_f32 v11, v11, v70
    v_add_f32 v11, v11, v71
    v_add_f32 v12, v12, v77
    v_add_f32 v12, v12, v78
    v_mfma_f32_16x16x32_bf16 v[168:171], v[24:27], v[64:67], v[168:171]
    v_add_f32 v12, v12, v79
    v_max3_f32 v13, v80, v81, v82
    v_max3_f32 v13, v13, v83, v84
    v_max3_f32 v13, v13, v85, v86
    v_max3_f32 v13, v13, v87, v88
    v_mfma_f32_16x16x32_bf16 v[200:203], v[24:27], v[72:75], v[200:203]
    s_waitcnt vmcnt(4) lgkmcnt(0)
    s_barrier
    ds_read_b128 v[16:19], v4 offset:0
    ds_read_b128 v[20:23], v4 offset:64
    ds_read_b128 v[24:27], v4 offset:128
    v_mfma_f32_16x16x32_bf16 v[172:175], v[28:31], v[64:67], v[172:175]
    v_max3_f32 v13, v13, v89, v90
    v_max3_f32 v13, v13, v91, v92
    v_max3_f32 v13, v13, v93, v94
    v_max_f32 v13, v13, v95
    v_cmp_lt_f32 vcc, s46, v13
    v_mfma_f32_16x16x32_bf16 v[204:207], v[28:31], v[72:75], v[204:207]
    s_add_u32 m0, s40, 43520
    ds_read_b128 v[28:31], v4 offset:192
    buffer_load_dwordx4 v7, s[4:7], s32 offen nt lds
    s_add_u32 m0, s40, 43584
    s_nop 0
    buffer_load_dwordx4 v7, s[4:7], s32 offen offset:1024 nt lds
    v_mfma_f32_16x16x32_bf16 v[176:179], v[32:35], v[64:67], v[176:179]
    s_add_u32 s32, s32, 8192
    s_add_u32 m0, s39, 60928
    s_nop 0
    buffer_load_dwordx4 v8, s[8:11], s33 offen nt lds
    v_mfma_f32_16x16x32_bf16 v[208:211], v[32:35], v[72:75], v[208:211]
    ds_read_b128 v[32:35], v4 offset:4352
    v_mfma_f32_16x16x32_bf16 v[180:183], v[36:39], v[64:67], v[180:183]
    v_mfma_f32_16x16x32_bf16 v[212:215], v[36:39], v[72:75], v[212:215]
    ds_read_b128 v[36:39], v4 offset:4416
    v_mfma_f32_16x16x32_bf16 v[184:187], v[40:43], v[64:67], v[184:187]
    v_mfma_f32_16x16x32_bf16 v[216:219], v[40:43], v[72:75], v[216:219]
    ds_read_b128 v[40:43], v4 offset:4480
    v_mfma_f32_16x16x32_bf16 v[188:191], v[44:47], v[64:67], v[188:191]
    v_mfma_f32_16x16x32_bf16 v[220:223], v[44:47], v[72:75], v[220:223]
    ds_read_b128 v[44:47], v4 offset:4544
    s_cbranch_vccnz L_rare_t7
L_back_t7:
    s_waitcnt lgkmcnt(4)
    s_add_u32 m0, s39, 61728
    v_mfma_f32_16x16x32_bf16 v[64:67], v[16:19], v[96:99], v[48:51]
    buffer_load_dwordx4 v8, s[8:11], s33 offen offset:256 nt lds
    s_add_u32 s33, s33, 8192
    v_exp_f32 v80, v80
    v_mfma_f32_16x16x32_bf16 v[72:75], v[16:19], v[100:103], v[52:55]
    ds_read_b64_tr_b16 v[16:17], v5 offset:26112
    ds_read_b64_tr_b16 v[18:19], v5 offset:26624
    v_exp_f32 v81, v81
    v_mfma_f32_16x16x32_bf16 v[64:67], v[20:23], v[104:107], v[64:67]
    v_exp_f32 v82, v82
    v_add_f32 v11, v11, v80
    v_add_f32 v11, v11, v81
    v_cvt_pk_bf16_f32 v80, v80, v81
    v_mfma_f32_16x16x32_bf16 v[72:75], v[20:23], v[108:111], v[72:75]
    ds_read_b64_tr_b16 v[20:21], v5 offset:26144
    ds_read_b64_tr_b16 v[22:23], v5 offset:26656
    v_exp_f32 v83, v83
    v_mfma_f32_16x16x32_bf16 v[64:67], v[24:27], v[112:115], v[64:67]
    v_exp_f32 v84, v84
    v_add_f32 v11, v11, v82
    v_add_f32 v11, v11, v83
    v_cvt_pk_bf16_f32 v81, v82, v83
    v_mfma_f32_16x16x32_bf16 v[72:75], v[24:27], v[116:119], v[72:75]
    ds_read_b64_tr_b16 v[24:25], v5 offset:26176
    ds_read_b64_tr_b16 v[26:27], v5 offset:26688
    v_exp_f32 v85, v85
    v_mfma_f32_16x16x32_bf16 v[64:67], v[28:31], v[120:123], v[64:67]
    v_exp_f32 v86, v86
    v_cvt_pk_bf16_f32 v82, v84, v85
    v_exp_f32 v87, v87
    v_mfma_f32_16x16x32_bf16 v[72:75], v[28:31], v[124:127], v[72:75]
    ds_read_b64_tr_b16 v[28:29], v5 offset:26208
    ds_read_b64_tr_b16 v[30:31], v5 offset:26720
    v_add_f32 v11, v11, v84
    v_cvt_pk_bf16_f32 v83, v86, v87
    s_waitcnt lgkmcnt(8)
    v_mfma_f32_16x16x32_bf16 v[68:71], v[32:35], v[96:99], v[48:51]
    v_exp_f32 v88, v88
    v_exp_f32 v89, v89
    v_mfma_f32_16x16x32_bf16 v[76:79], v[32:35], v[100:103], v[52:55]
    ds_read_b64_tr_b16 v[32:33], v5 offset:26240
    ds_read_b64_tr_b16 v[34:35], v5 offset:26752
    v_exp_f32 v90, v90
    v_add_f32 v12, v12, v88
    v_mfma_f32_16x16x32_bf16 v[68:71], v[36:39], v[104:107], v[68:71]
    v_add_f32 v12, v12, v89
    v_cvt_pk_bf16_f32 v88, v88, v89
    v_exp_f32 v91, v91
    v_mfma_f32_16x16x32_bf16 v[76:79], v[36:39], v[108:111], v[76:79]
    ds_read_b64_tr_b16 v[36:37], v5 offset:26272
    ds_read_b64_tr_b16 v[38:39], v5 offset:26784
    v_exp_f32 v92, v92
    v_add_f32 v12, v12, v90
    v_mfma_f32_16x16x32_bf16 v[68:71], v[40:43], v[112:115], v[68:71]
    v_add_f32 v12, v12, v91
    v_cvt_pk_bf16_f32 v89, v90, v91
    v_exp_f32 v93, v93
    v_mfma_f32_16x16x32_bf16 v[76:79], v[40:43], v[116:119], v[76:79]
    ds_read_b64_tr_b16 v[40:41], v5 offset:26304
    ds_read_b64_tr_b16 v[42:43], v5 offset:26816
    v_exp_f32 v94, v94
    v_cvt_pk_bf16_f32 v90, v92, v93
    v_mfma_f32_16x16x32_bf16 v[68:71], v[44:47], v[120:123], v[68:71]
    v_exp_f32 v95, v95
    v_add_f32 v12, v12, v92
    v_cvt_pk_bf16_f32 v91, v94, v95
    v_mfma_f32_16x16x32_bf16 v[76:79], v[44:47], v[124:127], v[76:79]
    ds_read_b64_tr_b16 v[44:45], v5 offset:26336
    ds_read_b64_tr_b16 v[46:47], v5 offset:26848
    s_waitcnt lgkmcnt(10)
    v_mfma_f32_16x16x32_bf16 v[160:163], v[16:19], v[80:83], v[160:163]
    v_mfma_f32_16x16x32_bf16 v[192:195], v[16:19], v[88:91], v[192:195]
    v_mfma_f32_16x16x32_bf16 v[164:167], v[20:23], v[80:83], v[164:167]
    v_mfma_f32_16x16x32_bf16 v[196:199], v[20:23], v[88:91], v[196:199]
    v_add_f32 v11, v11, v85
    v_add_f32 v11, v11, v86
    v_add_f32 v11, v11, v87
    v_add_f32 v12, v12, v93
    v_add_f32 v12, v12, v94
    v_mfma_f32_16x16x32_bf16 v[168:171], v[24:27], v[80:83], v[168:171]
    v_add_f32 v12, v12, v95
    v_max3_f32 v13, v64, v65, v66
    v_max3_f32 v13, v13, v67, v68
    v_max3_f32 v13, v13, v69, v70
    v_max3_f32 v13, v13, v71, v72
    v_mfma_f32_16x16x32_bf16 v[200:203], v[24:27], v[88:91], v[200:203]
    s_waitcnt vmcnt(4) lgkmcnt(0)
    s_barrier
    ds_read_b128 v[16:19], v4 offset:34816
    ds_read_b128 v[20:23], v4 offset:34880
    ds_read_b128 v[24:27], v4 offset:34944
    v_mfma_f32_16x16x32_bf16 v[172:175], v[28:31], v[80:83], v[172:175]
    v_max3_f32 v13, v13, v73, v74
    v_max3_f32 v13, v13, v75, v76
    v_max3_f32 v13, v13, v77, v78
    v_max_f32 v13, v13, v79
    v_cmp_lt_f32 vcc, s46, v13
    v_mfma_f32_16x16x32_bf16 v[204:207], v[28:31], v[88:91], v[204:207]
    s_add_u32 m0, s40, 69632
    ds_read_b128 v[28:31], v4 offset:35008
    buffer_load_dwordx4 v7, s[4:7], s32 offen nt lds
    s_add_u32 m0, s40, 69696
    s_nop 0
    buffer_load_dwordx4 v7, s[4:7], s32 offen offset:1024 nt lds
    v_mfma_f32_16x16x32_bf16 v[176:179], v[32:35], v[80:83], v[176:179]
    s_add_u32 s32, s32, 8192
    s_add_u32 m0, s39, 87040
    s_nop 0
    buffer_load_dwordx4 v8, s[8:11], s33 offen nt lds
    s_add_u32 m0, s39, 87840
    s_nop 0
    buffer_load_dwordx4 v8, s[8:11], s33 offen offset:256 nt lds
    v_mfma_f32_16x16x32_bf16 v[208:211], v[32:35], v[88:91], v[208:211]
    ds_read_b128 v[32:35], v4 offset:39168
    v_mfma_f32_16x16x32_bf16 v[180:183], v[36:39], v[80:83], v[180:183]
    v_mfma_f32_16x16x32_bf16 v[212:215], v[36:39], v[88:91], v[212:215]
    ds_read_b128 v[36:39], v4 offset:39232
    v_mfma_f32_16x16x32_bf16 v[184:187], v[40:43], v[80:83], v[184:187]
    v_mfma_f32_16x16x32_bf16 v[216:219], v[40:43], v[88:91], v[216:219]
    ds_read_b128 v[40:43], v4 offset:39296
    v_mfma_f32_16x16x32_bf16 v[188:191], v[44:47], v[80:83], v[188:191]
    v_mfma_f32_16x16x32_bf16 v[220:223], v[44:47], v[88:91], v[220:223]
    ds_read_b128 v[44:47], v4 offset:39360
    s_cbranch_vccnz L_rare_t8
L_back_t8:
    s_waitcnt lgkmcnt(4)
    v_mfma_f32_16x16x32_bf16 v[80:83], v[16:19], v[96:99], v[48:51]
    s_add_u32 m0, s40, 95744
    s_add_u32 s33, s33, 8192
    buffer_load_dwordx4 v7, s[4:7], s32 offen nt lds
    v_exp_f32 v64, v64
    v_mfma_f32_16x16x32_bf16 v[88:91], v[16:19], v[100:103], v[52:55]
    ds_read_b64_tr_b16 v[16:17], v2 offset:8704
    ds_read_b64_tr_b16 v[18:19], v2 offset:9216
    v_exp_f32 v65, v65
    v_mfma_f32_16x16x32_bf16 v[80:83], v[20:23], v[104:107], v[80:83]
    v_exp_f32 v66, v66
    v_add_f32 v11, v11, v64
    v_add_f32 v11, v11, v65
    v_cvt_pk_bf16_f32 v64, v64, v65
    v_mfma_f32_16x16x32_bf16 v[88:91], v[20:23], v[108:111], v[88:91]
    ds_read_b64_tr_b16 v[20:21], v2 offset:8736
    ds_read_b64_tr_b16 v[22:23], v2 offset:9248
    v_exp_f32 v67, v67
    v_mfma_f32_16x16x32_bf16 v[80:83], v[24:27], v[112:115], v[80:83]
    v_exp_f32 v68, v68
    v_add_f32 v11, v11, v66
    v_add_f32 v11, v11, v67
    v_cvt_pk_bf16_f32 v65, v66, v67
    v_mfma_f32_16x16x32_bf16 v[88:91], v[24:27], v[116:119], v[88:91]
    ds_read_b64_tr_b16 v[24:25], v2 offset:8768
    ds_read_b64_tr_b16 v[26:27], v2 offset:9280
    v_exp_f32 v69, v69
    v_mfma_f32_16x16x32_bf16 v[80:83], v[28:31], v[120:123], v[80:83]
    v_exp_f32 v70, v70
    v_cvt_pk_bf16_f32 v66, v68, v69
    v_exp_f32 v71, v71
    v_add_f32 v11, v11, v68
    v_mfma_f32_16x16x32_bf16 v[88:91], v[28:31], v[124:127], v[88:91]
    ds_read_b64_tr_b16 v[28:29], v2 offset:8800
    ds_read_b64_tr_b16 v[30:31], v2 offset:9312
    v_cvt_pk_bf16_f32 v67, v70, v71
    s_waitcnt lgkmcnt(8)
    s_add_u32 m0, s40, 95808
    v_mfma_f32_16x16x32_bf16 v[84:87], v[32:35], v[96:99], v[48:51]
    buffer_load_dwordx4 v7, s[4:7], s32 offen offset:1024 nt lds
    s_add_u32 s32, s32, 8192
    v_exp_f32 v72, v72
    v_exp_f32 v73, v73
    v_mfma_f32_16x16x32_bf16 v[92:95], v[32:35], v[100:103], v[52:55]
    ds_read_b64_tr_b16 v[32:33], v2 offset:8832
    ds_read_b64_tr_b16 v[34:35], v2 offset:9344
    v_exp_f32 v74, v74
    v_mfma_f32_16x16x32_bf16 v[84:87], v[36:39], v[104:107], v[84:87]
    v_add_f32 v12, v12, v72
    v_add_f32 v12, v12, v73
    v_cvt_pk_bf16_f32 v72, v72, v73
    v_exp_f32 v75, v75
    v_mfma_f32_16x16x32_bf16 v[92:95], v[36:39], v[108:111], v[92:95]
    ds_read_b64_tr_b16 v[36:37], v2 offset:8864
    ds_read_b64_tr_b16 v[38:39], v2 offset:9376
    v_exp_f32 v76, v76
    v_mfma_f32_16x16x32_bf16 v[84:87], v[40:43], v[112:115], v[84:87]
    v_add_f32 v12, v12, v74
    v_add_f32 v12, v12, v75
    v_cvt_pk_bf16_f32 v73, v74, v75
    v_exp_f32 v77, v77
    v_mfma_f32_16x16x32_bf16 v[92:95], v[40:43], v[116:119], v[92:95]
    ds_read_b64_tr_b16 v[40:41], v2 offset:8896
    ds_read_b64_tr_b16 v[42:43], v2 offset:9408
    v_exp_f32 v78, v78
    v_mfma_f32_16x16x32_bf16 v[84:87], v[44:47], v[120:123], v[84:87]
    v_cvt_pk_bf16_f32 v74, v76, v77
    v_exp_f32 v79, v79
    v_add_f32 v12, v12, v76
    v_cvt_pk_bf16_f32 v75, v78, v79
    v_mfma_f32_16x16x32_bf16 v[92:95], v[44:47], v[124:127], v[92:95]
    ds_read_b64_tr_b16 v[44:45], v2 offset:8928
    ds_read_b64_tr_b16 v[46:47], v2 offset:9440
    s_waitcnt lgkmcnt(10)
    v_mfma_f32_16x16x32_bf16 v[160:163], v[16:19], v[64:67], v[160:163]
    v_mfma_f32_16x16x32_bf16 v[192:195], v[16:19], v[72:75], v[192:195]
    v_mfma_f32_16x16x32_bf16 v[164:167], v[20:23], v[64:67], v[164:167]
    v_mfma_f32_16x16x32_bf16 v[196:199], v[20:23], v[72:75], v[196:199]
    v_add_f32 v11, v11, v69
    v_add_f32 v11, v11, v70
    v_add_f32 v11, v11, v71
    v_add_f32 v12, v12, v77
    v_add_f32 v12, v12, v78
    v_add_f32 v12, v12, v79
    v_mfma_f32_16x16x32_bf16 v[168:171], v[24:27], v[64:67], v[168:171]
    v_max3_f32 v13, v80, v81, v82
    v_max3_f32 v13, v13, v83, v84
    v_max3_f32 v13, v13, v85, v86
    v_max3_f32 v13, v13, v87, v88
    v_mfma_f32_16x16x32_bf16 v[200:203], v[24:27], v[72:75], v[200:203]
    s_waitcnt vmcnt(6) lgkmcnt(0)
    s_barrier
    ds_read_b128 v[16:19], v1 offset:17408
    ds_read_b128 v[20:23], v1 offset:17472
    ds_read_b128 v[24:27], v1 offset:17536
    v_max3_f32 v13, v13, v89, v90
    v_mfma_f32_16x16x32_bf16 v[172:175], v[28:31], v[64:67], v[172:175]
    v_max3_f32 v13, v13, v91, v92
    v_max3_f32 v13, v13, v93, v94
    v_max_f32 v13, v13, v95
    v_cmp_lt_f32 vcc, s46, v13
    v_mfma_f32_16x16x32_bf16 v[204:207], v[28:31], v[72:75], v[204:207]
    ds_read_b128 v[28:31], v1 offset:17600
    s_add_u32 m0, s39, 26112
    s_nop 0
    buffer_load_dwordx4 v8, s[8:11], s33 offen nt lds
    s_add_u32 m0, s39, 26912
    s_nop 0
    buffer_load_dwordx4 v8, s[8:11], s33 offen offset:256 nt lds
    v_mfma_f32_16x16x32_bf16 v[176:179], v[32:35], v[64:67], v[176:179]
    s_add_u32 m0, s40, 34816
    s_add_u32 s33, s33, 8192
    buffer_load_dwordx4 v7, s[4:7], s32 offen nt lds
    v_mfma_f32_16x16x32_bf16 v[208:211], v[32:35], v[72:75], v[208:211]
    ds_read_b128 v[32:35], v1 offset:21760
    v_mfma_f32_16x16x32_bf16 v[180:183], v[36:39], v[64:67], v[180:183]
    v_mfma_f32_16x16x32_bf16 v[212:215], v[36:39], v[72:75], v[212:215]
    ds_read_b128 v[36:39], v1 offset:21824
    v_mfma_f32_16x16x32_bf16 v[184:187], v[40:43], v[64:67], v[184:187]
    v_mfma_f32_16x16x32_bf16 v[216:219], v[40:43], v[72:75], v[216:219]
    ds_read_b128 v[40:43], v1 offset:21888
    v_mfma_f32_16x16x32_bf16 v[188:191], v[44:47], v[64:67], v[188:191]
    v_mfma_f32_16x16x32_bf16 v[220:223], v[44:47], v[72:75], v[220:223]
    ds_read_b128 v[44:47], v1 offset:21952
    s_cbranch_vccnz L_rare_t9
L_back_t9:
    s_waitcnt lgkmcnt(4)
    s_add_u32 m0, s40, 34880
    v_mfma_f32_16x16x32_bf16 v[64:67], v[16:19], v[96:99], v[48:51]
    buffer_load_dwordx4 v7, s[4:7], s32 offen offset:1024 nt lds
    s_add_u32 s32, s32, 8192
    v_exp_f32 v80, v80
    v_mfma_f32_16x16x32_bf16 v[72:75], v[16:19], v[100:103], v[52:55]
    ds_read_b64_tr_b16 v[16:17], v2 offset:34816
    ds_read_b64_tr_b16 v[18:19], v2 offset:35328
    v_exp_f32 v81, v81
    v_mfma_f32_16x16x32_bf16 v[64:67], v[20:23], v[104:107], v[64:67]
    v_exp_f32 v82, v82
    v_add_f32 v11, v11, v80
    v_add_f32 v11, v11, v81
    v_cvt_pk_bf16_f32 v80, v80, v81
    v_mfma_f32_16x16x32_bf16 v[72:75], v[20:23], v[108:111], v[72:75]
    ds_read_b64_tr_b16 v[20:21], v2 offset:34848
    ds_read_b64_tr_b16 v[22:23], v2 offset:35360
    v_exp_f32 v83, v83
    v_mfma_f32_16x16x32_bf16 v[64:67], v[24:27], v[112:115], v[64:67]
    v_exp_f32 v84, v84
    v_add_f32 v11, v11, v82
    v_add_f32 v11, v11, v83
    v_cvt_pk_bf16_f32 v81, v82, v83
    v_mfma_f32_16x16x32_bf16 v[72:75], v[24:27], v[116:119], v[72:75]
    ds_read_b64_tr_b16 v[24:25], v2 offset:34880
    ds_read_b64_tr_b16 v[26:27], v2 offset:35392
    v_exp_f32 v85, v85
    v_mfma_f32_16x16x32_bf16 v[64:67], v[28:31], v[120:123], v[64:67]
    v_exp_f32 v86, v86
    v_cvt_pk_bf16_f32 v82, v84, v85
    v_exp_f32 v87, v87
    v_mfma_f32_16x16x32_bf16 v[72:75], v[28:31], v[124:127], v[72:75]
    ds_read_b64_tr_b16 v[28:29], v2 offset:34912
    ds_read_b64_tr_b16 v[30:31], v2 offset:35424
    v_add_f32 v11, v11, v84
    v_cvt_pk_bf16_f32 v83, v86, v87
    s_waitcnt lgkmcnt(8)
    v_mfma_f32_16x16x32_bf16 v[68:71], v[32:35], v[96:99], v[48:51]
    v_exp_f32 v88, v88
    v_exp_f32 v89, v89
    v_mfma_f32_16x16x32_bf16 v[76:79], v[32:35], v[100:103], v[52:55]
    ds_read_b64_tr_b16 v[32:33], v2 offset:34944
    ds_read_b64_tr_b16 v[34:35], v2 offset:35456
    v_exp_f32 v90, v90
    v_add_f32 v12, v12, v88
    v_mfma_f32_16x16x32_bf16 v[68:71], v[36:39], v[104:107], v[68:71]
    v_add_f32 v12, v12, v89
    v_cvt_pk_bf16_f32 v88, v88, v89
    v_exp_f32 v91, v91
    v_mfma_f32_16x16x32_bf16 v[76:79], v[36:39], v[108:111], v[76:79]
    ds_read_b64_tr_b16 v[36:37], v2 offset:34976
    ds_read_b64_tr_b16 v[38:39], v2 offset:35488
    v_exp_f32 v92, v92
    v_add_f32 v12, v12, v90
    v_mfma_f32_16x16x32_bf16 v[68:71], v[40:43], v[112:115], v[68:71]
    v_add_f32 v12, v12, v91
    v_cvt_pk_bf16_f32 v89, v90, v91
    v_exp_f32 v93, v93
    v_mfma_f32_16x16x32_bf16 v[76:79], v[40:43], v[116:119], v[76:79]
    ds_read_b64_tr_b16 v[40:41], v2 offset:35008
    ds_read_b64_tr_b16 v[42:43], v2 offset:35520
    v_exp_f32 v94, v94
    v_cvt_pk_bf16_f32 v90, v92, v93
    v_mfma_f32_16x16x32_bf16 v[68:71], v[44:47], v[120:123], v[68:71]
    v_exp_f32 v95, v95
    v_add_f32 v12, v12, v92
    v_cvt_pk_bf16_f32 v91, v94, v95
    v_mfma_f32_16x16x32_bf16 v[76:79], v[44:47], v[124:127], v[76:79]
    ds_read_b64_tr_b16 v[44:45], v2 offset:35040
    ds_read_b64_tr_b16 v[46:47], v2 offset:35552
    s_waitcnt lgkmcnt(10)
    v_mfma_f32_16x16x32_bf16 v[160:163], v[16:19], v[80:83], v[160:163]
    v_mfma_f32_16x16x32_bf16 v[192:195], v[16:19], v[88:91], v[192:195]
    v_mfma_f32_16x16x32_bf16 v[164:167], v[20:23], v[80:83], v[164:167]
    v_mfma_f32_16x16x32_bf16 v[196:199], v[20:23], v[88:91], v[196:199]
    v_add_f32 v11, v11, v85
    v_add_f32 v11, v11, v86
    v_add_f32 v11, v11, v87
    v_add_f32 v12, v12, v93
    v_add_f32 v12, v12, v94
    v_mfma_f32_16x16x32_bf16 v[168:171], v[24:27], v[80:83], v[168:171]
    v_add_f32 v12, v12, v95
    v_max3_f32 v13, v64, v65, v66
    v_max3_f32 v13, v13, v67, v68
    v_max3_f32 v13, v13, v69, v70
    v_max3_f32 v13, v13, v71, v72
    v_mfma_f32_16x16x32_bf16 v[200:203], v[24:27], v[88:91], v[200:203]
    s_waitcnt vmcnt(6) lgkmcnt(0)
    s_barrier
    ds_read_b128 v[16:19], v4 offset:0
    ds_read_b128 v[20:23], v4 offset:64
    ds_read_b128 v[24:27], v4 offset:128
    v_mfma_f32_16x16x32_bf16 v[172:175], v[28:31], v[80:83], v[172:175]
    v_max3_f32 v13, v13, v73, v74
    v_max3_f32 v13, v13, v75, v76
    v_max3_f32 v13, v13, v77, v78
    v_max_f32 v13, v13, v79
    v_cmp_lt_f32 vcc, s46, v13
    v_mfma_f32_16x16x32_bf16 v[204:207], v[28:31], v[88:91], v[204:207]
    ds_read_b128 v[28:31], v4 offset:192
    s_add_u32 m0, s39, 52224
    s_nop 0
    buffer_load_dwordx4 v8, s[8:11], s33 offen nt lds
    s_add_u32 m0, s39, 53024
    s_nop 0
    buffer_load_dwordx4 v8, s[8:11], s33 offen offset:256 nt lds
    v_mfma_f32_16x16x32_bf16 v[176:179], v[32:35], v[80:83], v[176:179]
    s_add_u32 m0, s40, 60928
    s_add_u32 s33, s33, 8192
    buffer_load_dwordx4 v7, s[4:7], s32 offen nt lds
    v_mfma_f32_16x16x32_bf16 v[208:211], v[32:35], v[88:91], v[208:211]
    ds_read_b128 v[32:35], v4 offset:4352
    v_mfma_f32_16x16x32_bf16 v[180:183], v[36:39], v[80:83], v[180:183]
    v_mfma_f32_16x16x32_bf16 v[212:215], v[36:39], v[88:91], v[212:215]
    ds_read_b128 v[36:39], v4 offset:4416
    v_mfma_f32_16x16x32_bf16 v[184:187], v[40:43], v[80:83], v[184:187]
    v_mfma_f32_16x16x32_bf16 v[216:219], v[40:43], v[88:91], v[216:219]
    ds_read_b128 v[40:43], v4 offset:4480
    v_mfma_f32_16x16x32_bf16 v[188:191], v[44:47], v[80:83], v[188:191]
    v_mfma_f32_16x16x32_bf16 v[220:223], v[44:47], v[88:91], v[220:223]
    ds_read_b128 v[44:47], v4 offset:4544
    s_cbranch_vccnz L_rare_t10
L_back_t10:
    s_waitcnt lgkmcnt(4)
    s_add_u32 m0, s40, 60992
    v_mfma_f32_16x16x32_bf16 v[80:83], v[16:19], v[96:99], v[48:51]
    buffer_load_dwordx4 v7, s[4:7], s32 offen offset:1024 nt lds
    s_add_u32 s32, s32, 8192
    v_exp_f32 v64, v64
    v_mfma_f32_16x16x32_bf16 v[88:91], v[16:19], v[100:103], v[52:55]
    ds_read_b64_tr_b16 v[16:17], v5 offset:17408
    ds_read_b64_tr_b16 v[18:19], v5 offset:17920
    v_exp_f32 v65, v65
    v_mfma_f32_16x16x32_bf16 v[80:83], v[20:23], v[104:107], v[80:83]
    v_exp_f32 v66, v66
    v_add_f32 v11, v11, v64
    v_add_f32 v11, v11, v65
    v_cvt_pk_bf16_f32 v64, v64, v65
    v_mfma_f32_16x16x32_bf16 v[88:91], v[20:23], v[108:111], v[88:91]
    ds_read_b64_tr_b16 v[20:21], v5 offset:17440
    ds_read_b64_tr_b16 v[22:23], v5 offset:17952
    v_exp_f32 v67, v67
    v_mfma_f32_16x16x32_bf16 v[80:83], v[24:27], v[112:115], v[80:83]
    v_exp_f32 v68, v68
    v_add_f32 v11, v11, v66
    v_add_f32 v11, v11, v67
    v_cvt_pk_bf16_f32 v65, v66, v67
    v_mfma_f32_16x16x32_bf16 v[88:91], v[24:27], v[116:119], v[88:91]
    ds_read_b64_tr_b16 v[24:25], v5 offset:17472
    ds_read_b64_tr_b16 v[26:27], v5 offset:17984
    v_exp_f32 v69, v69
    v_mfma_f32_16x16x32_bf16 v[80:83], v[28:31], v[120:123], v[80:83]
    v_exp_f32 v70, v70
    v_cvt_pk_bf16_f32 v66, v68, v69
    v_exp_f32 v71, v71
    v_mfma_f32_16x16x32_bf16 v[88:91], v[28:31], v[124:127], v[88:91]
    ds_read_b64_tr_b16 v[28:29], v5 offset:17504
    ds_read_b64_tr_b16 v[30:31], v5 offset:18016
    v_add_f32 v11, v11, v68
    v_cvt_pk_bf16_f32 v67, v70, v71
    s_waitcnt lgkmcnt(8)
    v_mfma_f32_16x16x32_bf16 v[84:87], v[32:35], v[96:99], v[48:51]
    v_exp_f32 v72, v72
    v_exp_f32 v73, v73
    v_mfma_f32_16x16x32_bf16 v[92:95], v[32:35], v[100:103], v[52:55]
    ds_read_b64_tr_b16 v[32:33], v5 offset:17536
    ds_read_b64_tr_b16 v[34:35], v5 offset:18048
    v_exp_f32 v74, v74
    v_add_f32 v12, v12, v72
    v_mfma_f32_16x16x32_bf16 v[84:87], v[36:39], v[104:107], v[84:87]
    v_add_f32 v12, v12, v73
    v_cvt_pk_bf16_f32 v72, v72, v73
    v_exp_f32 v75, v75
    v_mfma_f32_16x16x32_bf16 v[92:95], v[36:39], v[108:111], v[92:95]
    ds_read_b64_tr_b16 v[36:37], v5 offset:17568
    ds_read_b64_tr_b16 v[38:39], v5 offset:18080
    v_exp_f32 v76, v76
    v_add_f32 v12, v12, v74
    v_mfma_f32_16x16x32_bf16 v[84:87], v[40:43], v[112:115], v[84:87]
    v_add_f32 v12, v12, v75
    v_cvt_pk_bf16_f32 v73, v74, v75
    v_exp_f32 v77, v77
    v_mfma_f32_16x16x32_bf16 v[92:95], v[40:43], v[116:119], v[92:95]
    ds_read_b64_tr_b16 v[40:41], v5 offset:17600
    ds_read_b64_tr_b16 v[42:43], v5 offset:18112
    v_exp_f32 v78, v78
    v_cvt_pk_bf16_f32 v74, v76, v77
    v_mfma_f32_16x16x32_bf16 v[84:87], v[44:47], v[120:123], v[84:87]
    v_exp_f32 v79, v79
    v_add_f32 v12, v12, v76
    v_cvt_pk_bf16_f32 v75, v78, v79
    v_mfma_f32_16x16x32_bf16 v[92:95], v[44:47], v[124:127], v[92:95]
    ds_read_b64_tr_b16 v[44:45], v5 offset:17632
    ds_read_b64_tr_b16 v[46:47], v5 offset:18144
    s_waitcnt lgkmcnt(10)
    v_mfma_f32_16x16x32_bf16 v[160:163], v[16:19], v[64:67], v[160:163]
    v_mfma_f32_16x16x32_bf16 v[192:195], v[16:19], v[72:75], v[192:195]
    v_mfma_f32_16x16x32_bf16 v[164:167], v[20:23], v[64:67], v[164:167]
    v_mfma_f32_16x16x32_bf16 v[196:199], v[20:23], v[72:75], v[196:199]
    v_add_f32 v11, v11, v69
    v_add_f32 v11, v11, v70
    v_add_f32 v11, v11, v71
    v_add_f32 v12, v12, v77
    v_add_f32 v12, v12, v78
    v_mfma_f32_16x16x32_bf16 v[168:171], v[24:27], v[64:67], v[168:171]
    v_add_f32 v12, v12, v79
    v_max3_f32 v13, v80, v81, v82
    v_max3_f32 v13, v13, v83, v84
    v_max3_f32 v13, v13, v85, v86
    v_max3_f32 v13, v13, v87, v88
    v_mfma_f32_16x16x32_bf16 v[200:203], v[24:27], v[72:75], v[200:203]
    s_waitcnt vmcnt(6) lgkmcnt(0)
    s_barrier
    ds_read_b128 v[16:19], v4 offset:26112
    ds_read_b128 v[20:23], v4 offset:26176
    ds_read_b128 v[24:27], v4 offset:26240
    v_mfma_f32_16x16x32_bf16 v[172:175], v[28:31], v[64:67], v[172:175]
    v_max3_f32 v13, v13, v89, v90
    v_max3_f32 v13, v13, v91, v92
    v_max3_f32 v13, v13, v93, v94
    v_max_f32 v13, v13, v95
    v_cmp_lt_f32 vcc, s46, v13
    v_mfma_f32_16x16x32_bf16 v[204:207], v[28:31], v[72:75], v[204:207]
    ds_read_b128 v[28:31], v4 offset:26304
    s_add_u32 m0, s39, 78336
    s_nop 0
    buffer_load_dwordx4 v8, s[8:11], s33 offen nt lds
    s_add_u32 m0, s39, 79136
    s_nop 0
    buffer_load_dwordx4 v8, s[8:11], s33 offen offset:256 nt lds
    v_mfma_f32_16x16x32_bf16 v[176:179], v[32:35], v[64:67], v[176:179]
    s_add_u32 m0, s40, 87040
    s_add_u32 s33, s33, 8192
    buffer_load_dwordx4 v7, s[4:7], s32 offen nt lds
    v_mfma_f32_16x16x32_bf16 v[208:211], v[32:35], v[72:75], v[208:211]
    ds_read_b128 v[32:35], v4 offset:30464
    v_mfma_f32_16x16x32_bf16 v[180:183], v[36:39], v[64:67], v[180:183]
    v_mfma_f32_16x16x32_bf16 v[212:215], v[36:39], v[72:75], v[212:215]
    ds_read_b128 v[36:39], v4 offset:30528
    v_mfma_f32_16x16x32_bf16 v[184:187], v[40:43], v[64:67], v[184:187]
    v_mfma_f32_16x16x32_bf16 v[216:219], v[40:43], v[72:75], v[216:219]
    ds_read_b128 v[40:43], v4 offset:30592
    v_mfma_f32_16x16x32_bf16 v[188:191], v[44:47], v[64:67], v[188:191]
    v_mfma_f32_16x16x32_bf16 v[220:223], v[44:47], v[72:75], v[220:223]
    ds_read_b128 v[44:47], v4 offset:30656
    s_cbranch_vccnz L_rare_t11
L_back_t11:
    s_waitcnt lgkmcnt(4)
    s_add_u32 m0, s40, 87104
    v_mfma_f32_16x16x32_bf16 v[64:67], v[16:19], v[96:99], v[48:51]
    buffer_load_dwordx4 v7, s[4:7], s32 offen offset:1024 nt lds
    s_add_u32 s32, s32, 8192
    v_exp_f32 v80, v80
    v_mfma_f32_16x16x32_bf16 v[72:75], v[16:19], v[100:103], v[52:55]
    ds_read_b64_tr_b16 v[16:17], v2 offset:0
    ds_read_b64_tr_b16 v[18:19], v2 offset:512
    v_exp_f32 v81, v81
    v_mfma_f32_16x16x32_bf16 v[64:67], v[20:23], v[104:107], v[64:67]
    v_exp_f32 v82, v82
    v_add_f32 v11, v11, v80
    v_add_f32 v11, v11, v81
    v_cvt_pk_bf16_f32 v80, v80, v81
    v_mfma_f32_16x16x32_bf16 v[72:75], v[20:23], v[108:111], v[72:75]
    ds_read_b64_tr_b16 v[20:21], v2 offset:32
    ds_read_b64_tr_b16 v[22:23], v2 offset:544
    v_exp_f32 v83, v83
    v_mfma_f32_16x16x32_bf16 v[64:67], v[24:27], v[112:115], v[64:67]
    v_exp_f32 v84, v84
    v_add_f32 v11, v11, v82
    v_add_f32 v11, v11, v83
    v_cvt_pk_bf16_f32 v81, v82, v83
    v_mfma_f32_16x16x32_bf16 v[72:75], v[24:27], v[116:119], v[72:75]
    ds_read_b64_tr_b16 v[24:25], v2 offset:64
    ds_read_b64_tr_b16 v[26:27], v2 offset:576
    v_exp_f32 v85, v85
    v_mfma_f32_16x16x32_bf16 v[64:67], v[28:31], v[120:123], v[64:67]
    v_exp_f32 v86, v86
    v_cvt_pk_bf16_f32 v82, v84, v85
    v_exp_f32 v87, v87
    v_mfma_f32_16x16x32_bf16 v[72:75], v[28:31], v[124:127], v[72:75]
    ds_read_b64_tr_b16 v[28:29], v2 offset:96
    ds_read_b64_tr_b16 v[30:31], v2 offset:608
    v_add_f32 v11, v11, v84
    v_cvt_pk_bf16_f32 v83, v86, v87
    s_waitcnt lgkmcnt(8)
    v_mfma_f32_16x16x32_bf16 v[68:71], v[32:35], v[96:99], v[48:51]
    v_exp_f32 v88, v88
    v_exp_f32 v89, v89
    v_mfma_f32_16x16x32_bf16 v[76:79], v[32:35], v[100:103], v[52:55]
    ds_read_b64_tr_b16 v[32:33], v2 offset:128
    ds_read_b64_tr_b16 v[34:35], v2 offset:640
    v_exp_f32 v90, v90
    v_add_f32 v12, v12, v88
    v_mfma_f32_16x16x32_bf16 v[68:71], v[36:39], v[104:107], v[68:71]
    v_add_f32 v12, v12, v89
    v_cvt_pk_bf16_f32 v88, v88, v89
    v_exp_f32 v91, v91
    v_mfma_f32_16x16x32_bf16 v[76:79], v[36:39], v[108:111], v[76:79]
    ds_read_b64_tr_b16 v[36:37], v2 offset:160
    ds_read_b64_tr_b16 v[38:39], v2 offset:672
    v_exp_f32 v92, v92
    v_add_f32 v12, v12, v90
    v_mfma_f32_16x16x32_bf16 v[68:71], v[40:43], v[112:115], v[68:71]
    v_add_f32 v12, v12, v91
    v_cvt_pk_bf16_f32 v89, v90, v91
    v_exp_f32 v93, v93
    v_mfma_f32_16x16x32_bf16 v[76:79], v[40:43], v[116:119], v[76:79]
    ds_read_b64_tr_b16 v[40:41], v2 offset:192
    ds_read_b64_tr_b16 v[42:43], v2 offset:704
    v_exp_f32 v94, v94
    v_cvt_pk_bf16_f32 v90, v92, v93
    v_mfma_f32_16x16x32_bf16 v[68:71], v[44:47], v[120:123], v[68:71]
    v_exp_f32 v95, v95
    v_add_f32 v12, v12, v92
    v_cvt_pk_bf16_f32 v91, v94, v95
    v_mfma_f32_16x16x32_bf16 v[76:79], v[44:47], v[124:127], v[76:79]
    ds_read_b64_tr_b16 v[44:45], v2 offset:224
    ds_read_b64_tr_b16 v[46:47], v2 offset:736
    s_waitcnt lgkmcnt(10)
    v_mfma_f32_16x16x32_bf16 v[160:163], v[16:19], v[80:83], v[160:163]
    v_mfma_f32_16x16x32_bf16 v[192:195], v[16:19], v[88:91], v[192:195]
    v_mfma_f32_16x16x32_bf16 v[164:167], v[20:23], v[80:83], v[164:167]
    v_mfma_f32_16x16x32_bf16 v[196:199], v[20:23], v[88:91], v[196:199]
    v_add_f32 v11, v11, v85
    v_add_f32 v11, v11, v86
    v_add_f32 v11, v11, v87
    v_add_f32 v12, v12, v93
    v_add_f32 v12, v12, v94
    v_mfma_f32_16x16x32_bf16 v[168:171], v[24:27], v[80:83], v[168:171]
    v_add_f32 v12, v12, v95
    v_max3_f32 v13, v64, v65, v66
    v_max3_f32 v13, v13, v67, v68
    v_max3_f32 v13, v13, v69, v70
    v_max3_f32 v13, v13, v71, v72
    v_mfma_f32_16x16x32_bf16 v[200:203], v[24:27], v[88:91], v[200:203]
    s_waitcnt vmcnt(6) lgkmcnt(0)
    s_barrier
    ds_read_b128 v[16:19], v1 offset:8704
    ds_read_b128 v[20:23], v1 offset:8768
    ds_read_b128 v[24:27], v1 offset:8832
    v_mfma_f32_16x16x32_bf16 v[172:175], v[28:31], v[80:83], v[172:175]
    v_max3_f32 v13, v13, v73, v74
    v_max3_f32 v13, v13, v75, v76
    v_max3_f32 v13, v13, v77, v78
    v_max_f32 v13, v13, v79
    v_cmp_lt_f32 vcc, s46, v13
    v_mfma_f32_16x16x32_bf16 v[204:207], v[28:31], v[88:91], v[204:207]
    ds_read_b128 v[28:31], v1 offset:8896
    s_add_u32 m0, s39, 104448
    s_nop 0
    buffer_load_dwordx4 v8, s[8:11], s33 offen nt lds
    s_add_u32 m0, s39, 105248
    s_nop 0
    buffer_load_dwordx4 v8, s[8:11], s33 offen offset:256 nt lds
    v_mfma_f32_16x16x32_bf16 v[176:179], v[32:35], v[80:83], v[176:179]
    s_add_u32 s33, s33, 8192
    s_lshl_b32 s48, s30, 2
    s_lshr_b32 s48, s41, s48
    s_and_b32 s48, s48, 3
    s_lshl_b32 s49, s44, 2
    v_mfma_f32_16x16x32_bf16 v[208:211], v[32:35], v[88:91], v[208:211]
    ds_read_b128 v[32:35], v1 offset:13056
    s_add_u32 s48, s48, s49
    s_lshl_b32 s49, s43, 5
    s_add_u32 s48, s48, s49
    s_lshl_b32 s74, s48, 17
    s_mov_b32 s32, s74
    v_mfma_f32_16x16x32_bf16 v[180:183], v[36:39], v[80:83], v[180:183]
    s_add_u32 m0, s40, 26112
    s_add_u32 s30, s30, 1
    buffer_load_dwordx4 v7, s[4:7], s32 offen nt lds
    v_mfma_f32_16x16x32_bf16 v[212:215], v[36:39], v[88:91], v[212:215]
    ds_read_b128 v[36:39], v1 offset:13120
    v_mfma_f32_16x16x32_bf16 v[184:187], v[40:43], v[80:83], v[184:187]
    v_mfma_f32_16x16x32_bf16 v[216:219], v[40:43], v[88:91], v[216:219]
    ds_read_b128 v[40:43], v1 offset:13184
    v_mfma_f32_16x16x32_bf16 v[188:191], v[44:47], v[80:83], v[188:191]
    v_mfma_f32_16x16x32_bf16 v[220:223], v[44:47], v[88:91], v[220:223]
    ds_read_b128 v[44:47], v1 offset:13248
    s_cbranch_vccnz L_rare_t12
L_back_t12:
    s_waitcnt lgkmcnt(4)
    s_add_u32 m0, s40, 26176
    v_mfma_f32_16x16x32_bf16 v[80:83], v[16:19], v[96:99], v[48:51]
    buffer_load_dwordx4 v7, s[4:7], s32 offen offset:1024 nt lds
    s_add_u32 s32, s32, 8192
    v_exp_f32 v64, v64
    v_mfma_f32_16x16x32_bf16 v[88:91], v[16:19], v[100:103], v[52:55]
    ds_read_b64_tr_b16 v[16:17], v2 offset:26112
    ds_read_b64_tr_b16 v[18:19], v2 offset:26624
    v_exp_f32 v65, v65
    v_mfma_f32_16x16x32_bf16 v[80:83], v[20:23], v[104:107], v[80:83]
    v_exp_f32 v66, v66
    v_add_f32 v11, v11, v64
    v_add_f32 v11, v11, v65
    v_cvt_pk_bf16_f32 v64, v64, v65
    v_mfma_f32_16x16x32_bf16 v[88:91], v[20:23], v[108:111], v[88:91]
    ds_read_b64_tr_b16 v[20:21], v2 offset:26144
    ds_read_b64_tr_b16 v[22:23], v2 offset:26656
    v_exp_f32 v67, v67
    v_mfma_f32_16x16x32_bf16 v[80:83], v[24:27], v[112:115], v[80:83]
    v_exp_f32 v68, v68
    v_add_f32 v11, v11, v66
    v_add_f32 v11, v11, v67
    v_cvt_pk_bf16_f32 v65, v66, v67
    v_mfma_f32_16x16x32_bf16 v[88:91], v[24:27], v[116:119], v[88:91]
    ds_read_b64_tr_b16 v[24:25], v2 offset:26176
    ds_read_b64_tr_b16 v[26:27], v2 offset:26688
    v_exp_f32 v69, v69
    v_mfma_f32_16x16x32_bf16 v[80:83], v[28:31], v[120:123], v[80:83]
    v_exp_f32 v70, v70
    v_cvt_pk_bf16_f32 v66, v68, v69
    v_exp_f32 v71, v71
    v_mfma_f32_16x16x32_bf16 v[88:91], v[28:31], v[124:127], v[88:91]
    ds_read_b64_tr_b16 v[28:29], v2 offset:26208
    ds_read_b64_tr_b16 v[30:31], v2 offset:26720
    v_add_f32 v11, v11, v68
    v_cvt_pk_bf16_f32 v67, v70, v71
    s_waitcnt lgkmcnt(8)
    v_mfma_f32_16x16x32_bf16 v[84:87], v[32:35], v[96:99], v[48:51]
    v_exp_f32 v72, v72
    v_exp_f32 v73, v73
    v_mfma_f32_16x16x32_bf16 v[92:95], v[32:35], v[100:103], v[52:55]
    ds_read_b64_tr_b16 v[32:33], v2 offset:26240
    ds_read_b64_tr_b16 v[34:35], v2 offset:26752
    v_exp_f32 v74, v74
    v_add_f32 v12, v12, v72
    v_mfma_f32_16x16x32_bf16 v[84:87], v[36:39], v[104:107], v[84:87]
    v_add_f32 v12, v12, v73
    v_cvt_pk_bf16_f32 v72, v72, v73
    v_exp_f32 v75, v75
    v_mfma_f32_16x16x32_bf16 v[92:95], v[36:39], v[108:111], v[92:95]
    ds_read_b64_tr_b16 v[36:37], v2 offset:26272
    ds_read_b64_tr_b16 v[38:39], v2 offset:26784
    v_exp_f32 v76, v76
    v_add_f32 v12, v12, v74
    v_mfma_f32_16x16x32_bf16 v[84:87], v[40:43], v[112:115], v[84:87]
    v_add_f32 v12, v12, v75
    v_cvt_pk_bf16_f32 v73, v74, v75
    v_exp_f32 v77, v77
    v_mfma_f32_16x16x32_bf16 v[92:95], v[40:43], v[116:119], v[92:95]
    ds_read_b64_tr_b16 v[40:41], v2 offset:26304
    ds_read_b64_tr_b16 v[42:43], v2 offset:26816
    v_exp_f32 v78, v78
    v_cvt_pk_bf16_f32 v74, v76, v77
    v_mfma_f32_16x16x32_bf16 v[84:87], v[44:47], v[120:123], v[84:87]
    v_exp_f32 v79, v79
    v_add_f32 v12, v12, v76
    v_cvt_pk_bf16_f32 v75, v78, v79
    v_mfma_f32_16x16x32_bf16 v[92:95], v[44:47], v[124:127], v[92:95]
    ds_read_b64_tr_b16 v[44:45], v2 offset:26336
    ds_read_b64_tr_b16 v[46:47], v2 offset:26848
    s_waitcnt lgkmcnt(10)
    v_mfma_f32_16x16x32_bf16 v[160:163], v[16:19], v[64:67], v[160:163]
    v_mfma_f32_16x16x32_bf16 v[192:195], v[16:19], v[72:75], v[192:195]
    v_mfma_f32_16x16x32_bf16 v[164:167], v[20:23], v[64:67], v[164:167]
    v_mfma_f32_16x16x32_bf16 v[196:199], v[20:23], v[72:75], v[196:199]
    v_add_f32 v11, v11, v69
    v_add_f32 v11, v11, v70
    v_add_f32 v11, v11, v71
    v_add_f32 v12, v12, v77
    v_add_f32 v12, v12, v78
    v_mfma_f32_16x16x32_bf16 v[168:171], v[24:27], v[64:67], v[168:171]
    v_add_f32 v12, v12, v79
    v_max3_f32 v13, v80, v81, v82
    v_max3_f32 v13, v13, v83, v84
    v_max3_f32 v13, v13, v85, v86
    v_max3_f32 v13, v13, v87, v88
    v_mfma_f32_16x16x32_bf16 v[200:203], v[24:27], v[72:75], v[200:203]
    s_waitcnt vmcnt(6) lgkmcnt(0)
    s_barrier
    ds_read_b128 v[16:19], v1 offset:34816
    ds_read_b128 v[20:23], v1 offset:34880
    ds_read_b128 v[24:27], v1 offset:34944
    v_mfma_f32_16x16x32_bf16 v[172:175], v[28:31], v[64:67], v[172:175]
    v_max3_f32 v13, v13, v89, v90
    v_max3_f32 v13, v13, v91, v92
    v_max3_f32 v13, v13, v93, v94
    v_max_f32 v13, v13, v95
    v_cmp_lt_f32 vcc, s46, v13
    v_mfma_f32_16x16x32_bf16 v[204:207], v[28:31], v[72:75], v[204:207]
    ds_read_b128 v[28:31], v1 offset:35008
    s_add_u32 m0, s39, 43520
    s_nop 0
    buffer_load_dwordx4 v8, s[8:11], s33 offen nt lds
    s_add_u32 m0, s39, 44320
    s_nop 0
    buffer_load_dwordx4 v8, s[8:11], s33 offen offset:256 nt lds
    v_mfma_f32_16x16x32_bf16 v[176:179], v[32:35], v[64:67], v[176:179]
    s_add_u32 m0, s40, 52224
    s_add_u32 s33, s33, 8192
    buffer_load_dwordx4 v7, s[4:7], s32 offen nt lds
    v_mfma_f32_16x16x32_bf16 v[208:211], v[32:35], v[72:75], v[208:211]
    ds_read_b128 v[32:35], v1 offset:39168
    v_mfma_f32_16x16x32_bf16 v[180:183], v[36:39], v[64:67], v[180:183]
    v_mfma_f32_16x16x32_bf16 v[212:215], v[36:39], v[72:75], v[212:215]
    ds_read_b128 v[36:39], v1 offset:39232
    v_mfma_f32_16x16x32_bf16 v[184:187], v[40:43], v[64:67], v[184:187]
    v_mfma_f32_16x16x32_bf16 v[216:219], v[40:43], v[72:75], v[216:219]
    ds_read_b128 v[40:43], v1 offset:39296
    v_mfma_f32_16x16x32_bf16 v[188:191], v[44:47], v[64:67], v[188:191]
    v_mfma_f32_16x16x32_bf16 v[220:223], v[44:47], v[72:75], v[220:223]
    ds_read_b128 v[44:47], v1 offset:39360
    s_cbranch_vccnz L_rare_t13
L_back_t13:
    s_waitcnt lgkmcnt(4)
    s_add_u32 m0, s40, 52288
    v_mfma_f32_16x16x32_bf16 v[64:67], v[16:19], v[96:99], v[48:51]
    buffer_load_dwordx4 v7, s[4:7], s32 offen offset:1024 nt lds
    s_add_u32 s32, s32, 8192
    v_exp_f32 v80, v80
    v_mfma_f32_16x16x32_bf16 v[72:75], v[16:19], v[100:103], v[52:55]
    ds_read_b64_tr_b16 v[16:17], v5 offset:8704
    ds_read_b64_tr_b16 v[18:19], v5 offset:9216
    v_exp_f32 v81, v81
    v_mfma_f32_16x16x32_bf16 v[64:67], v[20:23], v[104:107], v[64:67]
    v_exp_f32 v82, v82
    v_add_f32 v11, v11, v80
    v_add_f32 v11, v11, v81
    v_cvt_pk_bf16_f32 v80, v80, v81
    v_mfma_f32_16x16x32_bf16 v[72:75], v[20:23], v[108:111], v[72:75]
    ds_read_b64_tr_b16 v[20:21], v5 offset:8736
    ds_read_b64_tr_b16 v[22:23], v5 offset:9248
    v_exp_f32 v83, v83
    v_mfma_f32_16x16x32_bf16 v[64:67], v[24:27], v[112:115], v[64:67]
    v_exp_f32 v84, v84
    v_add_f32 v11, v11, v82
    v_add_f32 v11, v11, v83
    v_cvt_pk_bf16_f32 v81, v82, v83
    v_mfma_f32_16x16x32_bf16 v[72:75], v[24:27], v[116:119], v[72:75]
    ds_read_b64_tr_b16 v[24:25], v5 offset:8768
    ds_read_b64_tr_b16 v[26:27], v5 offset:9280
    v_exp_f32 v85, v85
    v_mfma_f32_16x16x32_bf16 v[64:67], v[28:31], v[120:123], v[64:67]
    v_exp_f32 v86, v86
    v_cvt_pk_bf16_f32 v82, v84, v85
    v_exp_f32 v87, v87
    v_mfma_f32_16x16x32_bf16 v[72:75], v[28:31], v[124:127], v[72:75]
    ds_read_b64_tr_b16 v[28:29], v5 offset:8800
    ds_read_b64_tr_b16 v[30:31], v5 offset:9312
    v_add_f32 v11, v11, v84
    v_cvt_pk_bf16_f32 v83, v86, v87
    s_waitcnt lgkmcnt(8)
    v_mfma_f32_16x16x32_bf16 v[68:71], v[32:35], v[96:99], v[48:51]
    v_exp_f32 v88, v88
    v_exp_f32 v89, v89
    v_mfma_f32_16x16x32_bf16 v[76:79], v[32:35], v[100:103], v[52:55]
    ds_read_b64_tr_b16 v[32:33], v5 offset:8832
    ds_read_b64_tr_b16 v[34:35], v5 offset:9344
    v_exp_f32 v90, v90
    v_add_f32 v12, v12, v88
    v_mfma_f32_16x16x32_bf16 v[68:71], v[36:39], v[104:107], v[68:71]
    v_add_f32 v12, v12, v89
    v_cvt_pk_bf16_f32 v88, v88, v89
    v_exp_f32 v91, v91
    v_mfma_f32_16x16x32_bf16 v[76:79], v[36:39], v[108:111], v[76:79]
    ds_read_b64_tr_b16 v[36:37], v5 offset:8864
    ds_read_b64_tr_b16 v[38:39], v5 offset:9376
    v_exp_f32 v92, v92
    v_add_f32 v12, v12, v90
    v_mfma_f32_16x16x32_bf16 v[68:71], v[40:43], v[112:115], v[68:71]
    v_add_f32 v12, v12, v91
    v_cvt_pk_bf16_f32 v89, v90, v91
    v_exp_f32 v93, v93
    v_mfma_f32_16x16x32_bf16 v[76:79], v[40:43], v[116:119], v[76:79]
    ds_read_b64_tr_b16 v[40:41], v5 offset:8896
    ds_read_b64_tr_b16 v[42:43], v5 offset:9408
    v_exp_f32 v94, v94
    v_cvt_pk_bf16_f32 v90, v92, v93
    v_mfma_f32_16x16x32_bf16 v[68:71], v[44:47], v[120:123], v[68:71]
    v_exp_f32 v95, v95
    v_add_f32 v12, v12, v92
    v_cvt_pk_bf16_f32 v91, v94, v95
    v_mfma_f32_16x16x32_bf16 v[76:79], v[44:47], v[124:127], v[76:79]
    ds_read_b64_tr_b16 v[44:45], v5 offset:8928
    ds_read_b64_tr_b16 v[46:47], v5 offset:9440
    s_waitcnt lgkmcnt(10)
    v_mfma_f32_16x16x32_bf16 v[160:163], v[16:19], v[80:83], v[160:163]
    v_mfma_f32_16x16x32_bf16 v[192:195], v[16:19], v[88:91], v[192:195]
    v_mfma_f32_16x16x32_bf16 v[164:167], v[20:23], v[80:83], v[164:167]
    v_mfma_f32_16x16x32_bf16 v[196:199], v[20:23], v[88:91], v[196:199]
    v_add_f32 v11, v11, v85
    v_add_f32 v11, v11, v86
    v_add_f32 v11, v11, v87
    v_add_f32 v12, v12, v93
    v_add_f32 v12, v12, v94
    v_mfma_f32_16x16x32_bf16 v[168:171], v[24:27], v[80:83], v[168:171]
    v_add_f32 v12, v12, v95
    v_max3_f32 v13, v64, v65, v66
    v_max3_f32 v13, v13, v67, v68
    v_max3_f32 v13, v13, v69, v70
    v_max3_f32 v13, v13, v71, v72
    v_mfma_f32_16x16x32_bf16 v[200:203], v[24:27], v[88:91], v[200:203]
    s_waitcnt vmcnt(6) lgkmcnt(0)
    s_barrier
    ds_read_b128 v[16:19], v4 offset:17408
    ds_read_b128 v[20:23], v4 offset:17472
    ds_read_b128 v[24:27], v4 offset:17536
    v_mfma_f32_16x16x32_bf16 v[172:175], v[28:31], v[80:83], v[172:175]
    v_max3_f32 v13, v13, v73, v74
    v_max3_f32 v13, v13, v75, v76
    v_max3_f32 v13, v13, v77, v78
    v_max_f32 v13, v13, v79
    v_cmp_lt_f32 vcc, s46, v13
    v_mfma_f32_16x16x32_bf16 v[204:207], v[28:31], v[88:91], v[204:207]
    ds_read_b128 v[28:31], v4 offset:17600
    s_add_u32 m0, s39, 69632
    s_mov_b32 s33, s74
    buffer_load_dwordx4 v8, s[8:11], s33 offen nt lds
    s_add_u32 m0, s39, 70432
    v_mfma_f32_16x16x32_bf16 v[176:179], v[32:35], v[80:83], v[176:179]
    buffer_load_dwordx4 v8, s[8:11], s33 offen offset:256 nt lds
    s_add_u32 m0, s40, 78336
    s_add_u32 s33, s33, 8192
    buffer_load_dwordx4 v7, s[4:7], s32 offen nt lds
    v_mfma_f32_16x16x32_bf16 v[208:211], v[32:35], v[88:91], v[208:211]
    ds_read_b128 v[32:35], v4 offset:21760
    v_mfma_f32_16x16x32_bf16 v[180:183], v[36:39], v[80:83], v[180:183]
    v_mfma_f32_16x16x32_bf16 v[212:215], v[36:39], v[88:91], v[212:215]
    ds_read_b128 v[36:39], v4 offset:21824
    v_mfma_f32_16x16x32_bf16 v[184:187], v[40:43], v[80:83], v[184:187]
    v_mfma_f32_16x16x32_bf16 v[216:219], v[40:43], v[88:91], v[216:219]
    ds_read_b128 v[40:43], v4 offset:21888
    v_mfma_f32_16x16x32_bf16 v[188:191], v[44:47], v[80:83], v[188:191]
    v_mfma_f32_16x16x32_bf16 v[220:223], v[44:47], v[88:91], v[220:223]
    ds_read_b128 v[44:47], v4 offset:21952
    s_cbranch_vccnz L_rare_t14
L_back_t14:
    s_waitcnt lgkmcnt(4)
    s_add_u32 m0, s40, 78400
    v_mfma_f32_16x16x32_bf16 v[80:83], v[16:19], v[96:99], v[48:51]
    buffer_load_dwordx4 v7, s[4:7], s32 offen offset:1024 nt lds
    s_add_u32 s32, s32, 8192
    v_exp_f32 v64, v64
    v_mfma_f32_16x16x32_bf16 v[88:91], v[16:19], v[100:103], v[52:55]
    ds_read_b64_tr_b16 v[16:17], v5 offset:34816
    ds_read_b64_tr_b16 v[18:19], v5 offset:35328
    v_exp_f32 v65, v65
    v_mfma_f32_16x16x32_bf16 v[80:83], v[20:23], v[104:107], v[80:83]
    v_exp_f32 v66, v66
    v_add_f32 v11, v11, v64
    v_add_f32 v11, v11, v65
    v_cvt_pk_bf16_f32 v64, v64, v65
    v_mfma_f32_16x16x32_bf16 v[88:91], v[20:23], v[108:111], v[88:91]
    ds_read_b64_tr_b16 v[20:21], v5 offset:34848
    ds_read_b64_tr_b16 v[22:23], v5 offset:35360
    v_exp_f32 v67, v67
    v_mfma_f32_16x16x32_bf16 v[80:83], v[24:27], v[112:115], v[80:83]
    v_exp_f32 v68, v68
    v_add_f32 v11, v11, v66
    v_add_f32 v11, v11, v67
    v_cvt_pk_bf16_f32 v65, v66, v67
    v_mfma_f32_16x16x32_bf16 v[88:91], v[24:27], v[116:119], v[88:91]
    ds_read_b64_tr_b16 v[24:25], v5 offset:34880
    ds_read_b64_tr_b16 v[26:27], v5 offset:35392
    v_exp_f32 v69, v69
    v_mfma_f32_16x16x32_bf16 v[80:83], v[28:31], v[120:123], v[80:83]
    v_exp_f32 v70, v70
    v_cvt_pk_bf16_f32 v66, v68, v69
    v_exp_f32 v71, v71
    v_mfma_f32_16x16x32_bf16 v[88:91], v[28:31], v[124:127], v[88:91]
    ds_read_b64_tr_b16 v[28:29], v5 offset:34912
    ds_read_b64_tr_b16 v[30:31], v5 offset:35424
    v_add_f32 v11, v11, v68
    v_cvt_pk_bf16_f32 v67, v70, v71
    s_waitcnt lgkmcnt(8)
    v_mfma_f32_16x16x32_bf16 v[84:87], v[32:35], v[96:99], v[48:51]
    v_exp_f32 v72, v72
    v_exp_f32 v73, v73
    v_mfma_f32_16x16x32_bf16 v[92:95], v[32:35], v[100:103], v[52:55]
    ds_read_b64_tr_b16 v[32:33], v5 offset:34944
    ds_read_b64_tr_b16 v[34:35], v5 offset:35456
    v_exp_f32 v74, v74
    v_add_f32 v12, v12, v72
    v_mfma_f32_16x16x32_bf16 v[84:87], v[36:39], v[104:107], v[84:87]
    v_add_f32 v12, v12, v73
    v_cvt_pk_bf16_f32 v72, v72, v73
    v_exp_f32 v75, v75
    v_mfma_f32_16x16x32_bf16 v[92:95], v[36:39], v[108:111], v[92:95]
    ds_read_b64_tr_b16 v[36:37], v5 offset:34976
    ds_read_b64_tr_b16 v[38:39], v5 offset:35488
    v_exp_f32 v76, v76
    v_add_f32 v12, v12, v74
    v_mfma_f32_16x16x32_bf16 v[84:87], v[40:43], v[112:115], v[84:87]
    v_add_f32 v12, v12, v75
    v_cvt_pk_bf16_f32 v73, v74, v75
    v_exp_f32 v77, v77
    v_mfma_f32_16x16x32_bf16 v[92:95], v[40:43], v[116:119], v[92:95]
    ds_read_b64_tr_b16 v[40:41], v5 offset:35008
    ds_read_b64_tr_b16 v[42:43], v5 offset:35520
    v_exp_f32 v78, v78
    v_cvt_pk_bf16_f32 v74, v76, v77
    v_mfma_f32_16x16x32_bf16 v[84:87], v[44:47], v[120:123], v[84:87]
    v_exp_f32 v79, v79
    v_add_f32 v12, v12, v76
    v_cvt_pk_bf16_f32 v75, v78, v79
    v_mfma_f32_16x16x32_bf16 v[92:95], v[44:47], v[124:127], v[92:95]
    ds_read_b64_tr_b16 v[44:45], v5 offset:35040
    ds_read_b64_tr_b16 v[46:47], v5 offset:35552
    s_waitcnt lgkmcnt(10)
    v_mfma_f32_16x16x32_bf16 v[160:163], v[16:19], v[64:67], v[160:163]
    v_mfma_f32_16x16x32_bf16 v[192:195], v[16:19], v[72:75], v[192:195]
    v_mfma_f32_16x16x32_bf16 v[164:167], v[20:23], v[64:67], v[164:167]
    v_mfma_f32_16x16x32_bf16 v[196:199], v[20:23], v[72:75], v[196:199]
    v_add_f32 v11, v11, v69
    v_add_f32 v11, v11, v70
    v_add_f32 v11, v11, v71
    v_add_f32 v12, v12, v77
    v_add_f32 v12, v12, v78
    v_mfma_f32_16x16x32_bf16 v[168:171], v[24:27], v[64:67], v[168:171]
    v_add_f32 v12, v12, v79
    v_max3_f32 v13, v80, v81, v82
    v_max3_f32 v13, v13, v83, v84
    v_max3_f32 v13, v13, v85, v86
    v_max3_f32 v13, v13, v87, v88
    v_mfma_f32_16x16x32_bf16 v[200:203], v[24:27], v[72:75], v[200:203]
    s_waitcnt vmcnt(6) lgkmcnt(0)
    s_barrier
    ds_read_b128 v[16:19], v1 offset:0
    ds_read_b128 v[96:99], v0 offset:0
    ds_read_b128 v[20:23], v1 offset:64
    ds_read_b128 v[100:103], v0 offset:1024
    v_mfma_f32_16x16x32_bf16 v[172:175], v[28:31], v[64:67], v[172:175]
    ds_read_b128 v[24:27], v1 offset:128
    ds_read_b128 v[104:107], v0 offset:2048
    v_max3_f32 v13, v13, v89, v90
    v_max3_f32 v13, v13, v91, v92
    v_mfma_f32_16x16x32_bf16 v[204:207], v[28:31], v[72:75], v[204:207]
    ds_read_b128 v[28:31], v1 offset:192
    ds_read_b128 v[108:111], v0 offset:3072
    v_max3_f32 v13, v13, v93, v94
    v_max_f32 v13, v13, v95
    v_mfma_f32_16x16x32_bf16 v[176:179], v[32:35], v[64:67], v[176:179]
    s_lshl_b32 s48, s73, 2
    v_cmp_lt_f32 vcc, s46, v13
    s_lshr_b32 s48, s41, s48
    s_and_b32 s48, s48, 3
    s_lshl_b32 s49, s44, 2
    v_mfma_f32_16x16x32_bf16 v[208:211], v[32:35], v[72:75], v[208:211]
    ds_read_b128 v[32:35], v1 offset:4352
    ds_read_b128 v[112:115], v0 offset:4096
    s_add_u32 s48, s48, s49
    s_mul_i32 s34, s48, 147456
    s_cmp_ge_i32 s73, 0
    s_cselect_b32 s14, 4718592, 0
    v_mfma_f32_16x16x32_bf16 v[180:183], v[36:39], v[64:67], v[180:183]
    s_add_u32 m0, s39, 87040
    s_add_u32 s73, s73, 1
    buffer_load_dwordx4 v9, s[12:15], s34 offen  lds
    s_add_u32 m0, s39, 86944
    s_nop 0
    buffer_load_dwordx4 v9, s[12:15], s34 offen offset:1152  lds
    v_mfma_f32_16x16x32_bf16 v[212:215], v[36:39], v[72:75], v[212:215]
    ds_read_b128 v[36:39], v1 offset:4416
    ds_read_b128 v[116:119], v0 offset:5120
    s_add_u32 m0, s39, 95744
    s_add_u32 s34, s34, 73728
    buffer_load_dwordx4 v8, s[8:11], s33 offen nt lds
    s_add_u32 m0, s39, 96544
    v_mfma_f32_16x16x32_bf16 v[184:187], v[40:43], v[64:67], v[184:187]
    buffer_load_dwordx4 v8, s[8:11], s33 offen offset:256 nt lds
    v_mfma_f32_16x16x32_bf16 v[216:219], v[40:43], v[72:75], v[216:219]
    ds_read_b128 v[40:43], v1 offset:4480
    ds_read_b128 v[120:123], v0 offset:6144
    v_mfma_f32_16x16x32_bf16 v[188:191], v[44:47], v[64:67], v[188:191]
    v_mfma_f32_16x16x32_bf16 v[220:223], v[44:47], v[72:75], v[220:223]
    ds_read_b128 v[44:47], v1 offset:4544
    ds_read_b128 v[124:127], v0 offset:7168
    s_cbranch_vccnz L_rare_t15
L_back_t15:
    s_waitcnt lgkmcnt(0)
    v_mfma_f32_16x16x32_bf16 v[64:67], v[16:19], v[96:99], 0
    s_add_u32 m0, s40, 104448
    s_add_u32 s33, s33, 8192
    buffer_load_dwordx4 v7, s[4:7], s32 offen nt lds
    v_exp_f32 v80, v80
    v_mfma_f32_16x16x32_bf16 v[72:75], v[16:19], v[100:103], 0
    ds_read_b64_tr_b16 v[16:17], v2 offset:17408
    ds_read_b64_tr_b16 v[18:19], v2 offset:17920
    v_exp_f32 v81, v81
    v_mfma_f32_16x16x32_bf16 v[64:67], v[20:23], v[104:107], v[64:67]
    v_exp_f32 v82, v82
    v_add_f32 v11, v11, v80
    v_add_f32 v11, v11, v81
    v_cvt_pk_bf16_f32 v80, v80, v81
    v_mfma_f32_16x16x32_bf16 v[72:75], v[20:23], v[108:111], v[72:75]
    ds_read_b64_tr_b16 v[20:21], v2 offset:17440
    ds_read_b64_tr_b16 v[22:23], v2 offset:17952
    v_exp_f32 v83, v83
    v_mfma_f32_16x16x32_bf16 v[64:67], v[24:27], v[112:115], v[64:67]
    v_exp_f32 v84, v84
    v_add_f32 v11, v11, v82
    v_add_f32 v11, v11, v83
    v_cvt_pk_bf16_f32 v81, v82, v83
    v_mfma_f32_16x16x32_bf16 v[72:75], v[24:27], v[116:119], v[72:75]
    ds_read_b64_tr_b16 v[24:25], v2 offset:17472
    ds_read_b64_tr_b16 v[26:27], v2 offset:17984
    v_exp_f32 v85, v85
    v_mfma_f32_16x16x32_bf16 v[64:67], v[28:31], v[120:123], v[64:67]
    v_exp_f32 v86, v86
    v_cvt_pk_bf16_f32 v82, v84, v85
    v_exp_f32 v87, v87
    v_add_f32 v11, v11, v84
    v_mfma_f32_16x16x32_bf16 v[72:75], v[28:31], v[124:127], v[72:75]
    ds_read_b64_tr_b16 v[28:29], v2 offset:17504
    ds_read_b64_tr_b16 v[30:31], v2 offset:18016
    v_cvt_pk_bf16_f32 v83, v86, v87
    s_nop 0
    s_add_u32 m0, s40, 104512
    v_mfma_f32_16x16x32_bf16 v[68:71], v[32:35], v[96:99], 0
    buffer_load_dwordx4 v7, s[4:7], s32 offen offset:1024 nt lds
    s_add_u32 s32, s32, 8192
    v_exp_f32 v88, v88
    v_exp_f32 v89, v89
    v_mfma_f32_16x16x32_bf16 v[76:79], v[32:35], v[100:103], 0
    ds_read_b64_tr_b16 v[32:33], v2 offset:17536
    ds_read_b64_tr_b16 v[34:35], v2 offset:18048
    v_exp_f32 v90, v90
    v_mfma_f32_16x16x32_bf16 v[68:71], v[36:39], v[104:107], v[68:71]
    v_add_f32 v12, v12, v88
    v_add_f32 v12, v12, v89
    v_cvt_pk_bf16_f32 v88, v88, v89
    v_exp_f32 v91, v91
    v_mfma_f32_16x16x32_bf16 v[76:79], v[36:39], v[108:111], v[76:79]
    ds_read_b64_tr_b16 v[36:37], v2 offset:17568
    ds_read_b64_tr_b16 v[38:39], v2 offset:18080
    v_exp_f32 v92, v92
    v_mfma_f32_16x16x32_bf16 v[68:71], v[40:43], v[112:115], v[68:71]
    v_add_f32 v12, v12, v90
    v_add_f32 v12, v12, v91
    v_cvt_pk_bf16_f32 v89, v90, v91
    v_exp_f32 v93, v93
    v_mfma_f32_16x16x32_bf16 v[76:79], v[40:43], v[116:119], v[76:79]
    ds_read_b64_tr_b16 v[40:41], v2 offset:17600
    ds_read_b64_tr_b16 v[42:43], v2 offset:18112
    v_exp_f32 v94, v94
    v_mfma_f32_16x16x32_bf16 v[68:71], v[44:47], v[120:123], v[68:71]
    v_cvt_pk_bf16_f32 v90, v92, v93
    v_exp_f32 v95, v95
    v_add_f32 v12, v12, v92
    v_cvt_pk_bf16_f32 v91, v94, v95
    v_mfma_f32_16x16x32_bf16 v[76:79], v[44:47], v[124:127], v[76:79]
    ds_read_b64_tr_b16 v[44:45], v2 offset:17632
    ds_read_b64_tr_b16 v[46:47], v2 offset:18144
    s_waitcnt lgkmcnt(10)
    v_mfma_f32_16x16x32_bf16 v[160:163], v[16:19], v[80:83], v[160:163]
    v_add_f32 v11, v11, v85
    v_add_f32 v11, v11, v86
    v_add_f32 v11, v11, v87
    v_add_f32 v12, v12, v93
    v_add_f32 v12, v12, v94
    v_add_f32 v12, v12, v95
    v_mfma_f32_16x16x32_bf16 v[192:195], v[16:19], v[88:91], v[192:195]
    v_mov_b32 v62, v11
    v_mov_b32 v63, v12
    s_nop 0
    v_permlane32_swap_b32 v62, v11
    v_mfma_f32_16x16x32_bf16 v[164:167], v[20:23], v[80:83], v[164:167]
    v_permlane32_swap_b32 v63, v12
    v_add_f32 v11, v11, v62
    v_add_f32 v12, v12, v63
    v_mov_b32 v62, v11
    v_mov_b32 v63, v12
    v_mfma_f32_16x16x32_bf16 v[196:199], v[20:23], v[88:91], v[196:199]
    s_nop 0
    v_permlane16_swap_b32 v62, v11
    v_permlane16_swap_b32 v63, v12
    v_add_f32 v11, v11, v62
    v_mfma_f32_16x16x32_bf16 v[168:171], v[24:27], v[80:83], v[168:171]
    v_add_f32 v12, v12, v63
    v_rcp_f32 v59, v11
    v_rcp_f32 v60, v12
    v_mfma_f32_16x16x32_bf16 v[200:203], v[24:27], v[88:91], v[200:203]
    s_waitcnt vmcnt(8) lgkmcnt(0)
    s_barrier
    ds_read_b128 v[16:19], v1 offset:26112
    ds_read_b128 v[20:23], v1 offset:26176
    ds_read_b128 v[24:27], v1 offset:26240
    v_mfma_f32_16x16x32_bf16 v[172:175], v[28:31], v[80:83], v[172:175]
    v_mov_b32 v11, 0
    v_mov_b32 v12, 0
    v_max3_f32 v56, v64, v65, v66
    v_max3_f32 v57, v72, v73, v74
    v_max3_f32 v56, v56, v67, v68
    v_mfma_f32_16x16x32_bf16 v[204:207], v[28:31], v[88:91], v[204:207]
    ds_read_b128 v[28:31], v1 offset:26304
    v_max3_f32 v57, v57, v75, v76
    v_max3_f32 v56, v56, v69, v70
    v_max3_f32 v57, v57, v77, v78
    v_mfma_f32_16x16x32_bf16 v[176:179], v[32:35], v[80:83], v[176:179]
    v_max_f32 v56, v56, v71
    v_max_f32 v57, v57, v79
    v_mov_b32 v10, v56
    v_mov_b32 v58, v57
    s_nop 0
    v_mfma_f32_16x16x32_bf16 v[208:211], v[32:35], v[88:91], v[208:211]
    ds_read_b128 v[32:35], v1 offset:30464
    v_permlane32_swap_b32 v10, v56
    v_permlane32_swap_b32 v58, v57
    v_max_f32 v56, v56, v10
    v_mfma_f32_16x16x32_bf16 v[180:183], v[36:39], v[80:83], v[180:183]
    s_add_u32 m0, s39, 26112
    v_max_f32 v57, v57, v58
    v_mov_b32 v10, v56
    buffer_load_dwordx4 v9, s[12:15], s34 offen  lds
    s_add_u32 m0, s39, 26016
    s_nop 0
    buffer_load_dwordx4 v9, s[12:15], s34 offen offset:1152  lds
    v_mfma_f32_16x16x32_bf16 v[212:215], v[36:39], v[88:91], v[212:215]
    ds_read_b128 v[36:39], v1 offset:30528
    s_add_u32 m0, s39, 34816
    s_sub_u32 s34, s34, 73600
    buffer_load_dwordx4 v8, s[8:11], s33 offen nt lds
    s_add_u32 m0, s39, 35616
    s_nop 0
    buffer_load_dwordx4 v8, s[8:11], s33 offen offset:256 nt lds
    v_mfma_f32_16x16x32_bf16 v[184:187], v[40:43], v[80:83], v[184:187]
    v_mfma_f32_16x16x32_bf16 v[216:219], v[40:43], v[88:91], v[216:219]
    ds_read_b128 v[40:43], v1 offset:30592
    v_mfma_f32_16x16x32_bf16 v[188:191], v[44:47], v[80:83], v[188:191]
    v_mfma_f32_16x16x32_bf16 v[220:223], v[44:47], v[88:91], v[220:223]
    ds_read_b128 v[44:47], v1 offset:30656
    v_mov_b32 v58, v57
    s_nop 0
    v_permlane16_swap_b32 v10, v56
    v_permlane16_swap_b32 v58, v57
    v_max_f32 v56, v56, v10
    v_max_f32 v57, v57, v58
    v_sub_f32 v48, 0, v56
    v_sub_f32 v49, 0, v56
    v_sub_f32 v50, 0, v56
    v_sub_f32 v51, 0, v56
    v_sub_f32 v52, 0, v57
    v_sub_f32 v53, 0, v57
    v_sub_f32 v54, 0, v57
    v_sub_f32 v55, 0, v57
    v_sub_f32 v64, v64, v56
    v_sub_f32 v65, v65, v56
    v_sub_f32 v66, v66, v56
    v_sub_f32 v67, v67, v56
    v_sub_f32 v68, v68, v56
    v_sub_f32 v69, v69, v56
    v_sub_f32 v70, v70, v56
    v_sub_f32 v71, v71, v56
    v_sub_f32 v72, v72, v57
    v_sub_f32 v73, v73, v57
    v_sub_f32 v74, v74, v57
    v_sub_f32 v75, v75, v57
    v_sub_f32 v76, v76, v57
    v_sub_f32 v77, v77, v57
    v_sub_f32 v78, v78, v57
    v_sub_f32 v79, v79, v57
    s_nop 0
    s_waitcnt lgkmcnt(4)
    v_mfma_f32_16x16x32_bf16 v[80:83], v[16:19], v[96:99], v[48:51]
    s_add_u32 m0, s40, 43520
    s_add_u32 s33, s33, 8192
    buffer_load_dwordx4 v7, s[4:7], s32 offen nt lds
    v_exp_f32 v64, v64
    v_exp_f32 v65, v65
    v_exp_f32 v66, v66
    v_add_f32 v11, v11, v64
    v_add_f32 v11, v11, v65
    v_mfma_f32_16x16x32_bf16 v[88:91], v[16:19], v[100:103], v[52:55]
    ds_read_b64_tr_b16 v[16:17], v5 offset:0
    ds_read_b64_tr_b16 v[18:19], v5 offset:512
    v_cvt_pk_bf16_f32 v64, v64, v65
    v_exp_f32 v67, v67
    v_exp_f32 v68, v68
    v_add_f32 v11, v11, v66
    v_add_f32 v11, v11, v67
    v_cvt_pk_bf16_f32 v65, v66, v67
    v_mfma_f32_16x16x32_bf16 v[80:83], v[20:23], v[104:107], v[80:83]
    v_exp_f32 v69, v69
    v_exp_f32 v70, v70
    v_cvt_pk_bf16_f32 v66, v68, v69
    v_exp_f32 v71, v71
    v_add_f32 v11, v11, v68
    v_cvt_pk_bf16_f32 v67, v70, v71
    v_mfma_f32_16x16x32_bf16 v[88:91], v[20:23], v[108:111], v[88:91]
    ds_read_b64_tr_b16 v[20:21], v5 offset:32
    ds_read_b64_tr_b16 v[22:23], v5 offset:544
    v_exp_f32 v72, v72
    v_exp_f32 v73, v73
    v_exp_f32 v74, v74
    v_add_f32 v12, v12, v72
    v_add_f32 v12, v12, v73
    v_mfma_f32_16x16x32_bf16 v[80:83], v[24:27], v[112:115], v[80:83]
    v_cvt_pk_bf16_f32 v72, v72, v73
    v_exp_f32 v75, v75
    v_exp_f32 v76, v76
    v_add_f32 v12, v12, v74
    v_add_f32 v12, v12, v75
    v_cvt_pk_bf16_f32 v73, v74, v75
    v_exp_f32 v77, v77
    v_mfma_f32_16x16x32_bf16 v[88:91], v[24:27], v[116:119], v[88:91]
    ds_read_b64_tr_b16 v[24:25], v5 offset:64
    ds_read_b64_tr_b16 v[26:27], v5 offset:576
    v_exp_f32 v78, v78
    v_cvt_pk_bf16_f32 v74, v76, v77
    v_exp_f32 v79, v79
    v_add_f32 v12, v12, v76
    v_cvt_pk_bf16_f32 v75, v78, v79
    v_mul_f32 v160, v59, v160
    v_mfma_f32_16x16x32_bf16 v[80:83], v[28:31], v[120:123], v[80:83]
    v_mul_f32 v161, v59, v161
    v_mul_f32 v162, v59, v162
    v_mul_f32 v163, v59, v163
    v_mul_f32 v164, v59, v164
    v_mul_f32 v165, v59, v165
    v_mul_f32 v166, v59, v166
    v_mul_f32 v167, v59, v167
    v_cvt_pk_bf16_f32 v128, v160, v161
    v_cvt_pk_bf16_f32 v129, v162, v163
    v_cvt_pk_bf16_f32 v130, v164, v165
    v_mfma_f32_16x16x32_bf16 v[88:91], v[28:31], v[124:127], v[88:91]
    ds_read_b64_tr_b16 v[28:29], v5 offset:96
    ds_read_b64_tr_b16 v[30:31], v5 offset:608
    v_cvt_pk_bf16_f32 v131, v166, v167
    v_mul_f32 v192, v60, v192
    v_mul_f32 v193, v60, v193
    v_mul_f32 v194, v60, v194
    v_mul_f32 v195, v60, v195
    v_mul_f32 v196, v60, v196
    v_mul_f32 v197, v60, v197
    v_mul_f32 v198, v60, v198
    s_waitcnt lgkmcnt(8)
    s_add_u32 m0, s40, 43584
    v_mfma_f32_16x16x32_bf16 v[84:87], v[32:35], v[96:99], v[48:51]
    buffer_load_dwordx4 v7, s[4:7], s32 offen offset:1024 nt lds
    s_add_u32 s32, s32, 8192
    v_mul_f32 v199, v60, v199
    v_cvt_pk_bf16_f32 v132, v192, v193
    v_cvt_pk_bf16_f32 v133, v194, v195
    v_cvt_pk_bf16_f32 v134, v196, v197
    v_cvt_pk_bf16_f32 v135, v198, v199
    v_mul_f32 v168, v59, v168
    v_mul_f32 v169, v59, v169
    v_mul_f32 v170, v59, v170
    v_mfma_f32_16x16x32_bf16 v[92:95], v[32:35], v[100:103], v[52:55]
    ds_read_b64_tr_b16 v[32:33], v5 offset:128
    ds_read_b64_tr_b16 v[34:35], v5 offset:640
    v_mul_f32 v171, v59, v171
    v_mul_f32 v172, v59, v172
    v_mul_f32 v173, v59, v173
    v_mul_f32 v174, v59, v174
    v_mul_f32 v175, v59, v175
    v_cvt_pk_bf16_f32 v136, v168, v169
    v_cvt_pk_bf16_f32 v137, v170, v171
    v_cvt_pk_bf16_f32 v138, v172, v173
    v_mfma_f32_16x16x32_bf16 v[84:87], v[36:39], v[104:107], v[84:87]
    v_cvt_pk_bf16_f32 v139, v174, v175
    v_mul_f32 v200, v60, v200
    v_mul_f32 v201, v60, v201
    v_mul_f32 v202, v60, v202
    v_mul_f32 v203, v60, v203
    v_mul_f32 v204, v60, v204
    v_mul_f32 v205, v60, v205
    v_mul_f32 v206, v60, v206
    v_mul_f32 v207, v60, v207
    v_mfma_f32_16x16x32_bf16 v[92:95], v[36:39], v[108:111], v[92:95]
    ds_read_b64_tr_b16 v[36:37], v5 offset:160
    ds_read_b64_tr_b16 v[38:39], v5 offset:672
    v_cvt_pk_bf16_f32 v140, v200, v201
    v_cvt_pk_bf16_f32 v141, v202, v203
    v_cvt_pk_bf16_f32 v142, v204, v205
    v_cvt_pk_bf16_f32 v143, v206, v207
    v_mul_f32 v176, v59, v176
    v_mul_f32 v177, v59, v177
    v_mul_f32 v178, v59, v178
    v_mul_f32 v179, v59, v179
    v_mfma_f32_16x16x32_bf16 v[84:87], v[40:43], v[112:115], v[84:87]
    v_mul_f32 v180, v59, v180
    v_mul_f32 v181, v59, v181
    v_mul_f32 v182, v59, v182
    v_mul_f32 v183, v59, v183
    v_mul_f32 v208, v60, v208
    v_mul_f32 v209, v60, v209
    v_mul_f32 v210, v60, v210
    v_mul_f32 v211, v60, v211
    v_mul_f32 v212, v60, v212
    v_mul_f32 v213, v60, v213
    v_mfma_f32_16x16x32_bf16 v[92:95], v[40:43], v[116:119], v[92:95]
    ds_read_b64_tr_b16 v[40:41], v5 offset:192
    ds_read_b64_tr_b16 v[42:43], v5 offset:704
    v_mul_f32 v214, v60, v214
    v_mul_f32 v215, v60, v215
    v_mul_f32 v184, v59, v184
    v_mul_f32 v185, v59, v185
    v_mul_f32 v186, v59, v186
    v_mul_f32 v187, v59, v187
    v_mul_f32 v188, v59, v188
    v_mul_f32 v189, v59, v189
    v_mfma_f32_16x16x32_bf16 v[84:87], v[44:47], v[120:123], v[84:87]
    v_mul_f32 v190, v59, v190
    v_mul_f32 v191, v59, v191
    v_mul_f32 v216, v60, v216
    v_mul_f32 v217, v60, v217
    v_mul_f32 v218, v60, v218
    v_mul_f32 v219, v60, v219
    v_mul_f32 v220, v60, v220
    v_mul_f32 v221, v60, v221
    v_mul_f32 v222, v60, v222
    v_mul_f32 v223, v60, v223
    v_mfma_f32_16x16x32_bf16 v[92:95], v[44:47], v[124:127], v[92:95]
    ds_read_b64_tr_b16 v[44:45], v5 offset:224
    ds_read_b64_tr_b16 v[46:47], v5 offset:736
    v_cvt_pk_bf16_f32 v144, v176, v177
    v_cvt_pk_bf16_f32 v145, v178, v179
    v_cvt_pk_bf16_f32 v146, v180, v181
    v_cvt_pk_bf16_f32 v147, v182, v183
    v_cvt_pk_bf16_f32 v148, v208, v209
    v_cvt_pk_bf16_f32 v149, v210, v211
    v_cvt_pk_bf16_f32 v150, v212, v213
    v_cvt_pk_bf16_f32 v151, v214, v215
    s_waitcnt lgkmcnt(10)
    v_mfma_f32_16x16x32_bf16 v[160:163], v[16:19], v[64:67], 0
    v_cvt_pk_bf16_f32 v152, v184, v185
    v_cvt_pk_bf16_f32 v153, v186, v187
    v_cvt_pk_bf16_f32 v154, v188, v189
    v_cvt_pk_bf16_f32 v155, v190, v191
    v_cvt_pk_bf16_f32 v156, v216, v217
    v_cvt_pk_bf16_f32 v157, v218, v219
    v_cvt_pk_bf16_f32 v158, v220, v221
    v_cvt_pk_bf16_f32 v159, v222, v223
    v_mfma_f32_16x16x32_bf16 v[192:195], v[16:19], v[72:75], 0
    v_mfma_f32_16x16x32_bf16 v[164:167], v[20:23], v[64:67], 0
    v_mfma_f32_16x16x32_bf16 v[196:199], v[20:23], v[72:75], 0
    v_add_f32 v11, v11, v69
    v_add_f32 v11, v11, v70
    v_add_f32 v11, v11, v71
    v_add_f32 v12, v12, v77
    v_add_f32 v12, v12, v78
    v_add_f32 v12, v12, v79
    v_max3_f32 v13, v80, v81, v82
    v_max3_f32 v13, v13, v83, v84
    v_max3_f32 v13, v13, v85, v86
    v_max3_f32 v13, v13, v87, v88
    v_max3_f32 v13, v13, v89, v90
    v_mfma_f32_16x16x32_bf16 v[168:171], v[24:27], v[64:67], 0
    v_max3_f32 v13, v13, v91, v92
    v_max3_f32 v13, v13, v93, v94
    v_max_f32 v13, v13, v95
    v_cmp_lt_f32 vcc, s46, v13
    v_mfma_f32_16x16x32_bf16 v[200:203], v[24:27], v[72:75], 0
    s_waitcnt vmcnt(8) lgkmcnt(0)
    s_barrier
    ds_read_b128 v[16:19], v4 offset:8704
    ds_read_b128 v[20:23], v4 offset:8768
    ds_read_b128 v[24:27], v4 offset:8832
    s_add_u32 m0, s39, 52224
    v_mfma_f32_16x16x32_bf16 v[172:175], v[28:31], v[64:67], 0
    buffer_load_dwordx4 v9, s[12:15], s34 offen  lds
    s_add_u32 m0, s39, 52128
    s_nop 0
    buffer_load_dwordx4 v9, s[12:15], s34 offen offset:1152  lds
    s_add_u32 m0, s39, 60928
    s_add_u32 s34, s34, 73728
    buffer_load_dwordx4 v9, s[12:15], s34 offen  lds
    s_add_u32 m0, s39, 60832
    s_nop 0
    buffer_load_dwordx4 v9, s[12:15], s34 offen offset:1152  lds
    v_mfma_f32_16x16x32_bf16 v[204:207], v[28:31], v[72:75], 0
    ds_read_b128 v[28:31], v4 offset:8896
    v_mfma_f32_16x16x32_bf16 v[176:179], v[32:35], v[64:67], 0
    v_mfma_f32_16x16x32_bf16 v[208:211], v[32:35], v[72:75], 0
    ds_read_b128 v[32:35], v4 offset:13056
    v_mfma_f32_16x16x32_bf16 v[180:183], v[36:39], v[64:67], 0
    v_mfma_f32_16x16x32_bf16 v[212:215], v[36:39], v[72:75], 0
    ds_read_b128 v[36:39], v4 offset:13120
    v_mfma_f32_16x16x32_bf16 v[184:187], v[40:43], v[64:67], 0
    v_mfma_f32_16x16x32_bf16 v[216:219], v[40:43], v[72:75], 0
    ds_read_b128 v[40:43], v4 offset:13184
    v_mfma_f32_16x16x32_bf16 v[188:191], v[44:47], v[64:67], 0
    v_mfma_f32_16x16x32_bf16 v[220:223], v[44:47], v[72:75], 0
    ds_read_b128 v[44:47], v4 offset:13248
    s_cbranch_vccnz L_rare_t17
L_back_t17:
    s_add_u32 s28, s28, 1
L_around:
    s_waitcnt lgkmcnt(4)
    v_mfma_f32_16x16x32_bf16 v[64:67], v[16:19], v[96:99], v[48:51]
    s_add_u32 m0, s39, 69632
    s_sub_u32 s34, s34, 73600
    buffer_load_dwordx4 v8, s[8:11], s33 offen nt lds
    v_mfma_f32_16x16x32_bf16 v[72:75], v[16:19], v[100:103], v[52:55]
    ds_read_b64_tr_b16 v[16:17], v6 offset:17408
    ds_read_b64_tr_b16 v[18:19], v6 offset:17664
    v_mfma_f32_16x16x32_bf16 v[64:67], v[20:23], v[104:107], v[64:67]
    v_exp_f32 v80, v80
    v_exp_f32 v81, v81
    v_mfma_f32_16x16x32_bf16 v[72:75], v[20:23], v[108:111], v[72:75]
    ds_read_b64_tr_b16 v[20:21], v6 offset:17440
    ds_read_b64_tr_b16 v[22:23], v6 offset:17696
    v_mfma_f32_16x16x32_bf16 v[64:67], v[24:27], v[112:115], v[64:67]
    v_exp_f32 v82, v82
    v_add_f32 v11, v11, v80
    v_mfma_f32_16x16x32_bf16 v[72:75], v[24:27], v[116:119], v[72:75]
    ds_read_b64_tr_b16 v[24:25], v6 offset:17472
    ds_read_b64_tr_b16 v[26:27], v6 offset:17728
    v_add_f32 v11, v11, v81
    v_mfma_f32_16x16x32_bf16 v[64:67], v[28:31], v[120:123], v[64:67]
    v_cvt_pk_bf16_f32 v80, v80, v81
    v_exp_f32 v83, v83
    v_mfma_f32_16x16x32_bf16 v[72:75], v[28:31], v[124:127], v[72:75]
    ds_read_b64_tr_b16 v[28:29], v6 offset:17504
    ds_read_b64_tr_b16 v[30:31], v6 offset:17760
    s_waitcnt lgkmcnt(8)
    v_mfma_f32_16x16x32_bf16 v[68:71], v[32:35], v[96:99], v[48:51]
    v_exp_f32 v84, v84
    v_add_f32 v11, v11, v82
    v_mfma_f32_16x16x32_bf16 v[76:79], v[32:35], v[100:103], v[52:55]
    ds_read_b64_tr_b16 v[32:33], v6 offset:17920
    ds_read_b64_tr_b16 v[34:35], v6 offset:18176
    v_add_f32 v11, v11, v83
    v_mfma_f32_16x16x32_bf16 v[68:71], v[36:39], v[104:107], v[68:71]
    v_cvt_pk_bf16_f32 v81, v82, v83
    v_exp_f32 v85, v85
    v_mfma_f32_16x16x32_bf16 v[76:79], v[36:39], v[108:111], v[76:79]
    ds_read_b64_tr_b16 v[36:37], v6 offset:17952
    ds_read_b64_tr_b16 v[38:39], v6 offset:18208
    v_mfma_f32_16x16x32_bf16 v[68:71], v[40:43], v[112:115], v[68:71]
    v_exp_f32 v86, v86
    v_cvt_pk_bf16_f32 v82, v84, v85
    v_mfma_f32_16x16x32_bf16 v[76:79], v[40:43], v[116:119], v[76:79]
    ds_read_b64_tr_b16 v[40:41], v6 offset:17984
    ds_read_b64_tr_b16 v[42:43], v6 offset:18240
    s_add_u32 m0, s39, 70432
    v_mfma_f32_16x16x32_bf16 v[68:71], v[44:47], v[120:123], v[68:71]
    buffer_load_dwordx4 v8, s[8:11], s33 offen offset:256 nt lds
    s_add_u32 s33, s33, 8192
    v_exp_f32 v87, v87
    v_mfma_f32_16x16x32_bf16 v[76:79], v[44:47], v[124:127], v[76:79]
    ds_read_b64_tr_b16 v[44:45], v6 offset:18016
    ds_read_b64_tr_b16 v[46:47], v6 offset:18272
    s_waitcnt lgkmcnt(8)
    v_mfma_f32_16x16x32_bf16 a[0:3], v[16:19], v[128:131], a[0:3]
    v_add_f32 v11, v11, v84
    v_cvt_pk_bf16_f32 v83, v86, v87
    v_mfma_f32_16x16x32_bf16 a[4:7], v[16:19], v[132:135], a[4:7]
    ds_read_b64_tr_b16 v[16:17], v5 offset:26112
    ds_read_b64_tr_b16 v[18:19], v5 offset:26624
    v_exp_f32 v88, v88
    v_mfma_f32_16x16x32_bf16 a[8:11], v[20:23], v[128:131], a[8:11]
    v_exp_f32 v89, v89
    v_mfma_f32_16x16x32_bf16 a[12:15], v[20:23], v[132:135], a[12:15]
    ds_read_b64_tr_b16 v[20:21], v5 offset:26144
    ds_read_b64_tr_b16 v[22:23], v5 offset:26656
    v_mfma_f32_16x16x32_bf16 a[16:19], v[24:27], v[128:131], a[16:19]
    v_exp_f32 v90, v90
    v_add_f32 v12, v12, v88
    v_add_f32 v12, v12, v89
    v_mfma_f32_16x16x32_bf16 a[20:23], v[24:27], v[132:135], a[20:23]
    ds_read_b64_tr_b16 v[24:25], v5 offset:26176
    ds_read_b64_tr_b16 v[26:27], v5 offset:26688
    v_mfma_f32_16x16x32_bf16 a[24:27], v[28:31], v[128:131], a[24:27]
    v_cvt_pk_bf16_f32 v88, v88, v89
    v_exp_f32 v91, v91
    v_mfma_f32_16x16x32_bf16 a[28:31], v[28:31], v[132:135], a[28:31]
    ds_read_b64_tr_b16 v[28:29], v5 offset:26208
    ds_read_b64_tr_b16 v[30:31], v5 offset:26720
    s_waitcnt lgkmcnt(8)
    v_mfma_f32_16x16x32_bf16 a[0:3], v[32:35], v[136:139], a[0:3]
    v_exp_f32 v92, v92
    v_add_f32 v12, v12, v90
    v_add_f32 v12, v12, v91
    v_mfma_f32_16x16x32_bf16 a[4:7], v[32:35], v[140:143], a[4:7]
    ds_read_b64_tr_b16 v[32:33], v5 offset:26240
    ds_read_b64_tr_b16 v[34:35], v5 offset:26752
    v_mfma_f32_16x16x32_bf16 a[8:11], v[36:39], v[136:139], a[8:11]
    v_cvt_pk_bf16_f32 v89, v90, v91
    v_exp_f32 v93, v93
    v_mfma_f32_16x16x32_bf16 a[12:15], v[36:39], v[140:143], a[12:15]
    ds_read_b64_tr_b16 v[36:37], v5 offset:26272
    ds_read_b64_tr_b16 v[38:39], v5 offset:26784
    v_mfma_f32_16x16x32_bf16 a[16:19], v[40:43], v[136:139], a[16:19]
    v_exp_f32 v94, v94
    v_cvt_pk_bf16_f32 v90, v92, v93
    v_mfma_f32_16x16x32_bf16 a[20:23], v[40:43], v[140:143], a[20:23]
    ds_read_b64_tr_b16 v[40:41], v5 offset:26304
    ds_read_b64_tr_b16 v[42:43], v5 offset:26816
    v_mfma_f32_16x16x32_bf16 a[24:27], v[44:47], v[136:139], a[24:27]
    v_exp_f32 v95, v95
    v_add_f32 v12, v12, v92
    v_cvt_pk_bf16_f32 v91, v94, v95
    v_mfma_f32_16x16x32_bf16 a[28:31], v[44:47], v[140:143], a[28:31]
    ds_read_b64_tr_b16 v[44:45], v5 offset:26336
    ds_read_b64_tr_b16 v[46:47], v5 offset:26848
    s_waitcnt lgkmcnt(10)
    v_mfma_f32_16x16x32_bf16 v[160:163], v[16:19], v[80:83], v[160:163]
    v_add_f32 v11, v11, v85
    v_max3_f32 v13, v64, v65, v66
    v_add_f32 v11, v11, v86
    v_mfma_f32_16x16x32_bf16 v[192:195], v[16:19], v[88:91], v[192:195]
    v_max3_f32 v13, v13, v67, v68
    v_add_f32 v11, v11, v87
    v_max3_f32 v13, v13, v69, v70
    v_mfma_f32_16x16x32_bf16 v[164:167], v[20:23], v[80:83], v[164:167]
    v_add_f32 v12, v12, v93
    v_max3_f32 v13, v13, v71, v72
    v_add_f32 v12, v12, v94
    v_mfma_f32_16x16x32_bf16 v[196:199], v[20:23], v[88:91], v[196:199]
    v_max3_f32 v13, v13, v73, v74
    v_add_f32 v12, v12, v95
    v_mfma_f32_16x16x32_bf16 v[168:171], v[24:27], v[80:83], v[168:171]
    v_max3_f32 v13, v13, v75, v76
    v_max3_f32 v13, v13, v77, v78
    v_max_f32 v13, v13, v79
    v_mfma_f32_16x16x32_bf16 v[200:203], v[24:27], v[88:91], v[200:203]
    s_waitcnt vmcnt(8) lgkmcnt(0)
    s_barrier
    ds_read_b128 v[16:19], v4 offset:34816
    ds_read_b128 v[20:23], v4 offset:34880
    ds_read_b128 v[24:27], v4 offset:34944
    v_mfma_f32_16x16x32_bf16 v[172:175], v[28:31], v[80:83], v[172:175]
    s_add_u32 m0, s40, 78336
    v_cmp_lt_f32 vcc, s46, v13
    buffer_load_dwordx4 v7, s[4:7], s32 offen nt lds
    v_mfma_f32_16x16x32_bf16 v[204:207], v[28:31], v[88:91], v[204:207]
    s_add_u32 m0, s40, 78400
    ds_read_b128 v[28:31], v4 offset:35008
    buffer_load_dwordx4 v7, s[4:7], s32 offen offset:1024 nt lds
    v_mfma_f32_16x16x32_bf16 v[176:179], v[32:35], v[80:83], v[176:179]
    s_add_u32 m0, s39, 87040
    s_add_u32 s32, s32, 8192
    buffer_load_dwordx4 v9, s[12:15], s34 offen  lds
    v_mfma_f32_16x16x32_bf16 v[208:211], v[32:35], v[88:91], v[208:211]
    s_add_u32 m0, s39, 86944
    ds_read_b128 v[32:35], v4 offset:39168
    buffer_load_dwordx4 v9, s[12:15], s34 offen offset:1152  lds
    v_mfma_f32_16x16x32_bf16 v[180:183], v[36:39], v[80:83], v[180:183]
    v_mfma_f32_16x16x32_bf16 v[212:215], v[36:39], v[88:91], v[212:215]
    ds_read_b128 v[36:39], v4 offset:39232
    v_mfma_f32_16x16x32_bf16 v[184:187], v[40:43], v[80:83], v[184:187]
    v_mfma_f32_16x16x32_bf16 v[216:219], v[40:43], v[88:91], v[216:219]
    ds_read_b128 v[40:43], v4 offset:39296
    v_mfma_f32_16x16x32_bf16 v[188:191], v[44:47], v[80:83], v[188:191]
    v_mfma_f32_16x16x32_bf16 v[220:223], v[44:47], v[88:91], v[220:223]
    ds_read_b128 v[44:47], v4 offset:39360
    s_cbranch_vccnz L_rare_t18
L_back_t18:
    s_waitcnt lgkmcnt(4)
    v_mfma_f32_16x16x32_bf16 v[80:83], v[16:19], v[96:99], v[48:51]
    s_add_u32 m0, s39, 95744
    s_add_u32 s34, s34, 73728
    buffer_load_dwordx4 v8, s[8:11], s33 offen nt lds
    v_mfma_f32_16x16x32_bf16 v[88:91], v[16:19], v[100:103], v[52:55]
    ds_read_b64_tr_b16 v[16:17], v3 offset:0
    ds_read_b64_tr_b16 v[18:19], v3 offset:256
    v_mfma_f32_16x16x32_bf16 v[80:83], v[20:23], v[104:107], v[80:83]
    v_exp_f32 v64, v64
    v_exp_f32 v65, v65
    v_mfma_f32_16x16x32_bf16 v[88:91], v[20:23], v[108:111], v[88:91]
    ds_read_b64_tr_b16 v[20:21], v3 offset:32
    ds_read_b64_tr_b16 v[22:23], v3 offset:288
    v_mfma_f32_16x16x32_bf16 v[80:83], v[24:27], v[112:115], v[80:83]
    v_exp_f32 v66, v66
    v_add_f32 v11, v11, v64
    v_mfma_f32_16x16x32_bf16 v[88:91], v[24:27], v[116:119], v[88:91]
    ds_read_b64_tr_b16 v[24:25], v3 offset:64
    ds_read_b64_tr_b16 v[26:27], v3 offset:320
    v_add_f32 v11, v11, v65
    v_mfma_f32_16x16x32_bf16 v[80:83], v[28:31], v[120:123], v[80:83]
    v_cvt_pk_bf16_f32 v64, v64, v65
    v_exp_f32 v67, v67
    v_mfma_f32_16x16x32_bf16 v[88:91], v[28:31], v[124:127], v[88:91]
    ds_read_b64_tr_b16 v[28:29], v3 offset:96
    ds_read_b64_tr_b16 v[30:31], v3 offset:352
    s_waitcnt lgkmcnt(8)
    v_mfma_f32_16x16x32_bf16 v[84:87], v[32:35], v[96:99], v[48:51]
    v_exp_f32 v68, v68
    v_add_f32 v11, v11, v66
    v_mfma_f32_16x16x32_bf16 v[92:95], v[32:35], v[100:103], v[52:55]
    ds_read_b64_tr_b16 v[32:33], v3 offset:512
    ds_read_b64_tr_b16 v[34:35], v3 offset:768
    v_add_f32 v11, v11, v67
    v_mfma_f32_16x16x32_bf16 v[84:87], v[36:39], v[104:107], v[84:87]
    v_cvt_pk_bf16_f32 v65, v66, v67
    v_exp_f32 v69, v69
    v_mfma_f32_16x16x32_bf16 v[92:95], v[36:39], v[108:111], v[92:95]
    ds_read_b64_tr_b16 v[36:37], v3 offset:544
    ds_read_b64_tr_b16 v[38:39], v3 offset:800
    v_mfma_f32_16x16x32_bf16 v[84:87], v[40:43], v[112:115], v[84:87]
    v_exp_f32 v70, v70
    v_cvt_pk_bf16_f32 v66, v68, v69
    v_mfma_f32_16x16x32_bf16 v[92:95], v[40:43], v[116:119], v[92:95]
    ds_read_b64_tr_b16 v[40:41], v3 offset:576
    ds_read_b64_tr_b16 v[42:43], v3 offset:832
    s_add_u32 m0, s39, 96544
    v_mfma_f32_16x16x32_bf16 v[84:87], v[44:47], v[120:123], v[84:87]
    buffer_load_dwordx4 v8, s[8:11], s33 offen offset:256 nt lds
    s_add_u32 s33, s33, 8192
    v_exp_f32 v71, v71
    v_mfma_f32_16x16x32_bf16 v[92:95], v[44:47], v[124:127], v[92:95]
    ds_read_b64_tr_b16 v[44:45], v3 offset:608
    ds_read_b64_tr_b16 v[46:47], v3 offset:864
    s_waitcnt lgkmcnt(8)
    v_mfma_f32_16x16x32_bf16 a[0:3], v[16:19], v[144:147], a[0:3]
    v_add_f32 v11, v11, v68
    v_cvt_pk_bf16_f32 v67, v70, v71
    v_mfma_f32_16x16x32_bf16 a[4:7], v[16:19], v[148:151], a[4:7]
    ds_read_b64_tr_b16 v[16:17], v2 offset:8704
    ds_read_b64_tr_b16 v[18:19], v2 offset:9216
    v_exp_f32 v72, v72
    v_mfma_f32_16x16x32_bf16 a[8:11], v[20:23], v[144:147], a[8:11]
    v_exp_f32 v73, v73
    v_mfma_f32_16x16x32_bf16 a[12:15], v[20:23], v[148:151], a[12:15]
    ds_read_b64_tr_b16 v[20:21], v2 offset:8736
    ds_read_b64_tr_b16 v[22:23], v2 offset:9248
    v_mfma_f32_16x16x32_bf16 a[16:19], v[24:27], v[144:147], a[16:19]
    v_exp_f32 v74, v74
    v_add_f32 v12, v12, v72
    v_add_f32 v12, v12, v73
    v_mfma_f32_16x16x32_bf16 a[20:23], v[24:27], v[148:151], a[20:23]
    ds_read_b64_tr_b16 v[24:25], v2 offset:8768
    ds_read_b64_tr_b16 v[26:27], v2 offset:9280
    v_mfma_f32_16x16x32_bf16 a[24:27], v[28:31], v[144:147], a[24:27]
    v_cvt_pk_bf16_f32 v72, v72, v73
    v_exp_f32 v75, v75
    v_mfma_f32_16x16x32_bf16 a[28:31], v[28:31], v[148:151], a[28:31]
    ds_read_b64_tr_b16 v[28:29], v2 offset:8800
    ds_read_b64_tr_b16 v[30:31], v2 offset:9312
    s_waitcnt lgkmcnt(8)
    v_mfma_f32_16x16x32_bf16 a[0:3], v[32:35], v[152:155], a[0:3]
    v_exp_f32 v76, v76
    v_add_f32 v12, v12, v74
    v_add_f32 v12, v12, v75
    v_mfma_f32_16x16x32_bf16 a[4:7], v[32:35], v[156:159], a[4:7]
    ds_read_b64_tr_b16 v[32:33], v2 offset:8832
    ds_read_b64_tr_b16 v[34:35], v2 offset:9344
    v_mfma_f32_16x16x32_bf16 a[8:11], v[36:39], v[152:155], a[8:11]
    v_cvt_pk_bf16_f32 v73, v74, v75
    v_exp_f32 v77, v77
    v_mfma_f32_16x16x32_bf16 a[12:15], v[36:39], v[156:159], a[12:15]
    ds_read_b64_tr_b16 v[36:37], v2 offset:8864
    ds_read_b64_tr_b16 v[38:39], v2 offset:9376
    v_mfma_f32_16x16x32_bf16 a[16:19], v[40:43], v[152:155], a[16:19]
    v_exp_f32 v78, v78
    v_cvt_pk_bf16_f32 v74, v76, v77
    v_mfma_f32_16x16x32_bf16 a[20:23], v[40:43], v[156:159], a[20:23]
    ds_read_b64_tr_b16 v[40:41], v2 offset:8896
    ds_read_b64_tr_b16 v[42:43], v2 offset:9408
    v_mfma_f32_16x16x32_bf16 a[24:27], v[44:47], v[152:155], a[24:27]
    v_exp_f32 v79, v79
    v_add_f32 v12, v12, v76
    v_cvt_pk_bf16_f32 v75, v78, v79
    v_mfma_f32_16x16x32_bf16 a[28:31], v[44:47], v[156:159], a[28:31]
    ds_read_b64_tr_b16 v[44:45], v2 offset:8928
    ds_read_b64_tr_b16 v[46:47], v2 offset:9440
    s_waitcnt lgkmcnt(10)
    v_mfma_f32_16x16x32_bf16 v[160:163], v[16:19], v[64:67], v[160:163]
    v_add_f32 v11, v11, v69
    v_max3_f32 v13, v80, v81, v82
    v_add_f32 v11, v11, v70
    v_mfma_f32_16x16x32_bf16 v[192:195], v[16:19], v[72:75], v[192:195]
    v_max3_f32 v13, v13, v83, v84
    v_add_f32 v11, v11, v71
    v_max3_f32 v13, v13, v85, v86
    v_mfma_f32_16x16x32_bf16 v[164:167], v[20:23], v[64:67], v[164:167]
    v_add_f32 v12, v12, v77
    v_max3_f32 v13, v13, v87, v88
    v_add_f32 v12, v12, v78
    v_mfma_f32_16x16x32_bf16 v[196:199], v[20:23], v[72:75], v[196:199]
    v_max3_f32 v13, v13, v89, v90
    v_add_f32 v12, v12, v79
    v_mfma_f32_16x16x32_bf16 v[168:171], v[24:27], v[64:67], v[168:171]
    v_max3_f32 v13, v13, v91, v92
    v_max3_f32 v13, v13, v93, v94
    v_max_f32 v13, v13, v95
    v_mfma_f32_16x16x32_bf16 v[200:203], v[24:27], v[72:75], v[200:203]
    s_waitcnt vmcnt(6) lgkmcnt(0)
    s_barrier
    ds_read_b128 v[16:19], v1 offset:17408
    ds_read_b128 v[20:23], v1 offset:17472
    ds_read_b128 v[24:27], v1 offset:17536
    v_mfma_f32_16x16x32_bf16 v[172:175], v[28:31], v[64:67], v[172:175]
    s_add_u32 m0, s40, 104448
    v_cmp_lt_f32 vcc, s46, v13
    buffer_load_dwordx4 v7, s[4:7], s32 offen nt lds
    v_mfma_f32_16x16x32_bf16 v[204:207], v[28:31], v[72:75], v[204:207]
    s_add_u32 m0, s40, 104512
    ds_read_b128 v[28:31], v1 offset:17600
    buffer_load_dwordx4 v7, s[4:7], s32 offen offset:1024 nt lds
    v_mfma_f32_16x16x32_bf16 v[176:179], v[32:35], v[64:67], v[176:179]
    s_add_u32 m0, s39, 26112
    s_add_u32 s32, s32, 8192
    buffer_load_dwordx4 v9, s[12:15], s34 offen  lds
    v_mfma_f32_16x16x32_bf16 v[208:211], v[32:35], v[72:75], v[208:211]
    s_add_u32 m0, s39, 26016
    ds_read_b128 v[32:35], v1 offset:21760
    buffer_load_dwordx4 v9, s[12:15], s34 offen offset:1152  lds
    v_mfma_f32_16x16x32_bf16 v[180:183], v[36:39], v[64:67], v[180:183]
    v_mfma_f32_16x16x32_bf16 v[212:215], v[36:39], v[72:75], v[212:215]
    ds_read_b128 v[36:39], v1 offset:21824
    v_mfma_f32_16x16x32_bf16 v[184:187], v[40:43], v[64:67], v[184:187]
    v_mfma_f32_16x16x32_bf16 v[216:219], v[40:43], v[72:75], v[216:219]
    ds_read_b128 v[40:43], v1 offset:21888
    v_mfma_f32_16x16x32_bf16 v[188:191], v[44:47], v[64:67], v[188:191]
    v_mfma_f32_16x16x32_bf16 v[220:223], v[44:47], v[72:75], v[220:223]
    ds_read_b128 v[44:47], v1 offset:21952
    s_cbranch_vccnz L_rare_t19
L_back_t19:
    s_waitcnt lgkmcnt(4)
    v_mfma_f32_16x16x32_bf16 v[64:67], v[16:19], v[96:99], v[48:51]
    s_add_u32 m0, s39, 34816
    s_sub_u32 s34, s34, 73600
    buffer_load_dwordx4 v8, s[8:11], s33 offen nt lds
    v_mfma_f32_16x16x32_bf16 v[72:75], v[16:19], v[100:103], v[52:55]
    ds_read_b64_tr_b16 v[16:17], v3 offset:26112
    ds_read_b64_tr_b16 v[18:19], v3 offset:26368
    v_mfma_f32_16x16x32_bf16 v[64:67], v[20:23], v[104:107], v[64:67]
    v_exp_f32 v80, v80
    v_mfma_f32_16x16x32_bf16 v[72:75], v[20:23], v[108:111], v[72:75]
    ds_read_b64_tr_b16 v[20:21], v3 offset:26144
    ds_read_b64_tr_b16 v[22:23], v3 offset:26400
    v_mfma_f32_16x16x32_bf16 v[64:67], v[24:27], v[112:115], v[64:67]
    v_exp_f32 v81, v81
    v_mfma_f32_16x16x32_bf16 v[72:75], v[24:27], v[116:119], v[72:75]
    ds_read_b64_tr_b16 v[24:25], v3 offset:26176
    ds_read_b64_tr_b16 v[26:27], v3 offset:26432
    v_mfma_f32_16x16x32_bf16 v[64:67], v[28:31], v[120:123], v[64:67]
    v_exp_f32 v82, v82
    v_add_f32 v11, v11, v80
    v_mfma_f32_16x16x32_bf16 v[72:75], v[28:31], v[124:127], v[72:75]
    ds_read_b64_tr_b16 v[28:29], v3 offset:26208
    ds_read_b64_tr_b16 v[30:31], v3 offset:26464
    s_waitcnt lgkmcnt(8)
    v_mfma_f32_16x16x32_bf16 v[68:71], v[32:35], v[96:99], v[48:51]
    v_add_f32 v11, v11, v81
    v_cvt_pk_bf16_f32 v80, v80, v81
    v_mfma_f32_16x16x32_bf16 v[76:79], v[32:35], v[100:103], v[52:55]
    ds_read_b64_tr_b16 v[32:33], v3 offset:26624
    ds_read_b64_tr_b16 v[34:35], v3 offset:26880
    v_mfma_f32_16x16x32_bf16 v[68:71], v[36:39], v[104:107], v[68:71]
    v_exp_f32 v83, v83
    v_mfma_f32_16x16x32_bf16 v[76:79], v[36:39], v[108:111], v[76:79]
    ds_read_b64_tr_b16 v[36:37], v3 offset:26656
    ds_read_b64_tr_b16 v[38:39], v3 offset:26912
    v_mfma_f32_16x16x32_bf16 v[68:71], v[40:43], v[112:115], v[68:71]
    v_exp_f32 v84, v84
    v_add_f32 v11, v11, v82
    v_mfma_f32_16x16x32_bf16 v[76:79], v[40:43], v[116:119], v[76:79]
    ds_read_b64_tr_b16 v[40:41], v3 offset:26688
    ds_read_b64_tr_b16 v[42:43], v3 offset:26944
    v_mfma_f32_16x16x32_bf16 v[68:71], v[44:47], v[120:123], v[68:71]
    v_add_f32 v11, v11, v83
    v_cvt_pk_bf16_f32 v81, v82, v83
    v_mfma_f32_16x16x32_bf16 v[76:79], v[44:47], v[124:127], v[76:79]
    ds_read_b64_tr_b16 v[44:45], v3 offset:26720
    ds_read_b64_tr_b16 v[46:47], v3 offset:26976
    s_waitcnt lgkmcnt(8)
    v_mfma_f32_16x16x32_bf16 a[32:35], v[16:19], v[128:131], a[32:35]
    v_exp_f32 v85, v85
    v_mfma_f32_16x16x32_bf16 a[36:39], v[16:19], v[132:135], a[36:39]
    ds_read_b64_tr_b16 v[16:17], v3 offset:34816
    ds_read_b64_tr_b16 v[18:19], v3 offset:35072
    v_mfma_f32_16x16x32_bf16 a[40:43], v[20:23], v[128:131], a[40:43]
    v_exp_f32 v86, v86
    v_cvt_pk_bf16_f32 v82, v84, v85
    v_mfma_f32_16x16x32_bf16 a[44:47], v[20:23], v[132:135], a[44:47]
    ds_read_b64_tr_b16 v[20:21], v3 offset:34848
    ds_read_b64_tr_b16 v[22:23], v3 offset:35104
    s_add_u32 m0, s39, 35616
    v_mfma_f32_16x16x32_bf16 a[48:51], v[24:27], v[128:131], a[48:51]
    buffer_load_dwordx4 v8, s[8:11], s33 offen offset:256 nt lds
    s_add_u32 s33, s33, 8192
    v_mfma_f32_16x16x32_bf16 a[52:55], v[24:27], v[132:135], a[52:55]
    ds_read_b64_tr_b16 v[24:25], v3 offset:34880
    ds_read_b64_tr_b16 v[26:27], v3 offset:35136
    v_mfma_f32_16x16x32_bf16 a[56:59], v[28:31], v[128:131], a[56:59]
    v_exp_f32 v87, v87
    v_mfma_f32_16x16x32_bf16 a[60:63], v[28:31], v[132:135], a[60:63]
    ds_read_b64_tr_b16 v[28:29], v3 offset:34912
    ds_read_b64_tr_b16 v[30:31], v3 offset:35168
    v_add_f32 v11, v11, v84
    s_waitcnt lgkmcnt(8)
    v_mfma_f32_16x16x32_bf16 a[32:35], v[32:35], v[136:139], a[32:35]
    v_cvt_pk_bf16_f32 v83, v86, v87
    v_mfma_f32_16x16x32_bf16 a[36:39], v[32:35], v[140:143], a[36:39]
    ds_read_b64_tr_b16 v[32:33], v3 offset:35328
    ds_read_b64_tr_b16 v[34:35], v3 offset:35584
    v_mfma_f32_16x16x32_bf16 a[40:43], v[36:39], v[136:139], a[40:43]
    v_exp_f32 v88, v88
    v_mfma_f32_16x16x32_bf16 a[44:47], v[36:39], v[140:143], a[44:47]
    ds_read_b64_tr_b16 v[36:37], v3 offset:35360
    ds_read_b64_tr_b16 v[38:39], v3 offset:35616
    v_mfma_f32_16x16x32_bf16 a[48:51], v[40:43], v[136:139], a[48:51]
    v_exp_f32 v89, v89
    v_mfma_f32_16x16x32_bf16 a[52:55], v[40:43], v[140:143], a[52:55]
    ds_read_b64_tr_b16 v[40:41], v3 offset:35392
    ds_read_b64_tr_b16 v[42:43], v3 offset:35648
    v_mfma_f32_16x16x32_bf16 a[56:59], v[44:47], v[136:139], a[56:59]
    v_exp_f32 v90, v90
    v_add_f32 v12, v12, v88
    v_mfma_f32_16x16x32_bf16 a[60:63], v[44:47], v[140:143], a[60:63]
    ds_read_b64_tr_b16 v[44:45], v3 offset:35424
    ds_read_b64_tr_b16 v[46:47], v3 offset:35680
    s_waitcnt lgkmcnt(8)
    v_mfma_f32_16x16x32_bf16 a[32:35], v[16:19], v[144:147], a[32:35]
    v_add_f32 v12, v12, v89
    v_cvt_pk_bf16_f32 v88, v88, v89
    v_mfma_f32_16x16x32_bf16 a[36:39], v[16:19], v[148:151], a[36:39]
    ds_read_b64_tr_b16 v[16:17], v5 offset:0
    ds_read_b64_tr_b16 v[18:19], v5 offset:512
    v_mfma_f32_16x16x32_bf16 a[40:43], v[20:23], v[144:147], a[40:43]
    v_exp_f32 v91, v91
    v_mfma_f32_16x16x32_bf16 a[44:47], v[20:23], v[148:151], a[44:47]
    ds_read_b64_tr_b16 v[20:21], v5 offset:32
    ds_read_b64_tr_b16 v[22:23], v5 offset:544
    v_mfma_f32_16x16x32_bf16 a[48:51], v[24:27], v[144:147], a[48:51]
    v_exp_f32 v92, v92
    v_add_f32 v12, v12, v90
    v_mfma_f32_16x16x32_bf16 a[52:55], v[24:27], v[148:151], a[52:55]
    ds_read_b64_tr_b16 v[24:25], v5 offset:64
    ds_read_b64_tr_b16 v[26:27], v5 offset:576
    v_mfma_f32_16x16x32_bf16 a[56:59], v[28:31], v[144:147], a[56:59]
    v_add_f32 v12, v12, v91
    v_cvt_pk_bf16_f32 v89, v90, v91
    v_mfma_f32_16x16x32_bf16 a[60:63], v[28:31], v[148:151], a[60:63]
    ds_read_b64_tr_b16 v[28:29], v5 offset:96
    ds_read_b64_tr_b16 v[30:31], v5 offset:608
    s_waitcnt lgkmcnt(8)
    v_mfma_f32_16x16x32_bf16 a[32:35], v[32:35], v[152:155], a[32:35]
    v_exp_f32 v93, v93
    v_mfma_f32_16x16x32_bf16 a[36:39], v[32:35], v[156:159], a[36:39]
    ds_read_b64_tr_b16 v[32:33], v5 offset:128
    ds_read_b64_tr_b16 v[34:35], v5 offset:640
    v_mfma_f32_16x16x32_bf16 a[40:43], v[36:39], v[152:155], a[40:43]
    v_exp_f32 v94, v94
    v_cvt_pk_bf16_f32 v90, v92, v93
    v_mfma_f32_16x16x32_bf16 a[44:47], v[36:39], v[156:159], a[44:47]
    ds_read_b64_tr_b16 v[36:37], v5 offset:160
    ds_read_b64_tr_b16 v[38:39], v5 offset:672
    v_mfma_f32_16x16x32_bf16 a[48:51], v[40:43], v[152:155], a[48:51]
    v_exp_f32 v95, v95
    v_mfma_f32_16x16x32_bf16 a[52:55], v[40:43], v[156:159], a[52:55]
    ds_read_b64_tr_b16 v[40:41], v5 offset:192
    ds_read_b64_tr_b16 v[42:43], v5 offset:704
    v_mfma_f32_16x16x32_bf16 a[56:59], v[44:47], v[152:155], a[56:59]
    v_add_f32 v12, v12, v92
    v_cvt_pk_bf16_f32 v91, v94, v95
    v_mfma_f32_16x16x32_bf16 a[60:63], v[44:47], v[156:159], a[60:63]
    ds_read_b64_tr_b16 v[44:45], v5 offset:224
    ds_read_b64_tr_b16 v[46:47], v5 offset:736
    s_waitcnt lgkmcnt(10)
    v_mfma_f32_16x16x32_bf16 v[160:163], v[16:19], v[80:83], v[160:163]
    v_add_f32 v11, v11, v85
    v_max3_f32 v13, v64, v65, v66
    v_add_f32 v11, v11, v86
    v_mfma_f32_16x16x32_bf16 v[192:195], v[16:19], v[88:91], v[192:195]
    v_max3_f32 v13, v13, v67, v68
    v_add_f32 v11, v11, v87
    v_mfma_f32_16x16x32_bf16 v[164:167], v[20:23], v[80:83], v[164:167]
    v_max3_f32 v13, v13, v69, v70
    v_add_f32 v12, v12, v93
    v_mfma_f32_16x16x32_bf16 v[196:199], v[20:23], v[88:91], v[196:199]
    v_max3_f32 v13, v13, v71, v72
    v_add_f32 v12, v12, v94
    v_mfma_f32_16x16x32_bf16 v[168:171], v[24:27], v[80:83], v[168:171]
    v_max3_f32 v13, v13, v73, v74
    v_add_f32 v12, v12, v95
    v_mfma_f32_16x16x32_bf16 v[200:203], v[24:27], v[88:91], v[200:203]
    s_waitcnt vmcnt(6) lgkmcnt(0)
    s_barrier
    ds_read_b128 v[16:19], v4 offset:8704
    ds_read_b128 v[20:23], v4 offset:8768
    ds_read_b128 v[24:27], v4 offset:8832
    v_mfma_f32_16x16x32_bf16 v[172:175], v[28:31], v[80:83], v[172:175]
    v_max3_f32 v13, v13, v75, v76
    v_mfma_f32_16x16x32_bf16 v[204:207], v[28:31], v[88:91], v[204:207]
    ds_read_b128 v[28:31], v4 offset:8896
    v_max3_f32 v13, v13, v77, v78
    v_mfma_f32_16x16x32_bf16 v[176:179], v[32:35], v[80:83], v[176:179]
    v_max_f32 v13, v13, v79
    v_cmp_lt_f32 vcc, s46, v13
    v_mfma_f32_16x16x32_bf16 v[208:211], v[32:35], v[88:91], v[208:211]
    s_add_u32 m0, s40, 43520
    ds_read_b128 v[32:35], v4 offset:13056
    buffer_load_dwordx4 v7, s[4:7], s32 offen nt lds
    s_add_u32 m0, s40, 43584
    v_mfma_f32_16x16x32_bf16 v[180:183], v[36:39], v[80:83], v[180:183]
    buffer_load_dwordx4 v7, s[4:7], s32 offen offset:1024 nt lds
    v_mfma_f32_16x16x32_bf16 v[212:215], v[36:39], v[88:91], v[212:215]
    ds_read_b128 v[36:39], v4 offset:13120
    s_add_u32 m0, s39, 52224
    s_add_u32 s32, s32, 8192
    buffer_load_dwordx4 v9, s[12:15], s34 offen  lds
    s_add_u32 m0, s39, 52128
    v_mfma_f32_16x16x32_bf16 v[184:187], v[40:43], v[80:83], v[184:187]
    buffer_load_dwordx4 v9, s[12:15], s34 offen offset:1152  lds
    v_mfma_f32_16x16x32_bf16 v[216:219], v[40:43], v[88:91], v[216:219]
    ds_read_b128 v[40:43], v4 offset:13184
    s_add_u32 m0, s39, 60928
    s_add_u32 s34, s34, 73728
    buffer_load_dwordx4 v8, s[8:11], s33 offen nt lds
    s_add_u32 m0, s39, 61728
    v_mfma_f32_16x16x32_bf16 v[188:191], v[44:47], v[80:83], v[188:191]
    buffer_load_dwordx4 v8, s[8:11], s33 offen offset:256 nt lds
    v_mfma_f32_16x16x32_bf16 v[220:223], v[44:47], v[88:91], v[220:223]
    ds_read_b128 v[44:47], v4 offset:13248
    s_cbranch_vccnz L_rare_t20
L_back_t20:
    s_waitcnt lgkmcnt(4)
    v_mfma_f32_16x16x32_bf16 v[80:83], v[16:19], v[96:99], v[48:51]
    s_add_u32 m0, s40, 69632
    s_add_u32 s33, s33, 8192
    buffer_load_dwordx4 v7, s[4:7], s32 offen nt lds
    v_mfma_f32_16x16x32_bf16 v[88:91], v[16:19], v[100:103], v[52:55]
    ds_read_b64_tr_b16 v[16:17], v6 offset:17408
    ds_read_b64_tr_b16 v[18:19], v6 offset:17664
    v_mfma_f32_16x16x32_bf16 v[80:83], v[20:23], v[104:107], v[80:83]
    v_exp_f32 v64, v64
    v_exp_f32 v65, v65
    v_mfma_f32_16x16x32_bf16 v[88:91], v[20:23], v[108:111], v[88:91]
    ds_read_b64_tr_b16 v[20:21], v6 offset:17440
    ds_read_b64_tr_b16 v[22:23], v6 offset:17696
    v_mfma_f32_16x16x32_bf16 v[80:83], v[24:27], v[112:115], v[80:83]
    v_exp_f32 v66, v66
    v_add_f32 v11, v11, v64
    v_mfma_f32_16x16x32_bf16 v[88:91], v[24:27], v[116:119], v[88:91]
    ds_read_b64_tr_b16 v[24:25], v6 offset:17472
    ds_read_b64_tr_b16 v[26:27], v6 offset:17728
    v_add_f32 v11, v11, v65
    v_mfma_f32_16x16x32_bf16 v[80:83], v[28:31], v[120:123], v[80:83]
    v_cvt_pk_bf16_f32 v64, v64, v65
    v_exp_f32 v67, v67
    v_mfma_f32_16x16x32_bf16 v[88:91], v[28:31], v[124:127], v[88:91]
    ds_read_b64_tr_b16 v[28:29], v6 offset:17504
    ds_read_b64_tr_b16 v[30:31], v6 offset:17760
    s_waitcnt lgkmcnt(8)
    v_mfma_f32_16x16x32_bf16 v[84:87], v[32:35], v[96:99], v[48:51]
    v_exp_f32 v68, v68
    v_add_f32 v11, v11, v66
    v_mfma_f32_16x16x32_bf16 v[92:95], v[32:35], v[100:103], v[52:55]
    ds_read_b64_tr_b16 v[32:33], v6 offset:17920
    ds_read_b64_tr_b16 v[34:35], v6 offset:18176
    v_add_f32 v11, v11, v67
    v_mfma_f32_16x16x32_bf16 v[84:87], v[36:39], v[104:107], v[84:87]
    v_cvt_pk_bf16_f32 v65, v66, v67
    v_exp_f32 v69, v69
    v_mfma_f32_16x16x32_bf16 v[92:95], v[36:39], v[108:111], v[92:95]
    ds_read_b64_tr_b16 v[36:37], v6 offset:17952
    ds_read_b64_tr_b16 v[38:39], v6 offset:18208
    v_mfma_f32_16x16x32_bf16 v[84:87], v[40:43], v[112:115], v[84:87]
    v_exp_f32 v70, v70
    v_cvt_pk_bf16_f32 v66, v68, v69
    v_mfma_f32_16x16x32_bf16 v[92:95], v[40:43], v[116:119], v[92:95]
    ds_read_b64_tr_b16 v[40:41], v6 offset:17984
    ds_read_b64_tr_b16 v[42:43], v6 offset:18240
    s_add_u32 m0, s40, 69696
    v_mfma_f32_16x16x32_bf16 v[84:87], v[44:47], v[120:123], v[84:87]
    buffer_load_dwordx4 v7, s[4:7], s32 offen offset:1024 nt lds
    s_add_u32 s32, s32, 8192
    v_exp_f32 v71, v71
    v_mfma_f32_16x16x32_bf16 v[92:95], v[44:47], v[124:127], v[92:95]
    ds_read_b64_tr_b16 v[44:45], v6 offset:18016
    ds_read_b64_tr_b16 v[46:47], v6 offset:18272
    s_waitcnt lgkmcnt(8)
    v_mfma_f32_16x16x32_bf16 a[64:67], v[16:19], v[128:131], a[64:67]
    v_add_f32 v11, v11, v68
    v_cvt_pk_bf16_f32 v67, v70, v71
    v_mfma_f32_16x16x32_bf16 a[68:71], v[16:19], v[132:135], a[68:71]
    ds_read_b64_tr_b16 v[16:17], v5 offset:26112
    ds_read_b64_tr_b16 v[18:19], v5 offset:26624
    v_exp_f32 v72, v72
    v_mfma_f32_16x16x32_bf16 a[72:75], v[20:23], v[128:131], a[72:75]
    v_exp_f32 v73, v73
    v_mfma_f32_16x16x32_bf16 a[76:79], v[20:23], v[132:135], a[76:79]
    ds_read_b64_tr_b16 v[20:21], v5 offset:26144
    ds_read_b64_tr_b16 v[22:23], v5 offset:26656
    v_mfma_f32_16x16x32_bf16 a[80:83], v[24:27], v[128:131], a[80:83]
    v_exp_f32 v74, v74
    v_add_f32 v12, v12, v72
    v_add_f32 v12, v12, v73
    v_mfma_f32_16x16x32_bf16 a[84:87], v[24:27], v[132:135], a[84:87]
    ds_read_b64_tr_b16 v[24:25], v5 offset:26176
    ds_read_b64_tr_b16 v[26:27], v5 offset:26688
    v_mfma_f32_16x16x32_bf16 a[88:91], v[28:31], v[128:131], a[88:91]
    v_cvt_pk_bf16_f32 v72, v72, v73
    v_exp_f32 v75, v75
    v_mfma_f32_16x16x32_bf16 a[92:95], v[28:31], v[132:135], a[92:95]
    ds_read_b64_tr_b16 v[28:29], v5 offset:26208
    ds_read_b64_tr_b16 v[30:31], v5 offset:26720
    s_waitcnt lgkmcnt(8)
    v_mfma_f32_16x16x32_bf16 a[64:67], v[32:35], v[136:139], a[64:67]
    v_exp_f32 v76, v76
    v_add_f32 v12, v12, v74
    v_add_f32 v12, v12, v75
    v_mfma_f32_16x16x32_bf16 a[68:71], v[32:35], v[140:143], a[68:71]
    ds_read_b64_tr_b16 v[32:33], v5 offset:26240
    ds_read_b64_tr_b16 v[34:35], v5 offset:26752
    v_mfma_f32_16x16x32_bf16 a[72:75], v[36:39], v[136:139], a[72:75]
    v_cvt_pk_bf16_f32 v73, v74, v75
    v_exp_f32 v77, v77
    v_mfma_f32_16x16x32_bf16 a[76:79], v[36:39], v[140:143], a[76:79]
    ds_read_b64_tr_b16 v[36:37], v5 offset:26272
    ds_read_b64_tr_b16 v[38:39], v5 offset:26784
    v_mfma_f32_16x16x32_bf16 a[80:83], v[40:43], v[136:139], a[80:83]
    v_exp_f32 v78, v78
    v_cvt_pk_bf16_f32 v74, v76, v77
    v_mfma_f32_16x16x32_bf16 a[84:87], v[40:43], v[140:143], a[84:87]
    ds_read_b64_tr_b16 v[40:41], v5 offset:26304
    ds_read_b64_tr_b16 v[42:43], v5 offset:26816
    v_mfma_f32_16x16x32_bf16 a[88:91], v[44:47], v[136:139], a[88:91]
    v_exp_f32 v79, v79
    v_add_f32 v12, v12, v76
    v_cvt_pk_bf16_f32 v75, v78, v79
    v_mfma_f32_16x16x32_bf16 a[92:95], v[44:47], v[140:143], a[92:95]
    ds_read_b64_tr_b16 v[44:45], v5 offset:26336
    ds_read_b64_tr_b16 v[46:47], v5 offset:26848
    s_waitcnt lgkmcnt(10)
    v_mfma_f32_16x16x32_bf16 v[160:163], v[16:19], v[64:67], v[160:163]
    v_add_f32 v11, v11, v69
    v_max3_f32 v13, v80, v81, v82
    v_add_f32 v11, v11, v70
    v_mfma_f32_16x16x32_bf16 v[192:195], v[16:19], v[72:75], v[192:195]
    v_max3_f32 v13, v13, v83, v84
    v_add_f32 v11, v11, v71
    v_max3_f32 v13, v13, v85, v86
    v_mfma_f32_16x16x32_bf16 v[164:167], v[20:23], v[64:67], v[164:167]
    v_add_f32 v12, v12, v77
    v_max3_f32 v13, v13, v87, v88
    v_add_f32 v12, v12, v78
    v_mfma_f32_16x16x32_bf16 v[196:199], v[20:23], v[72:75], v[196:199]
    v_max3_f32 v13, v13, v89, v90
    v_add_f32 v12, v12, v79
    v_mfma_f32_16x16x32_bf16 v[168:171], v[24:27], v[64:67], v[168:171]
    v_max3_f32 v13, v13, v91, v92
    v_max3_f32 v13, v13, v93, v94
    v_max_f32 v13, v13, v95
    v_mfma_f32_16x16x32_bf16 v[200:203], v[24:27], v[72:75], v[200:203]
    s_waitcnt vmcnt(8) lgkmcnt(0)
    s_barrier
    ds_read_b128 v[16:19], v4 offset:34816
    ds_read_b128 v[20:23], v4 offset:34880
    ds_read_b128 v[24:27], v4 offset:34944
    v_mfma_f32_16x16x32_bf16 v[172:175], v[28:31], v[64:67], v[172:175]
    s_add_u32 m0, s39, 78336
    v_cmp_lt_f32 vcc, s46, v13
    buffer_load_dwordx4 v9, s[12:15], s34 offen  lds
    v_mfma_f32_16x16x32_bf16 v[204:207], v[28:31], v[72:75], v[204:207]
    s_add_u32 m0, s39, 78240
    ds_read_b128 v[28:31], v4 offset:35008
    buffer_load_dwordx4 v9, s[12:15], s34 offen offset:1152  lds
    v_mfma_f32_16x16x32_bf16 v[176:179], v[32:35], v[64:67], v[176:179]
    s_add_u32 m0, s39, 87040
    s_sub_u32 s34, s34, 73600
    buffer_load_dwordx4 v9, s[12:15], s34 offen  lds
    v_mfma_f32_16x16x32_bf16 v[208:211], v[32:35], v[72:75], v[208:211]
    s_add_u32 m0, s39, 86944
    ds_read_b128 v[32:35], v4 offset:39168
    buffer_load_dwordx4 v9, s[12:15], s34 offen offset:1152  lds
    v_mfma_f32_16x16x32_bf16 v[180:183], v[36:39], v[64:67], v[180:183]
    v_mfma_f32_16x16x32_bf16 v[212:215], v[36:39], v[72:75], v[212:215]
    ds_read_b128 v[36:39], v4 offset:39232
    v_mfma_f32_16x16x32_bf16 v[184:187], v[40:43], v[64:67], v[184:187]
    v_mfma_f32_16x16x32_bf16 v[216:219], v[40:43], v[72:75], v[216:219]
    ds_read_b128 v[40:43], v4 offset:39296
    v_mfma_f32_16x16x32_bf16 v[188:191], v[44:47], v[64:67], v[188:191]
    v_mfma_f32_16x16x32_bf16 v[220:223], v[44:47], v[72:75], v[220:223]
    ds_read_b128 v[44:47], v4 offset:39360
    s_cbranch_vccnz L_rare_t21
L_back_t21:
    s_waitcnt lgkmcnt(4)
    v_mfma_f32_16x16x32_bf16 v[64:67], v[16:19], v[96:99], v[48:51]
    s_add_u32 m0, s39, 95744
    s_add_u32 s34, s34, 73728
    buffer_load_dwordx4 v8, s[8:11], s33 offen nt lds
    v_mfma_f32_16x16x32_bf16 v[72:75], v[16:19], v[100:103], v[52:55]
    ds_read_b64_tr_b16 v[16:17], v3 offset:0
    ds_read_b64_tr_b16 v[18:19], v3 offset:256
    v_mfma_f32_16x16x32_bf16 v[64:67], v[20:23], v[104:107], v[64:67]
    v_exp_f32 v80, v80
    v_exp_f32 v81, v81
    v_mfma_f32_16x16x32_bf16 v[72:75], v[20:23], v[108:111], v[72:75]
    ds_read_b64_tr_b16 v[20:21], v3 offset:32
    ds_read_b64_tr_b16 v[22:23], v3 offset:288
    v_mfma_f32_16x16x32_bf16 v[64:67], v[24:27], v[112:115], v[64:67]
    v_exp_f32 v82, v82
    v_add_f32 v11, v11, v80
    v_mfma_f32_16x16x32_bf16 v[72:75], v[24:27], v[116:119], v[72:75]
    ds_read_b64_tr_b16 v[24:25], v3 offset:64
    ds_read_b64_tr_b16 v[26:27], v3 offset:320
    v_add_f32 v11, v11, v81
    v_mfma_f32_16x16x32_bf16 v[64:67], v[28:31], v[120:123], v[64:67]
    v_cvt_pk_bf16_f32 v80, v80, v81
    v_exp_f32 v83, v83
    v_mfma_f32_16x16x32_bf16 v[72:75], v[28:31], v[124:127], v[72:75]
    ds_read_b64_tr_b16 v[28:29], v3 offset:96
    ds_read_b64_tr_b16 v[30:31], v3 offset:352
    s_waitcnt lgkmcnt(8)
    v_mfma_f32_16x16x32_bf16 v[68:71], v[32:35], v[96:99], v[48:51]
    v_exp_f32 v84, v84
    v_add_f32 v11, v11, v82
    v_mfma_f32_16x16x32_bf16 v[76:79], v[32:35], v[100:103], v[52:55]
    ds_read_b64_tr_b16 v[32:33], v3 offset:512
    ds_read_b64_tr_b16 v[34:35], v3 offset:768
    v_add_f32 v11, v11, v83
    v_mfma_f32_16x16x32_bf16 v[68:71], v[36:39], v[104:107], v[68:71]
    v_cvt_pk_bf16_f32 v81, v82, v83
    v_exp_f32 v85, v85
    v_mfma_f32_16x16x32_bf16 v[76:79], v[36:39], v[108:111], v[76:79]
    ds_read_b64_tr_b16 v[36:37], v3 offset:544
    ds_read_b64_tr_b16 v[38:39], v3 offset:800
    v_mfma_f32_16x16x32_bf16 v[68:71], v[40:43], v[112:115], v[68:71]
    v_exp_f32 v86, v86
    v_cvt_pk_bf16_f32 v82, v84, v85
    v_mfma_f32_16x16x32_bf16 v[76:79], v[40:43], v[116:119], v[76:79]
    ds_read_b64_tr_b16 v[40:41], v3 offset:576
    ds_read_b64_tr_b16 v[42:43], v3 offset:832
    s_add_u32 m0, s39, 96544
    v_mfma_f32_16x16x32_bf16 v[68:71], v[44:47], v[120:123], v[68:71]
    buffer_load_dwordx4 v8, s[8:11], s33 offen offset:256 nt lds
    s_add_u32 s33, s33, 8192
    v_exp_f32 v87, v87
    v_mfma_f32_16x16x32_bf16 v[76:79], v[44:47], v[124:127], v[76:79]
    ds_read_b64_tr_b16 v[44:45], v3 offset:608
    ds_read_b64_tr_b16 v[46:47], v3 offset:864
    s_waitcnt lgkmcnt(8)
    v_mfma_f32_16x16x32_bf16 a[64:67], v[16:19], v[144:147], a[64:67]
    v_add_f32 v11, v11, v84
    v_cvt_pk_bf16_f32 v83, v86, v87
    v_mfma_f32_16x16x32_bf16 a[68:71], v[16:19], v[148:151], a[68:71]
    ds_read_b64_tr_b16 v[16:17], v2 offset:8704
    ds_read_b64_tr_b16 v[18:19], v2 offset:9216
    v_exp_f32 v88, v88
    v_mfma_f32_16x16x32_bf16 a[72:75], v[20:23], v[144:147], a[72:75]
    v_exp_f32 v89, v89
    v_mfma_f32_16x16x32_bf16 a[76:79], v[20:23], v[148:151], a[76:79]
    ds_read_b64_tr_b16 v[20:21], v2 offset:8736
    ds_read_b64_tr_b16 v[22:23], v2 offset:9248
    v_mfma_f32_16x16x32_bf16 a[80:83], v[24:27], v[144:147], a[80:83]
    v_exp_f32 v90, v90
    v_add_f32 v12, v12, v88
    v_add_f32 v12, v12, v89
    v_mfma_f32_16x16x32_bf16 a[84:87], v[24:27], v[148:151], a[84:87]
    ds_read_b64_tr_b16 v[24:25], v2 offset:8768
    ds_read_b64_tr_b16 v[26:27], v2 offset:9280
    v_mfma_f32_16x16x32_bf16 a[88:91], v[28:31], v[144:147], a[88:91]
    v_cvt_pk_bf16_f32 v88, v88, v89
    v_exp_f32 v91, v91
    v_mfma_f32_16x16x32_bf16 a[92:95], v[28:31], v[148:151], a[92:95]
    ds_read_b64_tr_b16 v[28:29], v2 offset:8800
    ds_read_b64_tr_b16 v[30:31], v2 offset:9312
    s_waitcnt lgkmcnt(8)
    v_mfma_f32_16x16x32_bf16 a[64:67], v[32:35], v[152:155], a[64:67]
    v_exp_f32 v92, v92
    v_add_f32 v12, v12, v90
    v_add_f32 v12, v12, v91
    v_mfma_f32_16x16x32_bf16 a[68:71], v[32:35], v[156:159], a[68:71]
    ds_read_b64_tr_b16 v[32:33], v2 offset:8832
    ds_read_b64_tr_b16 v[34:35], v2 offset:9344
    v_mfma_f32_16x16x32_bf16 a[72:75], v[36:39], v[152:155], a[72:75]
    v_cvt_pk_bf16_f32 v89, v90, v91
    v_exp_f32 v93, v93
    v_mfma_f32_16x16x32_bf16 a[76:79], v[36:39], v[156:159], a[76:79]
    ds_read_b64_tr_b16 v[36:37], v2 offset:8864
    ds_read_b64_tr_b16 v[38:39], v2 offset:9376
    v_mfma_f32_16x16x32_bf16 a[80:83], v[40:43], v[152:155], a[80:83]
    v_exp_f32 v94, v94
    v_cvt_pk_bf16_f32 v90, v92, v93
    v_mfma_f32_16x16x32_bf16 a[84:87], v[40:43], v[156:159], a[84:87]
    ds_read_b64_tr_b16 v[40:41], v2 offset:8896
    ds_read_b64_tr_b16 v[42:43], v2 offset:9408
    v_mfma_f32_16x16x32_bf16 a[88:91], v[44:47], v[152:155], a[88:91]
    v_exp_f32 v95, v95
    v_add_f32 v12, v12, v92
    v_cvt_pk_bf16_f32 v91, v94, v95
    v_mfma_f32_16x16x32_bf16 a[92:95], v[44:47], v[156:159], a[92:95]
    ds_read_b64_tr_b16 v[44:45], v2 offset:8928
    ds_read_b64_tr_b16 v[46:47], v2 offset:9440
    s_waitcnt lgkmcnt(10)
    v_mfma_f32_16x16x32_bf16 v[160:163], v[16:19], v[80:83], v[160:163]
    v_add_f32 v11, v11, v85
    v_max3_f32 v13, v64, v65, v66
    v_add_f32 v11, v11, v86
    v_mfma_f32_16x16x32_bf16 v[192:195], v[16:19], v[88:91], v[192:195]
    v_max3_f32 v13, v13, v67, v68
    v_add_f32 v11, v11, v87
    v_max3_f32 v13, v13, v69, v70
    v_mfma_f32_16x16x32_bf16 v[164:167], v[20:23], v[80:83], v[164:167]
    v_add_f32 v12, v12, v93
    v_max3_f32 v13, v13, v71, v72
    v_add_f32 v12, v12, v94
    v_mfma_f32_16x16x32_bf16 v[196:199], v[20:23], v[88:91], v[196:199]
    v_max3_f32 v13, v13, v73, v74
    v_add_f32 v12, v12, v95
    v_mfma_f32_16x16x32_bf16 v[168:171], v[24:27], v[80:83], v[168:171]
    v_max3_f32 v13, v13, v75, v76
    v_max3_f32 v13, v13, v77, v78
    v_max_f32 v13, v13, v79
    v_mfma_f32_16x16x32_bf16 v[200:203], v[24:27], v[88:91], v[200:203]
    s_waitcnt vmcnt(8) lgkmcnt(0)
    s_barrier
    ds_read_b128 v[16:19], v1 offset:17408
    ds_read_b128 v[20:23], v1 offset:17472
    ds_read_b128 v[24:27], v1 offset:17536
    v_mfma_f32_16x16x32_bf16 v[172:175], v[28:31], v[80:83], v[172:175]
    s_add_u32 m0, s40, 104448
    v_cmp_lt_f32 vcc, s46, v13
    buffer_load_dwordx4 v7, s[4:7], s32 offen nt lds
    v_mfma_f32_16x16x32_bf16 v[204:207], v[28:31], v[88:91], v[204:207]
    s_add_u32 m0, s40, 104512
    ds_read_b128 v[28:31], v1 offset:17600
    buffer_load_dwordx4 v7, s[4:7], s32 offen offset:1024 nt lds
    v_mfma_f32_16x16x32_bf16 v[176:179], v[32:35], v[80:83], v[176:179]
    s_add_u32 m0, s39, 26112
    s_add_u32 s32, s32, 8192
    buffer_load_dwordx4 v9, s[12:15], s34 offen  lds
    v_mfma_f32_16x16x32_bf16 v[208:211], v[32:35], v[88:91], v[208:211]
    s_add_u32 m0, s39, 26016
    ds_read_b128 v[32:35], v1 offset:21760
    buffer_load_dwordx4 v9, s[12:15], s34 offen offset:1152  lds
    v_mfma_f32_16x16x32_bf16 v[180:183], v[36:39], v[80:83], v[180:183]
    v_mfma_f32_16x16x32_bf16 v[212:215], v[36:39], v[88:91], v[212:215]
    ds_read_b128 v[36:39], v1 offset:21824
    v_mfma_f32_16x16x32_bf16 v[184:187], v[40:43], v[80:83], v[184:187]
    v_mfma_f32_16x16x32_bf16 v[216:219], v[40:43], v[88:91], v[216:219]
    ds_read_b128 v[40:43], v1 offset:21888
    v_mfma_f32_16x16x32_bf16 v[188:191], v[44:47], v[80:83], v[188:191]
    v_mfma_f32_16x16x32_bf16 v[220:223], v[44:47], v[88:91], v[220:223]
    ds_read_b128 v[44:47], v1 offset:21952
    s_cbranch_vccnz L_rare_t22
L_back_t22:
    s_waitcnt lgkmcnt(4)
    v_mfma_f32_16x16x32_bf16 v[80:83], v[16:19], v[96:99], v[48:51]
    s_add_u32 m0, s39, 34816
    s_sub_u32 s34, s34, 73600
    buffer_load_dwordx4 v8, s[8:11], s33 offen nt lds
    v_mfma_f32_16x16x32_bf16 v[88:91], v[16:19], v[100:103], v[52:55]
    ds_read_b64_tr_b16 v[16:17], v3 offset:26112
    ds_read_b64_tr_b16 v[18:19], v3 offset:26368
    v_mfma_f32_16x16x32_bf16 v[80:83], v[20:23], v[104:107], v[80:83]
    v_exp_f32 v64, v64
    v_exp_f32 v65, v65
    v_mfma_f32_16x16x32_bf16 v[88:91], v[20:23], v[108:111], v[88:91]
    ds_read_b64_tr_b16 v[20:21], v3 offset:26144
    ds_read_b64_tr_b16 v[22:23], v3 offset:26400
    v_mfma_f32_16x16x32_bf16 v[80:83], v[24:27], v[112:115], v[80:83]
    v_exp_f32 v66, v66
    v_add_f32 v11, v11, v64
    v_mfma_f32_16x16x32_bf16 v[88:91], v[24:27], v[116:119], v[88:91]
    ds_read_b64_tr_b16 v[24:25], v3 offset:26176
    ds_read_b64_tr_b16 v[26:27], v3 offset:26432
    v_add_f32 v11, v11, v65
    v_mfma_f32_16x16x32_bf16 v[80:83], v[28:31], v[120:123], v[80:83]
    v_cvt_pk_bf16_f32 v64, v64, v65
    v_exp_f32 v67, v67
    v_mfma_f32_16x16x32_bf16 v[88:91], v[28:31], v[124:127], v[88:91]
    ds_read_b64_tr_b16 v[28:29], v3 offset:26208
    ds_read_b64_tr_b16 v[30:31], v3 offset:26464
    s_waitcnt lgkmcnt(8)
    v_mfma_f32_16x16x32_bf16 v[84:87], v[32:35], v[96:99], v[48:51]
    v_exp_f32 v68, v68
    v_add_f32 v11, v11, v66
    v_mfma_f32_16x16x32_bf16 v[92:95], v[32:35], v[100:103], v[52:55]
    ds_read_b64_tr_b16 v[32:33], v3 offset:26624
    ds_read_b64_tr_b16 v[34:35], v3 offset:26880
    v_add_f32 v11, v11, v67
    v_mfma_f32_16x16x32_bf16 v[84:87], v[36:39], v[104:107], v[84:87]
    v_cvt_pk_bf16_f32 v65, v66, v67
    v_exp_f32 v69, v69
    v_mfma_f32_16x16x32_bf16 v[92:95], v[36:39], v[108:111], v[92:95]
    ds_read_b64_tr_b16 v[36:37], v3 offset:26656
    ds_read_b64_tr_b16 v[38:39], v3 offset:26912
    v_mfma_f32_16x16x32_bf16 v[84:87], v[40:43], v[112:115], v[84:87]
    v_exp_f32 v70, v70
    v_cvt_pk_bf16_f32 v66, v68, v69
    v_mfma_f32_16x16x32_bf16 v[92:95], v[40:43], v[116:119], v[92:95]
    ds_read_b64_tr_b16 v[40:41], v3 offset:26688
    ds_read_b64_tr_b16 v[42:43], v3 offset:26944
    s_add_u32 m0, s39, 35616
    v_mfma_f32_16x16x32_bf16 v[84:87], v[44:47], v[120:123], v[84:87]
    buffer_load_dwordx4 v8, s[8:11], s33 offen offset:256 nt lds
    s_add_u32 s33, s33, 8192
    v_exp_f32 v71, v71
    v_mfma_f32_16x16x32_bf16 v[92:95], v[44:47], v[124:127], v[92:95]
    ds_read_b64_tr_b16 v[44:45], v3 offset:26720
    ds_read_b64_tr_b16 v[46:47], v3 offset:26976
    s_waitcnt lgkmcnt(8)
    v_mfma_f32_16x16x32_bf16 a[96:99], v[16:19], v[128:131], a[96:99]
    v_add_f32 v11, v11, v68
    v_cvt_pk_bf16_f32 v67, v70, v71
    v_mfma_f32_16x16x32_bf16 a[100:103], v[16:19], v[132:135], a[100:103]
    ds_read_b64_tr_b16 v[16:17], v2 offset:34816
    ds_read_b64_tr_b16 v[18:19], v2 offset:35328
    v_exp_f32 v72, v72
    v_mfma_f32_16x16x32_bf16 a[104:107], v[20:23], v[128:131], a[104:107]
    v_exp_f32 v73, v73
    v_mfma_f32_16x16x32_bf16 a[108:111], v[20:23], v[132:135], a[108:111]
    ds_read_b64_tr_b16 v[20:21], v2 offset:34848
    ds_read_b64_tr_b16 v[22:23], v2 offset:35360
    v_mfma_f32_16x16x32_bf16 a[112:115], v[24:27], v[128:131], a[112:115]
    v_exp_f32 v74, v74
    v_add_f32 v12, v12, v72
    v_add_f32 v12, v12, v73
    v_mfma_f32_16x16x32_bf16 a[116:119], v[24:27], v[132:135], a[116:119]
    ds_read_b64_tr_b16 v[24:25], v2 offset:34880
    ds_read_b64_tr_b16 v[26:27], v2 offset:35392
    v_mfma_f32_16x16x32_bf16 a[120:123], v[28:31], v[128:131], a[120:123]
    v_cvt_pk_bf16_f32 v72, v72, v73
    v_exp_f32 v75, v75
    v_mfma_f32_16x16x32_bf16 a[124:127], v[28:31], v[132:135], a[124:127]
    ds_read_b64_tr_b16 v[28:29], v2 offset:34912
    ds_read_b64_tr_b16 v[30:31], v2 offset:35424
    s_waitcnt lgkmcnt(8)
    v_mfma_f32_16x16x32_bf16 a[96:99], v[32:35], v[136:139], a[96:99]
    v_exp_f32 v76, v76
    v_add_f32 v12, v12, v74
    v_add_f32 v12, v12, v75
    v_mfma_f32_16x16x32_bf16 a[100:103], v[32:35], v[140:143], a[100:103]
    ds_read_b64_tr_b16 v[32:33], v2 offset:34944
    ds_read_b64_tr_b16 v[34:35], v2 offset:35456
    v_mfma_f32_16x16x32_bf16 a[104:107], v[36:39], v[136:139], a[104:107]
    v_cvt_pk_bf16_f32 v73, v74, v75
    v_exp_f32 v77, v77
    v_mfma_f32_16x16x32_bf16 a[108:111], v[36:39], v[140:143], a[108:111]
    ds_read_b64_tr_b16 v[36:37], v2 offset:34976
    ds_read_b64_tr_b16 v[38:39], v2 offset:35488
    v_mfma_f32_16x16x32_bf16 a[112:115], v[40:43], v[136:139], a[112:115]
    v_exp_f32 v78, v78
    v_cvt_pk_bf16_f32 v74, v76, v77
    v_mfma_f32_16x16x32_bf16 a[116:119], v[40:43], v[140:143], a[116:119]
    ds_read_b64_tr_b16 v[40:41], v2 offset:35008
    ds_read_b64_tr_b16 v[42:43], v2 offset:35520
    v_mfma_f32_16x16x32_bf16 a[120:123], v[44:47], v[136:139], a[120:123]
    v_exp_f32 v79, v79
    v_add_f32 v12, v12, v76
    v_cvt_pk_bf16_f32 v75, v78, v79
    v_mfma_f32_16x16x32_bf16 a[124:127], v[44:47], v[140:143], a[124:127]
    ds_read_b64_tr_b16 v[44:45], v2 offset:35040
    ds_read_b64_tr_b16 v[46:47], v2 offset:35552
    s_waitcnt lgkmcnt(10)
    v_mfma_f32_16x16x32_bf16 v[160:163], v[16:19], v[64:67], v[160:163]
    v_add_f32 v11, v11, v69
    v_max3_f32 v13, v80, v81, v82
    v_add_f32 v11, v11, v70
    v_mfma_f32_16x16x32_bf16 v[192:195], v[16:19], v[72:75], v[192:195]
    v_max3_f32 v13, v13, v83, v84
    v_add_f32 v11, v11, v71
    v_max3_f32 v13, v13, v85, v86
    v_mfma_f32_16x16x32_bf16 v[164:167], v[20:23], v[64:67], v[164:167]
    v_add_f32 v12, v12, v77
    v_max3_f32 v13, v13, v87, v88
    v_add_f32 v12, v12, v78
    v_mfma_f32_16x16x32_bf16 v[196:199], v[20:23], v[72:75], v[196:199]
    v_max3_f32 v13, v13, v89, v90
    v_add_f32 v12, v12, v79
    v_mfma_f32_16x16x32_bf16 v[168:171], v[24:27], v[64:67], v[168:171]
    v_max3_f32 v13, v13, v91, v92
    v_max3_f32 v13, v13, v93, v94
    v_max_f32 v13, v13, v95
    v_mfma_f32_16x16x32_bf16 v[200:203], v[24:27], v[72:75], v[200:203]
    s_waitcnt vmcnt(6) lgkmcnt(0)
    s_barrier
    ds_read_b128 v[16:19], v4 offset:0
    ds_read_b128 v[20:23], v4 offset:64
    ds_read_b128 v[24:27], v4 offset:128
    v_mfma_f32_16x16x32_bf16 v[172:175], v[28:31], v[64:67], v[172:175]
    s_add_u32 m0, s40, 43520
    v_cmp_lt_f32 vcc, s46, v13
    buffer_load_dwordx4 v7, s[4:7], s32 offen nt lds
    v_mfma_f32_16x16x32_bf16 v[204:207], v[28:31], v[72:75], v[204:207]
    s_add_u32 m0, s40, 43584
    ds_read_b128 v[28:31], v4 offset:192
    buffer_load_dwordx4 v7, s[4:7], s32 offen offset:1024 nt lds
    v_mfma_f32_16x16x32_bf16 v[176:179], v[32:35], v[64:67], v[176:179]
    s_add_u32 m0, s39, 52224
    s_add_u32 s32, s32, 8192
    buffer_load_dwordx4 v9, s[12:15], s34 offen  lds
    v_mfma_f32_16x16x32_bf16 v[208:211], v[32:35], v[72:75], v[208:211]
    s_add_u32 m0, s39, 52128
    ds_read_b128 v[32:35], v4 offset:4352
    buffer_load_dwordx4 v9, s[12:15], s34 offen offset:1152  lds
    v_mfma_f32_16x16x32_bf16 v[180:183], v[36:39], v[64:67], v[180:183]
    v_mfma_f32_16x16x32_bf16 v[212:215], v[36:39], v[72:75], v[212:215]
    ds_read_b128 v[36:39], v4 offset:4416
    v_mfma_f32_16x16x32_bf16 v[184:187], v[40:43], v[64:67], v[184:187]
    v_mfma_f32_16x16x32_bf16 v[216:219], v[40:43], v[72:75], v[216:219]
    ds_read_b128 v[40:43], v4 offset:4480
    v_mfma_f32_16x16x32_bf16 v[188:191], v[44:47], v[64:67], v[188:191]
    v_mfma_f32_16x16x32_bf16 v[220:223], v[44:47], v[72:75], v[220:223]
    ds_read_b128 v[44:47], v4 offset:4544
    s_cbranch_vccnz L_rare_t23
L_back_t23:
    s_waitcnt lgkmcnt(4)
    v_mfma_f32_16x16x32_bf16 v[64:67], v[16:19], v[96:99], v[48:51]
    s_add_u32 m0, s39, 60928
    s_add_u32 s34, s34, 73728
    buffer_load_dwordx4 v8, s[8:11], s33 offen nt lds
    v_mfma_f32_16x16x32_bf16 v[72:75], v[16:19], v[100:103], v[52:55]
    ds_read_b64_tr_b16 v[16:17], v6 offset:8704
    ds_read_b64_tr_b16 v[18:19], v6 offset:8960
    v_mfma_f32_16x16x32_bf16 v[64:67], v[20:23], v[104:107], v[64:67]
    v_exp_f32 v80, v80
    v_mfma_f32_16x16x32_bf16 v[72:75], v[20:23], v[108:111], v[72:75]
    ds_read_b64_tr_b16 v[20:21], v6 offset:8736
    ds_read_b64_tr_b16 v[22:23], v6 offset:8992
    v_mfma_f32_16x16x32_bf16 v[64:67], v[24:27], v[112:115], v[64:67]
    v_exp_f32 v81, v81
    v_mfma_f32_16x16x32_bf16 v[72:75], v[24:27], v[116:119], v[72:75]
    ds_read_b64_tr_b16 v[24:25], v6 offset:8768
    ds_read_b64_tr_b16 v[26:27], v6 offset:9024
    v_mfma_f32_16x16x32_bf16 v[64:67], v[28:31], v[120:123], v[64:67]
    v_exp_f32 v82, v82
    v_add_f32 v11, v11, v80
    v_mfma_f32_16x16x32_bf16 v[72:75], v[28:31], v[124:127], v[72:75]
    ds_read_b64_tr_b16 v[28:29], v6 offset:8800
    ds_read_b64_tr_b16 v[30:31], v6 offset:9056
    s_waitcnt lgkmcnt(8)
    v_mfma_f32_16x16x32_bf16 v[68:71], v[32:35], v[96:99], v[48:51]
    v_add_f32 v11, v11, v81
    v_cvt_pk_bf16_f32 v80, v80, v81
    v_mfma_f32_16x16x32_bf16 v[76:79], v[32:35], v[100:103], v[52:55]
    ds_read_b64_tr_b16 v[32:33], v6 offset:9216
    ds_read_b64_tr_b16 v[34:35], v6 offset:9472
    v_mfma_f32_16x16x32_bf16 v[68:71], v[36:39], v[104:107], v[68:71]
    v_exp_f32 v83, v83
    v_mfma_f32_16x16x32_bf16 v[76:79], v[36:39], v[108:111], v[76:79]
    ds_read_b64_tr_b16 v[36:37], v6 offset:9248
    ds_read_b64_tr_b16 v[38:39], v6 offset:9504
    v_mfma_f32_16x16x32_bf16 v[68:71], v[40:43], v[112:115], v[68:71]
    v_exp_f32 v84, v84
    v_add_f32 v11, v11, v82
    v_mfma_f32_16x16x32_bf16 v[76:79], v[40:43], v[116:119], v[76:79]
    ds_read_b64_tr_b16 v[40:41], v6 offset:9280
    ds_read_b64_tr_b16 v[42:43], v6 offset:9536
    v_mfma_f32_16x16x32_bf16 v[68:71], v[44:47], v[120:123], v[68:71]
    v_add_f32 v11, v11, v83
    v_cvt_pk_bf16_f32 v81, v82, v83
    v_mfma_f32_16x16x32_bf16 v[76:79], v[44:47], v[124:127], v[76:79]
    ds_read_b64_tr_b16 v[44:45], v6 offset:9312
    ds_read_b64_tr_b16 v[46:47], v6 offset:9568
    s_waitcnt lgkmcnt(8)
    v_mfma_f32_16x16x32_bf16 a[96:99], v[16:19], v[144:147], a[96:99]
    v_exp_f32 v85, v85
    v_mfma_f32_16x16x32_bf16 a[100:103], v[16:19], v[148:151], a[100:103]
    ds_read_b64_tr_b16 v[16:17], v6 offset:17408
    ds_read_b64_tr_b16 v[18:19], v6 offset:17664
    v_mfma_f32_16x16x32_bf16 a[104:107], v[20:23], v[144:147], a[104:107]
    v_exp_f32 v86, v86
    v_cvt_pk_bf16_f32 v82, v84, v85
    v_mfma_f32_16x16x32_bf16 a[108:111], v[20:23], v[148:151], a[108:111]
    ds_read_b64_tr_b16 v[20:21], v6 offset:17440
    ds_read_b64_tr_b16 v[22:23], v6 offset:17696
    s_add_u32 m0, s39, 61728
    v_mfma_f32_16x16x32_bf16 a[112:115], v[24:27], v[144:147], a[112:115]
    buffer_load_dwordx4 v8, s[8:11], s33 offen offset:256 nt lds
    s_add_u32 s33, s33, 8192
    v_mfma_f32_16x16x32_bf16 a[116:119], v[24:27], v[148:151], a[116:119]
    ds_read_b64_tr_b16 v[24:25], v6 offset:17472
    ds_read_b64_tr_b16 v[26:27], v6 offset:17728
    v_mfma_f32_16x16x32_bf16 a[120:123], v[28:31], v[144:147], a[120:123]
    v_exp_f32 v87, v87
    v_mfma_f32_16x16x32_bf16 a[124:127], v[28:31], v[148:151], a[124:127]
    ds_read_b64_tr_b16 v[28:29], v6 offset:17504
    ds_read_b64_tr_b16 v[30:31], v6 offset:17760
    v_add_f32 v11, v11, v84
    s_waitcnt lgkmcnt(8)
    v_mfma_f32_16x16x32_bf16 a[96:99], v[32:35], v[152:155], a[96:99]
    v_cvt_pk_bf16_f32 v83, v86, v87
    v_mfma_f32_16x16x32_bf16 a[100:103], v[32:35], v[156:159], a[100:103]
    ds_read_b64_tr_b16 v[32:33], v6 offset:17920
    ds_read_b64_tr_b16 v[34:35], v6 offset:18176
    v_mfma_f32_16x16x32_bf16 a[104:107], v[36:39], v[152:155], a[104:107]
    v_exp_f32 v88, v88
    v_mfma_f32_16x16x32_bf16 a[108:111], v[36:39], v[156:159], a[108:111]
    ds_read_b64_tr_b16 v[36:37], v6 offset:17952
    ds_read_b64_tr_b16 v[38:39], v6 offset:18208
    v_mfma_f32_16x16x32_bf16 a[112:115], v[40:43], v[152:155], a[112:115]
    v_exp_f32 v89, v89
    v_mfma_f32_16x16x32_bf16 a[116:119], v[40:43], v[156:159], a[116:119]
    ds_read_b64_tr_b16 v[40:41], v6 offset:17984
    ds_read_b64_tr_b16 v[42:43], v6 offset:18240
    v_mfma_f32_16x16x32_bf16 a[120:123], v[44:47], v[152:155], a[120:123]
    v_exp_f32 v90, v90
    v_add_f32 v12, v12, v88
    v_mfma_f32_16x16x32_bf16 a[124:127], v[44:47], v[156:159], a[124:127]
    ds_read_b64_tr_b16 v[44:45], v6 offset:18016
    ds_read_b64_tr_b16 v[46:47], v6 offset:18272
    s_waitcnt lgkmcnt(8)
    v_mfma_f32_16x16x32_bf16 a[128:131], v[16:19], v[128:131], a[128:131]
    v_add_f32 v12, v12, v89
    v_cvt_pk_bf16_f32 v88, v88, v89
    v_mfma_f32_16x16x32_bf16 a[132:135], v[16:19], v[132:135], a[132:135]
    ds_read_b64_tr_b16 v[16:17], v5 offset:26112
    ds_read_b64_tr_b16 v[18:19], v5 offset:26624
    v_mfma_f32_16x16x32_bf16 a[136:139], v[20:23], v[128:131], a[136:139]
    v_exp_f32 v91, v91
    v_mfma_f32_16x16x32_bf16 a[140:143], v[20:23], v[132:135], a[140:143]
    ds_read_b64_tr_b16 v[20:21], v5 offset:26144
    ds_read_b64_tr_b16 v[22:23], v5 offset:26656
    v_mfma_f32_16x16x32_bf16 a[144:147], v[24:27], v[128:131], a[144:147]
    v_exp_f32 v92, v92
    v_add_f32 v12, v12, v90
    v_mfma_f32_16x16x32_bf16 a[148:151], v[24:27], v[132:135], a[148:151]
    ds_read_b64_tr_b16 v[24:25], v5 offset:26176
    ds_read_b64_tr_b16 v[26:27], v5 offset:26688
    v_mfma_f32_16x16x32_bf16 a[152:155], v[28:31], v[128:131], a[152:155]
    v_add_f32 v12, v12, v91
    v_cvt_pk_bf16_f32 v89, v90, v91
    v_mfma_f32_16x16x32_bf16 a[156:159], v[28:31], v[132:135], a[156:159]
    ds_read_b64_tr_b16 v[28:29], v5 offset:26208
    ds_read_b64_tr_b16 v[30:31], v5 offset:26720
    s_waitcnt lgkmcnt(8)
    v_mfma_f32_16x16x32_bf16 a[128:131], v[32:35], v[136:139], a[128:131]
    v_exp_f32 v93, v93
    v_mfma_f32_16x16x32_bf16 a[132:135], v[32:35], v[140:143], a[132:135]
    ds_read_b64_tr_b16 v[32:33], v5 offset:26240
    ds_read_b64_tr_b16 v[34:35], v5 offset:26752
    v_mfma_f32_16x16x32_bf16 a[136:139], v[36:39], v[136:139], a[136:139]
    v_exp_f32 v94, v94
    v_cvt_pk_bf16_f32 v90, v92, v93
    v_mfma_f32_16x16x32_bf16 a[140:143], v[36:39], v[140:143], a[140:143]
    ds_read_b64_tr_b16 v[36:37], v5 offset:26272
    ds_read_b64_tr_b16 v[38:39], v5 offset:26784
    v_mfma_f32_16x16x32_bf16 a[144:147], v[40:43], v[136:139], a[144:147]
    v_exp_f32 v95, v95
    v_mfma_f32_16x16x32_bf16 a[148:151], v[40:43], v[140:143], a[148:151]
    ds_read_b64_tr_b16 v[40:41], v5 offset:26304
    ds_read_b64_tr_b16 v[42:43], v5 offset:26816
    v_mfma_f32_16x16x32_bf16 a[152:155], v[44:47], v[136:139], a[152:155]
    v_add_f32 v12, v12, v92
    v_cvt_pk_bf16_f32 v91, v94, v95
    v_mfma_f32_16x16x32_bf16 a[156:159], v[44:47], v[140:143], a[156:159]
    ds_read_b64_tr_b16 v[44:45], v5 offset:26336
    ds_read_b64_tr_b16 v[46:47], v5 offset:26848
    s_waitcnt lgkmcnt(10)
    v_mfma_f32_16x16x32_bf16 v[160:163], v[16:19], v[80:83], v[160:163]
    v_add_f32 v11, v11, v85
    v_max3_f32 v13, v64, v65, v66
    v_add_f32 v11, v11, v86
    v_mfma_f32_16x16x32_bf16 v[192:195], v[16:19], v[88:91], v[192:195]
    v_max3_f32 v13, v13, v67, v68
    v_add_f32 v11, v11, v87
    v_mfma_f32_16x16x32_bf16 v[164:167], v[20:23], v[80:83], v[164:167]
    v_max3_f32 v13, v13, v69, v70
    v_add_f32 v12, v12, v93
    v_mfma_f32_16x16x32_bf16 v[196:199], v[20:23], v[88:91], v[196:199]
    v_max3_f32 v13, v13, v71, v72
    v_add_f32 v12, v12, v94
    v_mfma_f32_16x16x32_bf16 v[168:171], v[24:27], v[80:83], v[168:171]
    v_max3_f32 v13, v13, v73, v74
    v_add_f32 v12, v12, v95
    v_mfma_f32_16x16x32_bf16 v[200:203], v[24:27], v[88:91], v[200:203]
    s_waitcnt vmcnt(6) lgkmcnt(0)
    s_barrier
    ds_read_b128 v[16:19], v4 offset:34816
    ds_read_b128 v[20:23], v4 offset:34880
    ds_read_b128 v[24:27], v4 offset:34944
    v_mfma_f32_16x16x32_bf16 v[172:175], v[28:31], v[80:83], v[172:175]
    v_max3_f32 v13, v13, v75, v76
    v_mfma_f32_16x16x32_bf16 v[204:207], v[28:31], v[88:91], v[204:207]
    ds_read_b128 v[28:31], v4 offset:35008
    v_max3_f32 v13, v13, v77, v78
    v_mfma_f32_16x16x32_bf16 v[176:179], v[32:35], v[80:83], v[176:179]
    v_max_f32 v13, v13, v79
    v_cmp_lt_f32 vcc, s46, v13
    v_mfma_f32_16x16x32_bf16 v[208:211], v[32:35], v[88:91], v[208:211]
    s_add_u32 m0, s40, 69632
    ds_read_b128 v[32:35], v4 offset:39168
    buffer_load_dwordx4 v7, s[4:7], s32 offen nt lds
    s_add_u32 m0, s40, 69696
    v_mfma_f32_16x16x32_bf16 v[180:183], v[36:39], v[80:83], v[180:183]
    buffer_load_dwordx4 v7, s[4:7], s32 offen offset:1024 nt lds
    v_mfma_f32_16x16x32_bf16 v[212:215], v[36:39], v[88:91], v[212:215]
    ds_read_b128 v[36:39], v4 offset:39232
    s_add_u32 m0, s39, 78336
    s_add_u32 s32, s32, 8192
    buffer_load_dwordx4 v9, s[12:15], s34 offen  lds
    s_add_u32 m0, s39, 78240
    v_mfma_f32_16x16x32_bf16 v[184:187], v[40:43], v[80:83], v[184:187]
    buffer_load_dwordx4 v9, s[12:15], s34 offen offset:1152  lds
    v_mfma_f32_16x16x32_bf16 v[216:219], v[40:43], v[88:91], v[216:219]
    ds_read_b128 v[40:43], v4 offset:39296
    s_add_u32 m0, s39, 87040
    s_sub_u32 s34, s34, 73600
    buffer_load_dwordx4 v8, s[8:11], s33 offen nt lds
    s_add_u32 m0, s39, 87840
    v_mfma_f32_16x16x32_bf16 v[188:191], v[44:47], v[80:83], v[188:191]
    buffer_load_dwordx4 v8, s[8:11], s33 offen offset:256 nt lds
    v_mfma_f32_16x16x32_bf16 v[220:223], v[44:47], v[88:91], v[220:223]
    ds_read_b128 v[44:47], v4 offset:39360
    s_cbranch_vccnz L_rare_t24
L_back_t24:
    s_waitcnt lgkmcnt(4)
    v_mfma_f32_16x16x32_bf16 v[80:83], v[16:19], v[96:99], v[48:51]
    s_add_u32 m0, s40, 95744
    s_add_u32 s33, s33, 8192
    buffer_load_dwordx4 v7, s[4:7], s32 offen nt lds
    v_mfma_f32_16x16x32_bf16 v[88:91], v[16:19], v[100:103], v[52:55]
    ds_read_b64_tr_b16 v[16:17], v3 offset:0
    ds_read_b64_tr_b16 v[18:19], v3 offset:256
    v_mfma_f32_16x16x32_bf16 v[80:83], v[20:23], v[104:107], v[80:83]
    v_exp_f32 v64, v64
    v_exp_f32 v65, v65
    v_mfma_f32_16x16x32_bf16 v[88:91], v[20:23], v[108:111], v[88:91]
    ds_read_b64_tr_b16 v[20:21], v3 offset:32
    ds_read_b64_tr_b16 v[22:23], v3 offset:288
    v_mfma_f32_16x16x32_bf16 v[80:83], v[24:27], v[112:115], v[80:83]
    v_exp_f32 v66, v66
    v_add_f32 v11, v11, v64
    v_mfma_f32_16x16x32_bf16 v[88:91], v[24:27], v[116:119], v[88:91]
    ds_read_b64_tr_b16 v[24:25], v3 offset:64
    ds_read_b64_tr_b16 v[26:27], v3 offset:320
    v_add_f32 v11, v11, v65
    v_mfma_f32_16x16x32_bf16 v[80:83], v[28:31], v[120:123], v[80:83]
    v_cvt_pk_bf16_f32 v64, v64, v65
    v_exp_f32 v67, v67
    v_mfma_f32_16x16x32_bf16 v[88:91], v[28:31], v[124:127], v[88:91]
    ds_read_b64_tr_b16 v[28:29], v3 offset:96
    ds_read_b64_tr_b16 v[30:31], v3 offset:352
    s_waitcnt lgkmcnt(8)
    v_mfma_f32_16x16x32_bf16 v[84:87], v[32:35], v[96:99], v[48:51]
    v_exp_f32 v68, v68
    v_add_f32 v11, v11, v66
    v_mfma_f32_16x16x32_bf16 v[92:95], v[32:35], v[100:103], v[52:55]
    ds_read_b64_tr_b16 v[32:33], v3 offset:512
    ds_read_b64_tr_b16 v[34:35], v3 offset:768
    v_add_f32 v11, v11, v67
    v_mfma_f32_16x16x32_bf16 v[84:87], v[36:39], v[104:107], v[84:87]
    v_cvt_pk_bf16_f32 v65, v66, v67
    v_exp_f32 v69, v69
    v_mfma_f32_16x16x32_bf16 v[92:95], v[36:39], v[108:111], v[92:95]
    ds_read_b64_tr_b16 v[36:37], v3 offset:544
    ds_read_b64_tr_b16 v[38:39], v3 offset:800
    v_mfma_f32_16x16x32_bf16 v[84:87], v[40:43], v[112:115], v[84:87]
    v_exp_f32 v70, v70
    v_cvt_pk_bf16_f32 v66, v68, v69
    v_mfma_f32_16x16x32_bf16 v[92:95], v[40:43], v[116:119], v[92:95]
    ds_read_b64_tr_b16 v[40:41], v3 offset:576
    ds_read_b64_tr_b16 v[42:43], v3 offset:832
    s_add_u32 m0, s40, 95808
    v_mfma_f32_16x16x32_bf16 v[84:87], v[44:47], v[120:123], v[84:87]
    buffer_load_dwordx4 v7, s[4:7], s32 offen offset:1024 nt lds
    s_add_u32 s32, s32, 8192
    v_exp_f32 v71, v71
    v_mfma_f32_16x16x32_bf16 v[92:95], v[44:47], v[124:127], v[92:95]
    ds_read_b64_tr_b16 v[44:45], v3 offset:608
    ds_read_b64_tr_b16 v[46:47], v3 offset:864
    s_waitcnt lgkmcnt(8)
    v_mfma_f32_16x16x32_bf16 a[128:131], v[16:19], v[144:147], a[128:131]
    v_add_f32 v11, v11, v68
    v_cvt_pk_bf16_f32 v67, v70, v71
    v_mfma_f32_16x16x32_bf16 a[132:135], v[16:19], v[148:151], a[132:135]
    ds_read_b64_tr_b16 v[16:17], v2 offset:8704
    ds_read_b64_tr_b16 v[18:19], v2 offset:9216
    v_exp_f32 v72, v72
    v_mfma_f32_16x16x32_bf16 a[136:139], v[20:23], v[144:147], a[136:139]
    v_exp_f32 v73, v73
    v_mfma_f32_16x16x32_bf16 a[140:143], v[20:23], v[148:151], a[140:143]
    ds_read_b64_tr_b16 v[20:21], v2 offset:8736
    ds_read_b64_tr_b16 v[22:23], v2 offset:9248
    v_mfma_f32_16x16x32_bf16 a[144:147], v[24:27], v[144:147], a[144:147]
    v_exp_f32 v74, v74
    v_add_f32 v12, v12, v72
    v_add_f32 v12, v12, v73
    v_mfma_f32_16x16x32_bf16 a[148:151], v[24:27], v[148:151], a[148:151]
    ds_read_b64_tr_b16 v[24:25], v2 offset:8768
    ds_read_b64_tr_b16 v[26:27], v2 offset:9280
    v_mfma_f32_16x16x32_bf16 a[152:155], v[28:31], v[144:147], a[152:155]
    v_cvt_pk_bf16_f32 v72, v72, v73
    v_exp_f32 v75, v75
    v_mfma_f32_16x16x32_bf16 a[156:159], v[28:31], v[148:151], a[156:159]
    ds_read_b64_tr_b16 v[28:29], v2 offset:8800
    ds_read_b64_tr_b16 v[30:31], v2 offset:9312
    s_waitcnt lgkmcnt(8)
    v_mfma_f32_16x16x32_bf16 a[128:131], v[32:35], v[152:155], a[128:131]
    v_exp_f32 v76, v76
    v_add_f32 v12, v12, v74
    v_add_f32 v12, v12, v75
    v_mfma_f32_16x16x32_bf16 a[132:135], v[32:35], v[156:159], a[132:135]
    ds_read_b64_tr_b16 v[32:33], v2 offset:8832
    ds_read_b64_tr_b16 v[34:35], v2 offset:9344
    v_mfma_f32_16x16x32_bf16 a[136:139], v[36:39], v[152:155], a[136:139]
    v_cvt_pk_bf16_f32 v73, v74, v75
    v_exp_f32 v77, v77
    v_mfma_f32_16x16x32_bf16 a[140:143], v[36:39], v[156:159], a[140:143]
    ds_read_b64_tr_b16 v[36:37], v2 offset:8864
    ds_read_b64_tr_b16 v[38:39], v2 offset:9376
    v_mfma_f32_16x16x32_bf16 a[144:147], v[40:43], v[152:155], a[144:147]
    v_exp_f32 v78, v78
    v_cvt_pk_bf16_f32 v74, v76, v77
    v_mfma_f32_16x16x32_bf16 a[148:151], v[40:43], v[156:159], a[148:151]
    ds_read_b64_tr_b16 v[40:41], v2 offset:8896
    ds_read_b64_tr_b16 v[42:43], v2 offset:9408
    v_mfma_f32_16x16x32_bf16 a[152:155], v[44:47], v[152:155], a[152:155]
    v_exp_f32 v79, v79
    v_add_f32 v12, v12, v76
    v_cvt_pk_bf16_f32 v75, v78, v79
    v_mfma_f32_16x16x32_bf16 a[156:159], v[44:47], v[156:159], a[156:159]
    ds_read_b64_tr_b16 v[44:45], v2 offset:8928
    ds_read_b64_tr_b16 v[46:47], v2 offset:9440
    s_waitcnt lgkmcnt(10)
    v_mfma_f32_16x16x32_bf16 v[160:163], v[16:19], v[64:67], v[160:163]
    v_add_f32 v11, v11, v69
    v_max3_f32 v13, v80, v81, v82
    v_add_f32 v11, v11, v70
    v_mfma_f32_16x16x32_bf16 v[192:195], v[16:19], v[72:75], v[192:195]
    v_max3_f32 v13, v13, v83, v84
    v_add_f32 v11, v11, v71
    v_max3_f32 v13, v13, v85, v86
    v_mfma_f32_16x16x32_bf16 v[164:167], v[20:23], v[64:67], v[164:167]
    v_add_f32 v12, v12, v77
    v_max3_f32 v13, v13, v87, v88
    v_add_f32 v12, v12, v78
    v_mfma_f32_16x16x32_bf16 v[196:199], v[20:23], v[72:75], v[196:199]
    v_max3_f32 v13, v13, v89, v90
    v_add_f32 v12, v12, v79
    v_mfma_f32_16x16x32_bf16 v[168:171], v[24:27], v[64:67], v[168:171]
    v_max3_f32 v13, v13, v91, v92
    v_max3_f32 v13, v13, v93, v94
    v_max_f32 v13, v13, v95
    v_mfma_f32_16x16x32_bf16 v[200:203], v[24:27], v[72:75], v[200:203]
    s_waitcnt vmcnt(8) lgkmcnt(0)
    s_barrier
    ds_read_b128 v[16:19], v1 offset:17408
    ds_read_b128 v[20:23], v1 offset:17472
    ds_read_b128 v[24:27], v1 offset:17536
    v_mfma_f32_16x16x32_bf16 v[172:175], v[28:31], v[64:67], v[172:175]
    s_add_u32 m0, s39, 104448
    v_cmp_lt_f32 vcc, s46, v13
    buffer_load_dwordx4 v9, s[12:15], s34 offen  lds
    v_mfma_f32_16x16x32_bf16 v[204:207], v[28:31], v[72:75], v[204:207]
    s_add_u32 m0, s39, 104352
    ds_read_b128 v[28:31], v1 offset:17600
    buffer_load_dwordx4 v9, s[12:15], s34 offen offset:1152  lds
    v_mfma_f32_16x16x32_bf16 v[176:179], v[32:35], v[64:67], v[176:179]
    s_add_u32 m0, s39, 26112
    s_add_u32 s34, s34, 73728
    buffer_load_dwordx4 v8, s[8:11], s33 offen nt lds
    v_mfma_f32_16x16x32_bf16 v[208:211], v[32:35], v[72:75], v[208:211]
    s_add_u32 m0, s39, 26912
    ds_read_b128 v[32:35], v1 offset:21760
    buffer_load_dwordx4 v8, s[8:11], s33 offen offset:256 nt lds
    v_mfma_f32_16x16x32_bf16 v[180:183], v[36:39], v[64:67], v[180:183]
    v_mfma_f32_16x16x32_bf16 v[212:215], v[36:39], v[72:75], v[212:215]
    ds_read_b128 v[36:39], v1 offset:21824
    v_mfma_f32_16x16x32_bf16 v[184:187], v[40:43], v[64:67], v[184:187]
    v_mfma_f32_16x16x32_bf16 v[216:219], v[40:43], v[72:75], v[216:219]
    ds_read_b128 v[40:43], v1 offset:21888
    v_mfma_f32_16x16x32_bf16 v[188:191], v[44:47], v[64:67], v[188:191]
    v_mfma_f32_16x16x32_bf16 v[220:223], v[44:47], v[72:75], v[220:223]
    ds_read_b128 v[44:47], v1 offset:21952
    s_cbranch_vccnz L_rare_t25
L_back_t25:
    s_waitcnt lgkmcnt(4)
    v_mfma_f32_16x16x32_bf16 v[64:67], v[16:19], v[96:99], v[48:51]
    s_add_u32 m0, s40, 34816
    s_add_u32 s33, s33, 8192
    buffer_load_dwordx4 v7, s[4:7], s32 offen nt lds
    v_mfma_f32_16x16x32_bf16 v[72:75], v[16:19], v[100:103], v[52:55]
    ds_read_b64_tr_b16 v[16:17], v3 offset:26112
    ds_read_b64_tr_b16 v[18:19], v3 offset:26368
    v_mfma_f32_16x16x32_bf16 v[64:67], v[20:23], v[104:107], v[64:67]
    v_exp_f32 v80, v80
    v_exp_f32 v81, v81
    v_mfma_f32_16x16x32_bf16 v[72:75], v[20:23], v[108:111], v[72:75]
    ds_read_b64_tr_b16 v[20:21], v3 offset:26144
    ds_read_b64_tr_b16 v[22:23], v3 offset:26400
    v_mfma_f32_16x16x32_bf16 v[64:67], v[24:27], v[112:115], v[64:67]
    v_exp_f32 v82, v82
    v_add_f32 v11, v11, v80
    v_mfma_f32_16x16x32_bf16 v[72:75], v[24:27], v[116:119], v[72:75]
    ds_read_b64_tr_b16 v[24:25], v3 offset:26176
    ds_read_b64_tr_b16 v[26:27], v3 offset:26432
    v_add_f32 v11, v11, v81
    v_mfma_f32_16x16x32_bf16 v[64:67], v[28:31], v[120:123], v[64:67]
    v_cvt_pk_bf16_f32 v80, v80, v81
    v_exp_f32 v83, v83
    v_mfma_f32_16x16x32_bf16 v[72:75], v[28:31], v[124:127], v[72:75]
    ds_read_b64_tr_b16 v[28:29], v3 offset:26208
    ds_read_b64_tr_b16 v[30:31], v3 offset:26464
    s_waitcnt lgkmcnt(8)
    v_mfma_f32_16x16x32_bf16 v[68:71], v[32:35], v[96:99], v[48:51]
    v_exp_f32 v84, v84
    v_add_f32 v11, v11, v82
    v_mfma_f32_16x16x32_bf16 v[76:79], v[32:35], v[100:103], v[52:55]
    ds_read_b64_tr_b16 v[32:33], v3 offset:26624
    ds_read_b64_tr_b16 v[34:35], v3 offset:26880
    v_add_f32 v11, v11, v83
    v_mfma_f32_16x16x32_bf16 v[68:71], v[36:39], v[104:107], v[68:71]
    v_cvt_pk_bf16_f32 v81, v82, v83
    v_exp_f32 v85, v85
    v_mfma_f32_16x16x32_bf16 v[76:79], v[36:39], v[108:111], v[76:79]
    ds_read_b64_tr_b16 v[36:37], v3 offset:26656
    ds_read_b64_tr_b16 v[38:39], v3 offset:26912
    v_mfma_f32_16x16x32_bf16 v[68:71], v[40:43], v[112:115], v[68:71]
    v_exp_f32 v86, v86
    v_cvt_pk_bf16_f32 v82, v84, v85
    v_mfma_f32_16x16x32_bf16 v[76:79], v[40:43], v[116:119], v[76:79]
    ds_read_b64_tr_b16 v[40:41], v3 offset:26688
    ds_read_b64_tr_b16 v[42:43], v3 offset:26944
    s_add_u32 m0, s40, 34880
    v_mfma_f32_16x16x32_bf16 v[68:71], v[44:47], v[120:123], v[68:71]
    buffer_load_dwordx4 v7, s[4:7], s32 offen offset:1024 nt lds
    s_add_u32 s32, s32, 8192
    v_exp_f32 v87, v87
    v_mfma_f32_16x16x32_bf16 v[76:79], v[44:47], v[124:127], v[76:79]
    ds_read_b64_tr_b16 v[44:45], v3 offset:26720
    ds_read_b64_tr_b16 v[46:47], v3 offset:26976
    s_waitcnt lgkmcnt(8)
    v_mfma_f32_16x16x32_bf16 a[160:163], v[16:19], v[128:131], a[160:163]
    v_add_f32 v11, v11, v84
    v_cvt_pk_bf16_f32 v83, v86, v87
    v_mfma_f32_16x16x32_bf16 a[164:167], v[16:19], v[132:135], a[164:167]
    ds_read_b64_tr_b16 v[16:17], v2 offset:34816
    ds_read_b64_tr_b16 v[18:19], v2 offset:35328
    v_exp_f32 v88, v88
    v_mfma_f32_16x16x32_bf16 a[168:171], v[20:23], v[128:131], a[168:171]
    v_exp_f32 v89, v89
    v_mfma_f32_16x16x32_bf16 a[172:175], v[20:23], v[132:135], a[172:175]
    ds_read_b64_tr_b16 v[20:21], v2 offset:34848
    ds_read_b64_tr_b16 v[22:23], v2 offset:35360
    v_mfma_f32_16x16x32_bf16 a[176:179], v[24:27], v[128:131], a[176:179]
    v_exp_f32 v90, v90
    v_add_f32 v12, v12, v88
    v_add_f32 v12, v12, v89
    v_mfma_f32_16x16x32_bf16 a[180:183], v[24:27], v[132:135], a[180:183]
    ds_read_b64_tr_b16 v[24:25], v2 offset:34880
    ds_read_b64_tr_b16 v[26:27], v2 offset:35392
    v_mfma_f32_16x16x32_bf16 a[184:187], v[28:31], v[128:131], a[184:187]
    v_cvt_pk_bf16_f32 v88, v88, v89
    v_exp_f32 v91, v91
    v_mfma_f32_16x16x32_bf16 a[188:191], v[28:31], v[132:135], a[188:191]
    ds_read_b64_tr_b16 v[28:29], v2 offset:34912
    ds_read_b64_tr_b16 v[30:31], v2 offset:35424
    s_waitcnt lgkmcnt(8)
    v_mfma_f32_16x16x32_bf16 a[160:163], v[32:35], v[136:139], a[160:163]
    v_exp_f32 v92, v92
    v_add_f32 v12, v12, v90
    v_add_f32 v12, v12, v91
    v_mfma_f32_16x16x32_bf16 a[164:167], v[32:35], v[140:143], a[164:167]
    ds_read_b64_tr_b16 v[32:33], v2 offset:34944
    ds_read_b64_tr_b16 v[34:35], v2 offset:35456
    v_mfma_f32_16x16x32_bf16 a[168:171], v[36:39], v[136:139], a[168:171]
    v_cvt_pk_bf16_f32 v89, v90, v91
    v_exp_f32 v93, v93
    v_mfma_f32_16x16x32_bf16 a[172:175], v[36:39], v[140:143], a[172:175]
    ds_read_b64_tr_b16 v[36:37], v2 offset:34976
    ds_read_b64_tr_b16 v[38:39], v2 offset:35488
    v_mfma_f32_16x16x32_bf16 a[176:179], v[40:43], v[136:139], a[176:179]
    v_exp_f32 v94, v94
    v_cvt_pk_bf16_f32 v90, v92, v93
    v_mfma_f32_16x16x32_bf16 a[180:183], v[40:43], v[140:143], a[180:183]
    ds_read_b64_tr_b16 v[40:41], v2 offset:35008
    ds_read_b64_tr_b16 v[42:43], v2 offset:35520
    v_mfma_f32_16x16x32_bf16 a[184:187], v[44:47], v[136:139], a[184:187]
    v_exp_f32 v95, v95
    v_add_f32 v12, v12, v92
    v_cvt_pk_bf16_f32 v91, v94, v95
    v_mfma_f32_16x16x32_bf16 a[188:191], v[44:47], v[140:143], a[188:191]
    ds_read_b64_tr_b16 v[44:45], v2 offset:35040
    ds_read_b64_tr_b16 v[46:47], v2 offset:35552
    s_waitcnt lgkmcnt(10)
    v_mfma_f32_16x16x32_bf16 v[160:163], v[16:19], v[80:83], v[160:163]
    v_add_f32 v11, v11, v85
    v_max3_f32 v13, v64, v65, v66
    v_add_f32 v11, v11, v86
    v_mfma_f32_16x16x32_bf16 v[192:195], v[16:19], v[88:91], v[192:195]
    v_max3_f32 v13, v13, v67, v68
    v_add_f32 v11, v11, v87
    v_max3_f32 v13, v13, v69, v70
    v_mfma_f32_16x16x32_bf16 v[164:167], v[20:23], v[80:83], v[164:167]
    v_add_f32 v12, v12, v93
    v_max3_f32 v13, v13, v71, v72
    v_add_f32 v12, v12, v94
    v_mfma_f32_16x16x32_bf16 v[196:199], v[20:23], v[88:91], v[196:199]
    v_max3_f32 v13, v13, v73, v74
    v_add_f32 v12, v12, v95
    v_mfma_f32_16x16x32_bf16 v[168:171], v[24:27], v[80:83], v[168:171]
    v_max3_f32 v13, v13, v75, v76
    v_max3_f32 v13, v13, v77, v78
    v_max_f32 v13, v13, v79
    v_mfma_f32_16x16x32_bf16 v[200:203], v[24:27], v[88:91], v[200:203]
    s_waitcnt vmcnt(8) lgkmcnt(0)
    s_barrier
    ds_read_b128 v[16:19], v4 offset:0
    ds_read_b128 v[20:23], v4 offset:64
    ds_read_b128 v[24:27], v4 offset:128
    v_mfma_f32_16x16x32_bf16 v[172:175], v[28:31], v[80:83], v[172:175]
    s_add_u32 m0, s39, 43520
    v_cmp_lt_f32 vcc, s46, v13
    buffer_load_dwordx4 v9, s[12:15], s34 offen  lds
    v_mfma_f32_16x16x32_bf16 v[204:207], v[28:31], v[88:91], v[204:207]
    s_add_u32 m0, s39, 43424
    ds_read_b128 v[28:31], v4 offset:192
    buffer_load_dwordx4 v9, s[12:15], s34 offen offset:1152  lds
    v_mfma_f32_16x16x32_bf16 v[176:179], v[32:35], v[80:83], v[176:179]
    s_add_u32 m0, s39, 52224
    s_sub_u32 s34, s34, 73600
    buffer_load_dwordx4 v8, s[8:11], s33 offen nt lds
    v_mfma_f32_16x16x32_bf16 v[208:211], v[32:35], v[88:91], v[208:211]
    s_add_u32 m0, s39, 53024
    ds_read_b128 v[32:35], v4 offset:4352
    buffer_load_dwordx4 v8, s[8:11], s33 offen offset:256 nt lds
    v_mfma_f32_16x16x32_bf16 v[180:183], v[36:39], v[80:83], v[180:183]
    v_mfma_f32_16x16x32_bf16 v[212:215], v[36:39], v[88:91], v[212:215]
    ds_read_b128 v[36:39], v4 offset:4416
    v_mfma_f32_16x16x32_bf16 v[184:187], v[40:43], v[80:83], v[184:187]
    v_mfma_f32_16x16x32_bf16 v[216:219], v[40:43], v[88:91], v[216:219]
    ds_read_b128 v[40:43], v4 offset:4480
    v_mfma_f32_16x16x32_bf16 v[188:191], v[44:47], v[80:83], v[188:191]
    v_mfma_f32_16x16x32_bf16 v[220:223], v[44:47], v[88:91], v[220:223]
    ds_read_b128 v[44:47], v4 offset:4544
    s_cbranch_vccnz L_rare_t26
L_back_t26:
    s_waitcnt lgkmcnt(4)
    v_mfma_f32_16x16x32_bf16 v[80:83], v[16:19], v[96:99], v[48:51]
    s_add_u32 m0, s40, 60928
    s_add_u32 s33, s33, 8192
    buffer_load_dwordx4 v7, s[4:7], s32 offen nt lds
    v_mfma_f32_16x16x32_bf16 v[88:91], v[16:19], v[100:103], v[52:55]
    ds_read_b64_tr_b16 v[16:17], v6 offset:8704
    ds_read_b64_tr_b16 v[18:19], v6 offset:8960
    v_mfma_f32_16x16x32_bf16 v[80:83], v[20:23], v[104:107], v[80:83]
    v_exp_f32 v64, v64
    v_exp_f32 v65, v65
    v_mfma_f32_16x16x32_bf16 v[88:91], v[20:23], v[108:111], v[88:91]
    ds_read_b64_tr_b16 v[20:21], v6 offset:8736
    ds_read_b64_tr_b16 v[22:23], v6 offset:8992
    v_mfma_f32_16x16x32_bf16 v[80:83], v[24:27], v[112:115], v[80:83]
    v_exp_f32 v66, v66
    v_add_f32 v11, v11, v64
    v_mfma_f32_16x16x32_bf16 v[88:91], v[24:27], v[116:119], v[88:91]
    ds_read_b64_tr_b16 v[24:25], v6 offset:8768
    ds_read_b64_tr_b16 v[26:27], v6 offset:9024
    v_add_f32 v11, v11, v65
    v_mfma_f32_16x16x32_bf16 v[80:83], v[28:31], v[120:123], v[80:83]
    v_cvt_pk_bf16_f32 v64, v64, v65
    v_exp_f32 v67, v67
    v_mfma_f32_16x16x32_bf16 v[88:91], v[28:31], v[124:127], v[88:91]
    ds_read_b64_tr_b16 v[28:29], v6 offset:8800
    ds_read_b64_tr_b16 v[30:31], v6 offset:9056
    s_waitcnt lgkmcnt(8)
    v_mfma_f32_16x16x32_bf16 v[84:87], v[32:35], v[96:99], v[48:51]
    v_exp_f32 v68, v68
    v_add_f32 v11, v11, v66
    v_mfma_f32_16x16x32_bf16 v[92:95], v[32:35], v[100:103], v[52:55]
    ds_read_b64_tr_b16 v[32:33], v6 offset:9216
    ds_read_b64_tr_b16 v[34:35], v6 offset:9472
    v_add_f32 v11, v11, v67
    v_mfma_f32_16x16x32_bf16 v[84:87], v[36:39], v[104:107], v[84:87]
    v_cvt_pk_bf16_f32 v65, v66, v67
    v_exp_f32 v69, v69
    v_mfma_f32_16x16x32_bf16 v[92:95], v[36:39], v[108:111], v[92:95]
    ds_read_b64_tr_b16 v[36:37], v6 offset:9248
    ds_read_b64_tr_b16 v[38:39], v6 offset:9504
    v_mfma_f32_16x16x32_bf16 v[84:87], v[40:43], v[112:115], v[84:87]
    v_exp_f32 v70, v70
    v_cvt_pk_bf16_f32 v66, v68, v69
    v_mfma_f32_16x16x32_bf16 v[92:95], v[40:43], v[116:119], v[92:95]
    ds_read_b64_tr_b16 v[40:41], v6 offset:9280
    ds_read_b64_tr_b16 v[42:43], v6 offset:9536
    s_add_u32 m0, s40, 60992
    v_mfma_f32_16x16x32_bf16 v[84:87], v[44:47], v[120:123], v[84:87]
    buffer_load_dwordx4 v7, s[4:7], s32 offen offset:1024 nt lds
    s_add_u32 s32, s32, 8192
    v_exp_f32 v71, v71
    v_mfma_f32_16x16x32_bf16 v[92:95], v[44:47], v[124:127], v[92:95]
    ds_read_b64_tr_b16 v[44:45], v6 offset:9312
    ds_read_b64_tr_b16 v[46:47], v6 offset:9568
    s_waitcnt lgkmcnt(8)
    v_mfma_f32_16x16x32_bf16 a[160:163], v[16:19], v[144:147], a[160:163]
    v_add_f32 v11, v11, v68
    v_cvt_pk_bf16_f32 v67, v70, v71
    v_mfma_f32_16x16x32_bf16 a[164:167], v[16:19], v[148:151], a[164:167]
    ds_read_b64_tr_b16 v[16:17], v5 offset:17408
    ds_read_b64_tr_b16 v[18:19], v5 offset:17920
    v_exp_f32 v72, v72
    v_mfma_f32_16x16x32_bf16 a[168:171], v[20:23], v[144:147], a[168:171]
    v_exp_f32 v73, v73
    v_mfma_f32_16x16x32_bf16 a[172:175], v[20:23], v[148:151], a[172:175]
    ds_read_b64_tr_b16 v[20:21], v5 offset:17440
    ds_read_b64_tr_b16 v[22:23], v5 offset:17952
    v_mfma_f32_16x16x32_bf16 a[176:179], v[24:27], v[144:147], a[176:179]
    v_exp_f32 v74, v74
    v_add_f32 v12, v12, v72
    v_add_f32 v12, v12, v73
    v_mfma_f32_16x16x32_bf16 a[180:183], v[24:27], v[148:151], a[180:183]
    ds_read_b64_tr_b16 v[24:25], v5 offset:17472
    ds_read_b64_tr_b16 v[26:27], v5 offset:17984
    v_mfma_f32_16x16x32_bf16 a[184:187], v[28:31], v[144:147], a[184:187]
    v_cvt_pk_bf16_f32 v72, v72, v73
    v_exp_f32 v75, v75
    v_mfma_f32_16x16x32_bf16 a[188:191], v[28:31], v[148:151], a[188:191]
    ds_read_b64_tr_b16 v[28:29], v5 offset:17504
    ds_read_b64_tr_b16 v[30:31], v5 offset:18016
    s_waitcnt lgkmcnt(8)
    v_mfma_f32_16x16x32_bf16 a[160:163], v[32:35], v[152:155], a[160:163]
    v_exp_f32 v76, v76
    v_add_f32 v12, v12, v74
    v_add_f32 v12, v12, v75
    v_mfma_f32_16x16x32_bf16 a[164:167], v[32:35], v[156:159], a[164:167]
    ds_read_b64_tr_b16 v[32:33], v5 offset:17536
    ds_read_b64_tr_b16 v[34:35], v5 offset:18048
    v_mfma_f32_16x16x32_bf16 a[168:171], v[36:39], v[152:155], a[168:171]
    v_cvt_pk_bf16_f32 v73, v74, v75
    v_exp_f32 v77, v77
    v_mfma_f32_16x16x32_bf16 a[172:175], v[36:39], v[156:159], a[172:175]
    ds_read_b64_tr_b16 v[36:37], v5 offset:17568
    ds_read_b64_tr_b16 v[38:39], v5 offset:18080
    v_mfma_f32_16x16x32_bf16 a[176:179], v[40:43], v[152:155], a[176:179]
    v_exp_f32 v78, v78
    v_cvt_pk_bf16_f32 v74, v76, v77
    v_mfma_f32_16x16x32_bf16 a[180:183], v[40:43], v[156:159], a[180:183]
    ds_read_b64_tr_b16 v[40:41], v5 offset:17600
    ds_read_b64_tr_b16 v[42:43], v5 offset:18112
    v_mfma_f32_16x16x32_bf16 a[184:187], v[44:47], v[152:155], a[184:187]
    v_exp_f32 v79, v79
    v_add_f32 v12, v12, v76
    v_cvt_pk_bf16_f32 v75, v78, v79
    v_mfma_f32_16x16x32_bf16 a[188:191], v[44:47], v[156:159], a[188:191]
    ds_read_b64_tr_b16 v[44:45], v5 offset:17632
    ds_read_b64_tr_b16 v[46:47], v5 offset:18144
    s_waitcnt lgkmcnt(10)
    v_mfma_f32_16x16x32_bf16 v[160:163], v[16:19], v[64:67], v[160:163]
    v_add_f32 v11, v11, v69
    v_max3_f32 v13, v80, v81, v82
    v_add_f32 v11, v11, v70
    v_mfma_f32_16x16x32_bf16 v[192:195], v[16:19], v[72:75], v[192:195]
    v_max3_f32 v13, v13, v83, v84
    v_add_f32 v11, v11, v71
    v_max3_f32 v13, v13, v85, v86
    v_mfma_f32_16x16x32_bf16 v[164:167], v[20:23], v[64:67], v[164:167]
    v_add_f32 v12, v12, v77
    v_max3_f32 v13, v13, v87, v88
    v_add_f32 v12, v12, v78
    v_mfma_f32_16x16x32_bf16 v[196:199], v[20:23], v[72:75], v[196:199]
    v_max3_f32 v13, v13, v89, v90
    v_add_f32 v12, v12, v79
    v_mfma_f32_16x16x32_bf16 v[168:171], v[24:27], v[64:67], v[168:171]
    v_max3_f32 v13, v13, v91, v92
    v_max3_f32 v13, v13, v93, v94
    v_max_f32 v13, v13, v95
    v_mfma_f32_16x16x32_bf16 v[200:203], v[24:27], v[72:75], v[200:203]
    s_waitcnt vmcnt(8) lgkmcnt(0)
    s_barrier
    ds_read_b128 v[16:19], v4 offset:26112
    ds_read_b128 v[20:23], v4 offset:26176
    ds_read_b128 v[24:27], v4 offset:26240
    v_mfma_f32_16x16x32_bf16 v[172:175], v[28:31], v[64:67], v[172:175]
    s_add_u32 m0, s39, 69632
    v_cmp_lt_f32 vcc, s46, v13
    buffer_load_dwordx4 v9, s[12:15], s34 offen  lds
    v_mfma_f32_16x16x32_bf16 v[204:207], v[28:31], v[72:75], v[204:207]
    s_add_u32 m0, s39, 69536
    ds_read_b128 v[28:31], v4 offset:26304
    buffer_load_dwordx4 v9, s[12:15], s34 offen offset:1152  lds
    v_mfma_f32_16x16x32_bf16 v[176:179], v[32:35], v[64:67], v[176:179]
    s_add_u32 m0, s39, 78336
    s_add_u32 s34, s34, 73728
    buffer_load_dwordx4 v8, s[8:11], s33 offen nt lds
    v_mfma_f32_16x16x32_bf16 v[208:211], v[32:35], v[72:75], v[208:211]
    s_add_u32 m0, s39, 79136
    ds_read_b128 v[32:35], v4 offset:30464
    buffer_load_dwordx4 v8, s[8:11], s33 offen offset:256 nt lds
    v_mfma_f32_16x16x32_bf16 v[180:183], v[36:39], v[64:67], v[180:183]
    v_mfma_f32_16x16x32_bf16 v[212:215], v[36:39], v[72:75], v[212:215]
    ds_read_b128 v[36:39], v4 offset:30528
    v_mfma_f32_16x16x32_bf16 v[184:187], v[40:43], v[64:67], v[184:187]
    v_mfma_f32_16x16x32_bf16 v[216:219], v[40:43], v[72:75], v[216:219]
    ds_read_b128 v[40:43], v4 offset:30592
    v_mfma_f32_16x16x32_bf16 v[188:191], v[44:47], v[64:67], v[188:191]
    v_mfma_f32_16x16x32_bf16 v[220:223], v[44:47], v[72:75], v[220:223]
    ds_read_b128 v[44:47], v4 offset:30656
    s_cbranch_vccnz L_rare_t27
L_back_t27:
    s_cmp_eq_u32 s28, 3
    s_cbranch_scc1 L_alast
    s_waitcnt lgkmcnt(4)
    v_mfma_f32_16x16x32_bf16 v[64:67], v[16:19], v[96:99], v[48:51]
    s_add_u32 m0, s40, 87040
    s_add_u32 s33, s33, 8192
    buffer_load_dwordx4 v7, s[4:7], s32 offen nt lds
    v_mfma_f32_16x16x32_bf16 v[72:75], v[16:19], v[100:103], v[52:55]
    ds_read_b64_tr_b16 v[16:17], v6 offset:34816
    ds_read_b64_tr_b16 v[18:19], v6 offset:35072
    v_mfma_f32_16x16x32_bf16 v[64:67], v[20:23], v[104:107], v[64:67]
    v_exp_f32 v80, v80
    v_exp_f32 v81, v81
    v_mfma_f32_16x16x32_bf16 v[72:75], v[20:23], v[108:111], v[72:75]
    ds_read_b64_tr_b16 v[20:21], v6 offset:34848
    ds_read_b64_tr_b16 v[22:23], v6 offset:35104
    v_mfma_f32_16x16x32_bf16 v[64:67], v[24:27], v[112:115], v[64:67]
    v_exp_f32 v82, v82
    v_add_f32 v11, v11, v80
    v_mfma_f32_16x16x32_bf16 v[72:75], v[24:27], v[116:119], v[72:75]
    ds_read_b64_tr_b16 v[24:25], v6 offset:34880
    ds_read_b64_tr_b16 v[26:27], v6 offset:35136
    v_add_f32 v11, v11, v81
    v_mfma_f32_16x16x32_bf16 v[64:67], v[28:31], v[120:123], v[64:67]
    v_cvt_pk_bf16_f32 v80, v80, v81
    v_exp_f32 v83, v83
    v_mfma_f32_16x16x32_bf16 v[72:75], v[28:31], v[124:127], v[72:75]
    ds_read_b64_tr_b16 v[28:29], v6 offset:34912
    ds_read_b64_tr_b16 v[30:31], v6 offset:35168
    s_waitcnt lgkmcnt(8)
    v_mfma_f32_16x16x32_bf16 v[68:71], v[32:35], v[96:99], v[48:51]
    v_exp_f32 v84, v84
    v_add_f32 v11, v11, v82
    v_mfma_f32_16x16x32_bf16 v[76:79], v[32:35], v[100:103], v[52:55]
    ds_read_b64_tr_b16 v[32:33], v6 offset:35328
    ds_read_b64_tr_b16 v[34:35], v6 offset:35584
    v_add_f32 v11, v11, v83
    v_mfma_f32_16x16x32_bf16 v[68:71], v[36:39], v[104:107], v[68:71]
    v_cvt_pk_bf16_f32 v81, v82, v83
    v_exp_f32 v85, v85
    v_mfma_f32_16x16x32_bf16 v[76:79], v[36:39], v[108:111], v[76:79]
    ds_read_b64_tr_b16 v[36:37], v6 offset:35360
    ds_read_b64_tr_b16 v[38:39], v6 offset:35616
    v_mfma_f32_16x16x32_bf16 v[68:71], v[40:43], v[112:115], v[68:71]
    v_exp_f32 v86, v86
    v_cvt_pk_bf16_f32 v82, v84, v85
    v_mfma_f32_16x16x32_bf16 v[76:79], v[40:43], v[116:119], v[76:79]
    ds_read_b64_tr_b16 v[40:41], v6 offset:35392
    ds_read_b64_tr_b16 v[42:43], v6 offset:35648
    s_add_u32 m0, s40, 87104
    v_mfma_f32_16x16x32_bf16 v[68:71], v[44:47], v[120:123], v[68:71]
    buffer_load_dwordx4 v7, s[4:7], s32 offen offset:1024 nt lds
    s_add_u32 s32, s32, 8192
    v_exp_f32 v87, v87
    v_mfma_f32_16x16x32_bf16 v[76:79], v[44:47], v[124:127], v[76:79]
    ds_read_b64_tr_b16 v[44:45], v6 offset:35424
    ds_read_b64_tr_b16 v[46:47], v6 offset:35680
    s_waitcnt lgkmcnt(8)
    v_mfma_f32_16x16x32_bf16 a[192:195], v[16:19], v[128:131], a[192:195]
    v_add_f32 v11, v11, v84
    v_cvt_pk_bf16_f32 v83, v86, v87
    v_mfma_f32_16x16x32_bf16 a[196:199], v[16:19], v[132:135], a[196:199]
    ds_read_b64_tr_b16 v[16:17], v2 offset:0
    ds_read_b64_tr_b16 v[18:19], v2 offset:512
    v_exp_f32 v88, v88
    v_mfma_f32_16x16x32_bf16 a[200:203], v[20:23], v[128:131], a[200:203]
    v_exp_f32 v89, v89
    v_mfma_f32_16x16x32_bf16 a[204:207], v[20:23], v[132:135], a[204:207]
    ds_read_b64_tr_b16 v[20:21], v2 offset:32
    ds_read_b64_tr_b16 v[22:23], v2 offset:544
    v_mfma_f32_16x16x32_bf16 a[208:211], v[24:27], v[128:131], a[208:211]
    v_exp_f32 v90, v90
    v_add_f32 v12, v12, v88
    v_add_f32 v12, v12, v89
    v_mfma_f32_16x16x32_bf16 a[212:215], v[24:27], v[132:135], a[212:215]
    ds_read_b64_tr_b16 v[24:25], v2 offset:64
    ds_read_b64_tr_b16 v[26:27], v2 offset:576
    v_mfma_f32_16x16x32_bf16 a[216:219], v[28:31], v[128:131], a[216:219]
    v_cvt_pk_bf16_f32 v88, v88, v89
    v_exp_f32 v91, v91
    v_mfma_f32_16x16x32_bf16 a[220:223], v[28:31], v[132:135], a[220:223]
    ds_read_b64_tr_b16 v[28:29], v2 offset:96
    ds_read_b64_tr_b16 v[30:31], v2 offset:608
    s_waitcnt lgkmcnt(8)
    v_mfma_f32_16x16x32_bf16 a[192:195], v[32:35], v[136:139], a[192:195]
    v_exp_f32 v92, v92
    v_add_f32 v12, v12, v90
    v_add_f32 v12, v12, v91
    v_mfma_f32_16x16x32_bf16 a[196:199], v[32:35], v[140:143], a[196:199]
    ds_read_b64_tr_b16 v[32:33], v2 offset:128
    ds_read_b64_tr_b16 v[34:35], v2 offset:640
    v_mfma_f32_16x16x32_bf16 a[200:203], v[36:39], v[136:139], a[200:203]
    v_cvt_pk_bf16_f32 v89, v90, v91
    v_exp_f32 v93, v93
    v_mfma_f32_16x16x32_bf16 a[204:207], v[36:39], v[140:143], a[204:207]
    ds_read_b64_tr_b16 v[36:37], v2 offset:160
    ds_read_b64_tr_b16 v[38:39], v2 offset:672
    v_mfma_f32_16x16x32_bf16 a[208:211], v[40:43], v[136:139], a[208:211]
    v_exp_f32 v94, v94
    v_cvt_pk_bf16_f32 v90, v92, v93
    v_mfma_f32_16x16x32_bf16 a[212:215], v[40:43], v[140:143], a[212:215]
    ds_read_b64_tr_b16 v[40:41], v2 offset:192
    ds_read_b64_tr_b16 v[42:43], v2 offset:704
    v_mfma_f32_16x16x32_bf16 a[216:219], v[44:47], v[136:139], a[216:219]
    v_exp_f32 v95, v95
    v_add_f32 v12, v12, v92
    v_cvt_pk_bf16_f32 v91, v94, v95
    v_mfma_f32_16x16x32_bf16 a[220:223], v[44:47], v[140:143], a[220:223]
    ds_read_b64_tr_b16 v[44:45], v2 offset:224
    ds_read_b64_tr_b16 v[46:47], v2 offset:736
    s_waitcnt lgkmcnt(10)
    v_mfma_f32_16x16x32_bf16 v[160:163], v[16:19], v[80:83], v[160:163]
    v_add_f32 v11, v11, v85
    v_max3_f32 v13, v64, v65, v66
    v_add_f32 v11, v11, v86
    v_mfma_f32_16x16x32_bf16 v[192:195], v[16:19], v[88:91], v[192:195]
    v_max3_f32 v13, v13, v67, v68
    v_add_f32 v11, v11, v87
    v_max3_f32 v13, v13, v69, v70
    v_mfma_f32_16x16x32_bf16 v[164:167], v[20:23], v[80:83], v[164:167]
    v_add_f32 v12, v12, v93
    v_max3_f32 v13, v13, v71, v72
    v_add_f32 v12, v12, v94
    v_mfma_f32_16x16x32_bf16 v[196:199], v[20:23], v[88:91], v[196:199]
    v_max3_f32 v13, v13, v73, v74
    v_add_f32 v12, v12, v95
    v_mfma_f32_16x16x32_bf16 v[168:171], v[24:27], v[80:83], v[168:171]
    v_max3_f32 v13, v13, v75, v76
    v_max3_f32 v13, v13, v77, v78
    v_max_f32 v13, v13, v79
    v_mfma_f32_16x16x32_bf16 v[200:203], v[24:27], v[88:91], v[200:203]
    s_waitcnt vmcnt(8) lgkmcnt(0)
    s_barrier
    ds_read_b128 v[16:19], v1 offset:8704
    ds_read_b128 v[20:23], v1 offset:8768
    ds_read_b128 v[24:27], v1 offset:8832
    v_mfma_f32_16x16x32_bf16 v[172:175], v[28:31], v[80:83], v[172:175]
    s_add_u32 m0, s39, 95744
    v_cmp_lt_f32 vcc, s46, v13
    buffer_load_dwordx4 v9, s[12:15], s34 offen  lds
    v_mfma_f32_16x16x32_bf16 v[204:207], v[28:31], v[88:91], v[204:207]
    s_add_u32 m0, s39, 95648
    ds_read_b128 v[28:31], v1 offset:8896
    buffer_load_dwordx4 v9, s[12:15], s34 offen offset:1152  lds
    v_mfma_f32_16x16x32_bf16 v[176:179], v[32:35], v[80:83], v[176:179]
    s_add_u32 m0, s39, 104448
    s_sub_u32 s34, s34, 73600
    buffer_load_dwordx4 v8, s[8:11], s33 offen nt lds
    v_mfma_f32_16x16x32_bf16 v[208:211], v[32:35], v[88:91], v[208:211]
    s_add_u32 m0, s39, 105248
    ds_read_b128 v[32:35], v1 offset:13056
    buffer_load_dwordx4 v8, s[8:11], s33 offen offset:256 nt lds
    v_mfma_f32_16x16x32_bf16 v[180:183], v[36:39], v[80:83], v[180:183]
    v_mfma_f32_16x16x32_bf16 v[212:215], v[36:39], v[88:91], v[212:215]
    ds_read_b128 v[36:39], v1 offset:13120
    v_mfma_f32_16x16x32_bf16 v[184:187], v[40:43], v[80:83], v[184:187]
    v_mfma_f32_16x16x32_bf16 v[216:219], v[40:43], v[88:91], v[216:219]
    ds_read_b128 v[40:43], v1 offset:13184
    v_mfma_f32_16x16x32_bf16 v[188:191], v[44:47], v[80:83], v[188:191]
    v_mfma_f32_16x16x32_bf16 v[220:223], v[44:47], v[88:91], v[220:223]
    ds_read_b128 v[44:47], v1 offset:13248
    s_cbranch_vccnz L_rare_t28
L_back_t28:
    s_waitcnt lgkmcnt(4)
    v_mfma_f32_16x16x32_bf16 v[80:83], v[16:19], v[96:99], v[48:51]
    s_add_u32 s33, s33, 8192
    s_lshl_b32 s48, s30, 2
    s_lshr_b32 s48, s41, s48
    s_and_b32 s48, s48, 3
    s_lshl_b32 s49, s44, 2
    s_add_u32 s48, s48, s49
    s_lshl_b32 s49, s43, 5
    s_add_u32 s48, s48, s49
    s_lshl_b32 s74, s48, 17
    s_mov_b32 s32, s74
    s_add_u32 m0, s40, 26112
    s_add_u32 s30, s30, 1
    buffer_load_dwordx4 v7, s[4:7], s32 offen nt lds
    v_mfma_f32_16x16x32_bf16 v[88:91], v[16:19], v[100:103], v[52:55]
    ds_read_b64_tr_b16 v[16:17], v3 offset:17408
    ds_read_b64_tr_b16 v[18:19], v3 offset:17664
    v_mfma_f32_16x16x32_bf16 v[80:83], v[20:23], v[104:107], v[80:83]
    v_mfma_f32_16x16x32_bf16 v[88:91], v[20:23], v[108:111], v[88:91]
    ds_read_b64_tr_b16 v[20:21], v3 offset:17440
    ds_read_b64_tr_b16 v[22:23], v3 offset:17696
    v_mfma_f32_16x16x32_bf16 v[80:83], v[24:27], v[112:115], v[80:83]
    v_mfma_f32_16x16x32_bf16 v[88:91], v[24:27], v[116:119], v[88:91]
    ds_read_b64_tr_b16 v[24:25], v3 offset:17472
    ds_read_b64_tr_b16 v[26:27], v3 offset:17728
    v_mfma_f32_16x16x32_bf16 v[80:83], v[28:31], v[120:123], v[80:83]
    v_exp_f32 v64, v64
    v_exp_f32 v65, v65
    v_mfma_f32_16x16x32_bf16 v[88:91], v[28:31], v[124:127], v[88:91]
    ds_read_b64_tr_b16 v[28:29], v3 offset:17504
    ds_read_b64_tr_b16 v[30:31], v3 offset:17760
    s_waitcnt lgkmcnt(8)
    v_mfma_f32_16x16x32_bf16 v[84:87], v[32:35], v[96:99], v[48:51]
    v_exp_f32 v66, v66
    v_add_f32 v11, v11, v64
    v_add_f32 v11, v11, v65
    v_mfma_f32_16x16x32_bf16 v[92:95], v[32:35], v[100:103], v[52:55]
    ds_read_b64_tr_b16 v[32:33], v3 offset:17920
    ds_read_b64_tr_b16 v[34:35], v3 offset:18176
    v_cvt_pk_bf16_f32 v64, v64, v65
    v_mfma_f32_16x16x32_bf16 v[84:87], v[36:39], v[104:107], v[84:87]
    v_exp_f32 v67, v67
    v_mfma_f32_16x16x32_bf16 v[92:95], v[36:39], v[108:111], v[92:95]
    ds_read_b64_tr_b16 v[36:37], v3 offset:17952
    ds_read_b64_tr_b16 v[38:39], v3 offset:18208
    v_exp_f32 v68, v68
    v_mfma_f32_16x16x32_bf16 v[84:87], v[40:43], v[112:115], v[84:87]
    v_add_f32 v11, v11, v66
    v_add_f32 v11, v11, v67
    v_cvt_pk_bf16_f32 v65, v66, v67
    v_mfma_f32_16x16x32_bf16 v[92:95], v[40:43], v[116:119], v[92:95]
    ds_read_b64_tr_b16 v[40:41], v3 offset:17984
    ds_read_b64_tr_b16 v[42:43], v3 offset:18240
    s_add_u32 m0, s40, 26176
    v_mfma_f32_16x16x32_bf16 v[84:87], v[44:47], v[120:123], v[84:87]
    buffer_load_dwordx4 v7, s[4:7], s32 offen offset:1024 nt lds
    s_add_u32 s32, s32, 8192
    v_exp_f32 v69, v69
    v_mfma_f32_16x16x32_bf16 v[92:95], v[44:47], v[124:127], v[92:95]
    ds_read_b64_tr_b16 v[44:45], v3 offset:18016
    ds_read_b64_tr_b16 v[46:47], v3 offset:18272
    s_waitcnt lgkmcnt(8)
    v_mfma_f32_16x16x32_bf16 a[192:195], v[16:19], v[144:147], a[192:195]
    v_exp_f32 v70, v70
    v_cvt_pk_bf16_f32 v66, v68, v69
    v_mfma_f32_16x16x32_bf16 a[196:199], v[16:19], v[148:151], a[196:199]
    ds_read_b64_tr_b16 v[16:17], v2 offset:26112
    ds_read_b64_tr_b16 v[18:19], v2 offset:26624
    v_exp_f32 v71, v71
    v_mfma_f32_16x16x32_bf16 a[200:203], v[20:23], v[144:147], a[200:203]
    v_add_f32 v11, v11, v68
    v_cvt_pk_bf16_f32 v67, v70, v71
    v_mfma_f32_16x16x32_bf16 a[204:207], v[20:23], v[148:151], a[204:207]
    ds_read_b64_tr_b16 v[20:21], v2 offset:26144
    ds_read_b64_tr_b16 v[22:23], v2 offset:26656
    v_exp_f32 v72, v72
    v_mfma_f32_16x16x32_bf16 a[208:211], v[24:27], v[144:147], a[208:211]
    v_exp_f32 v73, v73
    v_mfma_f32_16x16x32_bf16 a[212:215], v[24:27], v[148:151], a[212:215]
    ds_read_b64_tr_b16 v[24:25], v2 offset:26176
    ds_read_b64_tr_b16 v[26:27], v2 offset:26688
    v_exp_f32 v74, v74
    v_mfma_f32_16x16x32_bf16 a[216:219], v[28:31], v[144:147], a[216:219]
    v_add_f32 v12, v12, v72
    v_add_f32 v12, v12, v73
    v_cvt_pk_bf16_f32 v72, v72, v73
    v_mfma_f32_16x16x32_bf16 a[220:223], v[28:31], v[148:151], a[220:223]
    ds_read_b64_tr_b16 v[28:29], v2 offset:26208
    ds_read_b64_tr_b16 v[30:31], v2 offset:26720
    s_waitcnt lgkmcnt(8)
    v_mfma_f32_16x16x32_bf16 a[192:195], v[32:35], v[152:155], a[192:195]
    v_exp_f32 v75, v75
    v_exp_f32 v76, v76
    v_mfma_f32_16x16x32_bf16 a[196:199], v[32:35], v[156:159], a[196:199]
    ds_read_b64_tr_b16 v[32:33], v2 offset:26240
    ds_read_b64_tr_b16 v[34:35], v2 offset:26752
    v_add_f32 v12, v12, v74
    v_mfma_f32_16x16x32_bf16 a[200:203], v[36:39], v[152:155], a[200:203]
    v_add_f32 v12, v12, v75
    v_cvt_pk_bf16_f32 v73, v74, v75
    v_mfma_f32_16x16x32_bf16 a[204:207], v[36:39], v[156:159], a[204:207]
    ds_read_b64_tr_b16 v[36:37], v2 offset:26272
    ds_read_b64_tr_b16 v[38:39], v2 offset:26784
    v_exp_f32 v77, v77
    v_mfma_f32_16x16x32_bf16 a[208:211], v[40:43], v[152:155], a[208:211]
    v_exp_f32 v78, v78
    v_cvt_pk_bf16_f32 v74, v76, v77
    v_mfma_f32_16x16x32_bf16 a[212:215], v[40:43], v[156:159], a[212:215]
    ds_read_b64_tr_b16 v[40:41], v2 offset:26304
    ds_read_b64_tr_b16 v[42:43], v2 offset:26816
    v_mfma_f32_16x16x32_bf16 a[216:219], v[44:47], v[152:155], a[216:219]
    v_exp_f32 v79, v79
    v_add_f32 v12, v12, v76
    v_cvt_pk_bf16_f32 v75, v78, v79
    v_mfma_f32_16x16x32_bf16 a[220:223], v[44:47], v[156:159], a[220:223]
    ds_read_b64_tr_b16 v[44:45], v2 offset:26336
    ds_read_b64_tr_b16 v[46:47], v2 offset:26848
    s_waitcnt lgkmcnt(10)
    v_mfma_f32_16x16x32_bf16 v[160:163], v[16:19], v[64:67], v[160:163]
    v_add_f32 v11, v11, v69
    v_max3_f32 v13, v80, v81, v82
    v_add_f32 v11, v11, v70
    v_max3_f32 v13, v13, v83, v84
    v_mfma_f32_16x16x32_bf16 v[192:195], v[16:19], v[72:75], v[192:195]
    v_add_f32 v11, v11, v71
    v_max3_f32 v13, v13, v85, v86
    v_add_f32 v12, v12, v77
    v_mfma_f32_16x16x32_bf16 v[164:167], v[20:23], v[64:67], v[164:167]
    v_max3_f32 v13, v13, v87, v88
    v_add_f32 v12, v12, v78
    v_max3_f32 v13, v13, v89, v90
    v_mfma_f32_16x16x32_bf16 v[196:199], v[20:23], v[72:75], v[196:199]
    v_add_f32 v12, v12, v79
    v_max3_f32 v13, v13, v91, v92
    v_max3_f32 v13, v13, v93, v94
    v_mfma_f32_16x16x32_bf16 v[168:171], v[24:27], v[64:67], v[168:171]
    v_max_f32 v13, v13, v95
    v_cmp_lt_f32 vcc, s46, v13
    v_mfma_f32_16x16x32_bf16 v[200:203], v[24:27], v[72:75], v[200:203]
    s_waitcnt vmcnt(8) lgkmcnt(0)
    s_barrier
    ds_read_b128 v[16:19], v1 offset:34816
    ds_read_b128 v[20:23], v1 offset:34880
    ds_read_b128 v[24:27], v1 offset:34944
    s_add_u32 m0, s39, 34816
    v_mfma_f32_16x16x32_bf16 v[172:175], v[28:31], v[64:67], v[172:175]
    buffer_load_dwordx4 v9, s[12:15], s34 offen  lds
    s_add_u32 m0, s39, 34720
    s_nop 0
    buffer_load_dwordx4 v9, s[12:15], s34 offen offset:1152  lds
    v_mfma_f32_16x16x32_bf16 v[204:207], v[28:31], v[72:75], v[204:207]
    ds_read_b128 v[28:31], v1 offset:35008
    s_add_u32 m0, s39, 43520
    s_add_u32 s34, s34, 73728
    buffer_load_dwordx4 v8, s[8:11], s33 offen nt lds
    s_add_u32 m0, s39, 44320
    v_mfma_f32_16x16x32_bf16 v[176:179], v[32:35], v[64:67], v[176:179]
    buffer_load_dwordx4 v8, s[8:11], s33 offen offset:256 nt lds
    v_mfma_f32_16x16x32_bf16 v[208:211], v[32:35], v[72:75], v[208:211]
    ds_read_b128 v[32:35], v1 offset:39168
    v_mfma_f32_16x16x32_bf16 v[180:183], v[36:39], v[64:67], v[180:183]
    v_mfma_f32_16x16x32_bf16 v[212:215], v[36:39], v[72:75], v[212:215]
    ds_read_b128 v[36:39], v1 offset:39232
    v_mfma_f32_16x16x32_bf16 v[184:187], v[40:43], v[64:67], v[184:187]
    v_mfma_f32_16x16x32_bf16 v[216:219], v[40:43], v[72:75], v[216:219]
    ds_read_b128 v[40:43], v1 offset:39296
    v_mfma_f32_16x16x32_bf16 v[188:191], v[44:47], v[64:67], v[188:191]
    v_mfma_f32_16x16x32_bf16 v[220:223], v[44:47], v[72:75], v[220:223]
    ds_read_b128 v[44:47], v1 offset:39360
    s_cbranch_vccnz L_rare_t29
L_back_t29:
    s_waitcnt lgkmcnt(4)
    v_mfma_f32_16x16x32_bf16 v[64:67], v[16:19], v[96:99], v[48:51]
    s_add_u32 m0, s40, 52224
    s_add_u32 s33, s33, 8192
    buffer_load_dwordx4 v7, s[4:7], s32 offen nt lds
    v_mfma_f32_16x16x32_bf16 v[72:75], v[16:19], v[100:103], v[52:55]
    ds_read_b64_tr_b16 v[16:17], v6 offset:0
    ds_read_b64_tr_b16 v[18:19], v6 offset:256
    v_mfma_f32_16x16x32_bf16 v[64:67], v[20:23], v[104:107], v[64:67]
    v_exp_f32 v80, v80
    v_exp_f32 v81, v81
    v_mfma_f32_16x16x32_bf16 v[72:75], v[20:23], v[108:111], v[72:75]
    ds_read_b64_tr_b16 v[20:21], v6 offset:32
    ds_read_b64_tr_b16 v[22:23], v6 offset:288
    v_mfma_f32_16x16x32_bf16 v[64:67], v[24:27], v[112:115], v[64:67]
    v_exp_f32 v82, v82
    v_add_f32 v11, v11, v80
    v_mfma_f32_16x16x32_bf16 v[72:75], v[24:27], v[116:119], v[72:75]
    ds_read_b64_tr_b16 v[24:25], v6 offset:64
    ds_read_b64_tr_b16 v[26:27], v6 offset:320
    v_add_f32 v11, v11, v81
    v_mfma_f32_16x16x32_bf16 v[64:67], v[28:31], v[120:123], v[64:67]
    v_cvt_pk_bf16_f32 v80, v80, v81
    v_exp_f32 v83, v83
    v_mfma_f32_16x16x32_bf16 v[72:75], v[28:31], v[124:127], v[72:75]
    ds_read_b64_tr_b16 v[28:29], v6 offset:96
    ds_read_b64_tr_b16 v[30:31], v6 offset:352
    s_waitcnt lgkmcnt(8)
    v_mfma_f32_16x16x32_bf16 v[68:71], v[32:35], v[96:99], v[48:51]
    v_exp_f32 v84, v84
    v_add_f32 v11, v11, v82
    v_mfma_f32_16x16x32_bf16 v[76:79], v[32:35], v[100:103], v[52:55]
    ds_read_b64_tr_b16 v[32:33], v6 offset:512
    ds_read_b64_tr_b16 v[34:35], v6 offset:768
    v_add_f32 v11, v11, v83
    v_mfma_f32_16x16x32_bf16 v[68:71], v[36:39], v[104:107], v[68:71]
    v_cvt_pk_bf16_f32 v81, v82, v83
    v_exp_f32 v85, v85
    v_mfma_f32_16x16x32_bf16 v[76:79], v[36:39], v[108:111], v[76:79]
    ds_read_b64_tr_b16 v[36:37], v6 offset:544
    ds_read_b64_tr_b16 v[38:39], v6 offset:800
    v_mfma_f32_16x16x32_bf16 v[68:71], v[40:43], v[112:115], v[68:71]
    v_exp_f32 v86, v86
    v_cvt_pk_bf16_f32 v82, v84, v85
    v_mfma_f32_16x16x32_bf16 v[76:79], v[40:43], v[116:119], v[76:79]
    ds_read_b64_tr_b16 v[40:41], v6 offset:576
    ds_read_b64_tr_b16 v[42:43], v6 offset:832
    s_add_u32 m0, s40, 52288
    v_mfma_f32_16x16x32_bf16 v[68:71], v[44:47], v[120:123], v[68:71]
    buffer_load_dwordx4 v7, s[4:7], s32 offen offset:1024 nt lds
    s_add_u32 s32, s32, 8192
    v_exp_f32 v87, v87
    v_mfma_f32_16x16x32_bf16 v[76:79], v[44:47], v[124:127], v[76:79]
    ds_read_b64_tr_b16 v[44:45], v6 offset:608
    ds_read_b64_tr_b16 v[46:47], v6 offset:864
    s_waitcnt lgkmcnt(8)
    v_mfma_f32_16x16x32_bf16 a[224:227], v[16:19], v[128:131], a[224:227]
    v_add_f32 v11, v11, v84
    v_cvt_pk_bf16_f32 v83, v86, v87
    v_mfma_f32_16x16x32_bf16 a[228:231], v[16:19], v[132:135], a[228:231]
    ds_read_b64_tr_b16 v[16:17], v5 offset:8704
    ds_read_b64_tr_b16 v[18:19], v5 offset:9216
    v_exp_f32 v88, v88
    v_mfma_f32_16x16x32_bf16 a[232:235], v[20:23], v[128:131], a[232:235]
    v_exp_f32 v89, v89
    v_mfma_f32_16x16x32_bf16 a[236:239], v[20:23], v[132:135], a[236:239]
    ds_read_b64_tr_b16 v[20:21], v5 offset:8736
    ds_read_b64_tr_b16 v[22:23], v5 offset:9248
    v_mfma_f32_16x16x32_bf16 a[240:243], v[24:27], v[128:131], a[240:243]
    v_exp_f32 v90, v90
    v_add_f32 v12, v12, v88
    v_add_f32 v12, v12, v89
    v_mfma_f32_16x16x32_bf16 a[244:247], v[24:27], v[132:135], a[244:247]
    ds_read_b64_tr_b16 v[24:25], v5 offset:8768
    ds_read_b64_tr_b16 v[26:27], v5 offset:9280
    v_mfma_f32_16x16x32_bf16 a[248:251], v[28:31], v[128:131], a[248:251]
    v_cvt_pk_bf16_f32 v88, v88, v89
    v_exp_f32 v91, v91
    v_mfma_f32_16x16x32_bf16 a[252:255], v[28:31], v[132:135], a[252:255]
    ds_read_b64_tr_b16 v[28:29], v5 offset:8800
    ds_read_b64_tr_b16 v[30:31], v5 offset:9312
    s_waitcnt lgkmcnt(8)
    v_mfma_f32_16x16x32_bf16 a[224:227], v[32:35], v[136:139], a[224:227]
    v_exp_f32 v92, v92
    v_add_f32 v12, v12, v90
    v_add_f32 v12, v12, v91
    v_mfma_f32_16x16x32_bf16 a[228:231], v[32:35], v[140:143], a[228:231]
    ds_read_b64_tr_b16 v[32:33], v5 offset:8832
    ds_read_b64_tr_b16 v[34:35], v5 offset:9344
    v_mfma_f32_16x16x32_bf16 a[232:235], v[36:39], v[136:139], a[232:235]
    v_cvt_pk_bf16_f32 v89, v90, v91
    v_exp_f32 v93, v93
    v_mfma_f32_16x16x32_bf16 a[236:239], v[36:39], v[140:143], a[236:239]
    ds_read_b64_tr_b16 v[36:37], v5 offset:8864
    ds_read_b64_tr_b16 v[38:39], v5 offset:9376
    v_mfma_f32_16x16x32_bf16 a[240:243], v[40:43], v[136:139], a[240:243]
    v_exp_f32 v94, v94
    v_cvt_pk_bf16_f32 v90, v92, v93
    v_mfma_f32_16x16x32_bf16 a[244:247], v[40:43], v[140:143], a[244:247]
    ds_read_b64_tr_b16 v[40:41], v5 offset:8896
    ds_read_b64_tr_b16 v[42:43], v5 offset:9408
    v_mfma_f32_16x16x32_bf16 a[248:251], v[44:47], v[136:139], a[248:251]
    v_exp_f32 v95, v95
    v_add_f32 v12, v12, v92
    v_cvt_pk_bf16_f32 v91, v94, v95
    v_mfma_f32_16x16x32_bf16 a[252:255], v[44:47], v[140:143], a[252:255]
    ds_read_b64_tr_b16 v[44:45], v5 offset:8928
    ds_read_b64_tr_b16 v[46:47], v5 offset:9440
    s_waitcnt lgkmcnt(10)
    v_mfma_f32_16x16x32_bf16 v[160:163], v[16:19], v[80:83], v[160:163]
    v_add_f32 v11, v11, v85
    v_max3_f32 v13, v64, v65, v66
    v_add_f32 v11, v11, v86
    v_mfma_f32_16x16x32_bf16 v[192:195], v[16:19], v[88:91], v[192:195]
    v_max3_f32 v13, v13, v67, v68
    v_add_f32 v11, v11, v87
    v_max3_f32 v13, v13, v69, v70
    v_mfma_f32_16x16x32_bf16 v[164:167], v[20:23], v[80:83], v[164:167]
    v_add_f32 v12, v12, v93
    v_max3_f32 v13, v13, v71, v72
    v_add_f32 v12, v12, v94
    v_mfma_f32_16x16x32_bf16 v[196:199], v[20:23], v[88:91], v[196:199]
    v_max3_f32 v13, v13, v73, v74
    v_add_f32 v12, v12, v95
    v_mfma_f32_16x16x32_bf16 v[168:171], v[24:27], v[80:83], v[168:171]
    v_max3_f32 v13, v13, v75, v76
    v_max3_f32 v13, v13, v77, v78
    v_max_f32 v13, v13, v79
    v_mfma_f32_16x16x32_bf16 v[200:203], v[24:27], v[88:91], v[200:203]
    s_waitcnt vmcnt(8) lgkmcnt(0)
    s_barrier
    ds_read_b128 v[16:19], v4 offset:17408
    ds_read_b128 v[20:23], v4 offset:17472
    ds_read_b128 v[24:27], v4 offset:17536
    v_mfma_f32_16x16x32_bf16 v[172:175], v[28:31], v[80:83], v[172:175]
    s_add_u32 m0, s39, 60928
    v_cmp_lt_f32 vcc, s46, v13
    buffer_load_dwordx4 v9, s[12:15], s34 offen  lds
    v_mfma_f32_16x16x32_bf16 v[204:207], v[28:31], v[88:91], v[204:207]
    s_add_u32 m0, s39, 60832
    ds_read_b128 v[28:31], v4 offset:17600
    buffer_load_dwordx4 v9, s[12:15], s34 offen offset:1152  lds
    v_mfma_f32_16x16x32_bf16 v[176:179], v[32:35], v[80:83], v[176:179]
    s_sub_u32 s34, s34, 73600
    s_add_u32 m0, s39, 69632
    s_mov_b32 s33, s74
    buffer_load_dwordx4 v8, s[8:11], s33 offen nt lds
    v_mfma_f32_16x16x32_bf16 v[208:211], v[32:35], v[88:91], v[208:211]
    s_add_u32 m0, s39, 70432
    ds_read_b128 v[32:35], v4 offset:21760
    buffer_load_dwordx4 v8, s[8:11], s33 offen offset:256 nt lds
    v_mfma_f32_16x16x32_bf16 v[180:183], v[36:39], v[80:83], v[180:183]
    v_mfma_f32_16x16x32_bf16 v[212:215], v[36:39], v[88:91], v[212:215]
    ds_read_b128 v[36:39], v4 offset:21824
    v_mfma_f32_16x16x32_bf16 v[184:187], v[40:43], v[80:83], v[184:187]
    v_mfma_f32_16x16x32_bf16 v[216:219], v[40:43], v[88:91], v[216:219]
    ds_read_b128 v[40:43], v4 offset:21888
    v_mfma_f32_16x16x32_bf16 v[188:191], v[44:47], v[80:83], v[188:191]
    v_mfma_f32_16x16x32_bf16 v[220:223], v[44:47], v[88:91], v[220:223]
    ds_read_b128 v[44:47], v4 offset:21952
    s_cbranch_vccnz L_rare_t30
L_back_t30:
    s_waitcnt lgkmcnt(4)
    v_mfma_f32_16x16x32_bf16 v[80:83], v[16:19], v[96:99], v[48:51]
    s_add_u32 m0, s40, 78336
    s_add_u32 s33, s33, 8192
    buffer_load_dwordx4 v7, s[4:7], s32 offen nt lds
    v_mfma_f32_16x16x32_bf16 v[88:91], v[16:19], v[100:103], v[52:55]
    ds_read_b64_tr_b16 v[16:17], v6 offset:26112
    ds_read_b64_tr_b16 v[18:19], v6 offset:26368
    v_mfma_f32_16x16x32_bf16 v[80:83], v[20:23], v[104:107], v[80:83]
    v_exp_f32 v64, v64
    v_exp_f32 v65, v65
    v_mfma_f32_16x16x32_bf16 v[88:91], v[20:23], v[108:111], v[88:91]
    ds_read_b64_tr_b16 v[20:21], v6 offset:26144
    ds_read_b64_tr_b16 v[22:23], v6 offset:26400
    v_mfma_f32_16x16x32_bf16 v[80:83], v[24:27], v[112:115], v[80:83]
    v_exp_f32 v66, v66
    v_add_f32 v11, v11, v64
    v_mfma_f32_16x16x32_bf16 v[88:91], v[24:27], v[116:119], v[88:91]
    ds_read_b64_tr_b16 v[24:25], v6 offset:26176
    ds_read_b64_tr_b16 v[26:27], v6 offset:26432
    v_add_f32 v11, v11, v65
    v_mfma_f32_16x16x32_bf16 v[80:83], v[28:31], v[120:123], v[80:83]
    v_cvt_pk_bf16_f32 v64, v64, v65
    v_exp_f32 v67, v67
    v_mfma_f32_16x16x32_bf16 v[88:91], v[28:31], v[124:127], v[88:91]
    ds_read_b64_tr_b16 v[28:29], v6 offset:26208
    ds_read_b64_tr_b16 v[30:31], v6 offset:26464
    s_waitcnt lgkmcnt(8)
    v_mfma_f32_16x16x32_bf16 v[84:87], v[32:35], v[96:99], v[48:51]
    v_exp_f32 v68, v68
    v_add_f32 v11, v11, v66
    v_mfma_f32_16x16x32_bf16 v[92:95], v[32:35], v[100:103], v[52:55]
    ds_read_b64_tr_b16 v[32:33], v6 offset:26624
    ds_read_b64_tr_b16 v[34:35], v6 offset:26880
    v_add_f32 v11, v11, v67
    v_mfma_f32_16x16x32_bf16 v[84:87], v[36:39], v[104:107], v[84:87]
    v_cvt_pk_bf16_f32 v65, v66, v67
    v_exp_f32 v69, v69
    v_mfma_f32_16x16x32_bf16 v[92:95], v[36:39], v[108:111], v[92:95]
    ds_read_b64_tr_b16 v[36:37], v6 offset:26656
    ds_read_b64_tr_b16 v[38:39], v6 offset:26912
    v_mfma_f32_16x16x32_bf16 v[84:87], v[40:43], v[112:115], v[84:87]
    v_exp_f32 v70, v70
    v_cvt_pk_bf16_f32 v66, v68, v69
    v_mfma_f32_16x16x32_bf16 v[92:95], v[40:43], v[116:119], v[92:95]
    ds_read_b64_tr_b16 v[40:41], v6 offset:26688
    ds_read_b64_tr_b16 v[42:43], v6 offset:26944
    s_add_u32 m0, s40, 78400
    v_mfma_f32_16x16x32_bf16 v[84:87], v[44:47], v[120:123], v[84:87]
    buffer_load_dwordx4 v7, s[4:7], s32 offen offset:1024 nt lds
    s_add_u32 s32, s32, 8192
    v_exp_f32 v71, v71
    v_mfma_f32_16x16x32_bf16 v[92:95], v[44:47], v[124:127], v[92:95]
    ds_read_b64_tr_b16 v[44:45], v6 offset:26720
    ds_read_b64_tr_b16 v[46:47], v6 offset:26976
    s_waitcnt lgkmcnt(8)
    v_mfma_f32_16x16x32_bf16 a[224:227], v[16:19], v[144:147], a[224:227]
    v_add_f32 v11, v11, v68
    v_cvt_pk_bf16_f32 v67, v70, v71
    v_mfma_f32_16x16x32_bf16 a[228:231], v[16:19], v[148:151], a[228:231]
    ds_read_b64_tr_b16 v[16:17], v5 offset:34816
    ds_read_b64_tr_b16 v[18:19], v5 offset:35328
    v_exp_f32 v72, v72
    v_mfma_f32_16x16x32_bf16 a[232:235], v[20:23], v[144:147], a[232:235]
    v_exp_f32 v73, v73
    v_mfma_f32_16x16x32_bf16 a[236:239], v[20:23], v[148:151], a[236:239]
    ds_read_b64_tr_b16 v[20:21], v5 offset:34848
    ds_read_b64_tr_b16 v[22:23], v5 offset:35360
    v_mfma_f32_16x16x32_bf16 a[240:243], v[24:27], v[144:147], a[240:243]
    v_exp_f32 v74, v74
    v_add_f32 v12, v12, v72
    v_add_f32 v12, v12, v73
    v_mfma_f32_16x16x32_bf16 a[244:247], v[24:27], v[148:151], a[244:247]
    ds_read_b64_tr_b16 v[24:25], v5 offset:34880
    ds_read_b64_tr_b16 v[26:27], v5 offset:35392
    v_mfma_f32_16x16x32_bf16 a[248:251], v[28:31], v[144:147], a[248:251]
    v_cvt_pk_bf16_f32 v72, v72, v73
    v_exp_f32 v75, v75
    v_mfma_f32_16x16x32_bf16 a[252:255], v[28:31], v[148:151], a[252:255]
    ds_read_b64_tr_b16 v[28:29], v5 offset:34912
    ds_read_b64_tr_b16 v[30:31], v5 offset:35424
    s_waitcnt lgkmcnt(8)
    v_mfma_f32_16x16x32_bf16 a[224:227], v[32:35], v[152:155], a[224:227]
    v_exp_f32 v76, v76
    v_add_f32 v12, v12, v74
    v_add_f32 v12, v12, v75
    v_mfma_f32_16x16x32_bf16 a[228:231], v[32:35], v[156:159], a[228:231]
    ds_read_b64_tr_b16 v[32:33], v5 offset:34944
    ds_read_b64_tr_b16 v[34:35], v5 offset:35456
    v_mfma_f32_16x16x32_bf16 a[232:235], v[36:39], v[152:155], a[232:235]
    v_cvt_pk_bf16_f32 v73, v74, v75
    v_exp_f32 v77, v77
    v_mfma_f32_16x16x32_bf16 a[236:239], v[36:39], v[156:159], a[236:239]
    ds_read_b64_tr_b16 v[36:37], v5 offset:34976
    ds_read_b64_tr_b16 v[38:39], v5 offset:35488
    v_mfma_f32_16x16x32_bf16 a[240:243], v[40:43], v[152:155], a[240:243]
    v_exp_f32 v78, v78
    v_cvt_pk_bf16_f32 v74, v76, v77
    v_mfma_f32_16x16x32_bf16 a[244:247], v[40:43], v[156:159], a[244:247]
    ds_read_b64_tr_b16 v[40:41], v5 offset:35008
    ds_read_b64_tr_b16 v[42:43], v5 offset:35520
    v_mfma_f32_16x16x32_bf16 a[248:251], v[44:47], v[152:155], a[248:251]
    v_exp_f32 v79, v79
    v_add_f32 v12, v12, v76
    v_cvt_pk_bf16_f32 v75, v78, v79
    v_mfma_f32_16x16x32_bf16 a[252:255], v[44:47], v[156:159], a[252:255]
    ds_read_b64_tr_b16 v[44:45], v5 offset:35040
    ds_read_b64_tr_b16 v[46:47], v5 offset:35552
    s_waitcnt lgkmcnt(10)
    v_mfma_f32_16x16x32_bf16 v[160:163], v[16:19], v[64:67], v[160:163]
    v_add_f32 v11, v11, v69
    v_max3_f32 v13, v80, v81, v82
    v_add_f32 v11, v11, v70
    v_mfma_f32_16x16x32_bf16 v[192:195], v[16:19], v[72:75], v[192:195]
    v_max3_f32 v13, v13, v83, v84
    v_add_f32 v11, v11, v71
    v_max3_f32 v13, v13, v85, v86
    v_mfma_f32_16x16x32_bf16 v[164:167], v[20:23], v[64:67], v[164:167]
    v_add_f32 v12, v12, v77
    v_max3_f32 v13, v13, v87, v88
    v_add_f32 v12, v12, v78
    v_mfma_f32_16x16x32_bf16 v[196:199], v[20:23], v[72:75], v[196:199]
    v_max3_f32 v13, v13, v89, v90
    v_add_f32 v12, v12, v79
    v_mfma_f32_16x16x32_bf16 v[168:171], v[24:27], v[64:67], v[168:171]
    v_max3_f32 v13, v13, v91, v92
    v_max3_f32 v13, v13, v93, v94
    v_max_f32 v13, v13, v95
    v_mfma_f32_16x16x32_bf16 v[200:203], v[24:27], v[72:75], v[200:203]
    s_waitcnt vmcnt(8) lgkmcnt(0)
    s_barrier
    ds_read_b128 v[16:19], v1 offset:0
    ds_read_b128 v[96:99], v0 offset:0
    ds_read_b128 v[20:23], v1 offset:64
    ds_read_b128 v[100:103], v0 offset:1024
    v_mfma_f32_16x16x32_bf16 v[172:175], v[28:31], v[64:67], v[172:175]
    ds_read_b128 v[24:27], v1 offset:128
    ds_read_b128 v[104:107], v0 offset:2048
    v_mfma_f32_16x16x32_bf16 v[204:207], v[28:31], v[72:75], v[204:207]
    ds_read_b128 v[28:31], v1 offset:192
    ds_read_b128 v[108:111], v0 offset:3072
    v_mfma_f32_16x16x32_bf16 v[176:179], v[32:35], v[64:67], v[176:179]
    s_lshl_b32 s48, s73, 2
    v_cmp_lt_f32 vcc, s46, v13
    s_lshr_b32 s48, s41, s48
    v_mfma_f32_16x16x32_bf16 v[208:211], v[32:35], v[72:75], v[208:211]
    ds_read_b128 v[32:35], v1 offset:4352
    ds_read_b128 v[112:115], v0 offset:4096
    s_and_b32 s48, s48, 3
    s_lshl_b32 s49, s44, 2
    v_mfma_f32_16x16x32_bf16 v[180:183], v[36:39], v[64:67], v[180:183]
    s_add_u32 s48, s48, s49
    s_mul_i32 s34, s48, 147456
    s_cmp_ge_i32 s73, 0
    s_cselect_b32 s14, 4718592, 0
    v_mfma_f32_16x16x32_bf16 v[212:215], v[36:39], v[72:75], v[212:215]
    ds_read_b128 v[36:39], v1 offset:4416
    ds_read_b128 v[116:119], v0 offset:5120
    v_mfma_f32_16x16x32_bf16 v[184:187], v[40:43], v[64:67], v[184:187]
    s_add_u32 m0, s39, 87040
    s_add_u32 s73, s73, 1
    buffer_load_dwordx4 v9, s[12:15], s34 offen  lds
    v_mfma_f32_16x16x32_bf16 v[216:219], v[40:43], v[72:75], v[216:219]
    ds_read_b128 v[40:43], v1 offset:4480
    s_add_u32 m0, s39, 86944
    ds_read_b128 v[120:123], v0 offset:6144
    buffer_load_dwordx4 v9, s[12:15], s34 offen offset:1152  lds
    v_mfma_f32_16x16x32_bf16 v[188:191], v[44:47], v[64:67], v[188:191]
    s_add_u32 m0, s39, 95744
    s_add_u32 s34, s34, 73728
    buffer_load_dwordx4 v8, s[8:11], s33 offen nt lds
    v_mfma_f32_16x16x32_bf16 v[220:223], v[44:47], v[72:75], v[220:223]
    ds_read_b128 v[44:47], v1 offset:4544
    s_add_u32 m0, s39, 96544
    ds_read_b128 v[124:127], v0 offset:7168
    buffer_load_dwordx4 v8, s[8:11], s33 offen offset:256 nt lds
    s_cbranch_vccnz L_rare_t31
L_back_t31:
    s_waitcnt lgkmcnt(0)
    v_mfma_f32_16x16x32_bf16 v[64:67], v[16:19], v[96:99], 0
    s_add_u32 m0, s40, 104448
    s_add_u32 s33, s33, 8192
    buffer_load_dwordx4 v7, s[4:7], s32 offen nt lds
    v_mfma_f32_16x16x32_bf16 v[72:75], v[16:19], v[100:103], 0
    ds_read_b64_tr_b16 v[16:17], v3 offset:8704
    ds_read_b64_tr_b16 v[18:19], v3 offset:8960
    v_exp_f32 v80, v80
    v_mfma_f32_16x16x32_bf16 v[64:67], v[20:23], v[104:107], v[64:67]
    v_exp_f32 v81, v81
    v_mfma_f32_16x16x32_bf16 v[72:75], v[20:23], v[108:111], v[72:75]
    ds_read_b64_tr_b16 v[20:21], v3 offset:8736
    ds_read_b64_tr_b16 v[22:23], v3 offset:8992
    v_exp_f32 v82, v82
    v_mfma_f32_16x16x32_bf16 v[64:67], v[24:27], v[112:115], v[64:67]
    v_add_f32 v11, v11, v80
    v_add_f32 v11, v11, v81
    v_cvt_pk_bf16_f32 v80, v80, v81
    v_mfma_f32_16x16x32_bf16 v[72:75], v[24:27], v[116:119], v[72:75]
    ds_read_b64_tr_b16 v[24:25], v3 offset:8768
    ds_read_b64_tr_b16 v[26:27], v3 offset:9024
    v_exp_f32 v83, v83
    v_mfma_f32_16x16x32_bf16 v[64:67], v[28:31], v[120:123], v[64:67]
    v_exp_f32 v84, v84
    v_add_f32 v11, v11, v82
    v_mfma_f32_16x16x32_bf16 v[72:75], v[28:31], v[124:127], v[72:75]
    ds_read_b64_tr_b16 v[28:29], v3 offset:8800
    ds_read_b64_tr_b16 v[30:31], v3 offset:9056
    v_add_f32 v11, v11, v83
    s_nop 0
    v_mfma_f32_16x16x32_bf16 v[68:71], v[32:35], v[96:99], 0
    v_cvt_pk_bf16_f32 v81, v82, v83
    v_exp_f32 v85, v85
    v_mfma_f32_16x16x32_bf16 v[76:79], v[32:35], v[100:103], 0
    ds_read_b64_tr_b16 v[32:33], v3 offset:9216
    ds_read_b64_tr_b16 v[34:35], v3 offset:9472
    v_exp_f32 v86, v86
    v_mfma_f32_16x16x32_bf16 v[68:71], v[36:39], v[104:107], v[68:71]
    v_cvt_pk_bf16_f32 v82, v84, v85
    v_exp_f32 v87, v87
    v_mfma_f32_16x16x32_bf16 v[76:79], v[36:39], v[108:111], v[76:79]
    ds_read_b64_tr_b16 v[36:37], v3 offset:9248
    ds_read_b64_tr_b16 v[38:39], v3 offset:9504
    v_add_f32 v11, v11, v84
    v_mfma_f32_16x16x32_bf16 v[68:71], v[40:43], v[112:115], v[68:71]
    v_cvt_pk_bf16_f32 v83, v86, v87
    v_exp_f32 v88, v88
    v_mfma_f32_16x16x32_bf16 v[76:79], v[40:43], v[116:119], v[76:79]
    ds_read_b64_tr_b16 v[40:41], v3 offset:9280
    ds_read_b64_tr_b16 v[42:43], v3 offset:9536
    v_exp_f32 v89, v89
    s_add_u32 m0, s40, 104512
    v_mfma_f32_16x16x32_bf16 v[68:71], v[44:47], v[120:123], v[68:71]
    buffer_load_dwordx4 v7, s[4:7], s32 offen offset:1024 nt lds
    s_add_u32 s32, s32, 8192
    v_mfma_f32_16x16x32_bf16 v[76:79], v[44:47], v[124:127], v[76:79]
    ds_read_b64_tr_b16 v[44:45], v3 offset:9312
    ds_read_b64_tr_b16 v[46:47], v3 offset:9568
    v_exp_f32 v90, v90
    s_waitcnt lgkmcnt(8)
    v_mfma_f32_16x16x32_bf16 v[224:227], v[16:19], v[128:131], v[224:227]
    v_add_f32 v12, v12, v88
    v_add_f32 v12, v12, v89
    v_cvt_pk_bf16_f32 v88, v88, v89
    v_mfma_f32_16x16x32_bf16 v[228:231], v[16:19], v[132:135], v[228:231]
    ds_read_b64_tr_b16 v[16:17], v2 offset:17408
    ds_read_b64_tr_b16 v[18:19], v2 offset:17920
    v_exp_f32 v91, v91
    v_mfma_f32_16x16x32_bf16 v[232:235], v[20:23], v[128:131], v[232:235]
    v_exp_f32 v92, v92
    v_add_f32 v12, v12, v90
    v_mfma_f32_16x16x32_bf16 v[236:239], v[20:23], v[132:135], v[236:239]
    ds_read_b64_tr_b16 v[20:21], v2 offset:17440
    ds_read_b64_tr_b16 v[22:23], v2 offset:17952
    v_add_f32 v12, v12, v91
    v_mfma_f32_16x16x32_bf16 v[240:243], v[24:27], v[128:131], v[240:243]
    v_cvt_pk_bf16_f32 v89, v90, v91
    v_exp_f32 v93, v93
    v_mfma_f32_16x16x32_bf16 v[244:247], v[24:27], v[132:135], v[244:247]
    ds_read_b64_tr_b16 v[24:25], v2 offset:17472
    ds_read_b64_tr_b16 v[26:27], v2 offset:17984
    v_exp_f32 v94, v94
    v_mfma_f32_16x16x32_bf16 v[248:251], v[28:31], v[128:131], v[248:251]
    v_cvt_pk_bf16_f32 v90, v92, v93
    v_exp_f32 v95, v95
    v_mfma_f32_16x16x32_bf16 v[252:255], v[28:31], v[132:135], v[252:255]
    ds_read_b64_tr_b16 v[28:29], v2 offset:17504
    ds_read_b64_tr_b16 v[30:31], v2 offset:18016
    v_add_f32 v12, v12, v92
    s_waitcnt lgkmcnt(8)
    v_mfma_f32_16x16x32_bf16 v[224:227], v[32:35], v[136:139], v[224:227]
    v_cvt_pk_bf16_f32 v91, v94, v95
    v_max3_f32 v56, v64, v65, v66
    v_max3_f32 v57, v72, v73, v74
    v_mfma_f32_16x16x32_bf16 v[228:231], v[32:35], v[140:143], v[228:231]
    ds_read_b64_tr_b16 v[32:33], v2 offset:17536
    ds_read_b64_tr_b16 v[34:35], v2 offset:18048
    v_max3_f32 v56, v56, v67, v68
    v_max3_f32 v57, v57, v75, v76
    v_mfma_f32_16x16x32_bf16 v[232:235], v[36:39], v[136:139], v[232:235]
    v_max3_f32 v56, v56, v69, v70
    v_max3_f32 v57, v57, v77, v78
    v_max_f32 v56, v56, v71
    v_mfma_f32_16x16x32_bf16 v[236:239], v[36:39], v[140:143], v[236:239]
    ds_read_b64_tr_b16 v[36:37], v2 offset:17568
    ds_read_b64_tr_b16 v[38:39], v2 offset:18080
    v_max_f32 v57, v57, v79
    v_mfma_f32_16x16x32_bf16 v[240:243], v[40:43], v[136:139], v[240:243]
    v_mov_b32 v10, v56
    v_mov_b32 v58, v57
    s_nop 0
    v_mfma_f32_16x16x32_bf16 v[244:247], v[40:43], v[140:143], v[244:247]
    ds_read_b64_tr_b16 v[40:41], v2 offset:17600
    ds_read_b64_tr_b16 v[42:43], v2 offset:18112
    v_permlane32_swap_b32 v10, v56
    v_permlane32_swap_b32 v58, v57
    v_mfma_f32_16x16x32_bf16 v[248:251], v[44:47], v[136:139], v[248:251]
    v_max_f32 v56, v56, v10
    v_max_f32 v57, v57, v58
    v_mov_b32 v10, v56
    v_mfma_f32_16x16x32_bf16 v[252:255], v[44:47], v[140:143], v[252:255]
    ds_read_b64_tr_b16 v[44:45], v2 offset:17632
    ds_read_b64_tr_b16 v[46:47], v2 offset:18144
    v_mov_b32 v58, v57
    s_waitcnt lgkmcnt(10)
    v_mfma_f32_16x16x32_bf16 v[160:163], v[16:19], v[80:83], v[160:163]
    v_add_f32 v11, v11, v85
    v_add_f32 v11, v11, v86
    v_add_f32 v11, v11, v87
    v_mfma_f32_16x16x32_bf16 v[192:195], v[16:19], v[88:91], v[192:195]
    v_add_f32 v12, v12, v93
    v_add_f32 v12, v12, v94
    v_add_f32 v12, v12, v95
    v_mov_b32 v62, v11
    v_mfma_f32_16x16x32_bf16 v[164:167], v[20:23], v[80:83], v[164:167]
    v_mov_b32 v63, v12
    s_nop 0
    v_permlane32_swap_b32 v62, v11
    v_mfma_f32_16x16x32_bf16 v[196:199], v[20:23], v[88:91], v[196:199]
    v_permlane32_swap_b32 v63, v12
    v_add_f32 v11, v11, v62
    v_add_f32 v12, v12, v63
    v_mfma_f32_16x16x32_bf16 v[168:171], v[24:27], v[80:83], v[168:171]
    v_mov_b32 v62, v11
    v_mov_b32 v63, v12
    s_nop 0
    v_mfma_f32_16x16x32_bf16 v[200:203], v[24:27], v[88:91], v[200:203]
    s_waitcnt vmcnt(8) lgkmcnt(0)
    s_barrier
    ds_read_b128 v[16:19], v1 offset:26112
    ds_read_b128 v[20:23], v1 offset:26176
    ds_read_b128 v[24:27], v1 offset:26240
    v_mfma_f32_16x16x32_bf16 v[172:175], v[28:31], v[80:83], v[172:175]
    v_permlane16_swap_b32 v62, v11
    v_permlane16_swap_b32 v63, v12
    v_add_f32 v11, v11, v62
    v_mfma_f32_16x16x32_bf16 v[204:207], v[28:31], v[88:91], v[204:207]
    ds_read_b128 v[28:31], v1 offset:26304
    v_add_f32 v12, v12, v63
    v_mfma_f32_16x16x32_bf16 v[176:179], v[32:35], v[80:83], v[176:179]
    v_rcp_f32 v59, v11
    v_rcp_f32 v60, v12
    v_mfma_f32_16x16x32_bf16 v[208:211], v[32:35], v[88:91], v[208:211]
    ds_read_b128 v[32:35], v1 offset:30464
    v_mov_b32 v11, 0
    v_mov_b32 v12, 0
    v_mfma_f32_16x16x32_bf16 v[180:183], v[36:39], v[80:83], v[180:183]
    s_nop 0
    v_permlane16_swap_b32 v10, v56
    v_permlane16_swap_b32 v58, v57
    v_max_f32 v56, v56, v10
    v_mfma_f32_16x16x32_bf16 v[212:215], v[36:39], v[88:91], v[212:215]
    ds_read_b128 v[36:39], v1 offset:30528
    v_max_f32 v57, v57, v58
    v_sub_f32 v48, 0, v56
    v_mfma_f32_16x16x32_bf16 v[184:187], v[40:43], v[80:83], v[184:187]
    v_sub_f32 v49, 0, v56
    v_sub_f32 v50, 0, v56
    v_sub_f32 v51, 0, v56
    v_mfma_f32_16x16x32_bf16 v[216:219], v[40:43], v[88:91], v[216:219]
    s_add_u32 m0, s39, 26112
    ds_read_b128 v[40:43], v1 offset:30592
    buffer_load_dwordx4 v9, s[12:15], s34 offen  lds
    s_add_u32 m0, s39, 26016
    v_mfma_f32_16x16x32_bf16 v[188:191], v[44:47], v[80:83], v[188:191]
    buffer_load_dwordx4 v9, s[12:15], s34 offen offset:1152  lds
    s_add_u32 m0, s39, 34816
    s_sub_u32 s34, s34, 73600
    buffer_load_dwordx4 v8, s[8:11], s33 offen nt lds
    v_mfma_f32_16x16x32_bf16 v[220:223], v[44:47], v[88:91], v[220:223]
    s_add_u32 m0, s39, 35616
    ds_read_b128 v[44:47], v1 offset:30656
    buffer_load_dwordx4 v8, s[8:11], s33 offen offset:256 nt lds
    v_sub_f32 v52, 0, v57
    v_sub_f32 v53, 0, v57
    v_sub_f32 v54, 0, v57
    v_sub_f32 v55, 0, v57
    v_sub_f32 v64, v64, v56
    v_sub_f32 v65, v65, v56
    v_sub_f32 v66, v66, v56
    v_sub_f32 v67, v67, v56
    v_sub_f32 v68, v68, v56
    v_sub_f32 v69, v69, v56
    v_sub_f32 v70, v70, v56
    v_sub_f32 v71, v71, v56
    v_sub_f32 v72, v72, v57
    v_sub_f32 v73, v73, v57
    v_sub_f32 v74, v74, v57
    v_sub_f32 v75, v75, v57
    v_sub_f32 v76, v76, v57
    v_sub_f32 v77, v77, v57
    v_sub_f32 v78, v78, v57
    v_sub_f32 v79, v79, v57
    s_nop 0
    s_waitcnt lgkmcnt(4)
    v_mfma_f32_16x16x32_bf16 v[80:83], v[16:19], v[96:99], v[48:51]
    s_add_u32 m0, s40, 43520
    s_add_u32 s33, s33, 8192
    buffer_load_dwordx4 v7, s[4:7], s32 offen nt lds
    v_exp_f32 v64, v64
    v_mfma_f32_16x16x32_bf16 v[88:91], v[16:19], v[100:103], v[52:55]
    ds_read_b64_tr_b16 v[16:17], v3 offset:34816
    ds_read_b64_tr_b16 v[18:19], v3 offset:35072
    v_exp_f32 v65, v65
    v_exp_f32 v66, v66
    v_mfma_f32_16x16x32_bf16 v[80:83], v[20:23], v[104:107], v[80:83]
    v_add_f32 v11, v11, v64
    v_add_f32 v11, v11, v65
    v_cvt_pk_bf16_f32 v64, v64, v65
    v_exp_f32 v67, v67
    v_mfma_f32_16x16x32_bf16 v[88:91], v[20:23], v[108:111], v[88:91]
    ds_read_b64_tr_b16 v[20:21], v3 offset:34848
    ds_read_b64_tr_b16 v[22:23], v3 offset:35104
    v_exp_f32 v68, v68
    v_add_f32 v11, v11, v66
    v_add_f32 v11, v11, v67
    v_mfma_f32_16x16x32_bf16 v[80:83], v[24:27], v[112:115], v[80:83]
    v_cvt_pk_bf16_f32 v65, v66, v67
    v_exp_f32 v69, v69
    v_exp_f32 v70, v70
    v_mfma_f32_16x16x32_bf16 v[88:91], v[24:27], v[116:119], v[88:91]
    ds_read_b64_tr_b16 v[24:25], v3 offset:34880
    ds_read_b64_tr_b16 v[26:27], v3 offset:35136
    v_cvt_pk_bf16_f32 v66, v68, v69
    v_exp_f32 v71, v71
    v_mfma_f32_16x16x32_bf16 v[80:83], v[28:31], v[120:123], v[80:83]
    v_add_f32 v11, v11, v68
    v_cvt_pk_bf16_f32 v67, v70, v71
    v_exp_f32 v72, v72
    v_exp_f32 v73, v73
    v_mfma_f32_16x16x32_bf16 v[88:91], v[28:31], v[124:127], v[88:91]
    ds_read_b64_tr_b16 v[28:29], v3 offset:34912
    ds_read_b64_tr_b16 v[30:31], v3 offset:35168
    v_exp_f32 v74, v74
    v_add_f32 v12, v12, v72
    s_waitcnt lgkmcnt(8)
    v_mfma_f32_16x16x32_bf16 v[84:87], v[32:35], v[96:99], v[48:51]
    v_add_f32 v12, v12, v73
    v_cvt_pk_bf16_f32 v72, v72, v73
    v_exp_f32 v75, v75
    v_mfma_f32_16x16x32_bf16 v[92:95], v[32:35], v[100:103], v[52:55]
    ds_read_b64_tr_b16 v[32:33], v3 offset:35328
    ds_read_b64_tr_b16 v[34:35], v3 offset:35584
    v_exp_f32 v76, v76
    v_add_f32 v12, v12, v74
    v_add_f32 v12, v12, v75
    v_mfma_f32_16x16x32_bf16 v[84:87], v[36:39], v[104:107], v[84:87]
    v_cvt_pk_bf16_f32 v73, v74, v75
    v_exp_f32 v77, v77
    v_exp_f32 v78, v78
    v_cvt_pk_bf16_f32 v74, v76, v77
    v_mfma_f32_16x16x32_bf16 v[92:95], v[36:39], v[108:111], v[92:95]
    ds_read_b64_tr_b16 v[36:37], v3 offset:35360
    ds_read_b64_tr_b16 v[38:39], v3 offset:35616
    v_exp_f32 v79, v79
    v_add_f32 v12, v12, v76
    v_mfma_f32_16x16x32_bf16 v[84:87], v[40:43], v[112:115], v[84:87]
    v_cvt_pk_bf16_f32 v75, v78, v79
    v_mul_f32 v160, v59, v160
    v_mul_f32 v161, v59, v161
    v_mul_f32 v162, v59, v162
    v_mul_f32 v163, v59, v163
    v_mfma_f32_16x16x32_bf16 v[92:95], v[40:43], v[116:119], v[92:95]
    ds_read_b64_tr_b16 v[40:41], v3 offset:35392
    ds_read_b64_tr_b16 v[42:43], v3 offset:35648
    v_mul_f32 v164, v59, v164
    v_mul_f32 v165, v59, v165
    v_mul_f32 v166, v59, v166
    s_add_u32 m0, s40, 43584
    v_mfma_f32_16x16x32_bf16 v[84:87], v[44:47], v[120:123], v[84:87]
    buffer_load_dwordx4 v7, s[4:7], s32 offen offset:1024 nt lds
    s_add_u32 s32, s32, 8192
    v_mul_f32 v167, v59, v167
    v_cvt_pk_bf16_f32 v128, v160, v161
    v_cvt_pk_bf16_f32 v129, v162, v163
    v_cvt_pk_bf16_f32 v130, v164, v165
    v_mfma_f32_16x16x32_bf16 v[92:95], v[44:47], v[124:127], v[92:95]
    ds_read_b64_tr_b16 v[44:45], v3 offset:35424
    ds_read_b64_tr_b16 v[46:47], v3 offset:35680
    v_cvt_pk_bf16_f32 v131, v166, v167
    v_mul_f32 v192, v60, v192
    v_mul_f32 v193, v60, v193
    s_waitcnt lgkmcnt(8)
    v_mfma_f32_16x16x32_bf16 v[224:227], v[16:19], v[144:147], v[224:227]
    v_mul_f32 v194, v60, v194
    v_mul_f32 v195, v60, v195
    v_mul_f32 v196, v60, v196
    v_mul_f32 v197, v60, v197
    v_mul_f32 v198, v60, v198
    v_mfma_f32_16x16x32_bf16 v[228:231], v[16:19], v[148:151], v[228:231]
    ds_read_b64_tr_b16 v[16:17], v5 offset:0
    ds_read_b64_tr_b16 v[18:19], v5 offset:512
    v_mul_f32 v199, v60, v199
    v_cvt_pk_bf16_f32 v132, v192, v193
    v_cvt_pk_bf16_f32 v133, v194, v195
    v_cvt_pk_bf16_f32 v134, v196, v197
    v_mfma_f32_16x16x32_bf16 v[232:235], v[20:23], v[144:147], v[232:235]
    v_cvt_pk_bf16_f32 v135, v198, v199
    v_mul_f32 v168, v59, v168
    v_mul_f32 v169, v59, v169
    v_mul_f32 v170, v59, v170
    v_mul_f32 v171, v59, v171
    v_mfma_f32_16x16x32_bf16 v[236:239], v[20:23], v[148:151], v[236:239]
    ds_read_b64_tr_b16 v[20:21], v5 offset:32
    ds_read_b64_tr_b16 v[22:23], v5 offset:544
    v_mul_f32 v172, v59, v172
    v_mul_f32 v173, v59, v173
    v_mul_f32 v174, v59, v174
    v_mfma_f32_16x16x32_bf16 v[240:243], v[24:27], v[144:147], v[240:243]
    v_mul_f32 v175, v59, v175
    v_cvt_pk_bf16_f32 v136, v168, v169
    v_cvt_pk_bf16_f32 v137, v170, v171
    v_cvt_pk_bf16_f32 v138, v172, v173
    v_cvt_pk_bf16_f32 v139, v174, v175
    v_mul_f32 v200, v60, v200
    v_mfma_f32_16x16x32_bf16 v[244:247], v[24:27], v[148:151], v[244:247]
    ds_read_b64_tr_b16 v[24:25], v5 offset:64
    ds_read_b64_tr_b16 v[26:27], v5 offset:576
    v_mul_f32 v201, v60, v201
    v_mul_f32 v202, v60, v202
    v_mul_f32 v203, v60, v203
    v_mfma_f32_16x16x32_bf16 v[248:251], v[28:31], v[144:147], v[248:251]
    v_mul_f32 v204, v60, v204
    v_mul_f32 v205, v60, v205
    v_mul_f32 v206, v60, v206
    v_mul_f32 v207, v60, v207
    v_cvt_pk_bf16_f32 v140, v200, v201
    v_mfma_f32_16x16x32_bf16 v[252:255], v[28:31], v[148:151], v[252:255]
    ds_read_b64_tr_b16 v[28:29], v5 offset:96
    ds_read_b64_tr_b16 v[30:31], v5 offset:608
    v_cvt_pk_bf16_f32 v141, v202, v203
    v_cvt_pk_bf16_f32 v142, v204, v205
    v_cvt_pk_bf16_f32 v143, v206, v207
    s_waitcnt lgkmcnt(8)
    v_mfma_f32_16x16x32_bf16 v[224:227], v[32:35], v[152:155], v[224:227]
    v_mul_f32 v176, v59, v176
    v_mul_f32 v177, v59, v177
    v_mul_f32 v178, v59, v178
    v_mul_f32 v179, v59, v179
    v_mul_f32 v180, v59, v180
    v_mul_f32 v181, v59, v181
    v_mfma_f32_16x16x32_bf16 v[228:231], v[32:35], v[156:159], v[228:231]
    ds_read_b64_tr_b16 v[32:33], v5 offset:128
    ds_read_b64_tr_b16 v[34:35], v5 offset:640
    v_mul_f32 v182, v59, v182
    v_mul_f32 v183, v59, v183
    v_mul_f32 v208, v60, v208
    v_mfma_f32_16x16x32_bf16 v[232:235], v[36:39], v[152:155], v[232:235]
    v_mul_f32 v209, v60, v209
    v_mul_f32 v210, v60, v210
    v_mul_f32 v211, v60, v211
    v_mul_f32 v212, v60, v212
    v_mul_f32 v213, v60, v213
    v_mfma_f32_16x16x32_bf16 v[236:239], v[36:39], v[156:159], v[236:239]
    ds_read_b64_tr_b16 v[36:37], v5 offset:160
    ds_read_b64_tr_b16 v[38:39], v5 offset:672
    v_mul_f32 v214, v60, v214
    v_mul_f32 v215, v60, v215
    v_mul_f32 v184, v59, v184
    v_mul_f32 v185, v59, v185
    v_mfma_f32_16x16x32_bf16 v[240:243], v[40:43], v[152:155], v[240:243]
    v_mul_f32 v186, v59, v186
    v_mul_f32 v187, v59, v187
    v_mul_f32 v188, v59, v188
    v_mul_f32 v189, v59, v189
    v_mul_f32 v190, v59, v190
    v_mfma_f32_16x16x32_bf16 v[244:247], v[40:43], v[156:159], v[244:247]
    ds_read_b64_tr_b16 v[40:41], v5 offset:192
    ds_read_b64_tr_b16 v[42:43], v5 offset:704
    v_mul_f32 v191, v59, v191
    v_mul_f32 v216, v60, v216
    v_mul_f32 v217, v60, v217
    v_mfma_f32_16x16x32_bf16 v[248:251], v[44:47], v[152:155], v[248:251]
    v_mul_f32 v218, v60, v218
    v_mul_f32 v219, v60, v219
    v_mul_f32 v220, v60, v220
    v_mul_f32 v221, v60, v221
    v_mul_f32 v222, v60, v222
    v_mul_f32 v223, v60, v223
    v_mfma_f32_16x16x32_bf16 v[252:255], v[44:47], v[156:159], v[252:255]
    ds_read_b64_tr_b16 v[44:45], v5 offset:224
    ds_read_b64_tr_b16 v[46:47], v5 offset:736
    v_cvt_pk_bf16_f32 v144, v176, v177
    v_cvt_pk_bf16_f32 v145, v178, v179
    v_cvt_pk_bf16_f32 v146, v180, v181
    s_waitcnt lgkmcnt(10)
    v_mfma_f32_16x16x32_bf16 v[160:163], v[16:19], v[64:67], 0
    v_cvt_pk_bf16_f32 v147, v182, v183
    v_cvt_pk_bf16_f32 v148, v208, v209
    v_cvt_pk_bf16_f32 v149, v210, v211
    v_cvt_pk_bf16_f32 v150, v212, v213
    v_cvt_pk_bf16_f32 v151, v214, v215
    v_mfma_f32_16x16x32_bf16 v[192:195], v[16:19], v[72:75], 0
    v_cvt_pk_bf16_f32 v152, v184, v185
    v_cvt_pk_bf16_f32 v153, v186, v187
    v_cvt_pk_bf16_f32 v154, v188, v189
    v_cvt_pk_bf16_f32 v155, v190, v191
    v_cvt_pk_bf16_f32 v156, v216, v217
    v_mfma_f32_16x16x32_bf16 v[164:167], v[20:23], v[64:67], 0
    v_cvt_pk_bf16_f32 v157, v218, v219
    v_cvt_pk_bf16_f32 v158, v220, v221
    v_cvt_pk_bf16_f32 v159, v222, v223
    v_add_f32 v11, v11, v69
    v_max3_f32 v13, v80, v81, v82
    v_add_f32 v11, v11, v70
    v_mfma_f32_16x16x32_bf16 v[196:199], v[20:23], v[72:75], 0
    v_max3_f32 v13, v13, v83, v84
    v_add_f32 v11, v11, v71
    v_max3_f32 v13, v13, v85, v86
    v_add_f32 v12, v12, v77
    v_max3_f32 v13, v13, v87, v88
    v_mfma_f32_16x16x32_bf16 v[168:171], v[24:27], v[64:67], 0
    v_add_f32 v12, v12, v78
    v_max3_f32 v13, v13, v89, v90
    v_add_f32 v12, v12, v79
    v_max3_f32 v13, v13, v91, v92
    v_max3_f32 v13, v13, v93, v94
    v_mfma_f32_16x16x32_bf16 v[200:203], v[24:27], v[72:75], 0
    s_waitcnt vmcnt(8) lgkmcnt(0)
    s_barrier
    ds_read_b128 v[16:19], v4 offset:8704
    ds_read_b128 v[20:23], v4 offset:8768
    ds_read_b128 v[24:27], v4 offset:8832
    v_max_f32 v13, v13, v95
    v_cmp_lt_f32 vcc, s46, v13
    s_add_u32 m0, s39, 52224
    v_mfma_f32_16x16x32_bf16 v[172:175], v[28:31], v[64:67], 0
    buffer_load_dwordx4 v9, s[12:15], s34 offen  lds
    s_add_u32 m0, s39, 52128
    s_nop 0
    buffer_load_dwordx4 v9, s[12:15], s34 offen offset:1152  lds
    v_mfma_f32_16x16x32_bf16 v[204:207], v[28:31], v[72:75], 0
    ds_read_b128 v[28:31], v4 offset:8896
    s_add_u32 m0, s39, 60928
    s_add_u32 s34, s34, 73728
    buffer_load_dwordx4 v9, s[12:15], s34 offen  lds
    s_add_u32 m0, s39, 60832
    s_nop 0
    buffer_load_dwordx4 v9, s[12:15], s34 offen offset:1152  lds
    v_mfma_f32_16x16x32_bf16 v[176:179], v[32:35], v[64:67], 0
    v_mfma_f32_16x16x32_bf16 v[208:211], v[32:35], v[72:75], 0
    ds_read_b128 v[32:35], v4 offset:13056
    v_mfma_f32_16x16x32_bf16 v[180:183], v[36:39], v[64:67], 0
    v_mfma_f32_16x16x32_bf16 v[212:215], v[36:39], v[72:75], 0
    ds_read_b128 v[36:39], v4 offset:13120
    v_mfma_f32_16x16x32_bf16 v[184:187], v[40:43], v[64:67], 0
    v_mfma_f32_16x16x32_bf16 v[216:219], v[40:43], v[72:75], 0
    ds_read_b128 v[40:43], v4 offset:13184
    v_mfma_f32_16x16x32_bf16 v[188:191], v[44:47], v[64:67], 0
    v_mfma_f32_16x16x32_bf16 v[220:223], v[44:47], v[72:75], 0
    ds_read_b128 v[44:47], v4 offset:13248
    s_cbranch_vccnz L_rare_t33
L_back_t33:
    s_add_u32 s28, s28, 1
    s_branch L_around
L_alast:
    s_load_dwordx2 s[56:57], s[0:1], 80
    s_load_dwordx2 s[60:61], s[0:1], 88
    s_waitcnt lgkmcnt(4)
    v_mfma_f32_16x16x32_bf16 v[64:67], v[16:19], v[96:99], v[48:51]
    s_add_u32 m0, s40, 87040
    s_add_u32 s33, s33, 8192
    buffer_load_dwordx4 v7, s[4:7], s32 offen nt lds
    v_mfma_f32_16x16x32_bf16 v[72:75], v[16:19], v[100:103], v[52:55]
    ds_read_b64_tr_b16 v[16:17], v6 offset:34816
    ds_read_b64_tr_b16 v[18:19], v6 offset:35072
    v_mfma_f32_16x16x32_bf16 v[64:67], v[20:23], v[104:107], v[64:67]
    v_exp_f32 v80, v80
    v_exp_f32 v81, v81
    v_mfma_f32_16x16x32_bf16 v[72:75], v[20:23], v[108:111], v[72:75]
    ds_read_b64_tr_b16 v[20:21], v6 offset:34848
    ds_read_b64_tr_b16 v[22:23], v6 offset:35104
    v_mfma_f32_16x16x32_bf16 v[64:67], v[24:27], v[112:115], v[64:67]
    v_exp_f32 v82, v82
    v_add_f32 v11, v11, v80
    v_mfma_f32_16x16x32_bf16 v[72:75], v[24:27], v[116:119], v[72:75]
    ds_read_b64_tr_b16 v[24:25], v6 offset:34880
    ds_read_b64_tr_b16 v[26:27], v6 offset:35136
    v_add_f32 v11, v11, v81
    v_mfma_f32_16x16x32_bf16 v[64:67], v[28:31], v[120:123], v[64:67]
    v_cvt_pk_bf16_f32 v80, v80, v81
    v_exp_f32 v83, v83
    v_mfma_f32_16x16x32_bf16 v[72:75], v[28:31], v[124:127], v[72:75]
    ds_read_b64_tr_b16 v[28:29], v6 offset:34912
    ds_read_b64_tr_b16 v[30:31], v6 offset:35168
    s_waitcnt lgkmcnt(8)
    v_mfma_f32_16x16x32_bf16 v[68:71], v[32:35], v[96:99], v[48:51]
    v_exp_f32 v84, v84
    v_add_f32 v11, v11, v82
    v_mfma_f32_16x16x32_bf16 v[76:79], v[32:35], v[100:103], v[52:55]
    ds_read_b64_tr_b16 v[32:33], v6 offset:35328
    ds_read_b64_tr_b16 v[34:35], v6 offset:35584
    v_add_f32 v11, v11, v83
    v_mfma_f32_16x16x32_bf16 v[68:71], v[36:39], v[104:107], v[68:71]
    v_cvt_pk_bf16_f32 v81, v82, v83
    v_exp_f32 v85, v85
    v_mfma_f32_16x16x32_bf16 v[76:79], v[36:39], v[108:111], v[76:79]
    ds_read_b64_tr_b16 v[36:37], v6 offset:35360
    ds_read_b64_tr_b16 v[38:39], v6 offset:35616
    v_mfma_f32_16x16x32_bf16 v[68:71], v[40:43], v[112:115], v[68:71]
    v_exp_f32 v86, v86
    v_cvt_pk_bf16_f32 v82, v84, v85
    v_mfma_f32_16x16x32_bf16 v[76:79], v[40:43], v[116:119], v[76:79]
    ds_read_b64_tr_b16 v[40:41], v6 offset:35392
    ds_read_b64_tr_b16 v[42:43], v6 offset:35648
    s_add_u32 m0, s40, 87104
    v_mfma_f32_16x16x32_bf16 v[68:71], v[44:47], v[120:123], v[68:71]
    buffer_load_dwordx4 v7, s[4:7], s32 offen offset:1024 nt lds
    s_add_u32 s32, s32, 8192
    v_exp_f32 v87, v87
    v_mfma_f32_16x16x32_bf16 v[76:79], v[44:47], v[124:127], v[76:79]
    ds_read_b64_tr_b16 v[44:45], v6 offset:35424
    ds_read_b64_tr_b16 v[46:47], v6 offset:35680
    s_waitcnt lgkmcnt(8)
    v_mfma_f32_16x16x32_bf16 a[192:195], v[16:19], v[128:131], a[192:195]
    v_add_f32 v11, v11, v84
    v_cvt_pk_bf16_f32 v83, v86, v87
    v_mfma_f32_16x16x32_bf16 a[196:199], v[16:19], v[132:135], a[196:199]
    ds_read_b64_tr_b16 v[16:17], v2 offset:0
    ds_read_b64_tr_b16 v[18:19], v2 offset:512
    v_exp_f32 v88, v88
    v_mfma_f32_16x16x32_bf16 a[200:203], v[20:23], v[128:131], a[200:203]
    v_exp_f32 v89, v89
    v_mfma_f32_16x16x32_bf16 a[204:207], v[20:23], v[132:135], a[204:207]
    ds_read_b64_tr_b16 v[20:21], v2 offset:32
    ds_read_b64_tr_b16 v[22:23], v2 offset:544
    v_mfma_f32_16x16x32_bf16 a[208:211], v[24:27], v[128:131], a[208:211]
    v_exp_f32 v90, v90
    v_add_f32 v12, v12, v88
    v_add_f32 v12, v12, v89
    v_mfma_f32_16x16x32_bf16 a[212:215], v[24:27], v[132:135], a[212:215]
    ds_read_b64_tr_b16 v[24:25], v2 offset:64
    ds_read_b64_tr_b16 v[26:27], v2 offset:576
    v_mfma_f32_16x16x32_bf16 a[216:219], v[28:31], v[128:131], a[216:219]
    v_cvt_pk_bf16_f32 v88, v88, v89
    v_exp_f32 v91, v91
    v_mfma_f32_16x16x32_bf16 a[220:223], v[28:31], v[132:135], a[220:223]
    ds_read_b64_tr_b16 v[28:29], v2 offset:96
    ds_read_b64_tr_b16 v[30:31], v2 offset:608
    s_waitcnt lgkmcnt(8)
    v_mfma_f32_16x16x32_bf16 a[192:195], v[32:35], v[136:139], a[192:195]
    v_exp_f32 v92, v92
    v_add_f32 v12, v12, v90
    v_add_f32 v12, v12, v91
    v_mfma_f32_16x16x32_bf16 a[196:199], v[32:35], v[140:143], a[196:199]
    ds_read_b64_tr_b16 v[32:33], v2 offset:128
    ds_read_b64_tr_b16 v[34:35], v2 offset:640
    v_mfma_f32_16x16x32_bf16 a[200:203], v[36:39], v[136:139], a[200:203]
    v_cvt_pk_bf16_f32 v89, v90, v91
    v_exp_f32 v93, v93
    v_mfma_f32_16x16x32_bf16 a[204:207], v[36:39], v[140:143], a[204:207]
    ds_read_b64_tr_b16 v[36:37], v2 offset:160
    ds_read_b64_tr_b16 v[38:39], v2 offset:672
    v_mfma_f32_16x16x32_bf16 a[208:211], v[40:43], v[136:139], a[208:211]
    v_exp_f32 v94, v94
    v_cvt_pk_bf16_f32 v90, v92, v93
    v_mfma_f32_16x16x32_bf16 a[212:215], v[40:43], v[140:143], a[212:215]
    ds_read_b64_tr_b16 v[40:41], v2 offset:192
    ds_read_b64_tr_b16 v[42:43], v2 offset:704
    v_mfma_f32_16x16x32_bf16 a[216:219], v[44:47], v[136:139], a[216:219]
    v_exp_f32 v95, v95
    v_add_f32 v12, v12, v92
    v_cvt_pk_bf16_f32 v91, v94, v95
    v_mfma_f32_16x16x32_bf16 a[220:223], v[44:47], v[140:143], a[220:223]
    ds_read_b64_tr_b16 v[44:45], v2 offset:224
    ds_read_b64_tr_b16 v[46:47], v2 offset:736
    s_waitcnt lgkmcnt(10)
    v_mfma_f32_16x16x32_bf16 v[160:163], v[16:19], v[80:83], v[160:163]
    v_add_f32 v11, v11, v85
    v_max3_f32 v13, v64, v65, v66
    v_add_f32 v11, v11, v86
    v_mfma_f32_16x16x32_bf16 v[192:195], v[16:19], v[88:91], v[192:195]
    v_max3_f32 v13, v13, v67, v68
    v_add_f32 v11, v11, v87
    v_max3_f32 v13, v13, v69, v70
    v_mfma_f32_16x16x32_bf16 v[164:167], v[20:23], v[80:83], v[164:167]
    v_add_f32 v12, v12, v93
    v_max3_f32 v13, v13, v71, v72
    v_add_f32 v12, v12, v94
    v_mfma_f32_16x16x32_bf16 v[196:199], v[20:23], v[88:91], v[196:199]
    v_max3_f32 v13, v13, v73, v74
    v_add_f32 v12, v12, v95
    v_mfma_f32_16x16x32_bf16 v[168:171], v[24:27], v[80:83], v[168:171]
    v_max3_f32 v13, v13, v75, v76
    v_max3_f32 v13, v13, v77, v78
    v_max_f32 v13, v13, v79
    v_mfma_f32_16x16x32_bf16 v[200:203], v[24:27], v[88:91], v[200:203]
    s_waitcnt vmcnt(8) lgkmcnt(0)
    s_barrier
    ds_read_b128 v[16:19], v1 offset:8704
    ds_read_b128 v[20:23], v1 offset:8768
    ds_read_b128 v[24:27], v1 offset:8832
    v_mfma_f32_16x16x32_bf16 v[172:175], v[28:31], v[80:83], v[172:175]
    s_add_u32 m0, s39, 95744
    v_cmp_lt_f32 vcc, s46, v13
    buffer_load_dwordx4 v9, s[12:15], s34 offen  lds
    v_mfma_f32_16x16x32_bf16 v[204:207], v[28:31], v[88:91], v[204:207]
    s_add_u32 m0, s39, 95648
    ds_read_b128 v[28:31], v1 offset:8896
    buffer_load_dwordx4 v9, s[12:15], s34 offen offset:1152  lds
    v_mfma_f32_16x16x32_bf16 v[176:179], v[32:35], v[80:83], v[176:179]
    s_add_u32 m0, s39, 104448
    s_sub_u32 s34, s34, 73600
    buffer_load_dwordx4 v8, s[8:11], s33 offen nt lds
    v_mfma_f32_16x16x32_bf16 v[208:211], v[32:35], v[88:91], v[208:211]
    s_add_u32 m0, s39, 105248
    ds_read_b128 v[32:35], v1 offset:13056
    buffer_load_dwordx4 v8, s[8:11], s33 offen offset:256 nt lds
    v_mfma_f32_16x16x32_bf16 v[180:183], v[36:39], v[80:83], v[180:183]
    v_mfma_f32_16x16x32_bf16 v[212:215], v[36:39], v[88:91], v[212:215]
    ds_read_b128 v[36:39], v1 offset:13120
    v_mfma_f32_16x16x32_bf16 v[184:187], v[40:43], v[80:83], v[184:187]
    v_mfma_f32_16x16x32_bf16 v[216:219], v[40:43], v[88:91], v[216:219]
    ds_read_b128 v[40:43], v1 offset:13184
    v_mfma_f32_16x16x32_bf16 v[188:191], v[44:47], v[80:83], v[188:191]
    v_mfma_f32_16x16x32_bf16 v[220:223], v[44:47], v[88:91], v[220:223]
    ds_read_b128 v[44:47], v1 offset:13248
    s_cbranch_vccnz L_rare_t60
L_back_t60:
    s_waitcnt lgkmcnt(4)
    v_mfma_f32_16x16x32_bf16 v[80:83], v[16:19], v[96:99], v[48:51]
    s_add_u32 m0, s39, 26112
    s_add_u32 s33, s33, 8192
    buffer_load_dwordx4 v9, s[12:15], s34 offen  lds
    v_mfma_f32_16x16x32_bf16 v[88:91], v[16:19], v[100:103], v[52:55]
    ds_read_b64_tr_b16 v[16:17], v3 offset:17408
    ds_read_b64_tr_b16 v[18:19], v3 offset:17664
    v_mfma_f32_16x16x32_bf16 v[80:83], v[20:23], v[104:107], v[80:83]
    v_exp_f32 v64, v64
    v_exp_f32 v65, v65
    v_mfma_f32_16x16x32_bf16 v[88:91], v[20:23], v[108:111], v[88:91]
    ds_read_b64_tr_b16 v[20:21], v3 offset:17440
    ds_read_b64_tr_b16 v[22:23], v3 offset:17696
    v_mfma_f32_16x16x32_bf16 v[80:83], v[24:27], v[112:115], v[80:83]
    v_exp_f32 v66, v66
    v_add_f32 v11, v11, v64
    v_mfma_f32_16x16x32_bf16 v[88:91], v[24:27], v[116:119], v[88:91]
    ds_read_b64_tr_b16 v[24:25], v3 offset:17472
    ds_read_b64_tr_b16 v[26:27], v3 offset:17728
    v_add_f32 v11, v11, v65
    v_mfma_f32_16x16x32_bf16 v[80:83], v[28:31], v[120:123], v[80:83]
    v_cvt_pk_bf16_f32 v64, v64, v65
    v_exp_f32 v67, v67
    v_mfma_f32_16x16x32_bf16 v[88:91], v[28:31], v[124:127], v[88:91]
    ds_read_b64_tr_b16 v[28:29], v3 offset:17504
    ds_read_b64_tr_b16 v[30:31], v3 offset:17760
    s_waitcnt lgkmcnt(8)
    v_mfma_f32_16x16x32_bf16 v[84:87], v[32:35], v[96:99], v[48:51]
    v_exp_f32 v68, v68
    v_add_f32 v11, v11, v66
    v_mfma_f32_16x16x32_bf16 v[92:95], v[32:35], v[100:103], v[52:55]
    ds_read_b64_tr_b16 v[32:33], v3 offset:17920
    ds_read_b64_tr_b16 v[34:35], v3 offset:18176
    v_add_f32 v11, v11, v67
    v_mfma_f32_16x16x32_bf16 v[84:87], v[36:39], v[104:107], v[84:87]
    v_cvt_pk_bf16_f32 v65, v66, v67
    v_exp_f32 v69, v69
    v_mfma_f32_16x16x32_bf16 v[92:95], v[36:39], v[108:111], v[92:95]
    ds_read_b64_tr_b16 v[36:37], v3 offset:17952
    ds_read_b64_tr_b16 v[38:39], v3 offset:18208
    v_mfma_f32_16x16x32_bf16 v[84:87], v[40:43], v[112:115], v[84:87]
    v_exp_f32 v70, v70
    v_cvt_pk_bf16_f32 v66, v68, v69
    v_mfma_f32_16x16x32_bf16 v[92:95], v[40:43], v[116:119], v[92:95]
    ds_read_b64_tr_b16 v[40:41], v3 offset:17984
    ds_read_b64_tr_b16 v[42:43], v3 offset:18240
    s_add_u32 m0, s39, 26016
    v_mfma_f32_16x16x32_bf16 v[84:87], v[44:47], v[120:123], v[84:87]
    buffer_load_dwordx4 v9, s[12:15], s34 offen offset:1152  lds
    s_add_u32 s34, s34, 73728
    v_exp_f32 v71, v71
    v_mfma_f32_16x16x32_bf16 v[92:95], v[44:47], v[124:127], v[92:95]
    ds_read_b64_tr_b16 v[44:45], v3 offset:18016
    ds_read_b64_tr_b16 v[46:47], v3 offset:18272
    s_waitcnt lgkmcnt(8)
    v_mfma_f32_16x16x32_bf16 a[192:195], v[16:19], v[144:147], a[192:195]
    v_add_f32 v11, v11, v68
    v_cvt_pk_bf16_f32 v67, v70, v71
    v_mfma_f32_16x16x32_bf16 a[196:199], v[16:19], v[148:151], a[196:199]
    ds_read_b64_tr_b16 v[16:17], v2 offset:26112
    ds_read_b64_tr_b16 v[18:19], v2 offset:26624
    v_exp_f32 v72, v72
    v_mfma_f32_16x16x32_bf16 a[200:203], v[20:23], v[144:147], a[200:203]
    v_exp_f32 v73, v73
    v_mfma_f32_16x16x32_bf16 a[204:207], v[20:23], v[148:151], a[204:207]
    ds_read_b64_tr_b16 v[20:21], v2 offset:26144
    ds_read_b64_tr_b16 v[22:23], v2 offset:26656
    v_mfma_f32_16x16x32_bf16 a[208:211], v[24:27], v[144:147], a[208:211]
    v_exp_f32 v74, v74
    v_add_f32 v12, v12, v72
    v_add_f32 v12, v12, v73
    v_mfma_f32_16x16x32_bf16 a[212:215], v[24:27], v[148:151], a[212:215]
    ds_read_b64_tr_b16 v[24:25], v2 offset:26176
    ds_read_b64_tr_b16 v[26:27], v2 offset:26688
    v_mfma_f32_16x16x32_bf16 a[216:219], v[28:31], v[144:147], a[216:219]
    v_cvt_pk_bf16_f32 v72, v72, v73
    v_exp_f32 v75, v75
    v_mfma_f32_16x16x32_bf16 a[220:223], v[28:31], v[148:151], a[220:223]
    ds_read_b64_tr_b16 v[28:29], v2 offset:26208
    ds_read_b64_tr_b16 v[30:31], v2 offset:26720
    s_waitcnt lgkmcnt(8)
    v_mfma_f32_16x16x32_bf16 a[192:195], v[32:35], v[152:155], a[192:195]
    v_exp_f32 v76, v76
    v_add_f32 v12, v12, v74
    v_add_f32 v12, v12, v75
    v_mfma_f32_16x16x32_bf16 a[196:199], v[32:35], v[156:159], a[196:199]
    ds_read_b64_tr_b16 v[32:33], v2 offset:26240
    ds_read_b64_tr_b16 v[34:35], v2 offset:26752
    v_mfma_f32_16x16x32_bf16 a[200:203], v[36:39], v[152:155], a[200:203]
    v_cvt_pk_bf16_f32 v73, v74, v75
    v_exp_f32 v77, v77
    v_mfma_f32_16x16x32_bf16 a[204:207], v[36:39], v[156:159], a[204:207]
    ds_read_b64_tr_b16 v[36:37], v2 offset:26272
    ds_read_b64_tr_b16 v[38:39], v2 offset:26784
    v_mfma_f32_16x16x32_bf16 a[208:211], v[40:43], v[152:155], a[208:211]
    v_exp_f32 v78, v78
    v_cvt_pk_bf16_f32 v74, v76, v77
    v_mfma_f32_16x16x32_bf16 a[212:215], v[40:43], v[156:159], a[212:215]
    ds_read_b64_tr_b16 v[40:41], v2 offset:26304
    ds_read_b64_tr_b16 v[42:43], v2 offset:26816
    v_mfma_f32_16x16x32_bf16 a[216:219], v[44:47], v[152:155], a[216:219]
    v_exp_f32 v79, v79
    v_add_f32 v12, v12, v76
    v_cvt_pk_bf16_f32 v75, v78, v79
    v_mfma_f32_16x16x32_bf16 a[220:223], v[44:47], v[156:159], a[220:223]
    ds_read_b64_tr_b16 v[44:45], v2 offset:26336
    ds_read_b64_tr_b16 v[46:47], v2 offset:26848
    s_waitcnt lgkmcnt(10)
    v_mfma_f32_16x16x32_bf16 v[160:163], v[16:19], v[64:67], v[160:163]
    v_add_f32 v11, v11, v69
    v_max3_f32 v13, v80, v81, v82
    v_add_f32 v11, v11, v70
    v_mfma_f32_16x16x32_bf16 v[192:195], v[16:19], v[72:75], v[192:195]
    v_max3_f32 v13, v13, v83, v84
    v_add_f32 v11, v11, v71
    v_max3_f32 v13, v13, v85, v86
    v_mfma_f32_16x16x32_bf16 v[164:167], v[20:23], v[64:67], v[164:167]
    v_add_f32 v12, v12, v77
    v_max3_f32 v13, v13, v87, v88
    v_add_f32 v12, v12, v78
    v_mfma_f32_16x16x32_bf16 v[196:199], v[20:23], v[72:75], v[196:199]
    v_max3_f32 v13, v13, v89, v90
    v_add_f32 v12, v12, v79
    v_mfma_f32_16x16x32_bf16 v[168:171], v[24:27], v[64:67], v[168:171]
    v_max3_f32 v13, v13, v91, v92
    v_max3_f32 v13, v13, v93, v94
    v_max_f32 v13, v13, v95
    v_mfma_f32_16x16x32_bf16 v[200:203], v[24:27], v[72:75], v[200:203]
    s_waitcnt vmcnt(8) lgkmcnt(0)
    s_barrier
    ds_read_b128 v[16:19], v1 offset:34816
    ds_read_b128 v[20:23], v1 offset:34880
    ds_read_b128 v[24:27], v1 offset:34944
    v_mfma_f32_16x16x32_bf16 v[172:175], v[28:31], v[64:67], v[172:175]
    s_add_u32 m0, s39, 34816
    v_cmp_lt_f32 vcc, s46, v13
    buffer_load_dwordx4 v8, s[8:11], s33 offen nt lds
    v_mfma_f32_16x16x32_bf16 v[204:207], v[28:31], v[72:75], v[204:207]
    s_add_u32 m0, s39, 35616
    ds_read_b128 v[28:31], v1 offset:35008
    buffer_load_dwordx4 v8, s[8:11], s33 offen offset:256 nt lds
    v_mfma_f32_16x16x32_bf16 v[176:179], v[32:35], v[64:67], v[176:179]
    s_add_u32 m0, s39, 43520
    s_add_u32 s33, s33, 8192
    buffer_load_dwordx4 v9, s[12:15], s34 offen  lds
    v_mfma_f32_16x16x32_bf16 v[208:211], v[32:35], v[72:75], v[208:211]
    ds_read_b128 v[32:35], v1 offset:39168
    v_mfma_f32_16x16x32_bf16 v[180:183], v[36:39], v[64:67], v[180:183]
    v_mfma_f32_16x16x32_bf16 v[212:215], v[36:39], v[72:75], v[212:215]
    ds_read_b128 v[36:39], v1 offset:39232
    v_mfma_f32_16x16x32_bf16 v[184:187], v[40:43], v[64:67], v[184:187]
    v_mfma_f32_16x16x32_bf16 v[216:219], v[40:43], v[72:75], v[216:219]
    ds_read_b128 v[40:43], v1 offset:39296
    v_mfma_f32_16x16x32_bf16 v[188:191], v[44:47], v[64:67], v[188:191]
    v_mfma_f32_16x16x32_bf16 v[220:223], v[44:47], v[72:75], v[220:223]
    ds_read_b128 v[44:47], v1 offset:39360
    s_cbranch_vccnz L_rare_t61
L_back_t61:
    s_waitcnt lgkmcnt(4)
    s_add_u32 m0, s39, 43424
    v_mfma_f32_16x16x32_bf16 v[64:67], v[16:19], v[96:99], v[48:51]
    buffer_load_dwordx4 v9, s[12:15], s34 offen offset:1152  lds
    s_sub_u32 s34, s34, 73600
    v_mfma_f32_16x16x32_bf16 v[72:75], v[16:19], v[100:103], v[52:55]
    ds_read_b64_tr_b16 v[16:17], v6 offset:0
    ds_read_b64_tr_b16 v[18:19], v6 offset:256
    v_mfma_f32_16x16x32_bf16 v[64:67], v[20:23], v[104:107], v[64:67]
    v_exp_f32 v80, v80
    v_exp_f32 v81, v81
    v_mfma_f32_16x16x32_bf16 v[72:75], v[20:23], v[108:111], v[72:75]
    ds_read_b64_tr_b16 v[20:21], v6 offset:32
    ds_read_b64_tr_b16 v[22:23], v6 offset:288
    v_mfma_f32_16x16x32_bf16 v[64:67], v[24:27], v[112:115], v[64:67]
    v_exp_f32 v82, v82
    v_add_f32 v11, v11, v80
    v_mfma_f32_16x16x32_bf16 v[72:75], v[24:27], v[116:119], v[72:75]
    ds_read_b64_tr_b16 v[24:25], v6 offset:64
    ds_read_b64_tr_b16 v[26:27], v6 offset:320
    v_add_f32 v11, v11, v81
    v_mfma_f32_16x16x32_bf16 v[64:67], v[28:31], v[120:123], v[64:67]
    v_cvt_pk_bf16_f32 v80, v80, v81
    v_mfma_f32_16x16x32_bf16 v[72:75], v[28:31], v[124:127], v[72:75]
    ds_read_b64_tr_b16 v[28:29], v6 offset:96
    ds_read_b64_tr_b16 v[30:31], v6 offset:352
    v_exp_f32 v83, v83
    s_waitcnt lgkmcnt(8)
    v_mfma_f32_16x16x32_bf16 v[68:71], v[32:35], v[96:99], v[48:51]
    v_exp_f32 v84, v84
    v_mfma_f32_16x16x32_bf16 v[76:79], v[32:35], v[100:103], v[52:55]
    ds_read_b64_tr_b16 v[32:33], v6 offset:512
    ds_read_b64_tr_b16 v[34:35], v6 offset:768
    v_add_f32 v11, v11, v82
    v_mfma_f32_16x16x32_bf16 v[68:71], v[36:39], v[104:107], v[68:71]
    v_add_f32 v11, v11, v83
    v_cvt_pk_bf16_f32 v81, v82, v83
    v_mfma_f32_16x16x32_bf16 v[76:79], v[36:39], v[108:111], v[76:79]
    ds_read_b64_tr_b16 v[36:37], v6 offset:544
    ds_read_b64_tr_b16 v[38:39], v6 offset:800
    v_mfma_f32_16x16x32_bf16 v[68:71], v[40:43], v[112:115], v[68:71]
    v_exp_f32 v85, v85
    v_exp_f32 v86, v86
    v_mfma_f32_16x16x32_bf16 v[76:79], v[40:43], v[116:119], v[76:79]
    ds_read_b64_tr_b16 v[40:41], v6 offset:576
    ds_read_b64_tr_b16 v[42:43], v6 offset:832
    v_mfma_f32_16x16x32_bf16 v[68:71], v[44:47], v[120:123], v[68:71]
    v_cvt_pk_bf16_f32 v82, v84, v85
    v_exp_f32 v87, v87
    v_mfma_f32_16x16x32_bf16 v[76:79], v[44:47], v[124:127], v[76:79]
    ds_read_b64_tr_b16 v[44:45], v6 offset:608
    ds_read_b64_tr_b16 v[46:47], v6 offset:864
    v_add_f32 v11, v11, v84
    s_waitcnt lgkmcnt(8)
    v_mfma_f32_16x16x32_bf16 a[224:227], v[16:19], v[128:131], a[224:227]
    v_cvt_pk_bf16_f32 v83, v86, v87
    v_mfma_f32_16x16x32_bf16 a[228:231], v[16:19], v[132:135], a[228:231]
    ds_read_b64_tr_b16 v[16:17], v5 offset:8704
    ds_read_b64_tr_b16 v[18:19], v5 offset:9216
    v_exp_f32 v88, v88
    v_mfma_f32_16x16x32_bf16 a[232:235], v[20:23], v[128:131], a[232:235]
    v_exp_f32 v89, v89
    v_mfma_f32_16x16x32_bf16 a[236:239], v[20:23], v[132:135], a[236:239]
    ds_read_b64_tr_b16 v[20:21], v5 offset:8736
    ds_read_b64_tr_b16 v[22:23], v5 offset:9248
    v_mfma_f32_16x16x32_bf16 a[240:243], v[24:27], v[128:131], a[240:243]
    v_exp_f32 v90, v90
    v_add_f32 v12, v12, v88
    v_add_f32 v12, v12, v89
    v_mfma_f32_16x16x32_bf16 a[244:247], v[24:27], v[132:135], a[244:247]
    ds_read_b64_tr_b16 v[24:25], v5 offset:8768
    ds_read_b64_tr_b16 v[26:27], v5 offset:9280
    v_mfma_f32_16x16x32_bf16 a[248:251], v[28:31], v[128:131], a[248:251]
    v_cvt_pk_bf16_f32 v88, v88, v89
    v_exp_f32 v91, v91
    v_mfma_f32_16x16x32_bf16 a[252:255], v[28:31], v[132:135], a[252:255]
    ds_read_b64_tr_b16 v[28:29], v5 offset:8800
    ds_read_b64_tr_b16 v[30:31], v5 offset:9312
    s_waitcnt lgkmcnt(8)
    v_mfma_f32_16x16x32_bf16 a[224:227], v[32:35], v[136:139], a[224:227]
    v_exp_f32 v92, v92
    v_add_f32 v12, v12, v90
    v_mfma_f32_16x16x32_bf16 a[228:231], v[32:35], v[140:143], a[228:231]
    ds_read_b64_tr_b16 v[32:33], v5 offset:8832
    ds_read_b64_tr_b16 v[34:35], v5 offset:9344
    v_add_f32 v12, v12, v91
    v_mfma_f32_16x16x32_bf16 a[232:235], v[36:39], v[136:139], a[232:235]
    v_cvt_pk_bf16_f32 v89, v90, v91
    v_exp_f32 v93, v93
    v_mfma_f32_16x16x32_bf16 a[236:239], v[36:39], v[140:143], a[236:239]
    ds_read_b64_tr_b16 v[36:37], v5 offset:8864
    ds_read_b64_tr_b16 v[38:39], v5 offset:9376
    v_mfma_f32_16x16x32_bf16 a[240:243], v[40:43], v[136:139], a[240:243]
    v_exp_f32 v94, v94
    v_cvt_pk_bf16_f32 v90, v92, v93
    v_mfma_f32_16x16x32_bf16 a[244:247], v[40:43], v[140:143], a[244:247]
    ds_read_b64_tr_b16 v[40:41], v5 offset:8896
    ds_read_b64_tr_b16 v[42:43], v5 offset:9408
    v_mfma_f32_16x16x32_bf16 a[248:251], v[44:47], v[136:139], a[248:251]
    v_exp_f32 v95, v95
    v_add_f32 v12, v12, v92
    v_cvt_pk_bf16_f32 v91, v94, v95
    v_mfma_f32_16x16x32_bf16 a[252:255], v[44:47], v[140:143], a[252:255]
    ds_read_b64_tr_b16 v[44:45], v5 offset:8928
    ds_read_b64_tr_b16 v[46:47], v5 offset:9440
    s_waitcnt lgkmcnt(10)
    v_mfma_f32_16x16x32_bf16 v[160:163], v[16:19], v[80:83], v[160:163]
    v_add_f32 v11, v11, v85
    v_max3_f32 v13, v64, v65, v66
    v_add_f32 v11, v11, v86
    v_mfma_f32_16x16x32_bf16 v[192:195], v[16:19], v[88:91], v[192:195]
    v_max3_f32 v13, v13, v67, v68
    v_add_f32 v11, v11, v87
    v_max3_f32 v13, v13, v69, v70
    v_mfma_f32_16x16x32_bf16 v[164:167], v[20:23], v[80:83], v[164:167]
    v_add_f32 v12, v12, v93
    v_max3_f32 v13, v13, v71, v72
    v_mfma_f32_16x16x32_bf16 v[196:199], v[20:23], v[88:91], v[196:199]
    v_add_f32 v12, v12, v94
    v_max3_f32 v13, v13, v73, v74
    v_add_f32 v12, v12, v95
    v_mfma_f32_16x16x32_bf16 v[168:171], v[24:27], v[80:83], v[168:171]
    v_max3_f32 v13, v13, v75, v76
    v_max3_f32 v13, v13, v77, v78
    v_max_f32 v13, v13, v79
    v_mfma_f32_16x16x32_bf16 v[200:203], v[24:27], v[88:91], v[200:203]
    s_waitcnt vmcnt(6) lgkmcnt(0)
    s_barrier
    ds_read_b128 v[16:19], v4 offset:17408
    ds_read_b128 v[20:23], v4 offset:17472
    ds_read_b128 v[24:27], v4 offset:17536
    v_mfma_f32_16x16x32_bf16 v[172:175], v[28:31], v[80:83], v[172:175]
    v_cmp_lt_f32 vcc, s46, v13
    v_mfma_f32_16x16x32_bf16 v[204:207], v[28:31], v[88:91], v[204:207]
    ds_read_b128 v[28:31], v4 offset:17600
    v_mfma_f32_16x16x32_bf16 v[176:179], v[32:35], v[80:83], v[176:179]
    v_mfma_f32_16x16x32_bf16 v[208:211], v[32:35], v[88:91], v[208:211]
    ds_read_b128 v[32:35], v4 offset:21760
    v_mfma_f32_16x16x32_bf16 v[180:183], v[36:39], v[80:83], v[180:183]
    v_mfma_f32_16x16x32_bf16 v[212:215], v[36:39], v[88:91], v[212:215]
    ds_read_b128 v[36:39], v4 offset:21824
    v_mfma_f32_16x16x32_bf16 v[184:187], v[40:43], v[80:83], v[184:187]
    v_mfma_f32_16x16x32_bf16 v[216:219], v[40:43], v[88:91], v[216:219]
    ds_read_b128 v[40:43], v4 offset:21888
    v_mfma_f32_16x16x32_bf16 v[188:191], v[44:47], v[80:83], v[188:191]
    v_mfma_f32_16x16x32_bf16 v[220:223], v[44:47], v[88:91], v[220:223]
    ds_read_b128 v[44:47], v4 offset:21952
    s_cbranch_vccnz L_rare_t62
L_back_t62:
    s_waitcnt lgkmcnt(4)
    v_mfma_f32_16x16x32_bf16 v[80:83], v[16:19], v[96:99], v[48:51]
    v_exp_f32 v64, v64
    v_mfma_f32_16x16x32_bf16 v[88:91], v[16:19], v[100:103], v[52:55]
    ds_read_b64_tr_b16 v[16:17], v6 offset:26112
    ds_read_b64_tr_b16 v[18:19], v6 offset:26368
    v_mfma_f32_16x16x32_bf16 v[80:83], v[20:23], v[104:107], v[80:83]
    v_exp_f32 v65, v65
    v_exp_f32 v66, v66
    v_mfma_f32_16x16x32_bf16 v[88:91], v[20:23], v[108:111], v[88:91]
    ds_read_b64_tr_b16 v[20:21], v6 offset:26144
    ds_read_b64_tr_b16 v[22:23], v6 offset:26400
    v_mfma_f32_16x16x32_bf16 v[80:83], v[24:27], v[112:115], v[80:83]
    v_add_f32 v11, v11, v64
    v_add_f32 v11, v11, v65
    v_cvt_pk_bf16_f32 v64, v64, v65
    v_mfma_f32_16x16x32_bf16 v[88:91], v[24:27], v[116:119], v[88:91]
    ds_read_b64_tr_b16 v[24:25], v6 offset:26176
    ds_read_b64_tr_b16 v[26:27], v6 offset:26432
    v_mfma_f32_16x16x32_bf16 v[80:83], v[28:31], v[120:123], v[80:83]
    v_exp_f32 v67, v67
    v_mfma_f32_16x16x32_bf16 v[88:91], v[28:31], v[124:127], v[88:91]
    ds_read_b64_tr_b16 v[28:29], v6 offset:26208
    ds_read_b64_tr_b16 v[30:31], v6 offset:26464
    v_exp_f32 v68, v68
    s_waitcnt lgkmcnt(8)
    v_mfma_f32_16x16x32_bf16 v[84:87], v[32:35], v[96:99], v[48:51]
    v_add_f32 v11, v11, v66
    v_add_f32 v11, v11, v67
    v_mfma_f32_16x16x32_bf16 v[92:95], v[32:35], v[100:103], v[52:55]
    ds_read_b64_tr_b16 v[32:33], v6 offset:26624
    ds_read_b64_tr_b16 v[34:35], v6 offset:26880
    v_cvt_pk_bf16_f32 v65, v66, v67
    v_mfma_f32_16x16x32_bf16 v[84:87], v[36:39], v[104:107], v[84:87]
    v_exp_f32 v69, v69
    v_mfma_f32_16x16x32_bf16 v[92:95], v[36:39], v[108:111], v[92:95]
    ds_read_b64_tr_b16 v[36:37], v6 offset:26656
    ds_read_b64_tr_b16 v[38:39], v6 offset:26912
    v_mfma_f32_16x16x32_bf16 v[84:87], v[40:43], v[112:115], v[84:87]
    v_exp_f32 v70, v70
    v_cvt_pk_bf16_f32 v66, v68, v69
    v_mfma_f32_16x16x32_bf16 v[92:95], v[40:43], v[116:119], v[92:95]
    ds_read_b64_tr_b16 v[40:41], v6 offset:26688
    ds_read_b64_tr_b16 v[42:43], v6 offset:26944
    v_mfma_f32_16x16x32_bf16 v[84:87], v[44:47], v[120:123], v[84:87]
    v_exp_f32 v71, v71
    v_add_f32 v11, v11, v68
    v_cvt_pk_bf16_f32 v67, v70, v71
    v_mfma_f32_16x16x32_bf16 v[92:95], v[44:47], v[124:127], v[92:95]
    ds_read_b64_tr_b16 v[44:45], v6 offset:26720
    ds_read_b64_tr_b16 v[46:47], v6 offset:26976
    s_waitcnt lgkmcnt(8)
    v_mfma_f32_16x16x32_bf16 a[224:227], v[16:19], v[144:147], a[224:227]
    v_exp_f32 v72, v72
    v_mfma_f32_16x16x32_bf16 a[228:231], v[16:19], v[148:151], a[228:231]
    ds_read_b64_tr_b16 v[16:17], v5 offset:34816
    ds_read_b64_tr_b16 v[18:19], v5 offset:35328
    v_mfma_f32_16x16x32_bf16 a[232:235], v[20:23], v[144:147], a[232:235]
    v_exp_f32 v73, v73
    v_exp_f32 v74, v74
    v_mfma_f32_16x16x32_bf16 a[236:239], v[20:23], v[148:151], a[236:239]
    ds_read_b64_tr_b16 v[20:21], v5 offset:34848
    ds_read_b64_tr_b16 v[22:23], v5 offset:35360
    v_mfma_f32_16x16x32_bf16 a[240:243], v[24:27], v[144:147], a[240:243]
    v_add_f32 v12, v12, v72
    v_add_f32 v12, v12, v73
    v_cvt_pk_bf16_f32 v72, v72, v73
    v_mfma_f32_16x16x32_bf16 a[244:247], v[24:27], v[148:151], a[244:247]
    ds_read_b64_tr_b16 v[24:25], v5 offset:34880
    ds_read_b64_tr_b16 v[26:27], v5 offset:35392
    v_mfma_f32_16x16x32_bf16 a[248:251], v[28:31], v[144:147], a[248:251]
    v_exp_f32 v75, v75
    v_mfma_f32_16x16x32_bf16 a[252:255], v[28:31], v[148:151], a[252:255]
    ds_read_b64_tr_b16 v[28:29], v5 offset:34912
    ds_read_b64_tr_b16 v[30:31], v5 offset:35424
    v_exp_f32 v76, v76
    s_waitcnt lgkmcnt(8)
    v_mfma_f32_16x16x32_bf16 a[224:227], v[32:35], v[152:155], a[224:227]
    v_add_f32 v12, v12, v74
    v_add_f32 v12, v12, v75
    v_mfma_f32_16x16x32_bf16 a[228:231], v[32:35], v[156:159], a[228:231]
    ds_read_b64_tr_b16 v[32:33], v5 offset:34944
    ds_read_b64_tr_b16 v[34:35], v5 offset:35456
    v_cvt_pk_bf16_f32 v73, v74, v75
    v_mfma_f32_16x16x32_bf16 a[232:235], v[36:39], v[152:155], a[232:235]
    v_exp_f32 v77, v77
    v_mfma_f32_16x16x32_bf16 a[236:239], v[36:39], v[156:159], a[236:239]
    ds_read_b64_tr_b16 v[36:37], v5 offset:34976
    ds_read_b64_tr_b16 v[38:39], v5 offset:35488
    v_mfma_f32_16x16x32_bf16 a[240:243], v[40:43], v[152:155], a[240:243]
    v_exp_f32 v78, v78
    v_cvt_pk_bf16_f32 v74, v76, v77
    v_mfma_f32_16x16x32_bf16 a[244:247], v[40:43], v[156:159], a[244:247]
    ds_read_b64_tr_b16 v[40:41], v5 offset:35008
    ds_read_b64_tr_b16 v[42:43], v5 offset:35520
    v_mfma_f32_16x16x32_bf16 a[248:251], v[44:47], v[152:155], a[248:251]
    v_exp_f32 v79, v79
    v_add_f32 v12, v12, v76
    v_cvt_pk_bf16_f32 v75, v78, v79
    v_mfma_f32_16x16x32_bf16 a[252:255], v[44:47], v[156:159], a[252:255]
    ds_read_b64_tr_b16 v[44:45], v5 offset:35040
    ds_read_b64_tr_b16 v[46:47], v5 offset:35552
    s_waitcnt lgkmcnt(10)
    v_mfma_f32_16x16x32_bf16 v[160:163], v[16:19], v[64:67], v[160:163]
    v_add_f32 v11, v11, v69
    v_max3_f32 v13, v80, v81, v82
    v_add_f32 v11, v11, v70
    v_mfma_f32_16x16x32_bf16 v[192:195], v[16:19], v[72:75], v[192:195]
    v_max3_f32 v13, v13, v83, v84
    v_add_f32 v11, v11, v71
    v_mfma_f32_16x16x32_bf16 v[164:167], v[20:23], v[64:67], v[164:167]
    v_max3_f32 v13, v13, v85, v86
    v_add_f32 v12, v12, v77
    v_max3_f32 v13, v13, v87, v88
    v_mfma_f32_16x16x32_bf16 v[196:199], v[20:23], v[72:75], v[196:199]
    v_add_f32 v12, v12, v78
    v_max3_f32 v13, v13, v89, v90
    v_add_f32 v12, v12, v79
    v_mfma_f32_16x16x32_bf16 v[168:171], v[24:27], v[64:67], v[168:171]
    v_max3_f32 v13, v13, v91, v92
    v_max3_f32 v13, v13, v93, v94
    v_mfma_f32_16x16x32_bf16 v[200:203], v[24:27], v[72:75], v[200:203]
    s_waitcnt vmcnt(2) lgkmcnt(0)
    s_barrier
    ds_read_b64_tr_b16 v[16:17], v3 offset:0
    ds_read_b64_tr_b16 v[18:19], v3 offset:256
    ds_read_b64_tr_b16 v[20:21], v3 offset:32
    ds_read_b64_tr_b16 v[22:23], v3 offset:288
    v_mfma_f32_16x16x32_bf16 v[172:175], v[28:31], v[64:67], v[172:175]
    ds_read_b64_tr_b16 v[24:25], v3 offset:64
    ds_read_b64_tr_b16 v[26:27], v3 offset:320
    v_mfma_f32_16x16x32_bf16 v[204:207], v[28:31], v[72:75], v[204:207]
    ds_read_b64_tr_b16 v[28:29], v3 offset:96
    ds_read_b64_tr_b16 v[30:31], v3 offset:352
    v_mfma_f32_16x16x32_bf16 v[176:179], v[32:35], v[64:67], v[176:179]
    v_max_f32 v13, v13, v95
    v_cmp_lt_f32 vcc, s46, v13
    v_mfma_f32_16x16x32_bf16 v[208:211], v[32:35], v[72:75], v[208:211]
    ds_read_b64_tr_b16 v[32:33], v3 offset:512
    ds_read_b64_tr_b16 v[34:35], v3 offset:768
    v_mfma_f32_16x16x32_bf16 v[180:183], v[36:39], v[64:67], v[180:183]
    v_mfma_f32_16x16x32_bf16 v[212:215], v[36:39], v[72:75], v[212:215]
    ds_read_b64_tr_b16 v[36:37], v3 offset:544
    ds_read_b64_tr_b16 v[38:39], v3 offset:800
    v_mfma_f32_16x16x32_bf16 v[184:187], v[40:43], v[64:67], v[184:187]
    v_mfma_f32_16x16x32_bf16 v[216:219], v[40:43], v[72:75], v[216:219]
    ds_read_b64_tr_b16 v[40:41], v3 offset:576
    ds_read_b64_tr_b16 v[42:43], v3 offset:832
    v_mfma_f32_16x16x32_bf16 v[188:191], v[44:47], v[64:67], v[188:191]
    v_mfma_f32_16x16x32_bf16 v[220:223], v[44:47], v[72:75], v[220:223]
    ds_read_b64_tr_b16 v[44:45], v3 offset:608
    ds_read_b64_tr_b16 v[46:47], v3 offset:864
    s_cbranch_vccnz L_rare_t63
L_back_t63:
    s_waitcnt lgkmcnt(8)
    v_mfma_f32_16x16x32_bf16 v[224:227], v[16:19], v[128:131], v[224:227]
    v_exp_f32 v80, v80
    v_exp_f32 v81, v81
    v_mfma_f32_16x16x32_bf16 v[228:231], v[16:19], v[132:135], v[228:231]
    ds_read_b64_tr_b16 v[16:17], v2 offset:8704
    ds_read_b64_tr_b16 v[18:19], v2 offset:9216
    v_exp_f32 v82, v82
    v_add_f32 v11, v11, v80
    v_mfma_f32_16x16x32_bf16 v[232:235], v[20:23], v[128:131], v[232:235]
    v_add_f32 v11, v11, v81
    v_cvt_pk_bf16_f32 v80, v80, v81
    v_exp_f32 v83, v83
    v_mfma_f32_16x16x32_bf16 v[236:239], v[20:23], v[132:135], v[236:239]
    ds_read_b64_tr_b16 v[20:21], v2 offset:8736
    ds_read_b64_tr_b16 v[22:23], v2 offset:9248
    v_exp_f32 v84, v84
    v_mfma_f32_16x16x32_bf16 v[240:243], v[24:27], v[128:131], v[240:243]
    v_add_f32 v11, v11, v82
    v_add_f32 v11, v11, v83
    v_cvt_pk_bf16_f32 v81, v82, v83
    v_mfma_f32_16x16x32_bf16 v[244:247], v[24:27], v[132:135], v[244:247]
    ds_read_b64_tr_b16 v[24:25], v2 offset:8768
    ds_read_b64_tr_b16 v[26:27], v2 offset:9280
    v_exp_f32 v85, v85
    v_mfma_f32_16x16x32_bf16 v[248:251], v[28:31], v[128:131], v[248:251]
    v_exp_f32 v86, v86
    v_cvt_pk_bf16_f32 v82, v84, v85
    v_exp_f32 v87, v87
    v_mfma_f32_16x16x32_bf16 v[252:255], v[28:31], v[132:135], v[252:255]
    ds_read_b64_tr_b16 v[28:29], v2 offset:8800
    ds_read_b64_tr_b16 v[30:31], v2 offset:9312
    v_add_f32 v11, v11, v84
    v_cvt_pk_bf16_f32 v83, v86, v87
    s_waitcnt lgkmcnt(8)
    v_mfma_f32_16x16x32_bf16 v[224:227], v[32:35], v[136:139], v[224:227]
    v_exp_f32 v88, v88
    v_exp_f32 v89, v89
    v_mfma_f32_16x16x32_bf16 v[228:231], v[32:35], v[140:143], v[228:231]
    ds_read_b64_tr_b16 v[32:33], v2 offset:8832
    ds_read_b64_tr_b16 v[34:35], v2 offset:9344
    v_exp_f32 v90, v90
    v_add_f32 v12, v12, v88
    v_mfma_f32_16x16x32_bf16 v[232:235], v[36:39], v[136:139], v[232:235]
    v_add_f32 v12, v12, v89
    v_cvt_pk_bf16_f32 v88, v88, v89
    v_exp_f32 v91, v91
    v_mfma_f32_16x16x32_bf16 v[236:239], v[36:39], v[140:143], v[236:239]
    ds_read_b64_tr_b16 v[36:37], v2 offset:8864
    ds_read_b64_tr_b16 v[38:39], v2 offset:9376
    v_exp_f32 v92, v92
    v_add_f32 v12, v12, v90
    v_mfma_f32_16x16x32_bf16 v[240:243], v[40:43], v[136:139], v[240:243]
    v_add_f32 v12, v12, v91
    v_cvt_pk_bf16_f32 v89, v90, v91
    v_exp_f32 v93, v93
    v_mfma_f32_16x16x32_bf16 v[244:247], v[40:43], v[140:143], v[244:247]
    ds_read_b64_tr_b16 v[40:41], v2 offset:8896
    ds_read_b64_tr_b16 v[42:43], v2 offset:9408
    v_exp_f32 v94, v94
    v_mfma_f32_16x16x32_bf16 v[248:251], v[44:47], v[136:139], v[248:251]
    v_cvt_pk_bf16_f32 v90, v92, v93
    v_exp_f32 v95, v95
    v_add_f32 v12, v12, v92
    v_cvt_pk_bf16_f32 v91, v94, v95
    v_mfma_f32_16x16x32_bf16 v[252:255], v[44:47], v[140:143], v[252:255]
    ds_read_b64_tr_b16 v[44:45], v2 offset:8928
    ds_read_b64_tr_b16 v[46:47], v2 offset:9440
    s_waitcnt lgkmcnt(10)
    v_mfma_f32_16x16x32_bf16 v[160:163], v[16:19], v[80:83], v[160:163]
    v_add_f32 v11, v11, v85
    v_add_f32 v11, v11, v86
    v_add_f32 v11, v11, v87
    v_add_f32 v12, v12, v93
    v_add_f32 v12, v12, v94
    v_mfma_f32_16x16x32_bf16 v[192:195], v[16:19], v[88:91], v[192:195]
    v_add_f32 v12, v12, v95
    v_mov_b32 v62, v11
    v_mov_b32 v63, v12
    s_nop 0
    v_permlane32_swap_b32 v62, v11
    v_mfma_f32_16x16x32_bf16 v[164:167], v[20:23], v[80:83], v[164:167]
    v_permlane32_swap_b32 v63, v12
    v_add_f32 v11, v11, v62
    v_add_f32 v12, v12, v63
    v_mov_b32 v62, v11
    v_mfma_f32_16x16x32_bf16 v[196:199], v[20:23], v[88:91], v[196:199]
    v_mov_b32 v63, v12
    s_nop 0
    v_permlane16_swap_b32 v62, v11
    v_permlane16_swap_b32 v63, v12
    v_mfma_f32_16x16x32_bf16 v[168:171], v[24:27], v[80:83], v[168:171]
    v_add_f32 v11, v11, v62
    v_add_f32 v12, v12, v63
    v_rcp_f32 v59, v11
    v_mfma_f32_16x16x32_bf16 v[200:203], v[24:27], v[88:91], v[200:203]
    s_waitcnt vmcnt(0) lgkmcnt(0)
    s_barrier
    ds_read_b64_tr_b16 v[16:17], v3 offset:17408
    ds_read_b64_tr_b16 v[18:19], v3 offset:17664
    ds_read_b64_tr_b16 v[20:21], v3 offset:17440
    ds_read_b64_tr_b16 v[22:23], v3 offset:17696
    v_mfma_f32_16x16x32_bf16 v[172:175], v[28:31], v[80:83], v[172:175]
    ds_read_b64_tr_b16 v[24:25], v3 offset:17472
    ds_read_b64_tr_b16 v[26:27], v3 offset:17728
    v_rcp_f32 v60, v12
    v_mfma_f32_16x16x32_bf16 v[204:207], v[28:31], v[88:91], v[204:207]
    ds_read_b64_tr_b16 v[28:29], v3 offset:17504
    ds_read_b64_tr_b16 v[30:31], v3 offset:17760
    v_mfma_f32_16x16x32_bf16 v[176:179], v[32:35], v[80:83], v[176:179]
    v_mfma_f32_16x16x32_bf16 v[208:211], v[32:35], v[88:91], v[208:211]
    ds_read_b64_tr_b16 v[32:33], v3 offset:17920
    ds_read_b64_tr_b16 v[34:35], v3 offset:18176
    v_mfma_f32_16x16x32_bf16 v[180:183], v[36:39], v[80:83], v[180:183]
    v_mfma_f32_16x16x32_bf16 v[212:215], v[36:39], v[88:91], v[212:215]
    ds_read_b64_tr_b16 v[36:37], v3 offset:17952
    ds_read_b64_tr_b16 v[38:39], v3 offset:18208
    v_mfma_f32_16x16x32_bf16 v[184:187], v[40:43], v[80:83], v[184:187]
    v_mfma_f32_16x16x32_bf16 v[216:219], v[40:43], v[88:91], v[216:219]
    ds_read_b64_tr_b16 v[40:41], v3 offset:17984
    ds_read_b64_tr_b16 v[42:43], v3 offset:18240
    v_mfma_f32_16x16x32_bf16 v[188:191], v[44:47], v[80:83], v[188:191]
    v_mfma_f32_16x16x32_bf16 v[220:223], v[44:47], v[88:91], v[220:223]
    ds_read_b64_tr_b16 v[44:45], v3 offset:18016
    ds_read_b64_tr_b16 v[46:47], v3 offset:18272
    s_waitcnt lgkmcnt(10)
    v_mfma_f32_16x16x32_bf16 v[224:227], v[16:19], v[144:147], v[224:227]
    v_mfma_f32_16x16x32_bf16 v[228:231], v[16:19], v[148:151], v[228:231]
    v_mfma_f32_16x16x32_bf16 v[232:235], v[20:23], v[144:147], v[232:235]
    v_mfma_f32_16x16x32_bf16 v[236:239], v[20:23], v[148:151], v[236:239]
    v_mul_f32 v160, v59, v160
    v_mul_f32 v161, v59, v161
    v_mul_f32 v162, v59, v162
    v_mul_f32 v163, v59, v163
    v_mul_f32 v164, v59, v164
    v_mul_f32 v165, v59, v165
    v_mfma_f32_16x16x32_bf16 v[240:243], v[24:27], v[144:147], v[240:243]
    v_mul_f32 v166, v59, v166
    v_mul_f32 v167, v59, v167
    v_cvt_pk_bf16_f32 v128, v160, v161
    v_cvt_pk_bf16_f32 v129, v162, v163
    v_cvt_pk_bf16_f32 v130, v164, v165
    v_mfma_f32_16x16x32_bf16 v[244:247], v[24:27], v[148:151], v[244:247]
    s_waitcnt lgkmcnt(0)
    s_barrier
    ds_read_b64_tr_b16 v[16:17], v3 offset:26112
    ds_read_b64_tr_b16 v[18:19], v3 offset:26368
    ds_read_b64_tr_b16 v[20:21], v3 offset:26144
    ds_read_b64_tr_b16 v[22:23], v3 offset:26400
    v_mfma_f32_16x16x32_bf16 v[248:251], v[28:31], v[144:147], v[248:251]
    ds_read_b64_tr_b16 v[24:25], v3 offset:26176
    ds_read_b64_tr_b16 v[26:27], v3 offset:26432
    v_cvt_pk_bf16_f32 v131, v166, v167
    v_mul_f32 v192, v60, v192
    v_mul_f32 v193, v60, v193
    v_mfma_f32_16x16x32_bf16 v[252:255], v[28:31], v[148:151], v[252:255]
    ds_read_b64_tr_b16 v[28:29], v3 offset:26208
    ds_read_b64_tr_b16 v[30:31], v3 offset:26464
    v_mul_f32 v194, v60, v194
    v_mul_f32 v195, v60, v195
    v_mfma_f32_16x16x32_bf16 v[224:227], v[32:35], v[152:155], v[224:227]
    v_mul_f32 v196, v60, v196
    v_mul_f32 v197, v60, v197
    v_mul_f32 v198, v60, v198
    v_mul_f32 v199, v60, v199
    v_cvt_pk_bf16_f32 v132, v192, v193
    v_mfma_f32_16x16x32_bf16 v[228:231], v[32:35], v[156:159], v[228:231]
    ds_read_b64_tr_b16 v[32:33], v3 offset:26624
    ds_read_b64_tr_b16 v[34:35], v3 offset:26880
    v_cvt_pk_bf16_f32 v133, v194, v195
    v_cvt_pk_bf16_f32 v134, v196, v197
    v_cvt_pk_bf16_f32 v135, v198, v199
    v_mfma_f32_16x16x32_bf16 v[232:235], v[36:39], v[152:155], v[232:235]
    v_mul_f32 v168, v59, v168
    v_mul_f32 v169, v59, v169
    v_mul_f32 v170, v59, v170
    v_mul_f32 v171, v59, v171
    v_mul_f32 v172, v59, v172
    v_mfma_f32_16x16x32_bf16 v[236:239], v[36:39], v[156:159], v[236:239]
    ds_read_b64_tr_b16 v[36:37], v3 offset:26656
    ds_read_b64_tr_b16 v[38:39], v3 offset:26912
    v_mul_f32 v173, v59, v173
    v_mul_f32 v174, v59, v174
    v_mul_f32 v175, v59, v175
    v_mfma_f32_16x16x32_bf16 v[240:243], v[40:43], v[152:155], v[240:243]
    v_cvt_pk_bf16_f32 v136, v168, v169
    v_cvt_pk_bf16_f32 v137, v170, v171
    v_cvt_pk_bf16_f32 v138, v172, v173
    v_cvt_pk_bf16_f32 v139, v174, v175
    v_mul_f32 v200, v60, v200
    v_mfma_f32_16x16x32_bf16 v[244:247], v[40:43], v[156:159], v[244:247]
    ds_read_b64_tr_b16 v[40:41], v3 offset:26688
    ds_read_b64_tr_b16 v[42:43], v3 offset:26944
    v_mul_f32 v201, v60, v201
    v_mul_f32 v202, v60, v202
    v_mul_f32 v203, v60, v203
    v_mfma_f32_16x16x32_bf16 v[248:251], v[44:47], v[152:155], v[248:251]
    v_mul_f32 v204, v60, v204
    v_mul_f32 v205, v60, v205
    v_mul_f32 v206, v60, v206
    v_mul_f32 v207, v60, v207
    v_cvt_pk_bf16_f32 v140, v200, v201
    v_mfma_f32_16x16x32_bf16 v[252:255], v[44:47], v[156:159], v[252:255]
    ds_read_b64_tr_b16 v[44:45], v3 offset:26720
    ds_read_b64_tr_b16 v[46:47], v3 offset:26976
    v_cvt_pk_bf16_f32 v141, v202, v203
    v_cvt_pk_bf16_f32 v142, v204, v205
    v_cvt_pk_bf16_f32 v143, v206, v207
    s_nop 0
    v_mbcnt_lo_u32_b32 v0, -1, 0
    v_mbcnt_hi_u32_b32 v0, -1, v0
    v_lshlrev_b32 v0, 4, v0
    s_waitcnt lgkmcnt(8)
    v_mfma_f32_16x16x32_bf16 a[0:3], v[16:19], v[128:131], a[0:3]
    v_mov_b32 v61, 130560
    v_mul_f32 v176, v59, v176
    v_mul_f32 v177, v59, v177
    v_mul_f32 v178, v59, v178
    v_mfma_f32_16x16x32_bf16 a[4:7], v[16:19], v[132:135], a[4:7]
    ds_read_b64_tr_b16 v[16:17], v3 offset:34816
    ds_read_b64_tr_b16 v[18:19], v3 offset:35072
    v_mul_f32 v179, v59, v179
    v_mul_f32 v180, v59, v180
    v_mul_f32 v181, v59, v181
    v_mfma_f32_16x16x32_bf16 a[8:11], v[20:23], v[128:131], a[8:11]
    v_mul_f32 v182, v59, v182
    v_mul_f32 v183, v59, v183
    v_cvt_pk_bf16_f32 v144, v176, v177
    v_cvt_pk_bf16_f32 v145, v178, v179
    v_mfma_f32_16x16x32_bf16 a[12:15], v[20:23], v[132:135], a[12:15]
    ds_read_b64_tr_b16 v[20:21], v3 offset:34848
    ds_read_b64_tr_b16 v[22:23], v3 offset:35104
    v_cvt_pk_bf16_f32 v146, v180, v181
    v_cvt_pk_bf16_f32 v147, v182, v183
    v_mul_f32 v208, v60, v208
    v_mfma_f32_16x16x32_bf16 a[16:19], v[24:27], v[128:131], a[16:19]
    v_mul_f32 v209, v60, v209
    v_mul_f32 v210, v60, v210
    v_mul_f32 v211, v60, v211
    v_mul_f32 v212, v60, v212
    v_mfma_f32_16x16x32_bf16 a[20:23], v[24:27], v[132:135], a[20:23]
    ds_read_b64_tr_b16 v[24:25], v3 offset:34880
    ds_read_b64_tr_b16 v[26:27], v3 offset:35136
    v_mul_f32 v213, v60, v213
    v_mul_f32 v214, v60, v214
    v_mul_f32 v215, v60, v215
    v_mfma_f32_16x16x32_bf16 a[24:27], v[28:31], v[128:131], a[24:27]
    v_cvt_pk_bf16_f32 v148, v208, v209
    v_cvt_pk_bf16_f32 v149, v210, v211
    v_cvt_pk_bf16_f32 v150, v212, v213
    v_cvt_pk_bf16_f32 v151, v214, v215
    v_mfma_f32_16x16x32_bf16 a[28:31], v[28:31], v[132:135], a[28:31]
    ds_read_b64_tr_b16 v[28:29], v3 offset:34912
    ds_read_b64_tr_b16 v[30:31], v3 offset:35168
    v_mul_f32 v184, v59, v184
    v_mul_f32 v185, v59, v185
    v_mul_f32 v186, v59, v186
    s_waitcnt lgkmcnt(8)
    v_mfma_f32_16x16x32_bf16 a[0:3], v[32:35], v[136:139], a[0:3]
    v_mul_f32 v187, v59, v187
    v_mul_f32 v188, v59, v188
    v_mul_f32 v189, v59, v189
    v_mul_f32 v190, v59, v190
    v_mfma_f32_16x16x32_bf16 a[4:7], v[32:35], v[140:143], a[4:7]
    ds_read_b64_tr_b16 v[32:33], v3 offset:35328
    ds_read_b64_tr_b16 v[34:35], v3 offset:35584
    v_mul_f32 v191, v59, v191
    v_cvt_pk_bf16_f32 v152, v184, v185
    v_cvt_pk_bf16_f32 v153, v186, v187
    v_mfma_f32_16x16x32_bf16 a[8:11], v[36:39], v[136:139], a[8:11]
    v_cvt_pk_bf16_f32 v154, v188, v189
    v_cvt_pk_bf16_f32 v155, v190, v191
    v_mul_f32 v216, v60, v216
    v_mul_f32 v217, v60, v217
    v_mfma_f32_16x16x32_bf16 a[12:15], v[36:39], v[140:143], a[12:15]
    ds_read_b64_tr_b16 v[36:37], v3 offset:35360
    ds_read_b64_tr_b16 v[38:39], v3 offset:35616
    v_mul_f32 v218, v60, v218
    v_mul_f32 v219, v60, v219
    v_mul_f32 v220, v60, v220
    v_mfma_f32_16x16x32_bf16 a[16:19], v[40:43], v[136:139], a[16:19]
    v_mul_f32 v221, v60, v221
    v_mul_f32 v222, v60, v222
    v_mul_f32 v223, v60, v223
    v_cvt_pk_bf16_f32 v156, v216, v217
    v_mfma_f32_16x16x32_bf16 a[20:23], v[40:43], v[140:143], a[20:23]
    ds_read_b64_tr_b16 v[40:41], v3 offset:35392
    ds_read_b64_tr_b16 v[42:43], v3 offset:35648
    v_cvt_pk_bf16_f32 v157, v218, v219
    v_cvt_pk_bf16_f32 v158, v220, v221
    v_cvt_pk_bf16_f32 v159, v222, v223
    v_mfma_f32_16x16x32_bf16 a[24:27], v[44:47], v[136:139], a[24:27]
    ds_read_b32 v61, v61
    v_mfma_f32_16x16x32_bf16 a[28:31], v[44:47], v[140:143], a[28:31]
    ds_read_b64_tr_b16 v[44:45], v3 offset:35424
    ds_read_b64_tr_b16 v[46:47], v3 offset:35680
    s_waitcnt lgkmcnt(9)
    v_mfma_f32_16x16x32_bf16 a[0:3], v[16:19], v[144:147], a[0:3]
    v_mfma_f32_16x16x32_bf16 a[4:7], v[16:19], v[148:151], a[4:7]
    ds_read_b64_tr_b16 v[16:17], v6 offset:0
    ds_read_b64_tr_b16 v[18:19], v6 offset:256
    v_mfma_f32_16x16x32_bf16 a[8:11], v[20:23], v[144:147], a[8:11]
    v_mfma_f32_16x16x32_bf16 a[12:15], v[20:23], v[148:151], a[12:15]
    ds_read_b64_tr_b16 v[20:21], v6 offset:32
    ds_read_b64_tr_b16 v[22:23], v6 offset:288
    v_mfma_f32_16x16x32_bf16 a[16:19], v[24:27], v[144:147], a[16:19]
    v_mfma_f32_16x16x32_bf16 a[20:23], v[24:27], v[148:151], a[20:23]
    ds_read_b64_tr_b16 v[24:25], v6 offset:64
    ds_read_b64_tr_b16 v[26:27], v6 offset:320
    v_mfma_f32_16x16x32_bf16 a[24:27], v[28:31], v[144:147], a[24:27]
    v_mfma_f32_16x16x32_bf16 a[28:31], v[28:31], v[148:151], a[28:31]
    ds_read_b64_tr_b16 v[28:29], v6 offset:96
    ds_read_b64_tr_b16 v[30:31], v6 offset:352
    s_waitcnt lgkmcnt(8)
    v_mfma_f32_16x16x32_bf16 a[0:3], v[32:35], v[152:155], a[0:3]
    v_mfma_f32_16x16x32_bf16 a[4:7], v[32:35], v[156:159], a[4:7]
    ds_read_b64_tr_b16 v[32:33], v6 offset:512
    ds_read_b64_tr_b16 v[34:35], v6 offset:768
    v_mfma_f32_16x16x32_bf16 a[8:11], v[36:39], v[152:155], a[8:11]
    s_nop 0
    v_readfirstlane_b32 s64, v61
    s_mul_i32 s48, s3, 9
    s_and_b32 s64, s64, 31
    s_sub_u32 s64, s48, s64
    v_mfma_f32_16x16x32_bf16 a[12:15], v[36:39], v[156:159], a[12:15]
    ds_read_b64_tr_b16 v[36:37], v6 offset:544
    ds_read_b64_tr_b16 v[38:39], v6 offset:800
    v_mfma_f32_16x16x32_bf16 a[16:19], v[40:43], v[152:155], a[16:19]
    v_mfma_f32_16x16x32_bf16 a[20:23], v[40:43], v[156:159], a[20:23]
    ds_read_b64_tr_b16 v[40:41], v6 offset:576
    ds_read_b64_tr_b16 v[42:43], v6 offset:832
    v_mfma_f32_16x16x32_bf16 a[24:27], v[44:47], v[152:155], a[24:27]
    v_mfma_f32_16x16x32_bf16 a[28:31], v[44:47], v[156:159], a[28:31]
    ds_read_b64_tr_b16 v[44:45], v6 offset:608
    ds_read_b64_tr_b16 v[46:47], v6 offset:864
    s_waitcnt lgkmcnt(10)
    v_mfma_f32_16x16x32_bf16 a[32:35], v[16:19], v[128:131], a[32:35]
    v_mfma_f32_16x16x32_bf16 a[36:39], v[16:19], v[132:135], a[36:39]
    v_mfma_f32_16x16x32_bf16 a[40:43], v[20:23], v[128:131], a[40:43]
    v_mfma_f32_16x16x32_bf16 a[44:47], v[20:23], v[132:135], a[44:47]
    s_lshl_b32 s48, s64, 12
    s_add_u32 s48, s48, 137728
    s_cmp_lt_u32 s64, 4
    s_cselect_b32 s22, 0, 28377088
    s_cselect_b32 s48, s48, 154112
    v_add_u32 v61, s48, v0
    v_mfma_f32_16x16x32_bf16 a[48:51], v[24:27], v[128:131], a[48:51]
    s_add_u32 s64, s64, 1
    v_accvgpr_read_b32 v160, a0
    v_accvgpr_read_b32 v161, a1
    v_cvt_pk_bf16_f32 v168, v160, v161
    v_accvgpr_read_b32 v162, a2
    v_accvgpr_read_b32 v163, a3
    v_mfma_f32_16x16x32_bf16 a[52:55], v[24:27], v[132:135], a[52:55]
    s_waitcnt lgkmcnt(0)
    s_barrier
    ds_read_b64_tr_b16 v[16:17], v6 offset:8704
    ds_read_b64_tr_b16 v[18:19], v6 offset:8960
    ds_read_b64_tr_b16 v[20:21], v6 offset:8736
    ds_read_b64_tr_b16 v[22:23], v6 offset:8992
    v_mfma_f32_16x16x32_bf16 a[56:59], v[28:31], v[128:131], a[56:59]
    ds_read_b64_tr_b16 v[24:25], v6 offset:8768
    ds_read_b64_tr_b16 v[26:27], v6 offset:9024
    v_cvt_pk_bf16_f32 v169, v162, v163
    v_accvgpr_read_b32 v164, a8
    v_mfma_f32_16x16x32_bf16 a[60:63], v[28:31], v[132:135], a[60:63]
    ds_read_b64_tr_b16 v[28:29], v6 offset:8800
    ds_read_b64_tr_b16 v[30:31], v6 offset:9056
    v_accvgpr_read_b32 v165, a9
    v_cvt_pk_bf16_f32 v170, v164, v165
    v_mfma_f32_16x16x32_bf16 a[32:35], v[32:35], v[136:139], a[32:35]
    v_accvgpr_read_b32 v166, a10
    v_accvgpr_read_b32 v167, a11
    v_cvt_pk_bf16_f32 v171, v166, v167
    buffer_store_dwordx4 v[168:171], v0, s[20:23], s54 offen sc1
    v_accvgpr_read_b32 v176, a16
    v_mfma_f32_16x16x32_bf16 a[36:39], v[32:35], v[140:143], a[36:39]
    ds_read_b64_tr_b16 v[32:33], v6 offset:9216
    ds_read_b64_tr_b16 v[34:35], v6 offset:9472
    v_accvgpr_read_b32 v177, a17
    v_cvt_pk_bf16_f32 v184, v176, v177
    v_mfma_f32_16x16x32_bf16 a[40:43], v[36:39], v[136:139], a[40:43]
    v_accvgpr_read_b32 v178, a18
    v_accvgpr_read_b32 v179, a19
    v_cvt_pk_bf16_f32 v185, v178, v179
    v_accvgpr_read_b32 v180, a24
    v_accvgpr_read_b32 v181, a25
    v_mfma_f32_16x16x32_bf16 a[44:47], v[36:39], v[140:143], a[44:47]
    ds_read_b64_tr_b16 v[36:37], v6 offset:9248
    ds_read_b64_tr_b16 v[38:39], v6 offset:9504
    v_cvt_pk_bf16_f32 v186, v180, v181
    v_accvgpr_read_b32 v182, a26
    v_mfma_f32_16x16x32_bf16 a[48:51], v[40:43], v[136:139], a[48:51]
    v_accvgpr_read_b32 v183, a27
    v_mfma_f32_16x16x32_bf16 a[52:55], v[40:43], v[140:143], a[52:55]
    ds_read_b64_tr_b16 v[40:41], v6 offset:9280
    ds_read_b64_tr_b16 v[42:43], v6 offset:9536
    v_mfma_f32_16x16x32_bf16 a[56:59], v[44:47], v[136:139], a[56:59]
    v_mfma_f32_16x16x32_bf16 a[60:63], v[44:47], v[140:143], a[60:63]
    ds_read_b64_tr_b16 v[44:45], v6 offset:9312
    ds_read_b64_tr_b16 v[46:47], v6 offset:9568
    s_waitcnt lgkmcnt(8)
    v_mfma_f32_16x16x32_bf16 a[32:35], v[16:19], v[144:147], a[32:35]
    v_cvt_pk_bf16_f32 v187, v182, v183
    buffer_store_dwordx4 v[184:187], v0, s[20:23], s54 offen offset:1024 sc1
    v_accvgpr_read_b32 v192, a4
    v_mfma_f32_16x16x32_bf16 a[36:39], v[16:19], v[148:151], a[36:39]
    ds_read_b64_tr_b16 v[16:17], v6 offset:17408
    ds_read_b64_tr_b16 v[18:19], v6 offset:17664
    v_accvgpr_read_b32 v193, a5
    v_mfma_f32_16x16x32_bf16 a[40:43], v[20:23], v[144:147], a[40:43]
    v_cvt_pk_bf16_f32 v200, v192, v193
    v_accvgpr_read_b32 v194, a6
    v_accvgpr_read_b32 v195, a7
    v_mfma_f32_16x16x32_bf16 a[44:47], v[20:23], v[148:151], a[44:47]
    ds_read_b64_tr_b16 v[20:21], v6 offset:17440
    ds_read_b64_tr_b16 v[22:23], v6 offset:17696
    v_cvt_pk_bf16_f32 v201, v194, v195
    v_mfma_f32_16x16x32_bf16 a[48:51], v[24:27], v[144:147], a[48:51]
    v_accvgpr_read_b32 v196, a12
    v_accvgpr_read_b32 v197, a13
    v_cvt_pk_bf16_f32 v202, v196, v197
    v_mfma_f32_16x16x32_bf16 a[52:55], v[24:27], v[148:151], a[52:55]
    ds_read_b64_tr_b16 v[24:25], v6 offset:17472
    ds_read_b64_tr_b16 v[26:27], v6 offset:17728
    v_accvgpr_read_b32 v198, a14
    v_mfma_f32_16x16x32_bf16 a[56:59], v[28:31], v[144:147], a[56:59]
    v_accvgpr_read_b32 v199, a15
    v_cvt_pk_bf16_f32 v203, v198, v199
    buffer_store_dwordx4 v[200:203], v0, s[20:23], s54 offen offset:2048 sc1
    v_mfma_f32_16x16x32_bf16 a[60:63], v[28:31], v[148:151], a[60:63]
    ds_read_b64_tr_b16 v[28:29], v6 offset:17504
    ds_read_b64_tr_b16 v[30:31], v6 offset:17760
    v_accvgpr_read_b32 v208, a20
    s_waitcnt lgkmcnt(8)
    v_mfma_f32_16x16x32_bf16 a[32:35], v[32:35], v[152:155], a[32:35]
    v_accvgpr_read_b32 v209, a21
    v_cvt_pk_bf16_f32 v216, v208, v209
    v_accvgpr_read_b32 v210, a22
    v_mfma_f32_16x16x32_bf16 a[36:39], v[32:35], v[156:159], a[36:39]
    ds_read_b64_tr_b16 v[32:33], v6 offset:17920
    ds_read_b64_tr_b16 v[34:35], v6 offset:18176
    v_accvgpr_read_b32 v211, a23
    v_mfma_f32_16x16x32_bf16 a[40:43], v[36:39], v[152:155], a[40:43]
    v_cvt_pk_bf16_f32 v217, v210, v211
    v_accvgpr_read_b32 v212, a28
    v_accvgpr_read_b32 v213, a29
    v_mfma_f32_16x16x32_bf16 a[44:47], v[36:39], v[156:159], a[44:47]
    ds_read_b64_tr_b16 v[36:37], v6 offset:17952
    ds_read_b64_tr_b16 v[38:39], v6 offset:18208
    v_cvt_pk_bf16_f32 v218, v212, v213
    v_mfma_f32_16x16x32_bf16 a[48:51], v[40:43], v[152:155], a[48:51]
    v_accvgpr_read_b32 v214, a30
    v_accvgpr_read_b32 v215, a31
    v_cvt_pk_bf16_f32 v219, v214, v215
    s_cmp_eq_u32 s22, 0
    s_cbranch_scc1 L_ow0
L_owb0:
    v_mfma_f32_16x16x32_bf16 a[52:55], v[40:43], v[156:159], a[52:55]
    ds_read_b64_tr_b16 v[40:41], v6 offset:17984
    ds_read_b64_tr_b16 v[42:43], v6 offset:18240
    buffer_store_dwordx4 v[216:219], v0, s[20:23], s54 offen offset:3072 sc1
    s_add_u32 s54, s54, 32768
    v_mfma_f32_16x16x32_bf16 a[56:59], v[44:47], v[152:155], a[56:59]
    v_mfma_f32_16x16x32_bf16 a[60:63], v[44:47], v[156:159], a[60:63]
    ds_read_b64_tr_b16 v[44:45], v6 offset:18016
    ds_read_b64_tr_b16 v[46:47], v6 offset:18272
    s_waitcnt lgkmcnt(8)
    v_mfma_f32_16x16x32_bf16 a[64:67], v[16:19], v[128:131], a[64:67]
    v_mfma_f32_16x16x32_bf16 a[68:71], v[16:19], v[132:135], a[68:71]
    ds_read_b64_tr_b16 v[16:17], v6 offset:26112
    ds_read_b64_tr_b16 v[18:19], v6 offset:26368
    v_mfma_f32_16x16x32_bf16 a[72:75], v[20:23], v[128:131], a[72:75]
    v_mfma_f32_16x16x32_bf16 a[76:79], v[20:23], v[132:135], a[76:79]
    ds_read_b64_tr_b16 v[20:21], v6 offset:26144
    ds_read_b64_tr_b16 v[22:23], v6 offset:26400
    s_lshl_b32 s48, s64, 12
    s_add_u32 s48, s48, 137728
    v_mfma_f32_16x16x32_bf16 a[80:83], v[24:27], v[128:131], a[80:83]
    s_cmp_lt_u32 s64, 4
    s_cselect_b32 s22, 0, 28377088
    s_cselect_b32 s48, s48, 154112
    v_add_u32 v61, s48, v0
    s_add_u32 s64, s64, 1
    v_mfma_f32_16x16x32_bf16 a[84:87], v[24:27], v[132:135], a[84:87]
    ds_read_b64_tr_b16 v[24:25], v6 offset:26176
    ds_read_b64_tr_b16 v[26:27], v6 offset:26432
    v_accvgpr_read_b32 v160, a32
    v_mfma_f32_16x16x32_bf16 a[88:91], v[28:31], v[128:131], a[88:91]
    v_accvgpr_read_b32 v161, a33
    v_cvt_pk_bf16_f32 v168, v160, v161
    v_accvgpr_read_b32 v162, a34
    v_mfma_f32_16x16x32_bf16 a[92:95], v[28:31], v[132:135], a[92:95]
    ds_read_b64_tr_b16 v[28:29], v6 offset:26208
    ds_read_b64_tr_b16 v[30:31], v6 offset:26464
    v_accvgpr_read_b32 v163, a35
    s_waitcnt lgkmcnt(8)
    v_mfma_f32_16x16x32_bf16 a[64:67], v[32:35], v[136:139], a[64:67]
    v_cvt_pk_bf16_f32 v169, v162, v163
    v_accvgpr_read_b32 v164, a40
    v_accvgpr_read_b32 v165, a41
    v_mfma_f32_16x16x32_bf16 a[68:71], v[32:35], v[140:143], a[68:71]
    ds_read_b64_tr_b16 v[32:33], v6 offset:26624
    ds_read_b64_tr_b16 v[34:35], v6 offset:26880
    v_cvt_pk_bf16_f32 v170, v164, v165
    v_mfma_f32_16x16x32_bf16 a[72:75], v[36:39], v[136:139], a[72:75]
    v_accvgpr_read_b32 v166, a42
    v_accvgpr_read_b32 v167, a43
    v_cvt_pk_bf16_f32 v171, v166, v167
    v_mfma_f32_16x16x32_bf16 a[76:79], v[36:39], v[140:143], a[76:79]
    ds_read_b64_tr_b16 v[36:37], v6 offset:26656
    ds_read_b64_tr_b16 v[38:39], v6 offset:26912
    buffer_store_dwordx4 v[168:171], v0, s[20:23], s54 offen sc1
    v_mfma_f32_16x16x32_bf16 a[80:83], v[40:43], v[136:139], a[80:83]
    v_accvgpr_read_b32 v176, a48
    v_accvgpr_read_b32 v177, a49
    v_cvt_pk_bf16_f32 v184, v176, v177
    v_mfma_f32_16x16x32_bf16 a[84:87], v[40:43], v[140:143], a[84:87]
    ds_read_b64_tr_b16 v[40:41], v6 offset:26688
    ds_read_b64_tr_b16 v[42:43], v6 offset:26944
    v_accvgpr_read_b32 v178, a50
    v_mfma_f32_16x16x32_bf16 a[88:91], v[44:47], v[136:139], a[88:91]
    v_accvgpr_read_b32 v179, a51
    v_cvt_pk_bf16_f32 v185, v178, v179
    v_accvgpr_read_b32 v180, a56
    v_mfma_f32_16x16x32_bf16 a[92:95], v[44:47], v[140:143], a[92:95]
    ds_read_b64_tr_b16 v[44:45], v6 offset:26720
    ds_read_b64_tr_b16 v[46:47], v6 offset:26976
    v_accvgpr_read_b32 v181, a57
    s_waitcnt lgkmcnt(10)
    v_mfma_f32_16x16x32_bf16 a[64:67], v[16:19], v[144:147], a[64:67]
    v_cvt_pk_bf16_f32 v186, v180, v181
    v_accvgpr_read_b32 v182, a58
    v_accvgpr_read_b32 v183, a59
    v_mfma_f32_16x16x32_bf16 a[68:71], v[16:19], v[148:151], a[68:71]
    v_cvt_pk_bf16_f32 v187, v182, v183
    buffer_store_dwordx4 v[184:187], v0, s[20:23], s54 offen offset:1024 sc1
    v_accvgpr_read_b32 v192, a36
    v_mfma_f32_16x16x32_bf16 a[72:75], v[20:23], v[144:147], a[72:75]
    v_accvgpr_read_b32 v193, a37
    v_cvt_pk_bf16_f32 v200, v192, v193
    v_accvgpr_read_b32 v194, a38
    v_mfma_f32_16x16x32_bf16 a[76:79], v[20:23], v[148:151], a[76:79]
    v_accvgpr_read_b32 v195, a39
    v_cvt_pk_bf16_f32 v201, v194, v195
    v_accvgpr_read_b32 v196, a44
    v_mfma_f32_16x16x32_bf16 a[80:83], v[24:27], v[144:147], a[80:83]
    v_accvgpr_read_b32 v197, a45
    v_cvt_pk_bf16_f32 v202, v196, v197
    v_accvgpr_read_b32 v198, a46
    v_mfma_f32_16x16x32_bf16 a[84:87], v[24:27], v[148:151], a[84:87]
    s_waitcnt lgkmcnt(0)
    s_barrier
    ds_read_b64_tr_b16 v[16:17], v6 offset:34816
    ds_read_b64_tr_b16 v[18:19], v6 offset:35072
    ds_read_b64_tr_b16 v[20:21], v6 offset:34848
    ds_read_b64_tr_b16 v[22:23], v6 offset:35104
    v_mfma_f32_16x16x32_bf16 a[88:91], v[28:31], v[144:147], a[88:91]
    ds_read_b64_tr_b16 v[24:25], v6 offset:34880
    ds_read_b64_tr_b16 v[26:27], v6 offset:35136
    v_mfma_f32_16x16x32_bf16 a[92:95], v[28:31], v[148:151], a[92:95]
    ds_read_b64_tr_b16 v[28:29], v6 offset:34912
    ds_read_b64_tr_b16 v[30:31], v6 offset:35168
    v_mfma_f32_16x16x32_bf16 a[64:67], v[32:35], v[152:155], a[64:67]
    v_accvgpr_read_b32 v199, a47
    v_cvt_pk_bf16_f32 v203, v198, v199
    buffer_store_dwordx4 v[200:203], v0, s[20:23], s54 offen offset:2048 sc1
    v_mfma_f32_16x16x32_bf16 a[68:71], v[32:35], v[156:159], a[68:71]
    ds_read_b64_tr_b16 v[32:33], v6 offset:35328
    ds_read_b64_tr_b16 v[34:35], v6 offset:35584
    v_accvgpr_read_b32 v208, a52
    v_mfma_f32_16x16x32_bf16 a[72:75], v[36:39], v[152:155], a[72:75]
    v_accvgpr_read_b32 v209, a53
    v_cvt_pk_bf16_f32 v216, v208, v209
    v_accvgpr_read_b32 v210, a54
    v_mfma_f32_16x16x32_bf16 a[76:79], v[36:39], v[156:159], a[76:79]
    ds_read_b64_tr_b16 v[36:37], v6 offset:35360
    ds_read_b64_tr_b16 v[38:39], v6 offset:35616
    v_accvgpr_read_b32 v211, a55
    v_mfma_f32_16x16x32_bf16 a[80:83], v[40:43], v[152:155], a[80:83]
    v_cvt_pk_bf16_f32 v217, v210, v211
    v_accvgpr_read_b32 v212, a60
    v_accvgpr_read_b32 v213, a61
    v_mfma_f32_16x16x32_bf16 a[84:87], v[40:43], v[156:159], a[84:87]
    ds_read_b64_tr_b16 v[40:41], v6 offset:35392
    ds_read_b64_tr_b16 v[42:43], v6 offset:35648
    v_cvt_pk_bf16_f32 v218, v212, v213
    v_mfma_f32_16x16x32_bf16 a[88:91], v[44:47], v[152:155], a[88:91]
    v_accvgpr_read_b32 v214, a62
    v_accvgpr_read_b32 v215, a63
    v_cvt_pk_bf16_f32 v219, v214, v215
    s_cmp_eq_u32 s22, 0
    s_cbranch_scc1 L_ow1
L_owb1:
    v_mfma_f32_16x16x32_bf16 a[92:95], v[44:47], v[156:159], a[92:95]
    ds_read_b64_tr_b16 v[44:45], v6 offset:35424
    ds_read_b64_tr_b16 v[46:47], v6 offset:35680
    buffer_store_dwordx4 v[216:219], v0, s[20:23], s54 offen offset:3072 sc1
    s_add_u32 s54, s54, 32768
    s_waitcnt lgkmcnt(8)
    v_mfma_f32_16x16x32_bf16 a[96:99], v[16:19], v[128:131], a[96:99]
    v_mfma_f32_16x16x32_bf16 a[100:103], v[16:19], v[132:135], a[100:103]
    ds_read_b64_tr_b16 v[16:17], v3 offset:0
    ds_read_b64_tr_b16 v[18:19], v3 offset:256
    v_mfma_f32_16x16x32_bf16 a[104:107], v[20:23], v[128:131], a[104:107]
    v_mfma_f32_16x16x32_bf16 a[108:111], v[20:23], v[132:135], a[108:111]
    ds_read_b64_tr_b16 v[20:21], v3 offset:32
    ds_read_b64_tr_b16 v[22:23], v3 offset:288
    s_lshl_b32 s48, s64, 12
    s_add_u32 s48, s48, 137728
    v_mfma_f32_16x16x32_bf16 a[112:115], v[24:27], v[128:131], a[112:115]
    s_cmp_lt_u32 s64, 4
    s_cselect_b32 s22, 0, 28377088
    s_cselect_b32 s48, s48, 154112
    v_add_u32 v61, s48, v0
    s_add_u32 s64, s64, 1
    v_mfma_f32_16x16x32_bf16 a[116:119], v[24:27], v[132:135], a[116:119]
    ds_read_b64_tr_b16 v[24:25], v3 offset:64
    ds_read_b64_tr_b16 v[26:27], v3 offset:320
    v_accvgpr_read_b32 v160, a64
    v_accvgpr_read_b32 v161, a65
    v_mfma_f32_16x16x32_bf16 a[120:123], v[28:31], v[128:131], a[120:123]
    v_cvt_pk_bf16_f32 v168, v160, v161
    v_accvgpr_read_b32 v162, a66
    v_accvgpr_read_b32 v163, a67
    v_mfma_f32_16x16x32_bf16 a[124:127], v[28:31], v[132:135], a[124:127]
    ds_read_b64_tr_b16 v[28:29], v3 offset:96
    ds_read_b64_tr_b16 v[30:31], v3 offset:352
    v_cvt_pk_bf16_f32 v169, v162, v163
    v_accvgpr_read_b32 v164, a72
    s_waitcnt lgkmcnt(8)
    v_mfma_f32_16x16x32_bf16 a[96:99], v[32:35], v[136:139], a[96:99]
    v_accvgpr_read_b32 v165, a73
    v_cvt_pk_bf16_f32 v170, v164, v165
    v_accvgpr_read_b32 v166, a74
    v_mfma_f32_16x16x32_bf16 a[100:103], v[32:35], v[140:143], a[100:103]
    ds_read_b64_tr_b16 v[32:33], v3 offset:512
    ds_read_b64_tr_b16 v[34:35], v3 offset:768
    v_accvgpr_read_b32 v167, a75
    v_cvt_pk_bf16_f32 v171, v166, v167
    v_mfma_f32_16x16x32_bf16 a[104:107], v[36:39], v[136:139], a[104:107]
    buffer_store_dwordx4 v[168:171], v0, s[20:23], s54 offen sc1
    v_accvgpr_read_b32 v176, a80
    v_accvgpr_read_b32 v177, a81
    v_mfma_f32_16x16x32_bf16 a[108:111], v[36:39], v[140:143], a[108:111]
    ds_read_b64_tr_b16 v[36:37], v3 offset:544
    ds_read_b64_tr_b16 v[38:39], v3 offset:800
    v_cvt_pk_bf16_f32 v184, v176, v177
    v_accvgpr_read_b32 v178, a82
    v_mfma_f32_16x16x32_bf16 a[112:115], v[40:43], v[136:139], a[112:115]
    v_accvgpr_read_b32 v179, a83
    v_cvt_pk_bf16_f32 v185, v178, v179
    v_accvgpr_read_b32 v180, a88
    v_mfma_f32_16x16x32_bf16 a[116:119], v[40:43], v[140:143], a[116:119]
    ds_read_b64_tr_b16 v[40:41], v3 offset:576
    ds_read_b64_tr_b16 v[42:43], v3 offset:832
    v_accvgpr_read_b32 v181, a89
    v_mfma_f32_16x16x32_bf16 a[120:123], v[44:47], v[136:139], a[120:123]
    v_cvt_pk_bf16_f32 v186, v180, v181
    v_accvgpr_read_b32 v182, a90
    v_accvgpr_read_b32 v183, a91
    v_cvt_pk_bf16_f32 v187, v182, v183
    v_mfma_f32_16x16x32_bf16 a[124:127], v[44:47], v[140:143], a[124:127]
    ds_read_b64_tr_b16 v[44:45], v3 offset:608
    ds_read_b64_tr_b16 v[46:47], v3 offset:864
    buffer_store_dwordx4 v[184:187], v0, s[20:23], s54 offen offset:1024 sc1
    s_waitcnt lgkmcnt(8)
    v_mfma_f32_16x16x32_bf16 a[96:99], v[16:19], v[144:147], a[96:99]
    v_accvgpr_read_b32 v192, a68
    v_accvgpr_read_b32 v193, a69
    v_cvt_pk_bf16_f32 v200, v192, v193
    v_accvgpr_read_b32 v194, a70
    v_mfma_f32_16x16x32_bf16 a[100:103], v[16:19], v[148:151], a[100:103]
    ds_read_b64_tr_b16 v[16:17], v3 offset:8704
    ds_read_b64_tr_b16 v[18:19], v3 offset:8960
    v_accvgpr_read_b32 v195, a71
    v_mfma_f32_16x16x32_bf16 a[104:107], v[20:23], v[144:147], a[104:107]
    v_cvt_pk_bf16_f32 v201, v194, v195
    v_accvgpr_read_b32 v196, a76
    v_accvgpr_read_b32 v197, a77
    v_cvt_pk_bf16_f32 v202, v196, v197
    v_mfma_f32_16x16x32_bf16 a[108:111], v[20:23], v[148:151], a[108:111]
    ds_read_b64_tr_b16 v[20:21], v3 offset:8736
    ds_read_b64_tr_b16 v[22:23], v3 offset:8992
    v_accvgpr_read_b32 v198, a78
    v_mfma_f32_16x16x32_bf16 a[112:115], v[24:27], v[144:147], a[112:115]
    v_accvgpr_read_b32 v199, a79
    v_cvt_pk_bf16_f32 v203, v198, v199
    buffer_store_dwordx4 v[200:203], v0, s[20:23], s54 offen offset:2048 sc1
    v_accvgpr_read_b32 v208, a84
    v_mfma_f32_16x16x32_bf16 a[116:119], v[24:27], v[148:151], a[116:119]
    ds_read_b64_tr_b16 v[24:25], v3 offset:8768
    ds_read_b64_tr_b16 v[26:27], v3 offset:9024
    v_accvgpr_read_b32 v209, a85
    v_mfma_f32_16x16x32_bf16 a[120:123], v[28:31], v[144:147], a[120:123]
    v_cvt_pk_bf16_f32 v216, v208, v209
    v_accvgpr_read_b32 v210, a86
    v_accvgpr_read_b32 v211, a87
    v_cvt_pk_bf16_f32 v217, v210, v211
    v_mfma_f32_16x16x32_bf16 a[124:127], v[28:31], v[148:151], a[124:127]
    ds_read_b64_tr_b16 v[28:29], v3 offset:8800
    ds_read_b64_tr_b16 v[30:31], v3 offset:9056
    v_accvgpr_read_b32 v212, a92
    s_waitcnt lgkmcnt(8)
    v_mfma_f32_16x16x32_bf16 a[96:99], v[32:35], v[152:155], a[96:99]
    v_accvgpr_read_b32 v213, a93
    v_cvt_pk_bf16_f32 v218, v212, v213
    v_accvgpr_read_b32 v214, a94
    v_mfma_f32_16x16x32_bf16 a[100:103], v[32:35], v[156:159], a[100:103]
    ds_read_b64_tr_b16 v[32:33], v3 offset:9216
    ds_read_b64_tr_b16 v[34:35], v3 offset:9472
    v_accvgpr_read_b32 v215, a95
    v_cvt_pk_bf16_f32 v219, v214, v215
    s_cmp_eq_u32 s22, 0
    s_cbranch_scc1 L_ow2
L_owb2:
    v_mfma_f32_16x16x32_bf16 a[104:107], v[36:39], v[152:155], a[104:107]
    buffer_store_dwordx4 v[216:219], v0, s[20:23], s54 offen offset:3072 sc1
    s_add_u32 s54, s54, 32768
    v_mfma_f32_16x16x32_bf16 a[108:111], v[36:39], v[156:159], a[108:111]
    ds_read_b64_tr_b16 v[36:37], v3 offset:9248
    ds_read_b64_tr_b16 v[38:39], v3 offset:9504
    v_mfma_f32_16x16x32_bf16 a[112:115], v[40:43], v[152:155], a[112:115]
    v_mfma_f32_16x16x32_bf16 a[116:119], v[40:43], v[156:159], a[116:119]
    ds_read_b64_tr_b16 v[40:41], v3 offset:9280
    ds_read_b64_tr_b16 v[42:43], v3 offset:9536
    v_mfma_f32_16x16x32_bf16 a[120:123], v[44:47], v[152:155], a[120:123]
    v_mfma_f32_16x16x32_bf16 a[124:127], v[44:47], v[156:159], a[124:127]
    ds_read_b64_tr_b16 v[44:45], v3 offset:9312
    ds_read_b64_tr_b16 v[46:47], v3 offset:9568
    s_waitcnt lgkmcnt(10)
    v_mfma_f32_16x16x32_bf16 a[128:131], v[16:19], v[128:131], a[128:131]
    v_mfma_f32_16x16x32_bf16 a[132:135], v[16:19], v[132:135], a[132:135]
    v_mfma_f32_16x16x32_bf16 a[136:139], v[20:23], v[128:131], a[136:139]
    v_mfma_f32_16x16x32_bf16 a[140:143], v[20:23], v[132:135], a[140:143]
    s_lshl_b32 s48, s64, 12
    s_add_u32 s48, s48, 137728
    s_cmp_lt_u32 s64, 4
    s_cselect_b32 s22, 0, 28377088
    s_cselect_b32 s48, s48, 154112
    v_mfma_f32_16x16x32_bf16 a[144:147], v[24:27], v[128:131], a[144:147]
    s_add_u32 s64, s64, 1
    v_add_u32 v61, s48, v0
    v_accvgpr_read_b32 v160, a96
    v_accvgpr_read_b32 v161, a97
    v_cvt_pk_bf16_f32 v168, v160, v161
    v_mfma_f32_16x16x32_bf16 a[148:151], v[24:27], v[132:135], a[148:151]
    s_waitcnt lgkmcnt(0)
    s_barrier
    ds_read_b64_tr_b16 v[16:17], v3 offset:17408
    ds_read_b64_tr_b16 v[18:19], v3 offset:17664
    ds_read_b64_tr_b16 v[20:21], v3 offset:17440
    ds_read_b64_tr_b16 v[22:23], v3 offset:17696
    v_mfma_f32_16x16x32_bf16 a[152:155], v[28:31], v[128:131], a[152:155]
    ds_read_b64_tr_b16 v[24:25], v3 offset:17472
    ds_read_b64_tr_b16 v[26:27], v3 offset:17728
    v_mfma_f32_16x16x32_bf16 a[156:159], v[28:31], v[132:135], a[156:159]
    ds_read_b64_tr_b16 v[28:29], v3 offset:17504
    ds_read_b64_tr_b16 v[30:31], v3 offset:17760
    v_accvgpr_read_b32 v162, a98
    v_mfma_f32_16x16x32_bf16 a[128:131], v[32:35], v[136:139], a[128:131]
    v_accvgpr_read_b32 v163, a99
    v_cvt_pk_bf16_f32 v169, v162, v163
    v_accvgpr_read_b32 v164, a104
    v_accvgpr_read_b32 v165, a105
    v_mfma_f32_16x16x32_bf16 a[132:135], v[32:35], v[140:143], a[132:135]
    ds_read_b64_tr_b16 v[32:33], v3 offset:17920
    ds_read_b64_tr_b16 v[34:35], v3 offset:18176
    v_cvt_pk_bf16_f32 v170, v164, v165
    v_mfma_f32_16x16x32_bf16 a[136:139], v[36:39], v[136:139], a[136:139]
    v_accvgpr_read_b32 v166, a106
    v_accvgpr_read_b32 v167, a107
    v_cvt_pk_bf16_f32 v171, v166, v167
    buffer_store_dwordx4 v[168:171], v0, s[20:23], s54 offen sc1
    v_mfma_f32_16x16x32_bf16 a[140:143], v[36:39], v[140:143], a[140:143]
    ds_read_b64_tr_b16 v[36:37], v3 offset:17952
    ds_read_b64_tr_b16 v[38:39], v3 offset:18208
    v_accvgpr_read_b32 v176, a112
    v_mfma_f32_16x16x32_bf16 a[144:147], v[40:43], v[136:139], a[144:147]
    v_accvgpr_read_b32 v177, a113
    v_cvt_pk_bf16_f32 v184, v176, v177
    v_accvgpr_read_b32 v178, a114
    v_mfma_f32_16x16x32_bf16 a[148:151], v[40:43], v[140:143], a[148:151]
    ds_read_b64_tr_b16 v[40:41], v3 offset:17984
    ds_read_b64_tr_b16 v[42:43], v3 offset:18240
    v_accvgpr_read_b32 v179, a115
    v_cvt_pk_bf16_f32 v185, v178, v179
    v_mfma_f32_16x16x32_bf16 a[152:155], v[44:47], v[136:139], a[152:155]
    v_accvgpr_read_b32 v180, a120
    v_accvgpr_read_b32 v181, a121
    v_cvt_pk_bf16_f32 v186, v180, v181
    v_mfma_f32_16x16x32_bf16 a[156:159], v[44:47], v[140:143], a[156:159]
    ds_read_b64_tr_b16 v[44:45], v3 offset:18016
    ds_read_b64_tr_b16 v[46:47], v3 offset:18272
    v_accvgpr_read_b32 v182, a122
    v_accvgpr_read_b32 v183, a123
    s_waitcnt lgkmcnt(8)
    v_mfma_f32_16x16x32_bf16 a[128:131], v[16:19], v[144:147], a[128:131]
    v_cvt_pk_bf16_f32 v187, v182, v183
    buffer_store_dwordx4 v[184:187], v0, s[20:23], s54 offen offset:1024 sc1
    v_accvgpr_read_b32 v192, a100
    v_mfma_f32_16x16x32_bf16 a[132:135], v[16:19], v[148:151], a[132:135]
    ds_read_b64_tr_b16 v[16:17], v3 offset:26112
    ds_read_b64_tr_b16 v[18:19], v3 offset:26368
    v_accvgpr_read_b32 v193, a101
    v_mfma_f32_16x16x32_bf16 a[136:139], v[20:23], v[144:147], a[136:139]
    v_cvt_pk_bf16_f32 v200, v192, v193
    v_accvgpr_read_b32 v194, a102
    v_accvgpr_read_b32 v195, a103
    v_mfma_f32_16x16x32_bf16 a[140:143], v[20:23], v[148:151], a[140:143]
    ds_read_b64_tr_b16 v[20:21], v3 offset:26144
    ds_read_b64_tr_b16 v[22:23], v3 offset:26400
    v_cvt_pk_bf16_f32 v201, v194, v195
    v_mfma_f32_16x16x32_bf16 a[144:147], v[24:27], v[144:147], a[144:147]
    v_accvgpr_read_b32 v196, a108
    v_accvgpr_read_b32 v197, a109
    v_cvt_pk_bf16_f32 v202, v196, v197
    v_mfma_f32_16x16x32_bf16 a[148:151], v[24:27], v[148:151], a[148:151]
    ds_read_b64_tr_b16 v[24:25], v3 offset:26176
    ds_read_b64_tr_b16 v[26:27], v3 offset:26432
    v_accvgpr_read_b32 v198, a110
    v_mfma_f32_16x16x32_bf16 a[152:155], v[28:31], v[144:147], a[152:155]
    v_accvgpr_read_b32 v199, a111
    v_cvt_pk_bf16_f32 v203, v198, v199
    buffer_store_dwordx4 v[200:203], v0, s[20:23], s54 offen offset:2048 sc1
    v_mfma_f32_16x16x32_bf16 a[156:159], v[28:31], v[148:151], a[156:159]
    ds_read_b64_tr_b16 v[28:29], v3 offset:26208
    ds_read_b64_tr_b16 v[30:31], v3 offset:26464
    v_accvgpr_read_b32 v208, a116
    s_waitcnt lgkmcnt(8)
    v_mfma_f32_16x16x32_bf16 a[128:131], v[32:35], v[152:155], a[128:131]
    v_accvgpr_read_b32 v209, a117
    v_cvt_pk_bf16_f32 v216, v208, v209
    v_accvgpr_read_b32 v210, a118
    v_mfma_f32_16x16x32_bf16 a[132:135], v[32:35], v[156:159], a[132:135]
    ds_read_b64_tr_b16 v[32:33], v3 offset:26624
    ds_read_b64_tr_b16 v[34:35], v3 offset:26880
    v_accvgpr_read_b32 v211, a119
    v_mfma_f32_16x16x32_bf16 a[136:139], v[36:39], v[152:155], a[136:139]
    v_cvt_pk_bf16_f32 v217, v210, v211
    v_accvgpr_read_b32 v212, a124
    v_accvgpr_read_b32 v213, a125
    v_mfma_f32_16x16x32_bf16 a[140:143], v[36:39], v[156:159], a[140:143]
    ds_read_b64_tr_b16 v[36:37], v3 offset:26656
    ds_read_b64_tr_b16 v[38:39], v3 offset:26912
    v_cvt_pk_bf16_f32 v218, v212, v213
    v_mfma_f32_16x16x32_bf16 a[144:147], v[40:43], v[152:155], a[144:147]
    v_accvgpr_read_b32 v214, a126
    v_accvgpr_read_b32 v215, a127
    v_cvt_pk_bf16_f32 v219, v214, v215
    s_cmp_eq_u32 s22, 0
    s_cbranch_scc1 L_ow3
L_owb3:
    v_mfma_f32_16x16x32_bf16 a[148:151], v[40:43], v[156:159], a[148:151]
    ds_read_b64_tr_b16 v[40:41], v3 offset:26688
    ds_read_b64_tr_b16 v[42:43], v3 offset:26944
    buffer_store_dwordx4 v[216:219], v0, s[20:23], s54 offen offset:3072 sc1
    s_add_u32 s54, s54, 32768
    v_mfma_f32_16x16x32_bf16 a[152:155], v[44:47], v[152:155], a[152:155]
    v_mfma_f32_16x16x32_bf16 a[156:159], v[44:47], v[156:159], a[156:159]
    ds_read_b64_tr_b16 v[44:45], v3 offset:26720
    ds_read_b64_tr_b16 v[46:47], v3 offset:26976
    s_waitcnt lgkmcnt(8)
    v_mfma_f32_16x16x32_bf16 a[160:163], v[16:19], v[128:131], a[160:163]
    v_mfma_f32_16x16x32_bf16 a[164:167], v[16:19], v[132:135], a[164:167]
    ds_read_b64_tr_b16 v[16:17], v3 offset:34816
    ds_read_b64_tr_b16 v[18:19], v3 offset:35072
    v_mfma_f32_16x16x32_bf16 a[168:171], v[20:23], v[128:131], a[168:171]
    v_mfma_f32_16x16x32_bf16 a[172:175], v[20:23], v[132:135], a[172:175]
    ds_read_b64_tr_b16 v[20:21], v3 offset:34848
    ds_read_b64_tr_b16 v[22:23], v3 offset:35104
    s_lshl_b32 s48, s64, 12
    s_add_u32 s48, s48, 137728
    v_mfma_f32_16x16x32_bf16 a[176:179], v[24:27], v[128:131], a[176:179]
    s_cmp_lt_u32 s64, 4
    s_cselect_b32 s22, 0, 28377088
    s_cselect_b32 s48, s48, 154112
    v_add_u32 v61, s48, v0
    s_add_u32 s64, s64, 1
    v_mfma_f32_16x16x32_bf16 a[180:183], v[24:27], v[132:135], a[180:183]
    ds_read_b64_tr_b16 v[24:25], v3 offset:34880
    ds_read_b64_tr_b16 v[26:27], v3 offset:35136
    v_accvgpr_read_b32 v160, a128
    v_mfma_f32_16x16x32_bf16 a[184:187], v[28:31], v[128:131], a[184:187]
    v_accvgpr_read_b32 v161, a129
    v_cvt_pk_bf16_f32 v168, v160, v161
    v_accvgpr_read_b32 v162, a130
    v_mfma_f32_16x16x32_bf16 a[188:191], v[28:31], v[132:135], a[188:191]
    ds_read_b64_tr_b16 v[28:29], v3 offset:34912
    ds_read_b64_tr_b16 v[30:31], v3 offset:35168
    v_accvgpr_read_b32 v163, a131
    s_waitcnt lgkmcnt(8)
    v_mfma_f32_16x16x32_bf16 a[160:163], v[32:35], v[136:139], a[160:163]
    v_cvt_pk_bf16_f32 v169, v162, v163
    v_accvgpr_read_b32 v164, a136
    v_accvgpr_read_b32 v165, a137
    v_mfma_f32_16x16x32_bf16 a[164:167], v[32:35], v[140:143], a[164:167]
    ds_read_b64_tr_b16 v[32:33], v3 offset:35328
    ds_read_b64_tr_b16 v[34:35], v3 offset:35584
    v_cvt_pk_bf16_f32 v170, v164, v165
    v_mfma_f32_16x16x32_bf16 a[168:171], v[36:39], v[136:139], a[168:171]
    v_accvgpr_read_b32 v166, a138
    v_accvgpr_read_b32 v167, a139
    v_cvt_pk_bf16_f32 v171, v166, v167
    v_mfma_f32_16x16x32_bf16 a[172:175], v[36:39], v[140:143], a[172:175]
    ds_read_b64_tr_b16 v[36:37], v3 offset:35360
    ds_read_b64_tr_b16 v[38:39], v3 offset:35616
    buffer_store_dwordx4 v[168:171], v0, s[20:23], s54 offen sc1
    v_mfma_f32_16x16x32_bf16 a[176:179], v[40:43], v[136:139], a[176:179]
    v_accvgpr_read_b32 v176, a144
    v_accvgpr_read_b32 v177, a145
    v_cvt_pk_bf16_f32 v184, v176, v177
    v_mfma_f32_16x16x32_bf16 a[180:183], v[40:43], v[140:143], a[180:183]
    ds_read_b64_tr_b16 v[40:41], v3 offset:35392
    ds_read_b64_tr_b16 v[42:43], v3 offset:35648
    v_accvgpr_read_b32 v178, a146
    v_mfma_f32_16x16x32_bf16 a[184:187], v[44:47], v[136:139], a[184:187]
    v_accvgpr_read_b32 v179, a147
    v_cvt_pk_bf16_f32 v185, v178, v179
    v_accvgpr_read_b32 v180, a152
    v_mfma_f32_16x16x32_bf16 a[188:191], v[44:47], v[140:143], a[188:191]
    ds_read_b64_tr_b16 v[44:45], v3 offset:35424
    ds_read_b64_tr_b16 v[46:47], v3 offset:35680
    v_accvgpr_read_b32 v181, a153
    s_waitcnt lgkmcnt(10)
    v_mfma_f32_16x16x32_bf16 a[160:163], v[16:19], v[144:147], a[160:163]
    v_cvt_pk_bf16_f32 v186, v180, v181
    v_accvgpr_read_b32 v182, a154
    v_accvgpr_read_b32 v183, a155
    v_mfma_f32_16x16x32_bf16 a[164:167], v[16:19], v[148:151], a[164:167]
    v_cvt_pk_bf16_f32 v187, v182, v183
    buffer_store_dwordx4 v[184:187], v0, s[20:23], s54 offen offset:1024 sc1
    v_accvgpr_read_b32 v192, a132
    v_mfma_f32_16x16x32_bf16 a[168:171], v[20:23], v[144:147], a[168:171]
    v_accvgpr_read_b32 v193, a133
    v_cvt_pk_bf16_f32 v200, v192, v193
    v_accvgpr_read_b32 v194, a134
    v_mfma_f32_16x16x32_bf16 a[172:175], v[20:23], v[148:151], a[172:175]
    v_accvgpr_read_b32 v195, a135
    v_cvt_pk_bf16_f32 v201, v194, v195
    v_accvgpr_read_b32 v196, a140
    v_mfma_f32_16x16x32_bf16 a[176:179], v[24:27], v[144:147], a[176:179]
    v_accvgpr_read_b32 v197, a141
    v_cvt_pk_bf16_f32 v202, v196, v197
    v_accvgpr_read_b32 v198, a142
    v_mfma_f32_16x16x32_bf16 a[180:183], v[24:27], v[148:151], a[180:183]
    s_waitcnt lgkmcnt(0)
    s_barrier
    ds_read_b64_tr_b16 v[16:17], v6 offset:0
    ds_read_b64_tr_b16 v[18:19], v6 offset:256
    ds_read_b64_tr_b16 v[20:21], v6 offset:32
    ds_read_b64_tr_b16 v[22:23], v6 offset:288
    v_mfma_f32_16x16x32_bf16 a[184:187], v[28:31], v[144:147], a[184:187]
    ds_read_b64_tr_b16 v[24:25], v6 offset:64
    ds_read_b64_tr_b16 v[26:27], v6 offset:320
    v_mfma_f32_16x16x32_bf16 a[188:191], v[28:31], v[148:151], a[188:191]
    ds_read_b64_tr_b16 v[28:29], v6 offset:96
    ds_read_b64_tr_b16 v[30:31], v6 offset:352
    v_mfma_f32_16x16x32_bf16 a[160:163], v[32:35], v[152:155], a[160:163]
    v_accvgpr_read_b32 v199, a143
    v_cvt_pk_bf16_f32 v203, v198, v199
    buffer_store_dwordx4 v[200:203], v0, s[20:23], s54 offen offset:2048 sc1
    v_mfma_f32_16x16x32_bf16 a[164:167], v[32:35], v[156:159], a[164:167]
    ds_read_b64_tr_b16 v[32:33], v6 offset:512
    ds_read_b64_tr_b16 v[34:35], v6 offset:768
    v_accvgpr_read_b32 v208, a148
    v_mfma_f32_16x16x32_bf16 a[168:171], v[36:39], v[152:155], a[168:171]
    v_accvgpr_read_b32 v209, a149
    v_cvt_pk_bf16_f32 v216, v208, v209
    v_accvgpr_read_b32 v210, a150
    v_mfma_f32_16x16x32_bf16 a[172:175], v[36:39], v[156:159], a[172:175]
    ds_read_b64_tr_b16 v[36:37], v6 offset:544
    ds_read_b64_tr_b16 v[38:39], v6 offset:800
    v_accvgpr_read_b32 v211, a151
    v_mfma_f32_16x16x32_bf16 a[176:179], v[40:43], v[152:155], a[176:179]
    v_cvt_pk_bf16_f32 v217, v210, v211
    v_accvgpr_read_b32 v212, a156
    v_accvgpr_read_b32 v213, a157
    v_mfma_f32_16x16x32_bf16 a[180:183], v[40:43], v[156:159], a[180:183]
    ds_read_b64_tr_b16 v[40:41], v6 offset:576
    ds_read_b64_tr_b16 v[42:43], v6 offset:832
    v_cvt_pk_bf16_f32 v218, v212, v213
    v_mfma_f32_16x16x32_bf16 a[184:187], v[44:47], v[152:155], a[184:187]
    v_accvgpr_read_b32 v214, a158
    v_accvgpr_read_b32 v215, a159
    v_cvt_pk_bf16_f32 v219, v214, v215
    s_cmp_eq_u32 s22, 0
    s_cbranch_scc1 L_ow4
L_owb4:
    v_mfma_f32_16x16x32_bf16 a[188:191], v[44:47], v[156:159], a[188:191]
    ds_read_b64_tr_b16 v[44:45], v6 offset:608
    ds_read_b64_tr_b16 v[46:47], v6 offset:864
    buffer_store_dwordx4 v[216:219], v0, s[20:23], s54 offen offset:3072 sc1
    s_add_u32 s54, s54, 32768
    s_waitcnt lgkmcnt(8)
    v_mfma_f32_16x16x32_bf16 a[192:195], v[16:19], v[128:131], a[192:195]
    v_mfma_f32_16x16x32_bf16 a[196:199], v[16:19], v[132:135], a[196:199]
    ds_read_b64_tr_b16 v[16:17], v6 offset:8704
    ds_read_b64_tr_b16 v[18:19], v6 offset:8960
    v_mfma_f32_16x16x32_bf16 a[200:203], v[20:23], v[128:131], a[200:203]
    v_mfma_f32_16x16x32_bf16 a[204:207], v[20:23], v[132:135], a[204:207]
    ds_read_b64_tr_b16 v[20:21], v6 offset:8736
    ds_read_b64_tr_b16 v[22:23], v6 offset:8992
    s_lshl_b32 s48, s64, 12
    s_add_u32 s48, s48, 137728
    v_mfma_f32_16x16x32_bf16 a[208:211], v[24:27], v[128:131], a[208:211]
    s_cmp_lt_u32 s64, 4
    s_cselect_b32 s22, 0, 28377088
    s_cselect_b32 s48, s48, 154112
    v_add_u32 v61, s48, v0
    s_add_u32 s64, s64, 1
    v_mfma_f32_16x16x32_bf16 a[212:215], v[24:27], v[132:135], a[212:215]
    ds_read_b64_tr_b16 v[24:25], v6 offset:8768
    ds_read_b64_tr_b16 v[26:27], v6 offset:9024
    v_accvgpr_read_b32 v160, a160
    v_accvgpr_read_b32 v161, a161
    v_mfma_f32_16x16x32_bf16 a[216:219], v[28:31], v[128:131], a[216:219]
    v_cvt_pk_bf16_f32 v168, v160, v161
    v_accvgpr_read_b32 v162, a162
    v_accvgpr_read_b32 v163, a163
    v_mfma_f32_16x16x32_bf16 a[220:223], v[28:31], v[132:135], a[220:223]
    ds_read_b64_tr_b16 v[28:29], v6 offset:8800
    ds_read_b64_tr_b16 v[30:31], v6 offset:9056
    v_cvt_pk_bf16_f32 v169, v162, v163
    v_accvgpr_read_b32 v164, a168
    s_waitcnt lgkmcnt(8)
    v_mfma_f32_16x16x32_bf16 a[192:195], v[32:35], v[136:139], a[192:195]
    v_accvgpr_read_b32 v165, a169
    v_cvt_pk_bf16_f32 v170, v164, v165
    v_accvgpr_read_b32 v166, a170
    v_mfma_f32_16x16x32_bf16 a[196:199], v[32:35], v[140:143], a[196:199]
    ds_read_b64_tr_b16 v[32:33], v6 offset:9216
    ds_read_b64_tr_b16 v[34:35], v6 offset:9472
    v_accvgpr_read_b32 v167, a171
    v_cvt_pk_bf16_f32 v171, v166, v167
    v_mfma_f32_16x16x32_bf16 a[200:203], v[36:39], v[136:139], a[200:203]
    buffer_store_dwordx4 v[168:171], v0, s[20:23], s54 offen sc1
    v_accvgpr_read_b32 v176, a176
    v_accvgpr_read_b32 v177, a177
    v_mfma_f32_16x16x32_bf16 a[204:207], v[36:39], v[140:143], a[204:207]
    ds_read_b64_tr_b16 v[36:37], v6 offset:9248
    ds_read_b64_tr_b16 v[38:39], v6 offset:9504
    v_cvt_pk_bf16_f32 v184, v176, v177
    v_accvgpr_read_b32 v178, a178
    v_mfma_f32_16x16x32_bf16 a[208:211], v[40:43], v[136:139], a[208:211]
    v_accvgpr_read_b32 v179, a179
    v_cvt_pk_bf16_f32 v185, v178, v179
    v_accvgpr_read_b32 v180, a184
    v_mfma_f32_16x16x32_bf16 a[212:215], v[40:43], v[140:143], a[212:215]
    ds_read_b64_tr_b16 v[40:41], v6 offset:9280
    ds_read_b64_tr_b16 v[42:43], v6 offset:9536
    v_accvgpr_read_b32 v181, a185
    v_mfma_f32_16x16x32_bf16 a[216:219], v[44:47], v[136:139], a[216:219]
    v_cvt_pk_bf16_f32 v186, v180, v181
    v_accvgpr_read_b32 v182, a186
    v_accvgpr_read_b32 v183, a187
    v_cvt_pk_bf16_f32 v187, v182, v183
    v_mfma_f32_16x16x32_bf16 a[220:223], v[44:47], v[140:143], a[220:223]
    ds_read_b64_tr_b16 v[44:45], v6 offset:9312
    ds_read_b64_tr_b16 v[46:47], v6 offset:9568
    buffer_store_dwordx4 v[184:187], v0, s[20:23], s54 offen offset:1024 sc1
    s_waitcnt lgkmcnt(8)
    v_mfma_f32_16x16x32_bf16 a[192:195], v[16:19], v[144:147], a[192:195]
    v_accvgpr_read_b32 v192, a164
    v_accvgpr_read_b32 v193, a165
    v_cvt_pk_bf16_f32 v200, v192, v193
    v_accvgpr_read_b32 v194, a166
    v_mfma_f32_16x16x32_bf16 a[196:199], v[16:19], v[148:151], a[196:199]
    ds_read_b64_tr_b16 v[16:17], v6 offset:17408
    ds_read_b64_tr_b16 v[18:19], v6 offset:17664
    v_accvgpr_read_b32 v195, a167
    v_mfma_f32_16x16x32_bf16 a[200:203], v[20:23], v[144:147], a[200:203]
    v_cvt_pk_bf16_f32 v201, v194, v195
    v_accvgpr_read_b32 v196, a172
    v_accvgpr_read_b32 v197, a173
    v_cvt_pk_bf16_f32 v202, v196, v197
    v_mfma_f32_16x16x32_bf16 a[204:207], v[20:23], v[148:151], a[204:207]
    ds_read_b64_tr_b16 v[20:21], v6 offset:17440
    ds_read_b64_tr_b16 v[22:23], v6 offset:17696
    v_accvgpr_read_b32 v198, a174
    v_mfma_f32_16x16x32_bf16 a[208:211], v[24:27], v[144:147], a[208:211]
    v_accvgpr_read_b32 v199, a175
    v_cvt_pk_bf16_f32 v203, v198, v199
    buffer_store_dwordx4 v[200:203], v0, s[20:23], s54 offen offset:2048 sc1
    v_accvgpr_read_b32 v208, a180
    v_mfma_f32_16x16x32_bf16 a[212:215], v[24:27], v[148:151], a[212:215]
    ds_read_b64_tr_b16 v[24:25], v6 offset:17472
    ds_read_b64_tr_b16 v[26:27], v6 offset:17728
    v_accvgpr_read_b32 v209, a181
    v_mfma_f32_16x16x32_bf16 a[216:219], v[28:31], v[144:147], a[216:219]
    v_cvt_pk_bf16_f32 v216, v208, v209
    v_accvgpr_read_b32 v210, a182
    v_accvgpr_read_b32 v211, a183
    v_cvt_pk_bf16_f32 v217, v210, v211
    v_mfma_f32_16x16x32_bf16 a[220:223], v[28:31], v[148:151], a[220:223]
    ds_read_b64_tr_b16 v[28:29], v6 offset:17504
    ds_read_b64_tr_b16 v[30:31], v6 offset:17760
    v_accvgpr_read_b32 v212, a188
    s_waitcnt lgkmcnt(8)
    v_mfma_f32_16x16x32_bf16 a[192:195], v[32:35], v[152:155], a[192:195]
    v_accvgpr_read_b32 v213, a189
    v_cvt_pk_bf16_f32 v218, v212, v213
    v_accvgpr_read_b32 v214, a190
    v_mfma_f32_16x16x32_bf16 a[196:199], v[32:35], v[156:159], a[196:199]
    ds_read_b64_tr_b16 v[32:33], v6 offset:17920
    ds_read_b64_tr_b16 v[34:35], v6 offset:18176
    v_accvgpr_read_b32 v215, a191
    v_cvt_pk_bf16_f32 v219, v214, v215
    s_cmp_eq_u32 s22, 0
    s_cbranch_scc1 L_ow5
L_owb5:
    v_mfma_f32_16x16x32_bf16 a[200:203], v[36:39], v[152:155], a[200:203]
    buffer_store_dwordx4 v[216:219], v0, s[20:23], s54 offen offset:3072 sc1
    s_add_u32 s54, s54, 32768
    v_mfma_f32_16x16x32_bf16 a[204:207], v[36:39], v[156:159], a[204:207]
    ds_read_b64_tr_b16 v[36:37], v6 offset:17952
    ds_read_b64_tr_b16 v[38:39], v6 offset:18208
    v_mfma_f32_16x16x32_bf16 a[208:211], v[40:43], v[152:155], a[208:211]
    v_mfma_f32_16x16x32_bf16 a[212:215], v[40:43], v[156:159], a[212:215]
    ds_read_b64_tr_b16 v[40:41], v6 offset:17984
    ds_read_b64_tr_b16 v[42:43], v6 offset:18240
    v_mfma_f32_16x16x32_bf16 a[216:219], v[44:47], v[152:155], a[216:219]
    v_mfma_f32_16x16x32_bf16 a[220:223], v[44:47], v[156:159], a[220:223]
    ds_read_b64_tr_b16 v[44:45], v6 offset:18016
    ds_read_b64_tr_b16 v[46:47], v6 offset:18272
    s_waitcnt lgkmcnt(10)
    v_mfma_f32_16x16x32_bf16 a[224:227], v[16:19], v[128:131], a[224:227]
    v_mfma_f32_16x16x32_bf16 a[228:231], v[16:19], v[132:135], a[228:231]
    v_mfma_f32_16x16x32_bf16 a[232:235], v[20:23], v[128:131], a[232:235]
    v_mfma_f32_16x16x32_bf16 a[236:239], v[20:23], v[132:135], a[236:239]
    s_lshl_b32 s48, s64, 12
    s_add_u32 s48, s48, 137728
    s_cmp_lt_u32 s64, 4
    s_cselect_b32 s22, 0, 28377088
    s_cselect_b32 s48, s48, 154112
    v_mfma_f32_16x16x32_bf16 a[240:243], v[24:27], v[128:131], a[240:243]
    s_add_u32 s64, s64, 1
    v_add_u32 v61, s48, v0
    v_accvgpr_read_b32 v160, a192
    v_accvgpr_read_b32 v161, a193
    v_cvt_pk_bf16_f32 v168, v160, v161
    v_mfma_f32_16x16x32_bf16 a[244:247], v[24:27], v[132:135], a[244:247]
    s_waitcnt lgkmcnt(0)
    s_barrier
    ds_read_b64_tr_b16 v[16:17], v6 offset:26112
    ds_read_b64_tr_b16 v[18:19], v6 offset:26368
    ds_read_b64_tr_b16 v[20:21], v6 offset:26144
    ds_read_b64_tr_b16 v[22:23], v6 offset:26400
    v_mfma_f32_16x16x32_bf16 a[248:251], v[28:31], v[128:131], a[248:251]
    ds_read_b64_tr_b16 v[24:25], v6 offset:26176
    ds_read_b64_tr_b16 v[26:27], v6 offset:26432
    v_mfma_f32_16x16x32_bf16 a[252:255], v[28:31], v[132:135], a[252:255]
    ds_read_b64_tr_b16 v[28:29], v6 offset:26208
    ds_read_b64_tr_b16 v[30:31], v6 offset:26464
    v_accvgpr_read_b32 v162, a194
    v_mfma_f32_16x16x32_bf16 a[224:227], v[32:35], v[136:139], a[224:227]
    v_accvgpr_read_b32 v163, a195
    v_cvt_pk_bf16_f32 v169, v162, v163
    v_accvgpr_read_b32 v164, a200
    v_accvgpr_read_b32 v165, a201
    v_mfma_f32_16x16x32_bf16 a[228:231], v[32:35], v[140:143], a[228:231]
    ds_read_b64_tr_b16 v[32:33], v6 offset:26624
    ds_read_b64_tr_b16 v[34:35], v6 offset:26880
    v_cvt_pk_bf16_f32 v170, v164, v165
    v_mfma_f32_16x16x32_bf16 a[232:235], v[36:39], v[136:139], a[232:235]
    v_accvgpr_read_b32 v166, a202
    v_accvgpr_read_b32 v167, a203
    v_cvt_pk_bf16_f32 v171, v166, v167
    buffer_store_dwordx4 v[168:171], v0, s[20:23], s54 offen sc1
    v_mfma_f32_16x16x32_bf16 a[236:239], v[36:39], v[140:143], a[236:239]
    ds_read_b64_tr_b16 v[36:37], v6 offset:26656
    ds_read_b64_tr_b16 v[38:39], v6 offset:26912
    v_accvgpr_read_b32 v176, a208
    v_mfma_f32_16x16x32_bf16 a[240:243], v[40:43], v[136:139], a[240:243]
    v_accvgpr_read_b32 v177, a209
    v_cvt_pk_bf16_f32 v184, v176, v177
    v_accvgpr_read_b32 v178, a210
    v_mfma_f32_16x16x32_bf16 a[244:247], v[40:43], v[140:143], a[244:247]
    ds_read_b64_tr_b16 v[40:41], v6 offset:26688
    ds_read_b64_tr_b16 v[42:43], v6 offset:26944
    v_accvgpr_read_b32 v179, a211
    v_cvt_pk_bf16_f32 v185, v178, v179
    v_mfma_f32_16x16x32_bf16 a[248:251], v[44:47], v[136:139], a[248:251]
    v_accvgpr_read_b32 v180, a216
    v_accvgpr_read_b32 v181, a217
    v_cvt_pk_bf16_f32 v186, v180, v181
    v_mfma_f32_16x16x32_bf16 a[252:255], v[44:47], v[140:143], a[252:255]
    ds_read_b64_tr_b16 v[44:45], v6 offset:26720
    ds_read_b64_tr_b16 v[46:47], v6 offset:26976
    v_accvgpr_read_b32 v182, a218
    v_accvgpr_read_b32 v183, a219
    s_waitcnt lgkmcnt(8)
    v_mfma_f32_16x16x32_bf16 a[224:227], v[16:19], v[144:147], a[224:227]
    v_cvt_pk_bf16_f32 v187, v182, v183
    buffer_store_dwordx4 v[184:187], v0, s[20:23], s54 offen offset:1024 sc1
    v_accvgpr_read_b32 v192, a196
    v_mfma_f32_16x16x32_bf16 a[228:231], v[16:19], v[148:151], a[228:231]
    ds_read_b64_tr_b16 v[16:17], v6 offset:34816
    ds_read_b64_tr_b16 v[18:19], v6 offset:35072
    v_mfma_f32_16x16x32_bf16 a[232:235], v[20:23], v[144:147], a[232:235]
    v_accvgpr_read_b32 v193, a197
    v_cvt_pk_bf16_f32 v200, v192, v193
    v_accvgpr_read_b32 v194, a198
    v_mfma_f32_16x16x32_bf16 a[236:239], v[20:23], v[148:151], a[236:239]
    ds_read_b64_tr_b16 v[20:21], v6 offset:34848
    ds_read_b64_tr_b16 v[22:23], v6 offset:35104
    v_accvgpr_read_b32 v195, a199
    v_mfma_f32_16x16x32_bf16 a[240:243], v[24:27], v[144:147], a[240:243]
    v_cvt_pk_bf16_f32 v201, v194, v195
    v_accvgpr_read_b32 v196, a204
    v_accvgpr_read_b32 v197, a205
    v_mfma_f32_16x16x32_bf16 a[244:247], v[24:27], v[148:151], a[244:247]
    ds_read_b64_tr_b16 v[24:25], v6 offset:34880
    ds_read_b64_tr_b16 v[26:27], v6 offset:35136
    v_mfma_f32_16x16x32_bf16 a[248:251], v[28:31], v[144:147], a[248:251]
    v_cvt_pk_bf16_f32 v202, v196, v197
    v_accvgpr_read_b32 v198, a206
    v_accvgpr_read_b32 v199, a207
    v_mfma_f32_16x16x32_bf16 a[252:255], v[28:31], v[148:151], a[252:255]
    ds_read_b64_tr_b16 v[28:29], v6 offset:34912
    ds_read_b64_tr_b16 v[30:31], v6 offset:35168
    v_cvt_pk_bf16_f32 v203, v198, v199
    s_waitcnt lgkmcnt(8)
    v_mfma_f32_16x16x32_bf16 a[224:227], v[32:35], v[152:155], a[224:227]
    buffer_store_dwordx4 v[200:203], v0, s[20:23], s54 offen offset:2048 sc1
    v_accvgpr_read_b32 v208, a212
    v_accvgpr_read_b32 v209, a213
    v_mfma_f32_16x16x32_bf16 a[228:231], v[32:35], v[156:159], a[228:231]
    ds_read_b64_tr_b16 v[32:33], v6 offset:35328
    ds_read_b64_tr_b16 v[34:35], v6 offset:35584
    v_mfma_f32_16x16x32_bf16 a[232:235], v[36:39], v[152:155], a[232:235]
    v_cvt_pk_bf16_f32 v216, v208, v209
    v_accvgpr_read_b32 v210, a214
    v_accvgpr_read_b32 v211, a215
    v_mfma_f32_16x16x32_bf16 a[236:239], v[36:39], v[156:159], a[236:239]
    ds_read_b64_tr_b16 v[36:37], v6 offset:35360
    ds_read_b64_tr_b16 v[38:39], v6 offset:35616
    v_cvt_pk_bf16_f32 v217, v210, v211
    v_mfma_f32_16x16x32_bf16 a[240:243], v[40:43], v[152:155], a[240:243]
    v_accvgpr_read_b32 v212, a220
    v_accvgpr_read_b32 v213, a221
    v_cvt_pk_bf16_f32 v218, v212, v213
    v_mfma_f32_16x16x32_bf16 a[244:247], v[40:43], v[156:159], a[244:247]
    ds_read_b64_tr_b16 v[40:41], v6 offset:35392
    ds_read_b64_tr_b16 v[42:43], v6 offset:35648
    v_mfma_f32_16x16x32_bf16 a[248:251], v[44:47], v[152:155], a[248:251]
    v_accvgpr_read_b32 v214, a222
    v_accvgpr_read_b32 v215, a223
    v_cvt_pk_bf16_f32 v219, v214, v215
    s_cmp_eq_u32 s22, 0
    s_cbranch_scc1 L_ow6
L_owb6:
    v_mfma_f32_16x16x32_bf16 a[252:255], v[44:47], v[156:159], a[252:255]
    ds_read_b64_tr_b16 v[44:45], v6 offset:35424
    ds_read_b64_tr_b16 v[46:47], v6 offset:35680
    buffer_store_dwordx4 v[216:219], v0, s[20:23], s54 offen offset:3072 sc1
    s_add_u32 s54, s54, 32768
    s_waitcnt lgkmcnt(8)
    v_mfma_f32_16x16x32_bf16 v[224:227], v[16:19], v[128:131], v[224:227]
    v_mfma_f32_16x16x32_bf16 v[228:231], v[16:19], v[132:135], v[228:231]
    ds_read_b64_tr_b16 v[16:17], v3 offset:0
    ds_read_b64_tr_b16 v[18:19], v3 offset:256
    v_mfma_f32_16x16x32_bf16 v[232:235], v[20:23], v[128:131], v[232:235]
    v_mfma_f32_16x16x32_bf16 v[236:239], v[20:23], v[132:135], v[236:239]
    ds_read_b64_tr_b16 v[20:21], v3 offset:32
    ds_read_b64_tr_b16 v[22:23], v3 offset:288
    s_lshl_b32 s48, s64, 12
    s_add_u32 s48, s48, 137728
    v_mfma_f32_16x16x32_bf16 v[240:243], v[24:27], v[128:131], v[240:243]
    s_cmp_lt_u32 s64, 4
    s_cselect_b32 s22, 0, 28377088
    s_cselect_b32 s48, s48, 154112
    v_add_u32 v61, s48, v0
    v_mfma_f32_16x16x32_bf16 v[244:247], v[24:27], v[132:135], v[244:247]
    ds_read_b64_tr_b16 v[24:25], v3 offset:64
    ds_read_b64_tr_b16 v[26:27], v3 offset:320
    s_add_u32 s64, s64, 1
    v_accvgpr_read_b32 v160, a224
    v_mfma_f32_16x16x32_bf16 v[248:251], v[28:31], v[128:131], v[248:251]
    v_accvgpr_read_b32 v161, a225
    v_cvt_pk_bf16_f32 v168, v160, v161
    v_accvgpr_read_b32 v162, a226
    v_mfma_f32_16x16x32_bf16 v[252:255], v[28:31], v[132:135], v[252:255]
    ds_read_b64_tr_b16 v[28:29], v3 offset:96
    ds_read_b64_tr_b16 v[30:31], v3 offset:352
    v_accvgpr_read_b32 v163, a227
    s_waitcnt lgkmcnt(8)
    v_mfma_f32_16x16x32_bf16 v[224:227], v[32:35], v[136:139], v[224:227]
    v_cvt_pk_bf16_f32 v169, v162, v163
    v_accvgpr_read_b32 v164, a232
    v_mfma_f32_16x16x32_bf16 v[228:231], v[32:35], v[140:143], v[228:231]
    ds_read_b64_tr_b16 v[32:33], v3 offset:512
    ds_read_b64_tr_b16 v[34:35], v3 offset:768
    v_accvgpr_read_b32 v165, a233
    v_mfma_f32_16x16x32_bf16 v[232:235], v[36:39], v[136:139], v[232:235]
    v_cvt_pk_bf16_f32 v170, v164, v165
    v_accvgpr_read_b32 v166, a234
    v_accvgpr_read_b32 v167, a235
    v_mfma_f32_16x16x32_bf16 v[236:239], v[36:39], v[140:143], v[236:239]
    ds_read_b64_tr_b16 v[36:37], v3 offset:544
    ds_read_b64_tr_b16 v[38:39], v3 offset:800
    v_cvt_pk_bf16_f32 v171, v166, v167
    v_mfma_f32_16x16x32_bf16 v[240:243], v[40:43], v[136:139], v[240:243]
    buffer_store_dwordx4 v[168:171], v0, s[20:23], s54 offen sc1
    v_accvgpr_read_b32 v176, a240
    v_mfma_f32_16x16x32_bf16 v[244:247], v[40:43], v[140:143], v[244:247]
    ds_read_b64_tr_b16 v[40:41], v3 offset:576
    ds_read_b64_tr_b16 v[42:43], v3 offset:832
    v_accvgpr_read_b32 v177, a241
    v_mfma_f32_16x16x32_bf16 v[248:251], v[44:47], v[136:139], v[248:251]
    v_cvt_pk_bf16_f32 v184, v176, v177
    v_accvgpr_read_b32 v178, a242
    v_accvgpr_read_b32 v179, a243
    v_mfma_f32_16x16x32_bf16 v[252:255], v[44:47], v[140:143], v[252:255]
    ds_read_b64_tr_b16 v[44:45], v3 offset:608
    ds_read_b64_tr_b16 v[46:47], v3 offset:864
    v_cvt_pk_bf16_f32 v185, v178, v179
    s_waitcnt lgkmcnt(8)
    v_mfma_f32_16x16x32_bf16 v[224:227], v[16:19], v[144:147], v[224:227]
    v_accvgpr_read_b32 v180, a248
    v_accvgpr_read_b32 v181, a249
    v_mfma_f32_16x16x32_bf16 v[228:231], v[16:19], v[148:151], v[228:231]
    v_cvt_pk_bf16_f32 v186, v180, v181
    v_accvgpr_read_b32 v182, a250
    v_accvgpr_read_b32 v183, a251
    v_mfma_f32_16x16x32_bf16 v[232:235], v[20:23], v[144:147], v[232:235]
    v_cvt_pk_bf16_f32 v187, v182, v183
    buffer_store_dwordx4 v[184:187], v0, s[20:23], s54 offen offset:1024 sc1
    v_accvgpr_read_b32 v192, a228
    v_mfma_f32_16x16x32_bf16 v[236:239], v[20:23], v[148:151], v[236:239]
    v_accvgpr_read_b32 v193, a229
    v_cvt_pk_bf16_f32 v200, v192, v193
    v_accvgpr_read_b32 v194, a230
    v_mfma_f32_16x16x32_bf16 v[240:243], v[24:27], v[144:147], v[240:243]
    v_accvgpr_read_b32 v195, a231
    v_cvt_pk_bf16_f32 v201, v194, v195
    v_mfma_f32_16x16x32_bf16 v[244:247], v[24:27], v[148:151], v[244:247]
    v_accvgpr_read_b32 v196, a236
    v_accvgpr_read_b32 v197, a237
    v_cvt_pk_bf16_f32 v202, v196, v197
    v_mfma_f32_16x16x32_bf16 v[248:251], v[28:31], v[144:147], v[248:251]
    v_accvgpr_read_b32 v198, a238
    v_accvgpr_read_b32 v199, a239
    v_cvt_pk_bf16_f32 v203, v198, v199
    v_mfma_f32_16x16x32_bf16 v[252:255], v[28:31], v[148:151], v[252:255]
    buffer_store_dwordx4 v[200:203], v0, s[20:23], s54 offen offset:2048 sc1
    v_accvgpr_read_b32 v208, a244
    v_accvgpr_read_b32 v209, a245
    s_waitcnt lgkmcnt(0)
    v_mfma_f32_16x16x32_bf16 v[224:227], v[32:35], v[152:155], v[224:227]
    v_cvt_pk_bf16_f32 v216, v208, v209
    v_accvgpr_read_b32 v210, a246
    v_mfma_f32_16x16x32_bf16 v[228:231], v[32:35], v[156:159], v[228:231]
    v_accvgpr_read_b32 v211, a247
    v_cvt_pk_bf16_f32 v217, v210, v211
    v_accvgpr_read_b32 v212, a252
    v_mfma_f32_16x16x32_bf16 v[232:235], v[36:39], v[152:155], v[232:235]
    v_accvgpr_read_b32 v213, a253
    v_cvt_pk_bf16_f32 v218, v212, v213
    v_accvgpr_read_b32 v214, a254
    v_mfma_f32_16x16x32_bf16 v[236:239], v[36:39], v[156:159], v[236:239]
    v_accvgpr_read_b32 v215, a255
    v_cvt_pk_bf16_f32 v219, v214, v215
    s_cmp_eq_u32 s22, 0
    s_cbranch_scc1 L_ow7
L_owb7:
    buffer_store_dwordx4 v[216:219], v0, s[20:23], s54 offen offset:3072 sc1
    v_mfma_f32_16x16x32_bf16 v[240:243], v[40:43], v[152:155], v[240:243]
    s_add_u32 s54, s54, 32768
    v_mfma_f32_16x16x32_bf16 v[244:247], v[40:43], v[156:159], v[244:247]
    v_mfma_f32_16x16x32_bf16 v[248:251], v[44:47], v[152:155], v[248:251]
    v_mfma_f32_16x16x32_bf16 v[252:255], v[44:47], v[156:159], v[252:255]
    s_nop 7
    s_lshl_b32 s48, s64, 12
    s_add_u32 s48, s48, 137728
    s_cmp_lt_u32 s64, 4
    s_cselect_b32 s22, 0, 28377088
    s_cselect_b32 s48, s48, 154112
    v_add_u32 v61, s48, v0
    s_add_u32 s64, s64, 1
    v_cvt_pk_bf16_f32 v168, v224, v225
    v_cvt_pk_bf16_f32 v169, v226, v227
    v_cvt_pk_bf16_f32 v170, v232, v233
    v_cvt_pk_bf16_f32 v171, v234, v235
    buffer_store_dwordx4 v[168:171], v0, s[20:23], s54 offen sc1
    v_cvt_pk_bf16_f32 v184, v240, v241
    v_cvt_pk_bf16_f32 v185, v242, v243
    v_cvt_pk_bf16_f32 v186, v248, v249
    v_cvt_pk_bf16_f32 v187, v250, v251
    buffer_store_dwordx4 v[184:187], v0, s[20:23], s54 offen offset:1024 sc1
    v_cvt_pk_bf16_f32 v200, v228, v229
    v_cvt_pk_bf16_f32 v201, v230, v231
    v_cvt_pk_bf16_f32 v202, v236, v237
    v_cvt_pk_bf16_f32 v203, v238, v239
    buffer_store_dwordx4 v[200:203], v0, s[20:23], s54 offen offset:2048 sc1
    v_cvt_pk_bf16_f32 v216, v244, v245
    v_cvt_pk_bf16_f32 v217, v246, v247
    v_cvt_pk_bf16_f32 v218, v252, v253
    v_cvt_pk_bf16_f32 v219, v254, v255
    s_cmp_eq_u32 s22, 0
    s_cbranch_scc1 L_ow8
L_owb8:
    buffer_store_dwordx4 v[216:219], v0, s[20:23], s54 offen offset:3072 sc1
    s_add_u32 s54, s54, 32768
    s_mov_b32 s22, 28377088
    s_waitcnt vmcnt(0) lgkmcnt(0)
    s_barrier
L_reduce:
    v_mov_b32 v4, 130560
    ds_read_b32 v5, v4
    ds_read_b32 v6, v4 offset:4
    s_mov_b32 s58, 3538944
    s_mov_b32 s59, 0x20000
    v_mbcnt_lo_u32_b32 v8, -1, 0
    v_mbcnt_hi_u32_b32 v8, -1, v8
    v_lshlrev_b32 v9, 4, v8
    v_lshlrev_b32 v3, 2, v8
    s_lshl_b32 s70, s55, 3
    s_add_u32 s70, s70, s44
    s_lshl_b32 s70, s70, 8
    s_add_u32 s70, s70, 28311552
    s_lshl_b32 s71, 1, s44
    s_mov_b32 s68, 0
    s_mov_b32 s72, 0
    s_mov_b32 s74, 0x3f80
    s_mov_b32 s75, 0x3f800000
    s_waitcnt lgkmcnt(0)
    v_readfirstlane_b32 s50, v5
    s_and_b32 s50, s50, 31
    s_add_u32 s50, s50, s3
    s_cmp_ge_u32 s50, 27
    s_cbranch_scc1 L_done
    s_mul_i32 s73, s55, 27
    s_add_u32 s73, s73, s50
    s_lshl_b32 s73, s73, 15
    s_lshl_b32 s48, s3, 12
    s_add_u32 s48, s48, 137728
    v_add_u32 v7, s48, v9
    s_mov_b32 s68, s71
    ds_read_b128 v[208:211], v7 offset:0
    ds_read_b128 v[212:215], v7 offset:1024
    ds_read_b128 v[216:219], v7 offset:2048
    ds_read_b128 v[220:223], v7 offset:3072
    v_readfirstlane_b32 s69, v6
    s_and_b32 s69, s69, 255
    s_andn2_b32 s69, s69, s71
    s_cmp_lg_u32 s69, 0
    s_cbranch_scc1 L_have
L_poll:
    s_mov_b64 exec, 255
    buffer_load_dword v6, v3, s[20:23], s70 offen sc1
    s_mov_b64 exec, -1
L_polled:
    s_waitcnt vmcnt(0)
    v_cmp_eq_u32 vcc, 1, v6
    s_add_u32 s72, s72, 1
    s_nop 2
    s_and_b32 s69, vcc_lo, 255
    s_andn2_b32 s69, s69, s68
    s_cmp_lg_u32 s69, 0
    s_cbranch_scc1 L_have
    s_sleep 2
    s_cmp_lt_u32 s72, 1048576
    s_cbranch_scc1 L_poll
    s_branch L_done
L_have:
    s_mov_b32 s48, s73
    s_bcnt1_i32_b32 s49, s69
    s_bitcmp1_b32 s69, 0
    s_cbranch_scc0 L_nl0
    buffer_load_dwordx4 v[32:35], v9, s[20:23], s48 offen sc1
    buffer_load_dwordx4 v[36:39], v9, s[20:23], s48 offen offset:1024 sc1
    buffer_load_dwordx4 v[40:43], v9, s[20:23], s48 offen offset:2048 sc1
    buffer_load_dwordx4 v[44:47], v9, s[20:23], s48 offen offset:3072 sc1
L_nl0:
    s_add_u32 s48, s48, 4096
    s_bitcmp1_b32 s69, 1
    s_cbranch_scc0 L_nl1
    buffer_load_dwordx4 v[48:51], v9, s[20:23], s48 offen sc1
    buffer_load_dwordx4 v[52:55], v9, s[20:23], s48 offen offset:1024 sc1
    buffer_load_dwordx4 v[56:59], v9, s[20:23], s48 offen offset:2048 sc1
    buffer_load_dwordx4 v[60:63], v9, s[20:23], s48 offen offset:3072 sc1
L_nl1:
    s_add_u32 s48, s48, 4096
    s_bitcmp1_b32 s69, 2
    s_cbranch_scc0 L_nl2
    buffer_load_dwordx4 v[64:67], v9, s[20:23], s48 offen sc1
    buffer_load_dwordx4 v[68:71], v9, s[20:23], s48 offen offset:1024 sc1
    buffer_load_dwordx4 v[72:75], v9, s[20:23], s48 offen offset:2048 sc1
    buffer_load_dwordx4 v[76:79], v9, s[20:23], s48 offen offset:3072 sc1
L_nl2:
    s_add_u32 s48, s48, 4096
    s_bitcmp1_b32 s69, 3
    s_cbranch_scc0 L_nl3
    buffer_load_dwordx4 v[80:83], v9, s[20:23], s48 offen sc1
    buffer_load_dwordx4 v[84:87], v9, s[20:23], s48 offen offset:1024 sc1
    buffer_load_dwordx4 v[88:91], v9, s[20:23], s48 offen offset:2048 sc1
    buffer_load_dwordx4 v[92:95], v9, s[20:23], s48 offen offset:3072 sc1
L_nl3:
    s_add_u32 s48, s48, 4096
    s_bitcmp1_b32 s69, 4
    s_cbranch_scc0 L_nl4
    buffer_load_dwordx4 v[96:99], v9, s[20:23], s48 offen sc1
    buffer_load_dwordx4 v[100:103], v9, s[20:23], s48 offen offset:1024 sc1
    buffer_load_dwordx4 v[104:107], v9, s[20:23], s48 offen offset:2048 sc1
    buffer_load_dwordx4 v[108:111], v9, s[20:23], s48 offen offset:3072 sc1
L_nl4:
    s_add_u32 s48, s48, 4096
    s_bitcmp1_b32 s69, 5
    s_cbranch_scc0 L_nl5
    buffer_load_dwordx4 v[112:115], v9, s[20:23], s48 offen sc1
    buffer_load_dwordx4 v[116:119], v9, s[20:23], s48 offen offset:1024 sc1
    buffer_load_dwordx4 v[120:123], v9, s[20:23], s48 offen offset:2048 sc1
    buffer_load_dwordx4 v[124:127], v9, s[20:23], s48 offen offset:3072 sc1
L_nl5:
    s_add_u32 s48, s48, 4096
    s_bitcmp1_b32 s69, 6
    s_cbranch_scc0 L_nl6
    buffer_load_dwordx4 v[128:131], v9, s[20:23], s48 offen sc1
    buffer_load_dwordx4 v[132:135], v9, s[20:23], s48 offen offset:1024 sc1
    buffer_load_dwordx4 v[136:139], v9, s[20:23], s48 offen offset:2048 sc1
    buffer_load_dwordx4 v[140:143], v9, s[20:23], s48 offen offset:3072 sc1
L_nl6:
    s_add_u32 s48, s48, 4096
    s_bitcmp1_b32 s69, 7
    s_cbranch_scc0 L_nl7
    buffer_load_dwordx4 v[144:147], v9, s[20:23], s48 offen sc1
    buffer_load_dwordx4 v[148:151], v9, s[20:23], s48 offen offset:1024 sc1
    buffer_load_dwordx4 v[152:155], v9, s[20:23], s48 offen offset:2048 sc1
    buffer_load_dwordx4 v[156:159], v9, s[20:23], s48 offen offset:3072 sc1
L_nl7:
    s_add_u32 s48, s48, 4096
    s_mov_b64 exec, 255
    buffer_load_dword v6, v3, s[20:23], s70 offen sc1
    s_mov_b64 exec, -1
    s_cmp_lg_u32 s68, s71
    s_cbranch_scc1 L_notfirst
    s_mov_b32 s64, 0xffff0000
    s_waitcnt lgkmcnt(0)
    v_lshlrev_b32 v160, 16, v208
    v_and_b32 v161, s64, v208
    v_lshlrev_b32 v162, 16, v209
    v_and_b32 v163, s64, v209
    v_lshlrev_b32 v164, 16, v210
    v_and_b32 v165, s64, v210
    v_lshlrev_b32 v166, 16, v211
    v_and_b32 v167, s64, v211
    v_lshlrev_b32 v168, 16, v212
    v_and_b32 v169, s64, v212
    v_lshlrev_b32 v170, 16, v213
    v_and_b32 v171, s64, v213
    v_lshlrev_b32 v172, 16, v214
    v_and_b32 v173, s64, v214
    v_lshlrev_b32 v174, 16, v215
    v_and_b32 v175, s64, v215
    v_lshlrev_b32 v176, 16, v216
    v_and_b32 v177, s64, v216
    v_lshlrev_b32 v178, 16, v217
    v_and_b32 v179, s64, v217
    v_lshlrev_b32 v180, 16, v218
    v_and_b32 v181, s64, v218
    v_lshlrev_b32 v182, 16, v219
    v_and_b32 v183, s64, v219
    v_lshlrev_b32 v184, 16, v220
    v_and_b32 v185, s64, v220
    v_lshlrev_b32 v186, 16, v221
    v_and_b32 v187, s64, v221
    v_lshlrev_b32 v188, 16, v222
    v_and_b32 v189, s64, v222
    v_lshlrev_b32 v190, 16, v223
    v_and_b32 v191, s64, v223
    s_mul_hi_u32 s64, s50, 477218589
    s_mul_i32 s65, s64, 9
    s_sub_u32 s65, s50, s65
    s_mul_i32 s66, s43, 96
    s_lshl_b32 s64, s64, 5
    s_add_u32 s66, s66, s64
    s_mul_i32 s66, s66, 2304
    s_mul_i32 s64, s45, 1152
    s_add_u32 s66, s66, s64
    s_lshl_b32 s65, s65, 7
    s_add_u32 s66, s66, s65
    v_and_b32 v4, 15, v8
    v_mul_u32_u24 v4, 2304, v4
    v_lshrrev_b32 v5, 5, v8
    v_lshl_add_u32 v4, v5, 4, v4
    v_bfe_u32 v5, v8, 4, 1
    v_lshl_add_u32 v4, v5, 5, v4
    v_add_u32 v5, 36864, v4
L_notfirst:
    s_or_b32 s68, s68, s69
    s_bitcmp1_b32 s69, 0
    s_cbranch_scc0 L_na0
    s_sub_u32 s49, s49, 1
    s_waitcnt vmcnt(13)
    s_cmp_gt_u32 s49, 2
    s_cbranch_scc1 L_w0
    s_waitcnt vmcnt(9)
    s_cmp_gt_u32 s49, 1
    s_cbranch_scc1 L_w0
    s_waitcnt vmcnt(5)
    s_cmp_gt_u32 s49, 0
    s_cbranch_scc1 L_w0
    s_waitcnt vmcnt(1)
L_w0:
    v_dot2c_f32_bf16 v160, s74, v32
    v_dot2c_f32_bf16 v161, s75, v32
    v_dot2c_f32_bf16 v162, s74, v33
    v_dot2c_f32_bf16 v163, s75, v33
    v_dot2c_f32_bf16 v164, s74, v34
    v_dot2c_f32_bf16 v165, s75, v34
    v_dot2c_f32_bf16 v166, s74, v35
    v_dot2c_f32_bf16 v167, s75, v35
    v_dot2c_f32_bf16 v168, s74, v36
    v_dot2c_f32_bf16 v169, s75, v36
    v_dot2c_f32_bf16 v170, s74, v37
    v_dot2c_f32_bf16 v171, s75, v37
    v_dot2c_f32_bf16 v172, s74, v38
    v_dot2c_f32_bf16 v173, s75, v38
    v_dot2c_f32_bf16 v174, s74, v39
    v_dot2c_f32_bf16 v175, s75, v39
    v_dot2c_f32_bf16 v176, s74, v40
    v_dot2c_f32_bf16 v177, s75, v40
    v_dot2c_f32_bf16 v178, s74, v41
    v_dot2c_f32_bf16 v179, s75, v41
    v_dot2c_f32_bf16 v180, s74, v42
    v_dot2c_f32_bf16 v181, s75, v42
    v_dot2c_f32_bf16 v182, s74, v43
    v_dot2c_f32_bf16 v183, s75, v43
    v_dot2c_f32_bf16 v184, s74, v44
    v_dot2c_f32_bf16 v185, s75, v44
    v_dot2c_f32_bf16 v186, s74, v45
    v_dot2c_f32_bf16 v187, s75, v45
    v_dot2c_f32_bf16 v188, s74, v46
    v_dot2c_f32_bf16 v189, s75, v46
    v_dot2c_f32_bf16 v190, s74, v47
    v_dot2c_f32_bf16 v191, s75, v47
L_na0:
    s_bitcmp1_b32 s69, 1
    s_cbranch_scc0 L_na1
    s_sub_u32 s49, s49, 1
    s_waitcnt vmcnt(13)
    s_cmp_gt_u32 s49, 2
    s_cbranch_scc1 L_w1
    s_waitcnt vmcnt(9)
    s_cmp_gt_u32 s49, 1
    s_cbranch_scc1 L_w1
    s_waitcnt vmcnt(5)
    s_cmp_gt_u32 s49, 0
    s_cbranch_scc1 L_w1
    s_waitcnt vmcnt(1)
L_w1:
    v_dot2c_f32_bf16 v160, s74, v48
    v_dot2c_f32_bf16 v161, s75, v48
    v_dot2c_f32_bf16 v162, s74, v49
    v_dot2c_f32_bf16 v163, s75, v49
    v_dot2c_f32_bf16 v164, s74, v50
    v_dot2c_f32_bf16 v165, s75, v50
    v_dot2c_f32_bf16 v166, s74, v51
    v_dot2c_f32_bf16 v167, s75, v51
    v_dot2c_f32_bf16 v168, s74, v52
    v_dot2c_f32_bf16 v169, s75, v52
    v_dot2c_f32_bf16 v170, s74, v53
    v_dot2c_f32_bf16 v171, s75, v53
    v_dot2c_f32_bf16 v172, s74, v54
    v_dot2c_f32_bf16 v173, s75, v54
    v_dot2c_f32_bf16 v174, s74, v55
    v_dot2c_f32_bf16 v175, s75, v55
    v_dot2c_f32_bf16 v176, s74, v56
    v_dot2c_f32_bf16 v177, s75, v56
    v_dot2c_f32_bf16 v178, s74, v57
    v_dot2c_f32_bf16 v179, s75, v57
    v_dot2c_f32_bf16 v180, s74, v58
    v_dot2c_f32_bf16 v181, s75, v58
    v_dot2c_f32_bf16 v182, s74, v59
    v_dot2c_f32_bf16 v183, s75, v59
    v_dot2c_f32_bf16 v184, s74, v60
    v_dot2c_f32_bf16 v185, s75, v60
    v_dot2c_f32_bf16 v186, s74, v61
    v_dot2c_f32_bf16 v187, s75, v61
    v_dot2c_f32_bf16 v188, s74, v62
    v_dot2c_f32_bf16 v189, s75, v62
    v_dot2c_f32_bf16 v190, s74, v63
    v_dot2c_f32_bf16 v191, s75, v63
L_na1:
    s_bitcmp1_b32 s69, 2
    s_cbranch_scc0 L_na2
    s_sub_u32 s49, s49, 1
    s_waitcnt vmcnt(13)
    s_cmp_gt_u32 s49, 2
    s_cbranch_scc1 L_w2
    s_waitcnt vmcnt(9)
    s_cmp_gt_u32 s49, 1
    s_cbranch_scc1 L_w2
    s_waitcnt vmcnt(5)
    s_cmp_gt_u32 s49, 0
    s_cbranch_scc1 L_w2
    s_waitcnt vmcnt(1)
L_w2:
    v_dot2c_f32_bf16 v160, s74, v64
    v_dot2c_f32_bf16 v161, s75, v64
    v_dot2c_f32_bf16 v162, s74, v65
    v_dot2c_f32_bf16 v163, s75, v65
    v_dot2c_f32_bf16 v164, s74, v66
    v_dot2c_f32_bf16 v165, s75, v66
    v_dot2c_f32_bf16 v166, s74, v67
    v_dot2c_f32_bf16 v167, s75, v67
    v_dot2c_f32_bf16 v168, s74, v68
    v_dot2c_f32_bf16 v169, s75, v68
    v_dot2c_f32_bf16 v170, s74, v69
    v_dot2c_f32_bf16 v171, s75, v69
    v_dot2c_f32_bf16 v172, s74, v70
    v_dot2c_f32_bf16 v173, s75, v70
    v_dot2c_f32_bf16 v174, s74, v71
    v_dot2c_f32_bf16 v175, s75, v71
    v_dot2c_f32_bf16 v176, s74, v72
    v_dot2c_f32_bf16 v177, s75, v72
    v_dot2c_f32_bf16 v178, s74, v73
    v_dot2c_f32_bf16 v179, s75, v73
    v_dot2c_f32_bf16 v180, s74, v74
    v_dot2c_f32_bf16 v181, s75, v74
    v_dot2c_f32_bf16 v182, s74, v75
    v_dot2c_f32_bf16 v183, s75, v75
    v_dot2c_f32_bf16 v184, s74, v76
    v_dot2c_f32_bf16 v185, s75, v76
    v_dot2c_f32_bf16 v186, s74, v77
    v_dot2c_f32_bf16 v187, s75, v77
    v_dot2c_f32_bf16 v188, s74, v78
    v_dot2c_f32_bf16 v189, s75, v78
    v_dot2c_f32_bf16 v190, s74, v79
    v_dot2c_f32_bf16 v191, s75, v79
L_na2:
    s_bitcmp1_b32 s69, 3
    s_cbranch_scc0 L_na3
    s_sub_u32 s49, s49, 1
    s_waitcnt vmcnt(13)
    s_cmp_gt_u32 s49, 2
    s_cbranch_scc1 L_w3
    s_waitcnt vmcnt(9)
    s_cmp_gt_u32 s49, 1
    s_cbranch_scc1 L_w3
    s_waitcnt vmcnt(5)
    s_cmp_gt_u32 s49, 0
    s_cbranch_scc1 L_w3
    s_waitcnt vmcnt(1)
L_w3:
    v_dot2c_f32_bf16 v160, s74, v80
    v_dot2c_f32_bf16 v161, s75, v80
    v_dot2c_f32_bf16 v162, s74, v81
    v_dot2c_f32_bf16 v163, s75, v81
    v_dot2c_f32_bf16 v164, s74, v82
    v_dot2c_f32_bf16 v165, s75, v82
    v_dot2c_f32_bf16 v166, s74, v83
    v_dot2c_f32_bf16 v167, s75, v83
    v_dot2c_f32_bf16 v168, s74, v84
    v_dot2c_f32_bf16 v169, s75, v84
    v_dot2c_f32_bf16 v170, s74, v85
    v_dot2c_f32_bf16 v171, s75, v85
    v_dot2c_f32_bf16 v172, s74, v86
    v_dot2c_f32_bf16 v173, s75, v86
    v_dot2c_f32_bf16 v174, s74, v87
    v_dot2c_f32_bf16 v175, s75, v87
    v_dot2c_f32_bf16 v176, s74, v88
    v_dot2c_f32_bf16 v177, s75, v88
    v_dot2c_f32_bf16 v178, s74, v89
    v_dot2c_f32_bf16 v179, s75, v89
    v_dot2c_f32_bf16 v180, s74, v90
    v_dot2c_f32_bf16 v181, s75, v90
    v_dot2c_f32_bf16 v182, s74, v91
    v_dot2c_f32_bf16 v183, s75, v91
    v_dot2c_f32_bf16 v184, s74, v92
    v_dot2c_f32_bf16 v185, s75, v92
    v_dot2c_f32_bf16 v186, s74, v93
    v_dot2c_f32_bf16 v187, s75, v93
    v_dot2c_f32_bf16 v188, s74, v94
    v_dot2c_f32_bf16 v189, s75, v94
    v_dot2c_f32_bf16 v190, s74, v95
    v_dot2c_f32_bf16 v191, s75, v95
L_na3:
    s_bitcmp1_b32 s69, 4
    s_cbranch_scc0 L_na4
    s_sub_u32 s49, s49, 1
    s_waitcnt vmcnt(13)
    s_cmp_gt_u32 s49, 2
    s_cbranch_scc1 L_w4
    s_waitcnt vmcnt(9)
    s_cmp_gt_u32 s49, 1
    s_cbranch_scc1 L_w4
    s_waitcnt vmcnt(5)
    s_cmp_gt_u32 s49, 0
    s_cbranch_scc1 L_w4
    s_waitcnt vmcnt(1)
L_w4:
    v_dot2c_f32_bf16 v160, s74, v96
    v_dot2c_f32_bf16 v161, s75, v96
    v_dot2c_f32_bf16 v162, s74, v97
    v_dot2c_f32_bf16 v163, s75, v97
    v_dot2c_f32_bf16 v164, s74, v98
    v_dot2c_f32_bf16 v165, s75, v98
    v_dot2c_f32_bf16 v166, s74, v99
    v_dot2c_f32_bf16 v167, s75, v99
    v_dot2c_f32_bf16 v168, s74, v100
    v_dot2c_f32_bf16 v169, s75, v100
    v_dot2c_f32_bf16 v170, s74, v101
    v_dot2c_f32_bf16 v171, s75, v101
    v_dot2c_f32_bf16 v172, s74, v102
    v_dot2c_f32_bf16 v173, s75, v102
    v_dot2c_f32_bf16 v174, s74, v103
    v_dot2c_f32_bf16 v175, s75, v103
    v_dot2c_f32_bf16 v176, s74, v104
    v_dot2c_f32_bf16 v177, s75, v104
    v_dot2c_f32_bf16 v178, s74, v105
    v_dot2c_f32_bf16 v179, s75, v105
    v_dot2c_f32_bf16 v180, s74, v106
    v_dot2c_f32_bf16 v181, s75, v106
    v_dot2c_f32_bf16 v182, s74, v107
    v_dot2c_f32_bf16 v183, s75, v107
    v_dot2c_f32_bf16 v184, s74, v108
    v_dot2c_f32_bf16 v185, s75, v108
    v_dot2c_f32_bf16 v186, s74, v109
    v_dot2c_f32_bf16 v187, s75, v109
    v_dot2c_f32_bf16 v188, s74, v110
    v_dot2c_f32_bf16 v189, s75, v110
    v_dot2c_f32_bf16 v190, s74, v111
    v_dot2c_f32_bf16 v191, s75, v111
L_na4:
    s_bitcmp1_b32 s69, 5
    s_cbranch_scc0 L_na5
    s_sub_u32 s49, s49, 1
    s_waitcnt vmcnt(13)
    s_cmp_gt_u32 s49, 2
    s_cbranch_scc1 L_w5
    s_waitcnt vmcnt(9)
    s_cmp_gt_u32 s49, 1
    s_cbranch_scc1 L_w5
    s_waitcnt vmcnt(5)
    s_cmp_gt_u32 s49, 0
    s_cbranch_scc1 L_w5
    s_waitcnt vmcnt(1)
L_w5:
    v_dot2c_f32_bf16 v160, s74, v112
    v_dot2c_f32_bf16 v161, s75, v112
    v_dot2c_f32_bf16 v162, s74, v113
    v_dot2c_f32_bf16 v163, s75, v113
    v_dot2c_f32_bf16 v164, s74, v114
    v_dot2c_f32_bf16 v165, s75, v114
    v_dot2c_f32_bf16 v166, s74, v115
    v_dot2c_f32_bf16 v167, s75, v115
    v_dot2c_f32_bf16 v168, s74, v116
    v_dot2c_f32_bf16 v169, s75, v116
    v_dot2c_f32_bf16 v170, s74, v117
    v_dot2c_f32_bf16 v171, s75, v117
    v_dot2c_f32_bf16 v172, s74, v118
    v_dot2c_f32_bf16 v173, s75, v118
    v_dot2c_f32_bf16 v174, s74, v119
    v_dot2c_f32_bf16 v175, s75, v119
    v_dot2c_f32_bf16 v176, s74, v120
    v_dot2c_f32_bf16 v177, s75, v120
    v_dot2c_f32_bf16 v178, s74, v121
    v_dot2c_f32_bf16 v179, s75, v121
    v_dot2c_f32_bf16 v180, s74, v122
    v_dot2c_f32_bf16 v181, s75, v122
    v_dot2c_f32_bf16 v182, s74, v123
    v_dot2c_f32_bf16 v183, s75, v123
    v_dot2c_f32_bf16 v184, s74, v124
    v_dot2c_f32_bf16 v185, s75, v124
    v_dot2c_f32_bf16 v186, s74, v125
    v_dot2c_f32_bf16 v187, s75, v125
    v_dot2c_f32_bf16 v188, s74, v126
    v_dot2c_f32_bf16 v189, s75, v126
    v_dot2c_f32_bf16 v190, s74, v127
    v_dot2c_f32_bf16 v191, s75, v127
L_na5:
    s_bitcmp1_b32 s69, 6
    s_cbranch_scc0 L_na6
    s_sub_u32 s49, s49, 1
    s_waitcnt vmcnt(13)
    s_cmp_gt_u32 s49, 2
    s_cbranch_scc1 L_w6
    s_waitcnt vmcnt(9)
    s_cmp_gt_u32 s49, 1
    s_cbranch_scc1 L_w6
    s_waitcnt vmcnt(5)
    s_cmp_gt_u32 s49, 0
    s_cbranch_scc1 L_w6
    s_waitcnt vmcnt(1)
L_w6:
    v_dot2c_f32_bf16 v160, s74, v128
    v_dot2c_f32_bf16 v161, s75, v128
    v_dot2c_f32_bf16 v162, s74, v129
    v_dot2c_f32_bf16 v163, s75, v129
    v_dot2c_f32_bf16 v164, s74, v130
    v_dot2c_f32_bf16 v165, s75, v130
    v_dot2c_f32_bf16 v166, s74, v131
    v_dot2c_f32_bf16 v167, s75, v131
    v_dot2c_f32_bf16 v168, s74, v132
    v_dot2c_f32_bf16 v169, s75, v132
    v_dot2c_f32_bf16 v170, s74, v133
    v_dot2c_f32_bf16 v171, s75, v133
    v_dot2c_f32_bf16 v172, s74, v134
    v_dot2c_f32_bf16 v173, s75, v134
    v_dot2c_f32_bf16 v174, s74, v135
    v_dot2c_f32_bf16 v175, s75, v135
    v_dot2c_f32_bf16 v176, s74, v136
    v_dot2c_f32_bf16 v177, s75, v136
    v_dot2c_f32_bf16 v178, s74, v137
    v_dot2c_f32_bf16 v179, s75, v137
    v_dot2c_f32_bf16 v180, s74, v138
    v_dot2c_f32_bf16 v181, s75, v138
    v_dot2c_f32_bf16 v182, s74, v139
    v_dot2c_f32_bf16 v183, s75, v139
    v_dot2c_f32_bf16 v184, s74, v140
    v_dot2c_f32_bf16 v185, s75, v140
    v_dot2c_f32_bf16 v186, s74, v141
    v_dot2c_f32_bf16 v187, s75, v141
    v_dot2c_f32_bf16 v188, s74, v142
    v_dot2c_f32_bf16 v189, s75, v142
    v_dot2c_f32_bf16 v190, s74, v143
    v_dot2c_f32_bf16 v191, s75, v143
L_na6:
    s_bitcmp1_b32 s69, 7
    s_cbranch_scc0 L_na7
    s_sub_u32 s49, s49, 1
    s_waitcnt vmcnt(13)
    s_cmp_gt_u32 s49, 2
    s_cbranch_scc1 L_w7
    s_waitcnt vmcnt(9)
    s_cmp_gt_u32 s49, 1
    s_cbranch_scc1 L_w7
    s_waitcnt vmcnt(5)
    s_cmp_gt_u32 s49, 0
    s_cbranch_scc1 L_w7
    s_waitcnt vmcnt(1)
L_w7:
    v_dot2c_f32_bf16 v160, s74, v144
    v_dot2c_f32_bf16 v161, s75, v144
    v_dot2c_f32_bf16 v162, s74, v145
    v_dot2c_f32_bf16 v163, s75, v145
    v_dot2c_f32_bf16 v164, s74, v146
    v_dot2c_f32_bf16 v165, s75, v146
    v_dot2c_f32_bf16 v166, s74, v147
    v_dot2c_f32_bf16 v167, s75, v147
    v_dot2c_f32_bf16 v168, s74, v148
    v_dot2c_f32_bf16 v169, s75, v148
    v_dot2c_f32_bf16 v170, s74, v149
    v_dot2c_f32_bf16 v171, s75, v149
    v_dot2c_f32_bf16 v172, s74, v150
    v_dot2c_f32_bf16 v173, s75, v150
    v_dot2c_f32_bf16 v174, s74, v151
    v_dot2c_f32_bf16 v175, s75, v151
    v_dot2c_f32_bf16 v176, s74, v152
    v_dot2c_f32_bf16 v177, s75, v152
    v_dot2c_f32_bf16 v178, s74, v153
    v_dot2c_f32_bf16 v179, s75, v153
    v_dot2c_f32_bf16 v180, s74, v154
    v_dot2c_f32_bf16 v181, s75, v154
    v_dot2c_f32_bf16 v182, s74, v155
    v_dot2c_f32_bf16 v183, s75, v155
    v_dot2c_f32_bf16 v184, s74, v156
    v_dot2c_f32_bf16 v185, s75, v156
    v_dot2c_f32_bf16 v186, s74, v157
    v_dot2c_f32_bf16 v187, s75, v157
    v_dot2c_f32_bf16 v188, s74, v158
    v_dot2c_f32_bf16 v189, s75, v158
    v_dot2c_f32_bf16 v190, s74, v159
    v_dot2c_f32_bf16 v191, s75, v159
L_na7:
    s_cmp_lg_u32 s68, 255
    s_cbranch_scc1 L_polled
    s_nop 1
    v_cvt_pk_bf16_f32 v192, v160, v161
    v_cvt_pk_bf16_f32 v193, v162, v163
    v_cvt_pk_bf16_f32 v194, v164, v165
    v_cvt_pk_bf16_f32 v195, v166, v167
    s_nop 1
    v_permlane16_swap_b32 v192, v194
    v_permlane16_swap_b32 v193, v195
    buffer_store_dwordx4 v[192:195], v4, s[56:59], s66 offen nt
    v_cvt_pk_bf16_f32 v196, v168, v169
    v_cvt_pk_bf16_f32 v197, v170, v171
    v_cvt_pk_bf16_f32 v198, v172, v173
    v_cvt_pk_bf16_f32 v199, v174, v175
    s_nop 1
    v_permlane16_swap_b32 v196, v198
    v_permlane16_swap_b32 v197, v199
    buffer_store_dwordx4 v[196:199], v4, s[56:59], s66 offen offset:64 nt
    v_cvt_pk_bf16_f32 v200, v176, v177
    v_cvt_pk_bf16_f32 v201, v178, v179
    v_cvt_pk_bf16_f32 v202, v180, v181
    v_cvt_pk_bf16_f32 v203, v182, v183
    s_nop 1
    v_permlane16_swap_b32 v200, v202
    v_permlane16_swap_b32 v201, v203
    buffer_store_dwordx4 v[200:203], v5, s[56:59], s66 offen nt
    v_cvt_pk_bf16_f32 v204, v184, v185
    v_cvt_pk_bf16_f32 v205, v186, v187
    v_cvt_pk_bf16_f32 v206, v188, v189
    v_cvt_pk_bf16_f32 v207, v190, v191
    s_nop 1
    v_permlane16_swap_b32 v204, v206
    v_permlane16_swap_b32 v205, v207
    buffer_store_dwordx4 v[204:207], v5, s[56:59], s66 offen offset:64 nt
L_done:
    s_endpgm
L_rare_t1:
    s_call_b64 s[98:99], L_rare_sub1
    s_branch L_back_t1
L_rare_t2:
    s_call_b64 s[98:99], L_rare_sub0
    s_branch L_back_t2
L_rare_t3:
    s_call_b64 s[98:99], L_rare_sub1
    s_branch L_back_t3
L_rare_t4:
    s_call_b64 s[98:99], L_rare_sub0
    s_branch L_back_t4
L_rare_t5:
    s_call_b64 s[98:99], L_rare_sub1
    s_branch L_back_t5
L_rare_t6:
    s_call_b64 s[98:99], L_rare_sub0
    s_branch L_back_t6
L_rare_t7:
    s_call_b64 s[98:99], L_rare_sub1
    s_branch L_back_t7
L_rare_t8:
    s_call_b64 s[98:99], L_rare_sub0
    s_branch L_back_t8
L_rare_t9:
    s_call_b64 s[98:99], L_rare_sub1
    s_branch L_back_t9
L_rare_t10:
    s_call_b64 s[98:99], L_rare_sub0
    s_branch L_back_t10
L_rare_t11:
    s_call_b64 s[98:99], L_rare_sub1
    s_branch L_back_t11
L_rare_t12:
    s_call_b64 s[98:99], L_rare_sub0
    s_branch L_back_t12
L_rare_t13:
    s_call_b64 s[98:99], L_rare_sub1
    s_branch L_back_t13
L_rare_t14:
    s_call_b64 s[98:99], L_rare_sub0
    s_branch L_back_t14
L_rare_t15:
    s_call_b64 s[98:99], L_rare_sub1
    s_branch L_back_t15
L_rare_t17:
    s_call_b64 s[98:99], L_rare_sub1
    s_branch L_back_t17
L_rare_t18:
    s_call_b64 s[98:99], L_rare_sub0
    s_branch L_back_t18
L_rare_t19:
    s_call_b64 s[98:99], L_rare_sub1
    s_branch L_back_t19
L_rare_t20:
    s_call_b64 s[98:99], L_rare_sub0
    s_branch L_back_t20
L_rare_t21:
    s_call_b64 s[98:99], L_rare_sub1
    s_branch L_back_t21
L_rare_t22:
    s_call_b64 s[98:99], L_rare_sub0
    s_branch L_back_t22
L_rare_t23:
    s_call_b64 s[98:99], L_rare_sub1
    s_branch L_back_t23
L_rare_t24:
    s_call_b64 s[98:99], L_rare_sub0
    s_branch L_back_t24
L_rare_t25:
    s_call_b64 s[98:99], L_rare_sub1
    s_branch L_back_t25
L_rare_t26:
    s_call_b64 s[98:99], L_rare_sub0
    s_branch L_back_t26
L_rare_t27:
    s_call_b64 s[98:99], L_rare_sub1
    s_branch L_back_t27
L_rare_t28:
    s_call_b64 s[98:99], L_rare_sub0
    s_branch L_back_t28
L_rare_t29:
    s_call_b64 s[98:99], L_rare_sub1
    s_branch L_back_t29
L_rare_t30:
    s_call_b64 s[98:99], L_rare_sub0
    s_branch L_back_t30
L_rare_t31:
    s_call_b64 s[98:99], L_rare_sub1
    s_branch L_back_t31
L_rare_t33:
    s_call_b64 s[98:99], L_rare_sub1
    s_branch L_back_t33
L_rare_t60:
    s_call_b64 s[98:99], L_rare_sub0
    s_branch L_back_t60
L_rare_t61:
    s_call_b64 s[98:99], L_rare_sub1
    s_branch L_back_t61
L_rare_t62:
    s_call_b64 s[98:99], L_rare_sub0
    s_branch L_back_t62
L_rare_t63:
    s_call_b64 s[98:99], L_rare_sub1
    s_branch L_back_t63
L_rare_sub0:
    s_nop 7
    v_max3_f32 v56, v64, v65, v66
    v_max3_f32 v57, v72, v73, v74
    v_max3_f32 v56, v56, v67, v68
    v_max3_f32 v57, v57, v75, v76
    v_max3_f32 v56, v56, v69, v70
    v_max3_f32 v57, v57, v77, v78
    v_max_f32 v56, v56, v71
    v_max_f32 v57, v57, v79
    v_mov_b32 v10, v56
    v_mov_b32 v58, v57
    s_nop 0
    v_permlane32_swap_b32 v10, v56
    v_permlane32_swap_b32 v58, v57
    v_max_f32 v56, v56, v10
    v_max_f32 v57, v57, v58
    v_mov_b32 v10, v56
    v_mov_b32 v58, v57
    s_nop 0
    v_permlane16_swap_b32 v10, v56
    v_permlane16_swap_b32 v58, v57
    v_max_f32 v56, v56, v10
    v_max_f32 v57, v57, v58
    v_max_f32 v56, 0, v56
    v_sub_f32 v64, v64, v56
    v_sub_f32 v65, v65, v56
    v_sub_f32 v66, v66, v56
    v_sub_f32 v67, v67, v56
    v_sub_f32 v68, v68, v56
    v_sub_f32 v69, v69, v56
    v_sub_f32 v70, v70, v56
    v_sub_f32 v71, v71, v56
    v_sub_f32 v48, v48, v56
    v_sub_f32 v49, v49, v56
    v_sub_f32 v50, v50, v56
    v_sub_f32 v51, v51, v56
    v_sub_f32 v10, 0, v56
    v_exp_f32 v10, v10
    s_nop 0
    v_mul_f32 v11, v11, v10
    v_mul_f32 v160, v160, v10
    v_mul_f32 v161, v161, v10
    v_mul_f32 v162, v162, v10
    v_mul_f32 v163, v163, v10
    v_mul_f32 v164, v164, v10
    v_mul_f32 v165, v165, v10
    v_mul_f32 v166, v166, v10
    v_mul_f32 v167, v167, v10
    v_mul_f32 v168, v168, v10
    v_mul_f32 v169, v169, v10
    v_mul_f32 v170, v170, v10
    v_mul_f32 v171, v171, v10
    v_mul_f32 v172, v172, v10
    v_mul_f32 v173, v173, v10
    v_mul_f32 v174, v174, v10
    v_mul_f32 v175, v175, v10
    v_mul_f32 v176, v176, v10
    v_mul_f32 v177, v177, v10
    v_mul_f32 v178, v178, v10
    v_mul_f32 v179, v179, v10
    v_mul_f32 v180, v180, v10
    v_mul_f32 v181, v181, v10
    v_mul_f32 v182, v182, v10
    v_mul_f32 v183, v183, v10
    v_mul_f32 v184, v184, v10
    v_mul_f32 v185, v185, v10
    v_mul_f32 v186, v186, v10
    v_mul_f32 v187, v187, v10
    v_mul_f32 v188, v188, v10
    v_mul_f32 v189, v189, v10
    v_mul_f32 v190, v190, v10
    v_mul_f32 v191, v191, v10
    v_max_f32 v57, 0, v57
    v_sub_f32 v72, v72, v57
    v_sub_f32 v73, v73, v57
    v_sub_f32 v74, v74, v57
    v_sub_f32 v75, v75, v57
    v_sub_f32 v76, v76, v57
    v_sub_f32 v77, v77, v57
    v_sub_f32 v78, v78, v57
    v_sub_f32 v79, v79, v57
    v_sub_f32 v52, v52, v57
    v_sub_f32 v53, v53, v57
    v_sub_f32 v54, v54, v57
    v_sub_f32 v55, v55, v57
    v_sub_f32 v10, 0, v57
    v_exp_f32 v10, v10
    s_nop 0
    v_mul_f32 v12, v12, v10
    v_mul_f32 v192, v192, v10
    v_mul_f32 v193, v193, v10
    v_mul_f32 v194, v194, v10
    v_mul_f32 v195, v195, v10
    v_mul_f32 v196, v196, v10
    v_mul_f32 v197, v197, v10
    v_mul_f32 v198, v198, v10
    v_mul_f32 v199, v199, v10
    v_mul_f32 v200, v200, v10
    v_mul_f32 v201, v201, v10
    v_mul_f32 v202, v202, v10
    v_mul_f32 v203, v203, v10
    v_mul_f32 v204, v204, v10
    v_mul_f32 v205, v205, v10
    v_mul_f32 v206, v206, v10
    v_mul_f32 v207, v207, v10
    v_mul_f32 v208, v208, v10
    v_mul_f32 v209, v209, v10
    v_mul_f32 v210, v210, v10
    v_mul_f32 v211, v211, v10
    v_mul_f32 v212, v212, v10
    v_mul_f32 v213, v213, v10
    v_mul_f32 v214, v214, v10
    v_mul_f32 v215, v215, v10
    v_mul_f32 v216, v216, v10
    v_mul_f32 v217, v217, v10
    v_mul_f32 v218, v218, v10
    v_mul_f32 v219, v219, v10
    v_mul_f32 v220, v220, v10
    v_mul_f32 v221, v221, v10
    v_mul_f32 v222, v222, v10
    v_mul_f32 v223, v223, v10
    s_nop 1
    s_setpc_b64 s[98:99]
L_rare_sub1:
    s_nop 7
    v_max3_f32 v56, v80, v81, v82
    v_max3_f32 v57, v88, v89, v90
    v_max3_f32 v56, v56, v83, v84
    v_max3_f32 v57, v57, v91, v92
    v_max3_f32 v56, v56, v85, v86
    v_max3_f32 v57, v57, v93, v94
    v_max_f32 v56, v56, v87
    v_max_f32 v57, v57, v95
    v_mov_b32 v10, v56
    v_mov_b32 v58, v57
    s_nop 0
    v_permlane32_swap_b32 v10, v56
    v_permlane32_swap_b32 v58, v57
    v_max_f32 v56, v56, v10
    v_max_f32 v57, v57, v58
    v_mov_b32 v10, v56
    v_mov_b32 v58, v57
    s_nop 0
    v_permlane16_swap_b32 v10, v56
    v_permlane16_swap_b32 v58, v57
    v_max_f32 v56, v56, v10
    v_max_f32 v57, v57, v58
    v_max_f32 v56, 0, v56
    v_sub_f32 v80, v80, v56
    v_sub_f32 v81, v81, v56
    v_sub_f32 v82, v82, v56
    v_sub_f32 v83, v83, v56
    v_sub_f32 v84, v84, v56
    v_sub_f32 v85, v85, v56
    v_sub_f32 v86, v86, v56
    v_sub_f32 v87, v87, v56
    v_sub_f32 v48, v48, v56
    v_sub_f32 v49, v49, v56
    v_sub_f32 v50, v50, v56
    v_sub_f32 v51, v51, v56
    v_sub_f32 v10, 0, v56
    v_exp_f32 v10, v10
    s_nop 0
    v_mul_f32 v11, v11, v10
    v_mul_f32 v160, v160, v10
    v_mul_f32 v161, v161, v10
    v_mul_f32 v162, v162, v10
    v_mul_f32 v163, v163, v10
    v_mul_f32 v164, v164, v10
    v_mul_f32 v165, v165, v10
    v_mul_f32 v166, v166, v10
    v_mul_f32 v167, v167, v10
    v_mul_f32 v168, v168, v10
    v_mul_f32 v169, v169, v10
    v_mul_f32 v170, v170, v10
    v_mul_f32 v171, v171, v10
    v_mul_f32 v172, v172, v10
    v_mul_f32 v173, v173, v10
    v_mul_f32 v174, v174, v10
    v_mul_f32 v175, v175, v10
    v_mul_f32 v176, v176, v10
    v_mul_f32 v177, v177, v10
    v_mul_f32 v178, v178, v10
    v_mul_f32 v179, v179, v10
    v_mul_f32 v180, v180, v10
    v_mul_f32 v181, v181, v10
    v_mul_f32 v182, v182, v10
    v_mul_f32 v183, v183, v10
    v_mul_f32 v184, v184, v10
    v_mul_f32 v185, v185, v10
    v_mul_f32 v186, v186, v10
    v_mul_f32 v187, v187, v10
    v_mul_f32 v188, v188, v10
    v_mul_f32 v189, v189, v10
    v_mul_f32 v190, v190, v10
    v_mul_f32 v191, v191, v10
    v_max_f32 v57, 0, v57
    v_sub_f32 v88, v88, v57
    v_sub_f32 v89, v89, v57
    v_sub_f32 v90, v90, v57
    v_sub_f32 v91, v91, v57
    v_sub_f32 v92, v92, v57
    v_sub_f32 v93, v93, v57
    v_sub_f32 v94, v94, v57
    v_sub_f32 v95, v95, v57
    v_sub_f32 v52, v52, v57
    v_sub_f32 v53, v53, v57
    v_sub_f32 v54, v54, v57
    v_sub_f32 v55, v55, v57
    v_sub_f32 v10, 0, v57
    v_exp_f32 v10, v10
    s_nop 0
    v_mul_f32 v12, v12, v10
    v_mul_f32 v192, v192, v10
    v_mul_f32 v193, v193, v10
    v_mul_f32 v194, v194, v10
    v_mul_f32 v195, v195, v10
    v_mul_f32 v196, v196, v10
    v_mul_f32 v197, v197, v10
    v_mul_f32 v198, v198, v10
    v_mul_f32 v199, v199, v10
    v_mul_f32 v200, v200, v10
    v_mul_f32 v201, v201, v10
    v_mul_f32 v202, v202, v10
    v_mul_f32 v203, v203, v10
    v_mul_f32 v204, v204, v10
    v_mul_f32 v205, v205, v10
    v_mul_f32 v206, v206, v10
    v_mul_f32 v207, v207, v10
    v_mul_f32 v208, v208, v10
    v_mul_f32 v209, v209, v10
    v_mul_f32 v210, v210, v10
    v_mul_f32 v211, v211, v10
    v_mul_f32 v212, v212, v10
    v_mul_f32 v213, v213, v10
    v_mul_f32 v214, v214, v10
    v_mul_f32 v215, v215, v10
    v_mul_f32 v216, v216, v10
    v_mul_f32 v217, v217, v10
    v_mul_f32 v218, v218, v10
    v_mul_f32 v219, v219, v10
    v_mul_f32 v220, v220, v10
    v_mul_f32 v221, v221, v10
    v_mul_f32 v222, v222, v10
    v_mul_f32 v223, v223, v10
    s_nop 1
    s_setpc_b64 s[98:99]
L_ow0:
    ds_write_b128 v61, v[168:171] offset:0
    ds_write_b128 v61, v[184:187] offset:1024
    ds_write_b128 v61, v[200:203] offset:2048
    ds_write_b128 v61, v[216:219] offset:3072
    s_branch L_owb0
L_ow1:
    ds_write_b128 v61, v[168:171] offset:0
    ds_write_b128 v61, v[184:187] offset:1024
    ds_write_b128 v61, v[200:203] offset:2048
    ds_write_b128 v61, v[216:219] offset:3072
    s_branch L_owb1
L_ow2:
    ds_write_b128 v61, v[168:171] offset:0
    ds_write_b128 v61, v[184:187] offset:1024
    ds_write_b128 v61, v[200:203] offset:2048
    ds_write_b128 v61, v[216:219] offset:3072
    s_branch L_owb2
L_ow3:
    ds_write_b128 v61, v[168:171] offset:0
    ds_write_b128 v61, v[184:187] offset:1024
    ds_write_b128 v61, v[200:203] offset:2048
    ds_write_b128 v61, v[216:219] offset:3072
    s_branch L_owb3
L_ow4:
    ds_write_b128 v61, v[168:171] offset:0
    ds_write_b128 v61, v[184:187] offset:1024
    ds_write_b128 v61, v[200:203] offset:2048
    ds_write_b128 v61, v[216:219] offset:3072
    s_branch L_owb4
L_ow5:
    ds_write_b128 v61, v[168:171] offset:0
    ds_write_b128 v61, v[184:187] offset:1024
    ds_write_b128 v61, v[200:203] offset:2048
    ds_write_b128 v61, v[216:219] offset:3072
    s_branch L_owb5
L_ow6:
    ds_write_b128 v61, v[168:171] offset:0
    ds_write_b128 v61, v[184:187] offset:1024
    ds_write_b128 v61, v[200:203] offset:2048
    ds_write_b128 v61, v[216:219] offset:3072
    s_branch L_owb6
L_ow7:
    ds_write_b128 v61, v[168:171] offset:0
    ds_write_b128 v61, v[184:187] offset:1024
    ds_write_b128 v61, v[200:203] offset:2048
    ds_write_b128 v61, v[216:219] offset:3072
    s_branch L_owb7
L_ow8:
    ds_write_b128 v61, v[168:171] offset:0
    ds_write_b128 v61, v[184:187] offset:1024
    ds_write_b128 v61, v[200:203] offset:2048
    ds_write_b128 v61, v[216:219] offset:3072
    s_branch L_owb8
L_qwave:
    v_mov_b32 v1, v104
    v_and_b32 v106, 15, v100
    v_lshlrev_b32 v4, 4, v106
    v_lshrrev_b32 v106, 5, v100
    v_lshl_add_u32 v4, v106, 8, v4
    v_bfe_u32 v106, v100, 4, 1
    v_lshl_add_u32 v4, v106, 3, v4
    v_add_u32 v4, 113152, v4
    v_subrev_u32 v11, 24576, v113
    v_add_u32 v12, 8192, v11
    v_add_u32 v3, 16384, v11
    v_add_u32 v6, 24576, v11
    s_lshr_b32 s52, s43, 2
    s_and_b32 s52, s52, 1
    s_lshl_b32 s53, s52, 12
    s_mov_b32 s51, 1
    s_mov_b32 s73, -1
    v_add_u32 v110, 26112, v101
    v_add_u32 v111, 69632, v101
    v_add_u32 v2, 137728, v101
    v_mov_b32 v15, v114
    s_load_dwordx2 s[56:57], s[0:1], 80
    s_load_dwordx2 s[60:61], s[0:1], 88
    s_lshl_b32 s54, s55, 3
    s_add_u32 s54, s54, s44
    s_lshl_b32 s54, s54, 8
    s_add_u32 s54, s54, 28311552
    v_lshlrev_b32 v106, 2, v100
    v_mov_b32 v107, 0
    v_mov_b32 v108, 65536
    buffer_store_dword v107, v106, s[20:23], s54 offen sc1
    s_waitcnt vmcnt(13) lgkmcnt(0)
    s_barrier
    ds_read_b128 a[0:3], v110 offset:0
    ds_read_b128 a[4:7], v110 offset:4352
    ds_read_b128 a[8:11], v110 offset:8704
    ds_read_b128 a[12:15], v110 offset:13056
    ds_read_b128 a[16:19], v110 offset:17408
    ds_read_b128 a[20:23], v110 offset:21760
    ds_read_b128 a[24:27], v110 offset:64
    ds_read_b128 a[28:31], v110 offset:4416
    ds_read_b128 a[32:35], v110 offset:8768
    ds_read_b128 a[36:39], v110 offset:13120
    ds_read_b128 a[40:43], v110 offset:17472
    ds_read_b128 a[44:47], v110 offset:21824
    ds_read_b128 a[48:51], v110 offset:128
    ds_read_b128 a[52:55], v110 offset:4480
    ds_read_b128 a[56:59], v110 offset:8832
    ds_read_b128 a[60:63], v110 offset:13184
    ds_read_b128 a[64:67], v110 offset:17536
    ds_read_b128 a[68:71], v110 offset:21888
    ds_read_b128 a[72:75], v110 offset:192
    ds_read_b128 a[76:79], v110 offset:4544
    ds_read_b128 a[80:83], v110 offset:8896
    ds_read_b128 a[84:87], v110 offset:13248
    ds_read_b128 a[88:91], v110 offset:17600
    ds_read_b128 a[92:95], v110 offset:21952
    s_add_u32 m0, s37, 121600
    s_nop 0
    buffer_load_dwordx4 v113, s[16:19], s29 offen  lds
    s_add_u32 m0, s37, 125696
    s_nop 0
    buffer_load_dwordx4 v113, s[16:19], s29 offen offset:128  lds
    s_add_u32 m0, s37, 78336
    s_add_u32 s29, s29, 262144
    buffer_load_dwordx4 v113, s[16:19], s29 offen  lds
    s_add_u32 m0, s37, 82432
    s_nop 0
    buffer_load_dwordx4 v113, s[16:19], s29 offen offset:128  lds
    s_add_u32 s29, s29, 262144
    s_waitcnt vmcnt(15) lgkmcnt(0)
    s_barrier
    s_add_u32 m0, s37, 87040
    s_nop 0
    buffer_load_dwordx4 v113, s[16:19], s29 offen  lds
    s_add_u32 m0, s37, 91136
    s_nop 0
    buffer_load_dwordx4 v113, s[16:19], s29 offen offset:128  lds
    s_add_u32 s29, s29, 262144
    s_add_u32 m0, s42, 26112
    s_add_u32 s50, s36, 512
    buffer_load_dwordx4 v105, s[24:27], s50 offen  lds
    s_add_u32 m0, s42, 27200
    s_add_u32 s50, s36, 5120
    buffer_load_dwordx4 v105, s[24:27], s50 offen  lds
    s_add_u32 m0, s42, 34816
    s_add_u32 s50, s36, 37376
    buffer_load_dwordx4 v105, s[24:27], s50 offen  lds
    s_add_u32 m0, s42, 35904
    s_add_u32 s50, s36, 41984
    buffer_load_dwordx4 v105, s[24:27], s50 offen  lds
    s_add_u32 m0, s42, 43520
    s_add_u32 s50, s36, 74240
    buffer_load_dwordx4 v105, s[24:27], s50 offen  lds
    s_add_u32 m0, s42, 44608
    s_add_u32 s50, s36, 78848
    buffer_load_dwordx4 v105, s[24:27], s50 offen  lds
    s_waitcnt vmcnt(21) lgkmcnt(0)
    s_barrier
    s_add_u32 m0, s37, 95744
    s_nop 0
    buffer_load_dwordx4 v113, s[16:19], s29 offen  lds
    s_add_u32 m0, s37, 99840
    s_nop 0
    buffer_load_dwordx4 v113, s[16:19], s29 offen offset:128  lds
    s_add_u32 s29, s29, 262144
    s_waitcnt vmcnt(14) lgkmcnt(0)
    s_barrier
    s_add_u32 m0, s37, 104448
    s_nop 0
    buffer_load_dwordx4 v113, s[16:19], s29 offen  lds
    s_add_u32 m0, s37, 108544
    s_nop 0
    buffer_load_dwordx4 v113, s[16:19], s29 offen offset:128  lds
    s_add_u32 m0, s37, 0
    s_add_u32 s29, s29, 262144
    buffer_load_dwordx4 v113, s[16:19], s29 offen  lds
    s_add_u32 m0, s37, 4096
    s_nop 0
    buffer_load_dwordx4 v113, s[16:19], s29 offen offset:128  lds
    s_add_u32 s29, s29, 262144
    s_mov_b32 s62, 256
    s_mov_b32 s63, 0x20000
    s_lshl_b32 s48, s55, 2
    s_mov_b64 exec, 1
    buffer_atomic_add v108, v107, s[60:63], s48 offen offset:128
    s_mov_b64 exec, -1
    s_waitcnt vmcnt(17) lgkmcnt(0)
    s_barrier
    ds_read_b128 a[96:99], v110 offset:26112
    ds_read_b128 a[100:103], v110 offset:30464
    ds_read_b128 a[104:107], v110 offset:34816
    ds_read_b128 a[108:111], v110 offset:39168
    ds_read_b128 a[112:115], v110 offset:43520
    ds_read_b128 a[116:119], v110 offset:47872
    ds_read_b128 a[120:123], v110 offset:26176
    ds_read_b128 a[124:127], v110 offset:30528
    ds_read_b128 a[128:131], v110 offset:34880
    ds_read_b128 a[132:135], v110 offset:39232
    ds_read_b128 a[136:139], v110 offset:43584
    ds_read_b128 a[140:143], v110 offset:47936
    ds_read_b128 a[144:147], v110 offset:26240
    ds_read_b128 a[148:151], v110 offset:30592
    ds_read_b128 a[152:155], v110 offset:34944
    ds_read_b128 a[156:159], v110 offset:39296
    ds_read_b128 a[160:163], v110 offset:43648
    ds_read_b128 a[164:167], v110 offset:48000
    ds_read_b128 a[168:171], v110 offset:26304
    ds_read_b128 a[172:175], v110 offset:30656
    ds_read_b128 a[176:179], v110 offset:35008
    ds_read_b128 a[180:183], v110 offset:39360
    ds_read_b128 a[184:187], v110 offset:43712
    ds_read_b128 a[188:191], v110 offset:48064
    s_add_u32 m0, s37, 8448
    s_nop 0
    buffer_load_dwordx4 v113, s[16:19], s29 offen  lds
    s_add_u32 m0, s37, 12544
    s_nop 0
    buffer_load_dwordx4 v113, s[16:19], s29 offen offset:128  lds
    s_add_u32 s29, s29, 262144
    s_waitcnt vmcnt(17) lgkmcnt(0)
    s_barrier
    s_add_u32 m0, s42, 52224
    s_add_u32 s50, s36, 768
    buffer_load_dwordx4 v112, s[24:27], s50 offen  lds
    s_add_u32 m0, s42, 53312
    s_add_u32 s50, s36, 5376
    buffer_load_dwordx4 v112, s[24:27], s50 offen  lds
    s_add_u32 m0, s42, 60928
    s_add_u32 s50, s36, 37632
    buffer_load_dwordx4 v112, s[24:27], s50 offen  lds
    s_add_u32 m0, s42, 62016
    s_add_u32 s50, s36, 42240
    buffer_load_dwordx4 v112, s[24:27], s50 offen  lds
    s_add_u32 m0, s42, 69632
    s_add_u32 s50, s36, 74496
    buffer_load_dwordx4 v112, s[24:27], s50 offen  lds
    s_add_u32 m0, s42, 70720
    s_add_u32 s50, s36, 79104
    buffer_load_dwordx4 v112, s[24:27], s50 offen  lds
    s_add_u32 m0, s37, 16896
    s_nop 0
    buffer_load_dwordx4 v113, s[16:19], s29 offen  lds
    s_add_u32 m0, s37, 20992
    s_nop 0
    buffer_load_dwordx4 v113, s[16:19], s29 offen offset:128  lds
    s_add_u32 s29, s29, 262144
    s_waitcnt vmcnt(23) lgkmcnt(0)
    s_barrier
    s_add_u32 m0, s37, 113152
    s_nop 0
    buffer_load_dwordx4 v113, s[16:19], s29 offen  lds
    s_add_u32 m0, s37, 117248
    s_nop 0
    buffer_load_dwordx4 v113, s[16:19], s29 offen offset:128  lds
    s_add_u32 s29, s29, 262144
    s_add_u32 m0, s42, 137728
    s_add_u32 s50, s36, 896
    buffer_load_dwordx4 v105, s[24:27], s50 offen  lds
    s_add_u32 m0, s42, 138816
    s_add_u32 s50, s36, 5504
    buffer_load_dwordx4 v105, s[24:27], s50 offen  lds
    s_add_u32 m0, s42, 146432
    s_add_u32 s50, s36, 37760
    buffer_load_dwordx4 v105, s[24:27], s50 offen  lds
    s_add_u32 m0, s42, 147520
    s_add_u32 s50, s36, 42368
    buffer_load_dwordx4 v105, s[24:27], s50 offen  lds
    s_add_u32 m0, s42, 155136
    s_add_u32 s50, s36, 74624
    buffer_load_dwordx4 v105, s[24:27], s50 offen  lds
    s_add_u32 m0, s42, 156224
    s_add_u32 s50, s36, 79232
    buffer_load_dwordx4 v105, s[24:27], s50 offen  lds
    s_waitcnt vmcnt(23) lgkmcnt(0)
    s_barrier
    s_add_u32 m0, s37, 121600
    s_nop 0
    buffer_load_dwordx4 v113, s[16:19], s29 offen  lds
    s_add_u32 m0, s37, 125696
    s_nop 0
    buffer_load_dwordx4 v113, s[16:19], s29 offen offset:128  lds
    s_add_u32 s29, s29, 262144
    s_waitcnt vmcnt(23) lgkmcnt(0)
    s_barrier
    ds_read_b128 a[192:195], v110 offset:0
    ds_read_b128 a[196:199], v110 offset:4352
    ds_read_b128 a[200:203], v110 offset:8704
    ds_read_b128 a[204:207], v110 offset:13056
    ds_read_b128 a[208:211], v110 offset:17408
    ds_read_b128 a[212:215], v110 offset:21760
    ds_read_b128 a[216:219], v110 offset:64
    ds_read_b128 a[220:223], v110 offset:4416
    ds_read_b128 a[224:227], v110 offset:8768
    ds_read_b128 a[228:231], v110 offset:13120
    ds_read_b128 a[232:235], v110 offset:17472
    ds_read_b128 a[236:239], v110 offset:21824
    ds_read_b128 a[240:243], v110 offset:128
    ds_read_b128 a[244:247], v110 offset:4480
    ds_read_b128 a[248:251], v110 offset:8832
    ds_read_b128 a[252:255], v110 offset:13184
    ds_read_b128 v[176:179], v110 offset:17536
    ds_read_b128 v[180:183], v110 offset:21888
    ds_read_b128 v[184:187], v110 offset:192
    ds_read_b128 v[188:191], v110 offset:4544
    ds_read_b128 v[192:195], v110 offset:8896
    ds_read_b128 v[196:199], v110 offset:13248
    ds_read_b128 v[200:203], v110 offset:17600
    ds_read_b128 v[204:207], v110 offset:21952
    s_add_u32 m0, s37, 87040
    s_nop 0
    buffer_load_dwordx4 v113, s[16:19], s29 offen  lds
    s_add_u32 m0, s37, 91136
    s_nop 0
    buffer_load_dwordx4 v113, s[16:19], s29 offen offset:128  lds
    s_add_u32 s29, s29, 262144
    s_waitcnt vmcnt(23) lgkmcnt(0)
    s_barrier
    s_add_u32 m0, s37, 104448
    s_nop 0
    buffer_load_dwordx4 v113, s[16:19], s29 offen  lds
    s_add_u32 m0, s37, 108544
    s_nop 0
    buffer_load_dwordx4 v113, s[16:19], s29 offen offset:128  lds
    s_add_u32 m0, s37, 34816
    s_add_u32 s29, s29, 262144
    buffer_load_dwordx4 v113, s[16:19], s29 offen  lds
    s_add_u32 m0, s37, 38912
    s_nop 0
    buffer_load_dwordx4 v113, s[16:19], s29 offen offset:128  lds
    s_add_u32 s29, s29, 262144
    s_waitcnt vmcnt(24) lgkmcnt(0)
    s_barrier
    s_add_u32 m0, s37, 95744
    s_nop 0
    buffer_load_dwordx4 v113, s[16:19], s29 offen  lds
    s_add_u32 m0, s37, 99840
    s_nop 0
    buffer_load_dwordx4 v113, s[16:19], s29 offen offset:128  lds
    s_add_u32 m0, s40, 26112
    s_add_u32 s29, s29, 262144
    buffer_load_dwordx4 v7, s[4:7], s32 offen nt lds
    s_add_u32 m0, s40, 26176
    s_nop 0
    buffer_load_dwordx4 v7, s[4:7], s32 offen offset:1024 nt lds
    s_add_u32 s32, s32, 8192
    s_waitcnt vmcnt(20) lgkmcnt(0)
    s_barrier
    s_waitcnt vmcnt(18) lgkmcnt(0)
    s_barrier
    ds_read_b128 v[208:211], v110 offset:26112
    ds_read_b128 v[212:215], v110 offset:30464
    ds_read_b128 v[216:219], v110 offset:34816
    ds_read_b128 v[220:223], v110 offset:39168
    ds_read_b128 v[224:227], v110 offset:43520
    ds_read_b128 v[228:231], v110 offset:47872
    ds_read_b128 v[232:235], v110 offset:26176
    ds_read_b128 v[236:239], v110 offset:30528
    ds_read_b128 v[240:243], v110 offset:34880
    ds_read_b128 v[244:247], v110 offset:39232
    ds_read_b128 v[248:251], v110 offset:43584
    ds_read_b128 v[252:255], v110 offset:47936
    s_add_u32 s51, s51, 1
    s_lshr_b32 s49, s51, 1
    s_lshl_b32 s48, s49, 2
    s_lshr_b32 s48, s41, s48
    s_and_b32 s48, s48, 3
    s_lshl_b32 s49, s44, 2
    s_add_u32 s48, s48, s49
    s_lshl_b32 s48, s48, 8
    s_xor_b32 s49, s51, s52
    s_and_b32 s49, s49, 1
    s_lshl_b32 s49, s49, 7
    s_add_u32 s35, s48, s49
    s_cmp_ge_u32 s51, 8
    s_cselect_b32 s18, 0, s18
    s_mov_b32 m0, 0
    s_nop 0
    buffer_load_dwordx4 v11, s[16:19], s35 offen  lds
    s_mov_b32 m0, 1056
    s_nop 0
    buffer_load_dwordx4 v12, s[16:19], s35 offen  lds
    s_mov_b32 m0, 2112
    s_nop 0
    buffer_load_dwordx4 v3, s[16:19], s35 offen  lds
    s_mov_b32 m0, 3168
    s_nop 0
    buffer_load_dwordx4 v6, s[16:19], s35 offen  lds
    s_mov_b32 m0, 4224
    s_add_u32 s35, s35, 262144
    buffer_load_dwordx4 v11, s[16:19], s35 offen  lds
    s_mov_b32 m0, 5280
    s_nop 0
    buffer_load_dwordx4 v12, s[16:19], s35 offen  lds
    s_mov_b32 m0, 6336
    s_nop 0
    buffer_load_dwordx4 v3, s[16:19], s35 offen  lds
    s_mov_b32 m0, 7392
    s_nop 0
    buffer_load_dwordx4 v6, s[16:19], s35 offen  lds
    s_add_u32 s35, s35, 262144
    s_waitcnt vmcnt(18) lgkmcnt(0)
    s_barrier
    s_add_u32 m0, s40, 52224
    s_nop 0
    buffer_load_dwordx4 v7, s[4:7], s32 offen nt lds
    s_add_u32 m0, s40, 52288
    s_nop 0
    buffer_load_dwordx4 v7, s[4:7], s32 offen offset:1024 nt lds
    s_add_u32 s32, s32, 8192
    s_add_u32 m0, s39, 69632
    s_nop 0
    buffer_load_dwordx4 v8, s[8:11], s33 offen nt lds
    s_add_u32 m0, s39, 70432
    s_nop 0
    buffer_load_dwordx4 v8, s[8:11], s33 offen offset:256 nt lds
    s_add_u32 s33, s33, 8192
    s_waitcnt vmcnt(20) lgkmcnt(0)
    s_barrier
    s_mov_b32 m0, 8448
    s_nop 0
    buffer_load_dwordx4 v11, s[16:19], s35 offen  lds
    s_mov_b32 m0, 9504
    s_nop 0
    buffer_load_dwordx4 v12, s[16:19], s35 offen  lds
    s_mov_b32 m0, 10560
    s_nop 0
    buffer_load_dwordx4 v3, s[16:19], s35 offen  lds
    s_mov_b32 m0, 11616
    s_nop 0
    buffer_load_dwordx4 v6, s[16:19], s35 offen  lds
    s_mov_b32 m0, 12672
    s_add_u32 s35, s35, 262144
    buffer_load_dwordx4 v11, s[16:19], s35 offen  lds
    s_mov_b32 m0, 13728
    s_nop 0
    buffer_load_dwordx4 v12, s[16:19], s35 offen  lds
    s_mov_b32 m0, 14784
    s_nop 0
    buffer_load_dwordx4 v3, s[16:19], s35 offen  lds
    s_mov_b32 m0, 15840
    s_nop 0
    buffer_load_dwordx4 v6, s[16:19], s35 offen  lds
    s_add_u32 m0, s40, 78336
    s_add_u32 s35, s35, 262144
    buffer_load_dwordx4 v7, s[4:7], s32 offen nt lds
    s_add_u32 m0, s40, 78400
    s_nop 0
    buffer_load_dwordx4 v7, s[4:7], s32 offen offset:1024 nt lds
    s_add_u32 s32, s32, 8192
    s_waitcnt vmcnt(28) lgkmcnt(0)
    s_barrier
    s_mov_b32 m0, 16896
    s_nop 0
    buffer_load_dwordx4 v11, s[16:19], s35 offen  lds
    s_mov_b32 m0, 17952
    s_nop 0
    buffer_load_dwordx4 v12, s[16:19], s35 offen  lds
    s_mov_b32 m0, 19008
    s_nop 0
    buffer_load_dwordx4 v3, s[16:19], s35 offen  lds
    s_mov_b32 m0, 20064
    s_nop 0
    buffer_load_dwordx4 v6, s[16:19], s35 offen  lds
    s_mov_b32 m0, 21120
    s_add_u32 s35, s35, 262144
    buffer_load_dwordx4 v11, s[16:19], s35 offen  lds
    s_mov_b32 m0, 22176
    s_nop 0
    buffer_load_dwordx4 v12, s[16:19], s35 offen  lds
    s_mov_b32 m0, 23232
    s_nop 0
    buffer_load_dwordx4 v3, s[16:19], s35 offen  lds
    s_mov_b32 m0, 24288
    s_nop 0
    buffer_load_dwordx4 v6, s[16:19], s35 offen  lds
    s_add_u32 s35, s35, 262144
    s_waitcnt vmcnt(34) lgkmcnt(0)
    s_barrier
    s_waitcnt vmcnt(32) lgkmcnt(0)
    s_barrier
    s_waitcnt vmcnt(26)
    ds_read_b64_tr_b16 v[16:17], v1 offset:0
    ds_read_b64_tr_b16 v[18:19], v1 offset:256
    ds_read_b64_tr_b16 v[20:21], v1 offset:32
    ds_read_b64_tr_b16 v[22:23], v1 offset:288
    ds_read_b64_tr_b16 v[24:25], v1 offset:64
    ds_read_b64_tr_b16 v[26:27], v1 offset:320
    ds_read_b64_tr_b16 v[28:29], v1 offset:96
    ds_read_b64_tr_b16 v[30:31], v1 offset:352
L_qround:
    s_waitcnt vmcnt(14) lgkmcnt(0)
    s_barrier
    s_nop 0
    v_mfma_f32_16x16x32_bf16 v[80:83], v[16:19], a[0:3], 0
    s_waitcnt vmcnt(22)
    s_lshl_b32 s48, s73, 2
    s_lshr_b32 s48, s41, s48
    s_and_b32 s48, s48, 3
    s_lshl_b32 s49, s44, 2
    s_add_u32 s48, s48, s49
    s_mul_i32 s34, s48, 147456
    s_cmp_ge_i32 s73, 0
    s_cselect_b32 s14, 4718592, 0
    s_add_u32 m0, s39, 87040
    s_add_u32 s73, s73, 1
    buffer_load_dwordx4 v9, s[12:15], s34 offen  lds
    v_mfma_f32_16x16x32_bf16 v[84:87], v[20:23], a[0:3], 0
    ds_read_b64_tr_b16 v[32:33], v1 offset:4224
    s_mov_b32 m0, 0
    v_mfma_f32_16x16x32_bf16 v[88:91], v[24:27], a[0:3], 0
    buffer_load_dwordx4 v11, s[16:19], s35 offen  lds
    v_mfma_f32_16x16x32_bf16 v[92:95], v[28:31], a[0:3], 0
    ds_read_b64_tr_b16 v[34:35], v1 offset:4480
    v_mfma_f32_16x16x32_bf16 v[96:99], v[16:19], a[4:7], 0
    v_mfma_f32_16x16x32_bf16 v[100:103], v[20:23], a[4:7], 0
    ds_read_b64_tr_b16 v[36:37], v1 offset:4256
    v_mfma_f32_16x16x32_bf16 v[104:107], v[24:27], a[4:7], 0
    v_mfma_f32_16x16x32_bf16 v[108:111], v[28:31], a[4:7], 0
    s_add_u32 m0, s39, 86944
    ds_read_b64_tr_b16 v[38:39], v1 offset:4512
    buffer_load_dwordx4 v9, s[12:15], s34 offen offset:1152  lds
    s_mov_b32 m0, 1056
    v_mfma_f32_16x16x32_bf16 v[112:115], v[16:19], a[8:11], 0
    buffer_load_dwordx4 v12, s[16:19], s35 offen  lds
    v_mfma_f32_16x16x32_bf16 v[116:119], v[20:23], a[8:11], 0
    ds_read_b64_tr_b16 v[40:41], v1 offset:4288
    v_mfma_f32_16x16x32_bf16 v[120:123], v[24:27], a[8:11], 0
    v_mfma_f32_16x16x32_bf16 v[124:127], v[28:31], a[8:11], 0
    ds_read_b64_tr_b16 v[42:43], v1 offset:4544
    v_mfma_f32_16x16x32_bf16 v[128:131], v[16:19], a[12:15], 0
    v_mfma_f32_16x16x32_bf16 v[132:135], v[20:23], a[12:15], 0
    ds_read_b64_tr_b16 v[44:45], v1 offset:4320
    s_mov_b32 m0, 2112
    v_mfma_f32_16x16x32_bf16 v[136:139], v[24:27], a[12:15], 0
    buffer_load_dwordx4 v3, s[16:19], s35 offen  lds
    v_mfma_f32_16x16x32_bf16 v[140:143], v[28:31], a[12:15], 0
    ds_read_b64_tr_b16 v[46:47], v1 offset:4576
    v_mfma_f32_16x16x32_bf16 v[144:147], v[16:19], a[16:19], 0
    s_add_u32 m0, s39, 95744
    s_add_u32 s34, s34, 73728
    buffer_load_dwordx4 v8, s[8:11], s33 offen nt lds
    v_mfma_f32_16x16x32_bf16 v[148:151], v[20:23], a[16:19], 0
    v_mfma_f32_16x16x32_bf16 v[152:155], v[24:27], a[16:19], 0
    v_mfma_f32_16x16x32_bf16 v[156:159], v[28:31], a[16:19], 0
    s_mov_b32 m0, 3168
    v_mfma_f32_16x16x32_bf16 v[160:163], v[16:19], a[20:23], 0
    buffer_load_dwordx4 v6, s[16:19], s35 offen  lds
    s_add_u32 s35, s35, 262144
    v_mfma_f32_16x16x32_bf16 v[164:167], v[20:23], a[20:23], 0
    v_mfma_f32_16x16x32_bf16 v[168:171], v[24:27], a[20:23], 0
    v_mfma_f32_16x16x32_bf16 v[172:175], v[28:31], a[20:23], 0
    s_waitcnt lgkmcnt(0)
    v_mfma_f32_16x16x32_bf16 v[80:83], v[32:35], a[24:27], v[80:83]
    s_waitcnt vmcnt(21)
    s_add_u32 m0, s39, 96544
    s_nop 0
    buffer_load_dwordx4 v8, s[8:11], s33 offen offset:256 nt lds
    v_mfma_f32_16x16x32_bf16 v[84:87], v[36:39], a[24:27], v[84:87]
    ds_read_b64_tr_b16 v[16:17], v1 offset:8448
    s_mov_b32 m0, 4224
    v_mfma_f32_16x16x32_bf16 v[88:91], v[40:43], a[24:27], v[88:91]
    buffer_load_dwordx4 v11, s[16:19], s35 offen  lds
    v_mfma_f32_16x16x32_bf16 v[92:95], v[44:47], a[24:27], v[92:95]
    ds_read_b64_tr_b16 v[18:19], v1 offset:8704
    v_mfma_f32_16x16x32_bf16 v[96:99], v[32:35], a[28:31], v[96:99]
    v_mfma_f32_16x16x32_bf16 v[100:103], v[36:39], a[28:31], v[100:103]
    ds_read_b64_tr_b16 v[20:21], v1 offset:8480
    v_mfma_f32_16x16x32_bf16 v[104:107], v[40:43], a[28:31], v[104:107]
    v_mfma_f32_16x16x32_bf16 v[108:111], v[44:47], a[28:31], v[108:111]
    ds_read_b64_tr_b16 v[22:23], v1 offset:8736
    s_mov_b32 m0, 5280
    v_mfma_f32_16x16x32_bf16 v[112:115], v[32:35], a[32:35], v[112:115]
    buffer_load_dwordx4 v12, s[16:19], s35 offen  lds
    v_mfma_f32_16x16x32_bf16 v[116:119], v[36:39], a[32:35], v[116:119]
    ds_read_b64_tr_b16 v[24:25], v1 offset:8512
    s_add_u32 m0, s40, 104448
    s_add_u32 s33, s33, 8192
    buffer_load_dwordx4 v7, s[4:7], s32 offen nt lds
    v_mfma_f32_16x16x32_bf16 v[120:123], v[40:43], a[32:35], v[120:123]
    v_mfma_f32_16x16x32_bf16 v[124:127], v[44:47], a[32:35], v[124:127]
    ds_read_b64_tr_b16 v[26:27], v1 offset:8768
    v_mfma_f32_16x16x32_bf16 v[128:131], v[32:35], a[36:39], v[128:131]
    v_mfma_f32_16x16x32_bf16 v[132:135], v[36:39], a[36:39], v[132:135]
    ds_read_b64_tr_b16 v[28:29], v1 offset:8544
    s_mov_b32 m0, 6336
    v_mfma_f32_16x16x32_bf16 v[136:139], v[40:43], a[36:39], v[136:139]
    buffer_load_dwordx4 v3, s[16:19], s35 offen  lds
    v_mfma_f32_16x16x32_bf16 v[140:143], v[44:47], a[36:39], v[140:143]
    ds_read_b64_tr_b16 v[30:31], v1 offset:8800
    v_mfma_f32_16x16x32_bf16 v[144:147], v[32:35], a[40:43], v[144:147]
    s_add_u32 m0, s40, 104512
    v_mfma_f32_16x16x32_bf16 v[148:151], v[36:39], a[40:43], v[148:151]
    buffer_load_dwordx4 v7, s[4:7], s32 offen offset:1024 nt lds
    s_add_u32 s32, s32, 8192
    v_mfma_f32_16x16x32_bf16 v[152:155], v[40:43], a[40:43], v[152:155]
    v_mfma_f32_16x16x32_bf16 v[156:159], v[44:47], a[40:43], v[156:159]
    s_mov_b32 m0, 7392
    v_mfma_f32_16x16x32_bf16 v[160:163], v[32:35], a[44:47], v[160:163]
    buffer_load_dwordx4 v6, s[16:19], s35 offen  lds
    s_add_u32 s35, s35, 262144
    v_mfma_f32_16x16x32_bf16 v[164:167], v[36:39], a[44:47], v[164:167]
    v_mfma_f32_16x16x32_bf16 v[168:171], v[40:43], a[44:47], v[168:171]
    v_mfma_f32_16x16x32_bf16 v[172:175], v[44:47], a[44:47], v[172:175]
    s_waitcnt lgkmcnt(0)
    v_mfma_f32_16x16x32_bf16 v[80:83], v[16:19], a[48:51], v[80:83]
    s_waitcnt vmcnt(24)
    v_mfma_f32_16x16x32_bf16 v[84:87], v[20:23], a[48:51], v[84:87]
    ds_read_b64_tr_b16 v[32:33], v1 offset:12672
    s_mov_b32 m0, 8448
    v_mfma_f32_16x16x32_bf16 v[88:91], v[24:27], a[48:51], v[88:91]
    buffer_load_dwordx4 v11, s[16:19], s35 offen  lds
    v_mfma_f32_16x16x32_bf16 v[92:95], v[28:31], a[48:51], v[92:95]
    ds_read_b64_tr_b16 v[34:35], v1 offset:12928
    v_mfma_f32_16x16x32_bf16 v[96:99], v[16:19], a[52:55], v[96:99]
    v_mfma_f32_16x16x32_bf16 v[100:103], v[20:23], a[52:55], v[100:103]
    ds_read_b64_tr_b16 v[36:37], v1 offset:12704
    v_mfma_f32_16x16x32_bf16 v[104:107], v[24:27], a[52:55], v[104:107]
    v_mfma_f32_16x16x32_bf16 v[108:111], v[28:31], a[52:55], v[108:111]
    ds_read_b64_tr_b16 v[38:39], v1 offset:12960
    s_mov_b32 m0, 9504
    v_mfma_f32_16x16x32_bf16 v[112:115], v[16:19], a[56:59], v[112:115]
    buffer_load_dwordx4 v12, s[16:19], s35 offen  lds
    v_mfma_f32_16x16x32_bf16 v[116:119], v[20:23], a[56:59], v[116:119]
    ds_read_b64_tr_b16 v[40:41], v1 offset:12736
    v_mfma_f32_16x16x32_bf16 v[120:123], v[24:27], a[56:59], v[120:123]
    v_mfma_f32_16x16x32_bf16 v[124:127], v[28:31], a[56:59], v[124:127]
    ds_read_b64_tr_b16 v[42:43], v1 offset:12992
    v_mfma_f32_16x16x32_bf16 v[128:131], v[16:19], a[60:63], v[128:131]
    v_mfma_f32_16x16x32_bf16 v[132:135], v[20:23], a[60:63], v[132:135]
    ds_read_b64_tr_b16 v[44:45], v1 offset:12768
    s_mov_b32 m0, 10560
    v_mfma_f32_16x16x32_bf16 v[136:139], v[24:27], a[60:63], v[136:139]
    buffer_load_dwordx4 v3, s[16:19], s35 offen  lds
    s_waitcnt vmcnt(19)
    s_barrier
    v_mfma_f32_16x16x32_bf16 v[140:143], v[28:31], a[60:63], v[140:143]
    s_add_u32 m0, s39, 26112
    ds_read_b64_tr_b16 v[46:47], v1 offset:13024
    buffer_load_dwordx4 v9, s[12:15], s34 offen  lds
    v_mfma_f32_16x16x32_bf16 v[144:147], v[16:19], a[64:67], v[144:147]
    v_mfma_f32_16x16x32_bf16 v[148:151], v[20:23], a[64:67], v[148:151]
    v_mfma_f32_16x16x32_bf16 v[152:155], v[24:27], a[64:67], v[152:155]
    v_mfma_f32_16x16x32_bf16 v[156:159], v[28:31], a[64:67], v[156:159]
    s_mov_b32 m0, 11616
    v_mfma_f32_16x16x32_bf16 v[160:163], v[16:19], a[68:71], v[160:163]
    buffer_load_dwordx4 v6, s[16:19], s35 offen  lds
    s_add_u32 s35, s35, 262144
    v_mfma_f32_16x16x32_bf16 v[164:167], v[20:23], a[68:71], v[164:167]
    v_mfma_f32_16x16x32_bf16 v[168:171], v[24:27], a[68:71], v[168:171]
    v_mfma_f32_16x16x32_bf16 v[172:175], v[28:31], a[68:71], v[172:175]
    s_waitcnt lgkmcnt(0)
    v_mfma_f32_16x16x32_bf16 v[80:83], v[32:35], a[72:75], v[80:83]
    s_waitcnt vmcnt(23)
    v_mfma_f32_16x16x32_bf16 v[84:87], v[36:39], a[72:75], v[84:87]
    s_add_u32 m0, s39, 26016
    ds_read_b64_tr_b16 v[16:17], v1 offset:16896
    buffer_load_dwordx4 v9, s[12:15], s34 offen offset:1152  lds
    s_mov_b32 m0, 12672
    v_mfma_f32_16x16x32_bf16 v[88:91], v[40:43], a[72:75], v[88:91]
    buffer_load_dwordx4 v11, s[16:19], s35 offen  lds
    v_mfma_f32_16x16x32_bf16 v[92:95], v[44:47], a[72:75], v[92:95]
    ds_read_b64_tr_b16 v[18:19], v1 offset:17152
    v_mfma_f32_16x16x32_bf16 v[96:99], v[32:35], a[76:79], v[96:99]
    v_mfma_f32_16x16x32_bf16 v[100:103], v[36:39], a[76:79], v[100:103]
    ds_read_b64_tr_b16 v[20:21], v1 offset:16928
    v_mfma_f32_16x16x32_bf16 v[104:107], v[40:43], a[76:79], v[104:107]
    v_mfma_f32_16x16x32_bf16 v[108:111], v[44:47], a[76:79], v[108:111]
    ds_read_b64_tr_b16 v[22:23], v1 offset:17184
    s_mov_b32 m0, 13728
    v_mfma_f32_16x16x32_bf16 v[112:115], v[32:35], a[80:83], v[112:115]
    buffer_load_dwordx4 v12, s[16:19], s35 offen  lds
    v_mfma_f32_16x16x32_bf16 v[116:119], v[36:39], a[80:83], v[116:119]
    ds_read_b64_tr_b16 v[24:25], v1 offset:16960
    v_mfma_f32_16x16x32_bf16 v[120:123], v[40:43], a[80:83], v[120:123]
    v_mfma_f32_16x16x32_bf16 v[124:127], v[44:47], a[80:83], v[124:127]
    ds_read_b64_tr_b16 v[26:27], v1 offset:17216
    v_mfma_f32_16x16x32_bf16 v[128:131], v[32:35], a[84:87], v[128:131]
    v_mfma_f32_16x16x32_bf16 v[132:135], v[36:39], a[84:87], v[132:135]
    ds_read_b64_tr_b16 v[28:29], v1 offset:16992
    s_add_u32 m0, s39, 34816
    s_sub_u32 s34, s34, 73600
    buffer_load_dwordx4 v8, s[8:11], s33 offen nt lds
    s_mov_b32 m0, 14784
    v_mfma_f32_16x16x32_bf16 v[136:139], v[40:43], a[84:87], v[136:139]
    buffer_load_dwordx4 v3, s[16:19], s35 offen  lds
    v_mfma_f32_16x16x32_bf16 v[140:143], v[44:47], a[84:87], v[140:143]
    ds_read_b64_tr_b16 v[30:31], v1 offset:17248
    v_mfma_f32_16x16x32_bf16 v[144:147], v[32:35], a[88:91], v[144:147]
    v_mfma_f32_16x16x32_bf16 v[148:151], v[36:39], a[88:91], v[148:151]
    v_mfma_f32_16x16x32_bf16 v[152:155], v[40:43], a[88:91], v[152:155]
    v_mfma_f32_16x16x32_bf16 v[156:159], v[44:47], a[88:91], v[156:159]
    s_mov_b32 m0, 15840
    v_mfma_f32_16x16x32_bf16 v[160:163], v[32:35], a[92:95], v[160:163]
    buffer_load_dwordx4 v6, s[16:19], s35 offen  lds
    s_add_u32 s35, s35, 262144
    v_mfma_f32_16x16x32_bf16 v[164:167], v[36:39], a[92:95], v[164:167]
    v_mfma_f32_16x16x32_bf16 v[168:171], v[40:43], a[92:95], v[168:171]
    v_mfma_f32_16x16x32_bf16 v[172:175], v[44:47], a[92:95], v[172:175]
    s_waitcnt lgkmcnt(0)
    v_mfma_f32_16x16x32_bf16 v[80:83], v[16:19], a[96:99], v[80:83]
    s_waitcnt vmcnt(25)
    v_mfma_f32_16x16x32_bf16 v[84:87], v[20:23], a[96:99], v[84:87]
    s_add_u32 m0, s39, 35616
    ds_read_b64_tr_b16 v[32:33], v1 offset:21120
    buffer_load_dwordx4 v8, s[8:11], s33 offen offset:256 nt lds
    s_mov_b32 m0, 16896
    v_mfma_f32_16x16x32_bf16 v[88:91], v[24:27], a[96:99], v[88:91]
    buffer_load_dwordx4 v11, s[16:19], s35 offen  lds
    v_mfma_f32_16x16x32_bf16 v[92:95], v[28:31], a[96:99], v[92:95]
    ds_read_b64_tr_b16 v[34:35], v1 offset:21376
    v_mfma_f32_16x16x32_bf16 v[96:99], v[16:19], a[100:103], v[96:99]
    v_mfma_f32_16x16x32_bf16 v[100:103], v[20:23], a[100:103], v[100:103]
    ds_read_b64_tr_b16 v[36:37], v1 offset:21152
    v_mfma_f32_16x16x32_bf16 v[104:107], v[24:27], a[100:103], v[104:107]
    v_mfma_f32_16x16x32_bf16 v[108:111], v[28:31], a[100:103], v[108:111]
    ds_read_b64_tr_b16 v[38:39], v1 offset:21408
    s_mov_b32 m0, 17952
    v_mfma_f32_16x16x32_bf16 v[112:115], v[16:19], a[104:107], v[112:115]
    buffer_load_dwordx4 v12, s[16:19], s35 offen  lds
    v_mfma_f32_16x16x32_bf16 v[116:119], v[20:23], a[104:107], v[116:119]
    ds_read_b64_tr_b16 v[40:41], v1 offset:21184
    v_mfma_f32_16x16x32_bf16 v[120:123], v[24:27], a[104:107], v[120:123]
    v_mfma_f32_16x16x32_bf16 v[124:127], v[28:31], a[104:107], v[124:127]
    ds_read_b64_tr_b16 v[42:43], v1 offset:21440
    v_mfma_f32_16x16x32_bf16 v[128:131], v[16:19], a[108:111], v[128:131]
    s_add_u32 m0, s40, 43520
    s_add_u32 s33, s33, 8192
    buffer_load_dwordx4 v7, s[4:7], s32 offen nt lds
    v_mfma_f32_16x16x32_bf16 v[132:135], v[20:23], a[108:111], v[132:135]
    ds_read_b64_tr_b16 v[44:45], v1 offset:21216
    s_mov_b32 m0, 19008
    v_mfma_f32_16x16x32_bf16 v[136:139], v[24:27], a[108:111], v[136:139]
    buffer_load_dwordx4 v3, s[16:19], s35 offen  lds
    v_mfma_f32_16x16x32_bf16 v[140:143], v[28:31], a[108:111], v[140:143]
    ds_read_b64_tr_b16 v[46:47], v1 offset:21472
    v_mfma_f32_16x16x32_bf16 v[144:147], v[16:19], a[112:115], v[144:147]
    v_mfma_f32_16x16x32_bf16 v[148:151], v[20:23], a[112:115], v[148:151]
    v_mfma_f32_16x16x32_bf16 v[152:155], v[24:27], a[112:115], v[152:155]
    v_mfma_f32_16x16x32_bf16 v[156:159], v[28:31], a[112:115], v[156:159]
    s_mov_b32 m0, 20064
    v_mfma_f32_16x16x32_bf16 v[160:163], v[16:19], a[116:119], v[160:163]
    buffer_load_dwordx4 v6, s[16:19], s35 offen  lds
    s_add_u32 s35, s35, 262144
    v_mfma_f32_16x16x32_bf16 v[164:167], v[20:23], a[116:119], v[164:167]
    v_mfma_f32_16x16x32_bf16 v[168:171], v[24:27], a[116:119], v[168:171]
    v_mfma_f32_16x16x32_bf16 v[172:175], v[28:31], a[116:119], v[172:175]
    s_waitcnt lgkmcnt(0)
    v_mfma_f32_16x16x32_bf16 v[80:83], v[32:35], a[120:123], v[80:83]
    s_waitcnt vmcnt(24)
    s_add_u32 m0, s40, 43584
    s_nop 0
    buffer_load_dwordx4 v7, s[4:7], s32 offen offset:1024 nt lds
    s_add_u32 s32, s32, 8192
    v_mfma_f32_16x16x32_bf16 v[84:87], v[36:39], a[120:123], v[84:87]
    ds_read_b64_tr_b16 v[16:17], v1 offset:0
    s_mov_b32 m0, 21120
    v_mfma_f32_16x16x32_bf16 v[88:91], v[40:43], a[120:123], v[88:91]
    buffer_load_dwordx4 v11, s[16:19], s35 offen  lds
    v_mfma_f32_16x16x32_bf16 v[92:95], v[44:47], a[120:123], v[92:95]
    ds_read_b64_tr_b16 v[18:19], v1 offset:256
    v_mfma_f32_16x16x32_bf16 v[96:99], v[32:35], a[124:127], v[96:99]
    v_mfma_f32_16x16x32_bf16 v[100:103], v[36:39], a[124:127], v[100:103]
    ds_read_b64_tr_b16 v[20:21], v1 offset:32
    v_mfma_f32_16x16x32_bf16 v[104:107], v[40:43], a[124:127], v[104:107]
    v_mfma_f32_16x16x32_bf16 v[108:111], v[44:47], a[124:127], v[108:111]
    ds_read_b64_tr_b16 v[22:23], v1 offset:288
    s_mov_b32 m0, 22176
    v_mfma_f32_16x16x32_bf16 v[112:115], v[32:35], a[128:131], v[112:115]
    buffer_load_dwordx4 v12, s[16:19], s35 offen  lds
    v_mfma_f32_16x16x32_bf16 v[116:119], v[36:39], a[128:131], v[116:119]
    ds_read_b64_tr_b16 v[24:25], v1 offset:64
    v_mfma_f32_16x16x32_bf16 v[120:123], v[40:43], a[128:131], v[120:123]
    v_mfma_f32_16x16x32_bf16 v[124:127], v[44:47], a[128:131], v[124:127]
    ds_read_b64_tr_b16 v[26:27], v1 offset:320
    v_mfma_f32_16x16x32_bf16 v[128:131], v[32:35], a[132:135], v[128:131]
    v_mfma_f32_16x16x32_bf16 v[132:135], v[36:39], a[132:135], v[132:135]
    ds_read_b64_tr_b16 v[28:29], v1 offset:96
    s_mov_b32 m0, 23232
    v_mfma_f32_16x16x32_bf16 v[136:139], v[40:43], a[132:135], v[136:139]
    buffer_load_dwordx4 v3, s[16:19], s35 offen  lds
    v_mfma_f32_16x16x32_bf16 v[140:143], v[44:47], a[132:135], v[140:143]
    ds_read_b64_tr_b16 v[30:31], v1 offset:352
    v_mfma_f32_16x16x32_bf16 v[144:147], v[32:35], a[136:139], v[144:147]
    v_mfma_f32_16x16x32_bf16 v[148:151], v[36:39], a[136:139], v[148:151]
    v_mfma_f32_16x16x32_bf16 v[152:155], v[40:43], a[136:139], v[152:155]
    v_mfma_f32_16x16x32_bf16 v[156:159], v[44:47], a[136:139], v[156:159]
    s_mov_b32 m0, 24288
    v_mfma_f32_16x16x32_bf16 v[160:163], v[32:35], a[140:143], v[160:163]
    buffer_load_dwordx4 v6, s[16:19], s35 offen  lds
    s_add_u32 s35, s35, 262144
    v_mfma_f32_16x16x32_bf16 v[164:167], v[36:39], a[140:143], v[164:167]
    v_mfma_f32_16x16x32_bf16 v[168:171], v[40:43], a[140:143], v[168:171]
    v_mfma_f32_16x16x32_bf16 v[172:175], v[44:47], a[140:143], v[172:175]
    s_waitcnt lgkmcnt(0)
    v_mfma_f32_16x16x32_bf16 v[80:83], v[16:19], a[144:147], v[80:83]
    s_waitcnt vmcnt(22)
    v_mfma_f32_16x16x32_bf16 v[84:87], v[20:23], a[144:147], v[84:87]
    ds_read_b64_tr_b16 v[32:33], v1 offset:4224
    s_mov_b32 m0, 0
    v_mfma_f32_16x16x32_bf16 v[88:91], v[24:27], a[144:147], v[88:91]
    buffer_load_dwordx4 v11, s[16:19], s35 offen  lds
    v_mfma_f32_16x16x32_bf16 v[92:95], v[28:31], a[144:147], v[92:95]
    ds_read_b64_tr_b16 v[34:35], v1 offset:4480
    v_mfma_f32_16x16x32_bf16 v[96:99], v[16:19], a[148:151], v[96:99]
    v_mfma_f32_16x16x32_bf16 v[100:103], v[20:23], a[148:151], v[100:103]
    ds_read_b64_tr_b16 v[36:37], v1 offset:4256
    s_nop 0
    s_barrier
    s_add_u32 m0, s39, 52224
    v_mfma_f32_16x16x32_bf16 v[104:107], v[24:27], a[148:151], v[104:107]
    buffer_load_dwordx4 v9, s[12:15], s34 offen  lds
    v_mfma_f32_16x16x32_bf16 v[108:111], v[28:31], a[148:151], v[108:111]
    ds_read_b64_tr_b16 v[38:39], v1 offset:4512
    s_mov_b32 m0, 1056
    v_mfma_f32_16x16x32_bf16 v[112:115], v[16:19], a[152:155], v[112:115]
    buffer_load_dwordx4 v12, s[16:19], s35 offen  lds
    v_mfma_f32_16x16x32_bf16 v[116:119], v[20:23], a[152:155], v[116:119]
    ds_read_b64_tr_b16 v[40:41], v1 offset:4288
    v_mfma_f32_16x16x32_bf16 v[120:123], v[24:27], a[152:155], v[120:123]
    v_mfma_f32_16x16x32_bf16 v[124:127], v[28:31], a[152:155], v[124:127]
    ds_read_b64_tr_b16 v[42:43], v1 offset:4544
    v_mfma_f32_16x16x32_bf16 v[128:131], v[16:19], a[156:159], v[128:131]
    v_mfma_f32_16x16x32_bf16 v[132:135], v[20:23], a[156:159], v[132:135]
    s_add_u32 m0, s39, 52128
    ds_read_b64_tr_b16 v[44:45], v1 offset:4320
    buffer_load_dwordx4 v9, s[12:15], s34 offen offset:1152  lds
    s_mov_b32 m0, 2112
    v_mfma_f32_16x16x32_bf16 v[136:139], v[24:27], a[156:159], v[136:139]
    buffer_load_dwordx4 v3, s[16:19], s35 offen  lds
    v_mfma_f32_16x16x32_bf16 v[140:143], v[28:31], a[156:159], v[140:143]
    ds_read_b64_tr_b16 v[46:47], v1 offset:4576
    v_mfma_f32_16x16x32_bf16 v[144:147], v[16:19], a[160:163], v[144:147]
    v_mfma_f32_16x16x32_bf16 v[148:151], v[20:23], a[160:163], v[148:151]
    v_mfma_f32_16x16x32_bf16 v[152:155], v[24:27], a[160:163], v[152:155]
    v_mfma_f32_16x16x32_bf16 v[156:159], v[28:31], a[160:163], v[156:159]
    s_mov_b32 m0, 3168
    v_mfma_f32_16x16x32_bf16 v[160:163], v[16:19], a[164:167], v[160:163]
    buffer_load_dwordx4 v6, s[16:19], s35 offen  lds
    s_add_u32 s35, s35, 262144
    v_mfma_f32_16x16x32_bf16 v[164:167], v[20:23], a[164:167], v[164:167]
    s_add_u32 m0, s39, 60928
    s_add_u32 s34, s34, 73728
    buffer_load_dwordx4 v9, s[12:15], s34 offen  lds
    v_mfma_f32_16x16x32_bf16 v[168:171], v[24:27], a[164:167], v[168:171]
    v_mfma_f32_16x16x32_bf16 v[172:175], v[28:31], a[164:167], v[172:175]
    s_waitcnt lgkmcnt(0)
    v_mfma_f32_16x16x32_bf16 v[80:83], v[32:35], a[168:171], v[80:83]
    s_waitcnt vmcnt(24)
    v_mfma_f32_16x16x32_bf16 v[84:87], v[36:39], a[168:171], v[84:87]
    ds_read_b64_tr_b16 v[16:17], v1 offset:8448
    s_mov_b32 m0, 4224
    v_mfma_f32_16x16x32_bf16 v[88:91], v[40:43], a[168:171], v[88:91]
    buffer_load_dwordx4 v11, s[16:19], s35 offen  lds
    v_mfma_f32_16x16x32_bf16 v[92:95], v[44:47], a[168:171], v[92:95]
    ds_read_b64_tr_b16 v[18:19], v1 offset:8704
    v_mfma_f32_16x16x32_bf16 v[96:99], v[32:35], a[172:175], v[96:99]
    v_mfma_f32_16x16x32_bf16 v[100:103], v[36:39], a[172:175], v[100:103]
    s_add_u32 m0, s39, 60832
    ds_read_b64_tr_b16 v[20:21], v1 offset:8480
    buffer_load_dwordx4 v9, s[12:15], s34 offen offset:1152  lds
    v_mfma_f32_16x16x32_bf16 v[104:107], v[40:43], a[172:175], v[104:107]
    v_mfma_f32_16x16x32_bf16 v[108:111], v[44:47], a[172:175], v[108:111]
    ds_read_b64_tr_b16 v[22:23], v1 offset:8736
    s_mov_b32 m0, 5280
    v_mfma_f32_16x16x32_bf16 v[112:115], v[32:35], a[176:179], v[112:115]
    buffer_load_dwordx4 v12, s[16:19], s35 offen  lds
    v_mfma_f32_16x16x32_bf16 v[116:119], v[36:39], a[176:179], v[116:119]
    ds_read_b64_tr_b16 v[24:25], v1 offset:8512
    v_mfma_f32_16x16x32_bf16 v[120:123], v[40:43], a[176:179], v[120:123]
    v_mfma_f32_16x16x32_bf16 v[124:127], v[44:47], a[176:179], v[124:127]
    ds_read_b64_tr_b16 v[26:27], v1 offset:8768
    v_mfma_f32_16x16x32_bf16 v[128:131], v[32:35], a[180:183], v[128:131]
    s_add_u32 m0, s39, 69632
    s_sub_u32 s34, s34, 73600
    buffer_load_dwordx4 v8, s[8:11], s33 offen nt lds
    v_mfma_f32_16x16x32_bf16 v[132:135], v[36:39], a[180:183], v[132:135]
    ds_read_b64_tr_b16 v[28:29], v1 offset:8544
    s_mov_b32 m0, 6336
    v_mfma_f32_16x16x32_bf16 v[136:139], v[40:43], a[180:183], v[136:139]
    buffer_load_dwordx4 v3, s[16:19], s35 offen  lds
    v_mfma_f32_16x16x32_bf16 v[140:143], v[44:47], a[180:183], v[140:143]
    ds_read_b64_tr_b16 v[30:31], v1 offset:8800
    v_mfma_f32_16x16x32_bf16 v[144:147], v[32:35], a[184:187], v[144:147]
    v_mfma_f32_16x16x32_bf16 v[148:151], v[36:39], a[184:187], v[148:151]
    v_mfma_f32_16x16x32_bf16 v[152:155], v[40:43], a[184:187], v[152:155]
    s_add_u32 m0, s39, 70432
    v_mfma_f32_16x16x32_bf16 v[156:159], v[44:47], a[184:187], v[156:159]
    buffer_load_dwordx4 v8, s[8:11], s33 offen offset:256 nt lds
    s_add_u32 s33, s33, 8192
    s_mov_b32 m0, 7392
    v_mfma_f32_16x16x32_bf16 v[160:163], v[32:35], a[188:191], v[160:163]
    buffer_load_dwordx4 v6, s[16:19], s35 offen  lds
    s_add_u32 s35, s35, 262144
    v_mfma_f32_16x16x32_bf16 v[164:167], v[36:39], a[188:191], v[164:167]
    v_mfma_f32_16x16x32_bf16 v[168:171], v[40:43], a[188:191], v[168:171]
    v_mfma_f32_16x16x32_bf16 v[172:175], v[44:47], a[188:191], v[172:175]
    s_waitcnt lgkmcnt(0)
    v_mfma_f32_16x16x32_bf16 v[80:83], v[16:19], a[192:195], v[80:83]
    s_waitcnt vmcnt(25)
    v_mfma_f32_16x16x32_bf16 v[84:87], v[20:23], a[192:195], v[84:87]
    ds_read_b64_tr_b16 v[32:33], v1 offset:12672
    s_mov_b32 m0, 8448
    v_mfma_f32_16x16x32_bf16 v[88:91], v[24:27], a[192:195], v[88:91]
    buffer_load_dwordx4 v11, s[16:19], s35 offen  lds
    v_mfma_f32_16x16x32_bf16 v[92:95], v[28:31], a[192:195], v[92:95]
    ds_read_b64_tr_b16 v[34:35], v1 offset:12928
    v_mfma_f32_16x16x32_bf16 v[96:99], v[16:19], a[196:199], v[96:99]
    v_mfma_f32_16x16x32_bf16 v[100:103], v[20:23], a[196:199], v[100:103]
    ds_read_b64_tr_b16 v[36:37], v1 offset:12704
    v_mfma_f32_16x16x32_bf16 v[104:107], v[24:27], a[196:199], v[104:107]
    v_mfma_f32_16x16x32_bf16 v[108:111], v[28:31], a[196:199], v[108:111]
    ds_read_b64_tr_b16 v[38:39], v1 offset:12960
    s_mov_b32 m0, 9504
    v_mfma_f32_16x16x32_bf16 v[112:115], v[16:19], a[200:203], v[112:115]
    buffer_load_dwordx4 v12, s[16:19], s35 offen  lds
    v_mfma_f32_16x16x32_bf16 v[116:119], v[20:23], a[200:203], v[116:119]
    ds_read_b64_tr_b16 v[40:41], v1 offset:12736
    v_mfma_f32_16x16x32_bf16 v[120:123], v[24:27], a[200:203], v[120:123]
    v_mfma_f32_16x16x32_bf16 v[124:127], v[28:31], a[200:203], v[124:127]
    ds_read_b64_tr_b16 v[42:43], v1 offset:12992
    v_mfma_f32_16x16x32_bf16 v[128:131], v[16:19], a[204:207], v[128:131]
    v_mfma_f32_16x16x32_bf16 v[132:135], v[20:23], a[204:207], v[132:135]
    ds_read_b64_tr_b16 v[44:45], v1 offset:12768
    s_mov_b32 m0, 10560
    v_mfma_f32_16x16x32_bf16 v[136:139], v[24:27], a[204:207], v[136:139]
    buffer_load_dwordx4 v3, s[16:19], s35 offen  lds
    v_mfma_f32_16x16x32_bf16 v[140:143], v[28:31], a[204:207], v[140:143]
    ds_read_b64_tr_b16 v[46:47], v1 offset:13024
    s_waitcnt vmcnt(27)
    s_barrier
    s_add_u32 m0, s40, 78336
    v_mfma_f32_16x16x32_bf16 v[144:147], v[16:19], a[208:211], v[144:147]
    buffer_load_dwordx4 v7, s[4:7], s32 offen nt lds
    v_mfma_f32_16x16x32_bf16 v[148:151], v[20:23], a[208:211], v[148:151]
    v_mfma_f32_16x16x32_bf16 v[152:155], v[24:27], a[208:211], v[152:155]
    v_mfma_f32_16x16x32_bf16 v[156:159], v[28:31], a[208:211], v[156:159]
    s_mov_b32 m0, 11616
    v_mfma_f32_16x16x32_bf16 v[160:163], v[16:19], a[212:215], v[160:163]
    buffer_load_dwordx4 v6, s[16:19], s35 offen  lds
    s_add_u32 s35, s35, 262144
    v_mfma_f32_16x16x32_bf16 v[164:167], v[20:23], a[212:215], v[164:167]
    v_mfma_f32_16x16x32_bf16 v[168:171], v[24:27], a[212:215], v[168:171]
    s_add_u32 m0, s40, 78400
    v_mfma_f32_16x16x32_bf16 v[172:175], v[28:31], a[212:215], v[172:175]
    buffer_load_dwordx4 v7, s[4:7], s32 offen offset:1024 nt lds
    s_waitcnt lgkmcnt(0)
    v_mfma_f32_16x16x32_bf16 v[80:83], v[32:35], a[216:219], v[80:83]
    s_waitcnt vmcnt(25)
    v_mfma_f32_16x16x32_bf16 v[84:87], v[36:39], a[216:219], v[84:87]
    ds_read_b64_tr_b16 v[16:17], v1 offset:16896
    s_mov_b32 m0, 12672
    v_mfma_f32_16x16x32_bf16 v[88:91], v[40:43], a[216:219], v[88:91]
    buffer_load_dwordx4 v11, s[16:19], s35 offen  lds
    v_mfma_f32_16x16x32_bf16 v[92:95], v[44:47], a[216:219], v[92:95]
    ds_read_b64_tr_b16 v[18:19], v1 offset:17152
    v_mfma_f32_16x16x32_bf16 v[96:99], v[32:35], a[220:223], v[96:99]
    v_mfma_f32_16x16x32_bf16 v[100:103], v[36:39], a[220:223], v[100:103]
    ds_read_b64_tr_b16 v[20:21], v1 offset:16928
    v_mfma_f32_16x16x32_bf16 v[104:107], v[40:43], a[220:223], v[104:107]
    s_add_u32 m0, s39, 87040
    s_add_u32 s32, s32, 8192
    buffer_load_dwordx4 v9, s[12:15], s34 offen  lds
    v_mfma_f32_16x16x32_bf16 v[108:111], v[44:47], a[220:223], v[108:111]
    ds_read_b64_tr_b16 v[22:23], v1 offset:17184
    s_mov_b32 m0, 13728
    v_mfma_f32_16x16x32_bf16 v[112:115], v[32:35], a[224:227], v[112:115]
    buffer_load_dwordx4 v12, s[16:19], s35 offen  lds
    v_mfma_f32_16x16x32_bf16 v[116:119], v[36:39], a[224:227], v[116:119]
    ds_read_b64_tr_b16 v[24:25], v1 offset:16960
    v_mfma_f32_16x16x32_bf16 v[120:123], v[40:43], a[224:227], v[120:123]
    v_mfma_f32_16x16x32_bf16 v[124:127], v[44:47], a[224:227], v[124:127]
    ds_read_b64_tr_b16 v[26:27], v1 offset:17216
    v_mfma_f32_16x16x32_bf16 v[128:131], v[32:35], a[228:231], v[128:131]
    v_mfma_f32_16x16x32_bf16 v[132:135], v[36:39], a[228:231], v[132:135]
    s_add_u32 m0, s39, 86944
    ds_read_b64_tr_b16 v[28:29], v1 offset:16992
    buffer_load_dwordx4 v9, s[12:15], s34 offen offset:1152  lds
    s_mov_b32 m0, 14784
    v_mfma_f32_16x16x32_bf16 v[136:139], v[40:43], a[228:231], v[136:139]
    buffer_load_dwordx4 v3, s[16:19], s35 offen  lds
    v_mfma_f32_16x16x32_bf16 v[140:143], v[44:47], a[228:231], v[140:143]
    ds_read_b64_tr_b16 v[30:31], v1 offset:17248
    v_mfma_f32_16x16x32_bf16 v[144:147], v[32:35], a[232:235], v[144:147]
    v_mfma_f32_16x16x32_bf16 v[148:151], v[36:39], a[232:235], v[148:151]
    v_mfma_f32_16x16x32_bf16 v[152:155], v[40:43], a[232:235], v[152:155]
    v_mfma_f32_16x16x32_bf16 v[156:159], v[44:47], a[232:235], v[156:159]
    s_mov_b32 m0, 15840
    v_mfma_f32_16x16x32_bf16 v[160:163], v[32:35], a[236:239], v[160:163]
    buffer_load_dwordx4 v6, s[16:19], s35 offen  lds
    s_add_u32 s35, s35, 262144
    v_mfma_f32_16x16x32_bf16 v[164:167], v[36:39], a[236:239], v[164:167]
    s_add_u32 m0, s39, 95744
    s_add_u32 s34, s34, 73728
    buffer_load_dwordx4 v8, s[8:11], s33 offen nt lds
    v_mfma_f32_16x16x32_bf16 v[168:171], v[40:43], a[236:239], v[168:171]
    v_mfma_f32_16x16x32_bf16 v[172:175], v[44:47], a[236:239], v[172:175]
    s_waitcnt lgkmcnt(0)
    v_mfma_f32_16x16x32_bf16 v[80:83], v[16:19], a[240:243], v[80:83]
    s_waitcnt vmcnt(27)
    v_mfma_f32_16x16x32_bf16 v[84:87], v[20:23], a[240:243], v[84:87]
    ds_read_b64_tr_b16 v[32:33], v1 offset:21120
    s_mov_b32 m0, 16896
    v_mfma_f32_16x16x32_bf16 v[88:91], v[24:27], a[240:243], v[88:91]
    buffer_load_dwordx4 v11, s[16:19], s35 offen  lds
    v_mfma_f32_16x16x32_bf16 v[92:95], v[28:31], a[240:243], v[92:95]
    ds_read_b64_tr_b16 v[34:35], v1 offset:21376
    s_add_u32 m0, s39, 96544
    v_mfma_f32_16x16x32_bf16 v[96:99], v[16:19], a[244:247], v[96:99]
    buffer_load_dwordx4 v8, s[8:11], s33 offen offset:256 nt lds
    s_add_u32 s33, s33, 8192
    v_mfma_f32_16x16x32_bf16 v[100:103], v[20:23], a[244:247], v[100:103]
    ds_read_b64_tr_b16 v[36:37], v1 offset:21152
    v_mfma_f32_16x16x32_bf16 v[104:107], v[24:27], a[244:247], v[104:107]
    v_mfma_f32_16x16x32_bf16 v[108:111], v[28:31], a[244:247], v[108:111]
    ds_read_b64_tr_b16 v[38:39], v1 offset:21408
    s_mov_b32 m0, 17952
    v_mfma_f32_16x16x32_bf16 v[112:115], v[16:19], a[248:251], v[112:115]
    buffer_load_dwordx4 v12, s[16:19], s35 offen  lds
    v_mfma_f32_16x16x32_bf16 v[116:119], v[20:23], a[248:251], v[116:119]
    ds_read_b64_tr_b16 v[40:41], v1 offset:21184
    v_mfma_f32_16x16x32_bf16 v[120:123], v[24:27], a[248:251], v[120:123]
    v_mfma_f32_16x16x32_bf16 v[124:127], v[28:31], a[248:251], v[124:127]
    ds_read_b64_tr_b16 v[42:43], v1 offset:21440
    v_mfma_f32_16x16x32_bf16 v[128:131], v[16:19], a[252:255], v[128:131]
    v_mfma_f32_16x16x32_bf16 v[132:135], v[20:23], a[252:255], v[132:135]
    ds_read_b64_tr_b16 v[44:45], v1 offset:21216
    s_mov_b32 m0, 19008
    v_mfma_f32_16x16x32_bf16 v[136:139], v[24:27], a[252:255], v[136:139]
    buffer_load_dwordx4 v3, s[16:19], s35 offen  lds
    v_mfma_f32_16x16x32_bf16 v[140:143], v[28:31], a[252:255], v[140:143]
    ds_read_b64_tr_b16 v[46:47], v1 offset:21472
    v_mfma_f32_16x16x32_bf16 v[144:147], v[16:19], v[176:179], v[144:147]
    v_mfma_f32_16x16x32_bf16 v[148:151], v[20:23], v[176:179], v[148:151]
    v_mfma_f32_16x16x32_bf16 v[152:155], v[24:27], v[176:179], v[152:155]
    v_mfma_f32_16x16x32_bf16 v[156:159], v[28:31], v[176:179], v[156:159]
    s_mov_b32 m0, 20064
    v_mfma_f32_16x16x32_bf16 v[160:163], v[16:19], v[180:183], v[160:163]
    buffer_load_dwordx4 v6, s[16:19], s35 offen  lds
    s_add_u32 s35, s35, 262144
    v_mfma_f32_16x16x32_bf16 v[164:167], v[20:23], v[180:183], v[164:167]
    v_mfma_f32_16x16x32_bf16 v[168:171], v[24:27], v[180:183], v[168:171]
    v_mfma_f32_16x16x32_bf16 v[172:175], v[28:31], v[180:183], v[172:175]
    s_waitcnt vmcnt(19)
    s_barrier
    s_waitcnt lgkmcnt(0)
    v_mfma_f32_16x16x32_bf16 v[80:83], v[32:35], v[184:187], v[80:83]
    s_nop 0
    s_add_u32 m0, s40, 104448
    s_nop 0
    buffer_load_dwordx4 v7, s[4:7], s32 offen nt lds
    v_mfma_f32_16x16x32_bf16 v[84:87], v[36:39], v[184:187], v[84:87]
    ds_read_b64_tr_b16 v[16:17], v1 offset:0
    s_mov_b32 m0, 21120
    v_mfma_f32_16x16x32_bf16 v[88:91], v[40:43], v[184:187], v[88:91]
    buffer_load_dwordx4 v11, s[16:19], s35 offen  lds
    v_mfma_f32_16x16x32_bf16 v[92:95], v[44:47], v[184:187], v[92:95]
    ds_read_b64_tr_b16 v[18:19], v1 offset:256
    v_mfma_f32_16x16x32_bf16 v[96:99], v[32:35], v[188:191], v[96:99]
    v_mfma_f32_16x16x32_bf16 v[100:103], v[36:39], v[188:191], v[100:103]
    ds_read_b64_tr_b16 v[20:21], v1 offset:32
    v_mfma_f32_16x16x32_bf16 v[104:107], v[40:43], v[188:191], v[104:107]
    v_mfma_f32_16x16x32_bf16 v[108:111], v[44:47], v[188:191], v[108:111]
    ds_read_b64_tr_b16 v[22:23], v1 offset:288
    s_mov_b32 m0, 22176
    v_mfma_f32_16x16x32_bf16 v[112:115], v[32:35], v[192:195], v[112:115]
    buffer_load_dwordx4 v12, s[16:19], s35 offen  lds
    v_mfma_f32_16x16x32_bf16 v[116:119], v[36:39], v[192:195], v[116:119]
    s_add_u32 m0, s40, 104512
    ds_read_b64_tr_b16 v[24:25], v1 offset:64
    buffer_load_dwordx4 v7, s[4:7], s32 offen offset:1024 nt lds
    v_mfma_f32_16x16x32_bf16 v[120:123], v[40:43], v[192:195], v[120:123]
    v_mfma_f32_16x16x32_bf16 v[124:127], v[44:47], v[192:195], v[124:127]
    ds_read_b64_tr_b16 v[26:27], v1 offset:320
    v_mfma_f32_16x16x32_bf16 v[128:131], v[32:35], v[196:199], v[128:131]
    v_mfma_f32_16x16x32_bf16 v[132:135], v[36:39], v[196:199], v[132:135]
    ds_read_b64_tr_b16 v[28:29], v1 offset:96
    s_mov_b32 m0, 23232
    v_mfma_f32_16x16x32_bf16 v[136:139], v[40:43], v[196:199], v[136:139]
    buffer_load_dwordx4 v3, s[16:19], s35 offen  lds
    v_mfma_f32_16x16x32_bf16 v[140:143], v[44:47], v[196:199], v[140:143]
    ds_read_b64_tr_b16 v[30:31], v1 offset:352
    v_mfma_f32_16x16x32_bf16 v[144:147], v[32:35], v[200:203], v[144:147]
    v_mfma_f32_16x16x32_bf16 v[148:151], v[36:39], v[200:203], v[148:151]
    s_add_u32 m0, s39, 26112
    s_add_u32 s32, s32, 8192
    buffer_load_dwordx4 v9, s[12:15], s34 offen  lds
    v_mfma_f32_16x16x32_bf16 v[152:155], v[40:43], v[200:203], v[152:155]
    v_mfma_f32_16x16x32_bf16 v[156:159], v[44:47], v[200:203], v[156:159]
    s_mov_b32 m0, 24288
    v_mfma_f32_16x16x32_bf16 v[160:163], v[32:35], v[204:207], v[160:163]
    buffer_load_dwordx4 v6, s[16:19], s35 offen  lds
    s_add_u32 s35, s35, 262144
    v_mfma_f32_16x16x32_bf16 v[164:167], v[36:39], v[204:207], v[164:167]
    v_mfma_f32_16x16x32_bf16 v[168:171], v[40:43], v[204:207], v[168:171]
    v_mfma_f32_16x16x32_bf16 v[172:175], v[44:47], v[204:207], v[172:175]
    s_waitcnt lgkmcnt(0)
    v_mfma_f32_16x16x32_bf16 v[80:83], v[16:19], v[208:211], v[80:83]
    s_waitcnt vmcnt(25)
    v_mfma_f32_16x16x32_bf16 v[84:87], v[20:23], v[208:211], v[84:87]
    ds_read_b64_tr_b16 v[32:33], v1 offset:4224
    v_mfma_f32_16x16x32_bf16 v[88:91], v[24:27], v[208:211], v[88:91]
    s_add_u32 s51, s51, 1
    s_lshr_b32 s49, s51, 1
    s_lshl_b32 s48, s49, 2
    s_lshr_b32 s48, s41, s48
    s_and_b32 s48, s48, 3
    s_lshl_b32 s49, s44, 2
    s_add_u32 s48, s48, s49
    s_lshl_b32 s48, s48, 8
    s_xor_b32 s49, s51, s52
    s_and_b32 s49, s49, 1
    s_lshl_b32 s49, s49, 7
    s_add_u32 s35, s48, s49
    s_cmp_ge_u32 s51, 8
    s_cselect_b32 s18, 0, s18
    s_mov_b32 m0, 0
    s_nop 0
    buffer_load_dwordx4 v11, s[16:19], s35 offen  lds
    v_mfma_f32_16x16x32_bf16 v[92:95], v[28:31], v[208:211], v[92:95]
    s_add_u32 m0, s39, 26016
    ds_read_b64_tr_b16 v[34:35], v1 offset:4480
    buffer_load_dwordx4 v9, s[12:15], s34 offen offset:1152  lds
    v_mfma_f32_16x16x32_bf16 v[96:99], v[16:19], v[212:215], v[96:99]
    v_mfma_f32_16x16x32_bf16 v[100:103], v[20:23], v[212:215], v[100:103]
    ds_read_b64_tr_b16 v[36:37], v1 offset:4256
    v_mfma_f32_16x16x32_bf16 v[104:107], v[24:27], v[212:215], v[104:107]
    v_mfma_f32_16x16x32_bf16 v[108:111], v[28:31], v[212:215], v[108:111]
    ds_read_b64_tr_b16 v[38:39], v1 offset:4512
    s_mov_b32 m0, 1056
    v_mfma_f32_16x16x32_bf16 v[112:115], v[16:19], v[216:219], v[112:115]
    buffer_load_dwordx4 v12, s[16:19], s35 offen  lds
    v_mfma_f32_16x16x32_bf16 v[116:119], v[20:23], v[216:219], v[116:119]
    ds_read_b64_tr_b16 v[40:41], v1 offset:4288
    v_mfma_f32_16x16x32_bf16 v[120:123], v[24:27], v[216:219], v[120:123]
    v_mfma_f32_16x16x32_bf16 v[124:127], v[28:31], v[216:219], v[124:127]
    ds_read_b64_tr_b16 v[42:43], v1 offset:4544
    s_add_u32 m0, s39, 34816
    s_sub_u32 s34, s34, 73600
    buffer_load_dwordx4 v8, s[8:11], s33 offen nt lds
    v_mfma_f32_16x16x32_bf16 v[128:131], v[16:19], v[220:223], v[128:131]
    v_mfma_f32_16x16x32_bf16 v[132:135], v[20:23], v[220:223], v[132:135]
    ds_read_b64_tr_b16 v[44:45], v1 offset:4320
    s_mov_b32 m0, 2112
    v_mfma_f32_16x16x32_bf16 v[136:139], v[24:27], v[220:223], v[136:139]
    buffer_load_dwordx4 v3, s[16:19], s35 offen  lds
    v_mfma_f32_16x16x32_bf16 v[140:143], v[28:31], v[220:223], v[140:143]
    ds_read_b64_tr_b16 v[46:47], v1 offset:4576
    v_mfma_f32_16x16x32_bf16 v[144:147], v[16:19], v[224:227], v[144:147]
    v_mfma_f32_16x16x32_bf16 v[148:151], v[20:23], v[224:227], v[148:151]
    v_mfma_f32_16x16x32_bf16 v[152:155], v[24:27], v[224:227], v[152:155]
    s_add_u32 m0, s39, 35616
    v_mfma_f32_16x16x32_bf16 v[156:159], v[28:31], v[224:227], v[156:159]
    buffer_load_dwordx4 v8, s[8:11], s33 offen offset:256 nt lds
    s_add_u32 s33, s33, 8192
    s_mov_b32 m0, 3168
    v_mfma_f32_16x16x32_bf16 v[160:163], v[16:19], v[228:231], v[160:163]
    buffer_load_dwordx4 v6, s[16:19], s35 offen  lds
    s_add_u32 s35, s35, 262144
    v_mfma_f32_16x16x32_bf16 v[164:167], v[20:23], v[228:231], v[164:167]
    v_mfma_f32_16x16x32_bf16 v[168:171], v[24:27], v[228:231], v[168:171]
    v_mfma_f32_16x16x32_bf16 v[172:175], v[28:31], v[228:231], v[172:175]
    s_waitcnt lgkmcnt(0)
    v_mfma_f32_16x16x32_bf16 v[80:83], v[32:35], v[232:235], v[80:83]
    s_waitcnt vmcnt(27)
    v_mfma_f32_16x16x32_bf16 v[84:87], v[36:39], v[232:235], v[84:87]
    ds_read_b64_tr_b16 v[16:17], v1 offset:8448
    s_mov_b32 m0, 4224
    v_mfma_f32_16x16x32_bf16 v[88:91], v[40:43], v[232:235], v[88:91]
    buffer_load_dwordx4 v11, s[16:19], s35 offen  lds
    v_mfma_f32_16x16x32_bf16 v[92:95], v[44:47], v[232:235], v[92:95]
    ds_read_b64_tr_b16 v[18:19], v1 offset:8704
    ds_read_b128 v[48:51], v2 offset:0
    v_mfma_f32_16x16x32_bf16 v[96:99], v[32:35], v[236:239], v[96:99]
    v_mfma_f32_16x16x32_bf16 v[100:103], v[36:39], v[236:239], v[100:103]
    ds_read_b64_tr_b16 v[20:21], v1 offset:8480
    v_mfma_f32_16x16x32_bf16 v[104:107], v[40:43], v[236:239], v[104:107]
    v_mfma_f32_16x16x32_bf16 v[108:111], v[44:47], v[236:239], v[108:111]
    ds_read_b64_tr_b16 v[22:23], v1 offset:8736
    ds_read_b128 v[52:55], v2 offset:4352
    s_mov_b32 m0, 5280
    v_mfma_f32_16x16x32_bf16 v[112:115], v[32:35], v[240:243], v[112:115]
    buffer_load_dwordx4 v12, s[16:19], s35 offen  lds
    v_mfma_f32_16x16x32_bf16 v[116:119], v[36:39], v[240:243], v[116:119]
    ds_read_b64_tr_b16 v[24:25], v1 offset:8512
    v_mfma_f32_16x16x32_bf16 v[120:123], v[40:43], v[240:243], v[120:123]
    v_mfma_f32_16x16x32_bf16 v[124:127], v[44:47], v[240:243], v[124:127]
    ds_read_b64_tr_b16 v[26:27], v1 offset:8768
    ds_read_b128 v[56:59], v2 offset:8704
    v_mfma_f32_16x16x32_bf16 v[128:131], v[32:35], v[244:247], v[128:131]
    v_mfma_f32_16x16x32_bf16 v[132:135], v[36:39], v[244:247], v[132:135]
    ds_read_b64_tr_b16 v[28:29], v1 offset:8544
    s_mov_b32 m0, 6336
    v_mfma_f32_16x16x32_bf16 v[136:139], v[40:43], v[244:247], v[136:139]
    buffer_load_dwordx4 v3, s[16:19], s35 offen  lds
    v_mfma_f32_16x16x32_bf16 v[140:143], v[44:47], v[244:247], v[140:143]
    ds_read_b64_tr_b16 v[30:31], v1 offset:8800
    ds_read_b128 v[60:63], v2 offset:13056
    v_mfma_f32_16x16x32_bf16 v[144:147], v[32:35], v[248:251], v[144:147]
    v_mfma_f32_16x16x32_bf16 v[148:151], v[36:39], v[248:251], v[148:151]
    v_mfma_f32_16x16x32_bf16 v[152:155], v[40:43], v[248:251], v[152:155]
    s_waitcnt vmcnt(20)
    s_barrier
    v_mfma_f32_16x16x32_bf16 v[156:159], v[44:47], v[248:251], v[156:159]
    s_add_u32 m0, s40, 43520
    ds_read_b128 v[64:67], v2 offset:17408
    buffer_load_dwordx4 v7, s[4:7], s32 offen nt lds
    s_mov_b32 m0, 7392
    v_mfma_f32_16x16x32_bf16 v[160:163], v[32:35], v[252:255], v[160:163]
    buffer_load_dwordx4 v6, s[16:19], s35 offen  lds
    s_add_u32 s35, s35, 262144
    v_mfma_f32_16x16x32_bf16 v[164:167], v[36:39], v[252:255], v[164:167]
    v_mfma_f32_16x16x32_bf16 v[168:171], v[40:43], v[252:255], v[168:171]
    v_mfma_f32_16x16x32_bf16 v[172:175], v[44:47], v[252:255], v[172:175]
    ds_read_b128 v[68:71], v2 offset:21760
    s_waitcnt lgkmcnt(2)
    v_mfma_f32_16x16x32_bf16 v[80:83], v[16:19], v[48:51], v[80:83]
    s_nop 0
    s_add_u32 m0, s40, 43584
    s_nop 0
    buffer_load_dwordx4 v7, s[4:7], s32 offen offset:1024 nt lds
    v_mfma_f32_16x16x32_bf16 v[84:87], v[20:23], v[48:51], v[84:87]
    ds_read_b64_tr_b16 v[32:33], v1 offset:12672
    s_mov_b32 m0, 8448
    v_mfma_f32_16x16x32_bf16 v[88:91], v[24:27], v[48:51], v[88:91]
    buffer_load_dwordx4 v11, s[16:19], s35 offen  lds
    v_mfma_f32_16x16x32_bf16 v[92:95], v[28:31], v[48:51], v[92:95]
    ds_read_b64_tr_b16 v[34:35], v1 offset:12928
    ds_read_b128 v[48:51], v2 offset:64
    v_mfma_f32_16x16x32_bf16 v[96:99], v[16:19], v[52:55], v[96:99]
    v_mfma_f32_16x16x32_bf16 v[100:103], v[20:23], v[52:55], v[100:103]
    ds_read_b64_tr_b16 v[36:37], v1 offset:12704
    v_mfma_f32_16x16x32_bf16 v[104:107], v[24:27], v[52:55], v[104:107]
    s_add_u32 m0, s39, 52224
    s_add_u32 s32, s32, 8192
    buffer_load_dwordx4 v9, s[12:15], s34 offen  lds
    v_mfma_f32_16x16x32_bf16 v[108:111], v[28:31], v[52:55], v[108:111]
    ds_read_b64_tr_b16 v[38:39], v1 offset:12960
    ds_read_b128 v[52:55], v2 offset:4416
    s_mov_b32 m0, 9504
    v_mfma_f32_16x16x32_bf16 v[112:115], v[16:19], v[56:59], v[112:115]
    buffer_load_dwordx4 v12, s[16:19], s35 offen  lds
    v_mfma_f32_16x16x32_bf16 v[116:119], v[20:23], v[56:59], v[116:119]
    ds_read_b64_tr_b16 v[40:41], v1 offset:12736
    v_mfma_f32_16x16x32_bf16 v[120:123], v[24:27], v[56:59], v[120:123]
    v_mfma_f32_16x16x32_bf16 v[124:127], v[28:31], v[56:59], v[124:127]
    ds_read_b64_tr_b16 v[42:43], v1 offset:12992
    ds_read_b128 v[56:59], v2 offset:8768
    s_add_u32 m0, s39, 52128
    v_mfma_f32_16x16x32_bf16 v[128:131], v[16:19], v[60:63], v[128:131]
    buffer_load_dwordx4 v9, s[12:15], s34 offen offset:1152  lds
    v_mfma_f32_16x16x32_bf16 v[132:135], v[20:23], v[60:63], v[132:135]
    ds_read_b64_tr_b16 v[44:45], v1 offset:12768
    s_mov_b32 m0, 10560
    v_mfma_f32_16x16x32_bf16 v[136:139], v[24:27], v[60:63], v[136:139]
    buffer_load_dwordx4 v3, s[16:19], s35 offen  lds
    v_mfma_f32_16x16x32_bf16 v[140:143], v[28:31], v[60:63], v[140:143]
    ds_read_b64_tr_b16 v[46:47], v1 offset:13024
    ds_read_b128 v[60:63], v2 offset:13120
    s_waitcnt lgkmcnt(12)
    v_mfma_f32_16x16x32_bf16 v[144:147], v[16:19], v[64:67], v[144:147]
    v_mfma_f32_16x16x32_bf16 v[148:151], v[20:23], v[64:67], v[148:151]
    v_mfma_f32_16x16x32_bf16 v[152:155], v[24:27], v[64:67], v[152:155]
    s_add_u32 m0, s39, 60928
    s_add_u32 s34, s34, 73728
    buffer_load_dwordx4 v8, s[8:11], s33 offen nt lds
    v_mfma_f32_16x16x32_bf16 v[156:159], v[28:31], v[64:67], v[156:159]
    ds_read_b128 v[64:67], v2 offset:17472
    s_mov_b32 m0, 11616
    v_mfma_f32_16x16x32_bf16 v[160:163], v[16:19], v[68:71], v[160:163]
    buffer_load_dwordx4 v6, s[16:19], s35 offen  lds
    s_add_u32 s35, s35, 262144
    v_mfma_f32_16x16x32_bf16 v[164:167], v[20:23], v[68:71], v[164:167]
    v_mfma_f32_16x16x32_bf16 v[168:171], v[24:27], v[68:71], v[168:171]
    v_mfma_f32_16x16x32_bf16 v[172:175], v[28:31], v[68:71], v[172:175]
    s_add_u32 m0, s39, 61728
    ds_read_b128 v[68:71], v2 offset:21824
    buffer_load_dwordx4 v8, s[8:11], s33 offen offset:256 nt lds
    s_waitcnt lgkmcnt(2)
    v_mfma_f32_16x16x32_bf16 v[80:83], v[32:35], v[48:51], v[80:83]
    s_waitcnt vmcnt(28)
    v_mfma_f32_16x16x32_bf16 v[84:87], v[36:39], v[48:51], v[84:87]
    ds_read_b64_tr_b16 v[16:17], v1 offset:16896
    s_mov_b32 m0, 12672
    v_mfma_f32_16x16x32_bf16 v[88:91], v[40:43], v[48:51], v[88:91]
    buffer_load_dwordx4 v11, s[16:19], s35 offen  lds
    v_mfma_f32_16x16x32_bf16 v[92:95], v[44:47], v[48:51], v[92:95]
    ds_read_b64_tr_b16 v[18:19], v1 offset:17152
    ds_read_b128 v[48:51], v2 offset:128
    v_mfma_f32_16x16x32_bf16 v[96:99], v[32:35], v[52:55], v[96:99]
    v_mfma_f32_16x16x32_bf16 v[100:103], v[36:39], v[52:55], v[100:103]
    ds_read_b64_tr_b16 v[20:21], v1 offset:16928
    s_add_u32 m0, s40, 69632
    s_add_u32 s33, s33, 8192
    buffer_load_dwordx4 v7, s[4:7], s32 offen nt lds
    v_mfma_f32_16x16x32_bf16 v[104:107], v[40:43], v[52:55], v[104:107]
    v_mfma_f32_16x16x32_bf16 v[108:111], v[44:47], v[52:55], v[108:111]
    ds_read_b64_tr_b16 v[22:23], v1 offset:17184
    ds_read_b128 v[52:55], v2 offset:4480
    s_mov_b32 m0, 13728
    v_mfma_f32_16x16x32_bf16 v[112:115], v[32:35], v[56:59], v[112:115]
    buffer_load_dwordx4 v12, s[16:19], s35 offen  lds
    v_mfma_f32_16x16x32_bf16 v[116:119], v[36:39], v[56:59], v[116:119]
    ds_read_b64_tr_b16 v[24:25], v1 offset:16960
    v_mfma_f32_16x16x32_bf16 v[120:123], v[40:43], v[56:59], v[120:123]
    v_mfma_f32_16x16x32_bf16 v[124:127], v[44:47], v[56:59], v[124:127]
    ds_read_b64_tr_b16 v[26:27], v1 offset:17216
    s_add_u32 m0, s40, 69696
    ds_read_b128 v[56:59], v2 offset:8832
    buffer_load_dwordx4 v7, s[4:7], s32 offen offset:1024 nt lds
    s_add_u32 s32, s32, 8192
    v_mfma_f32_16x16x32_bf16 v[128:131], v[32:35], v[60:63], v[128:131]
    v_mfma_f32_16x16x32_bf16 v[132:135], v[36:39], v[60:63], v[132:135]
    ds_read_b64_tr_b16 v[28:29], v1 offset:16992
    s_mov_b32 m0, 14784
    v_mfma_f32_16x16x32_bf16 v[136:139], v[40:43], v[60:63], v[136:139]
    buffer_load_dwordx4 v3, s[16:19], s35 offen  lds
    v_mfma_f32_16x16x32_bf16 v[140:143], v[44:47], v[60:63], v[140:143]
    ds_read_b64_tr_b16 v[30:31], v1 offset:17248
    ds_read_b128 v[60:63], v2 offset:13184
    s_waitcnt lgkmcnt(12)
    v_mfma_f32_16x16x32_bf16 v[144:147], v[32:35], v[64:67], v[144:147]
    v_mfma_f32_16x16x32_bf16 v[148:151], v[36:39], v[64:67], v[148:151]
    v_mfma_f32_16x16x32_bf16 v[152:155], v[40:43], v[64:67], v[152:155]
    v_mfma_f32_16x16x32_bf16 v[156:159], v[44:47], v[64:67], v[156:159]
    ds_read_b128 v[64:67], v2 offset:17536
    s_mov_b32 m0, 15840
    v_mfma_f32_16x16x32_bf16 v[160:163], v[32:35], v[68:71], v[160:163]
    buffer_load_dwordx4 v6, s[16:19], s35 offen  lds
    s_add_u32 s35, s35, 262144
    v_mfma_f32_16x16x32_bf16 v[164:167], v[36:39], v[68:71], v[164:167]
    v_mfma_f32_16x16x32_bf16 v[168:171], v[40:43], v[68:71], v[168:171]
    v_mfma_f32_16x16x32_bf16 v[172:175], v[44:47], v[68:71], v[172:175]
    ds_read_b128 v[68:71], v2 offset:21888
    s_waitcnt lgkmcnt(2)
    v_mfma_f32_16x16x32_bf16 v[80:83], v[16:19], v[48:51], v[80:83]
    s_waitcnt vmcnt(27)
    v_mfma_f32_16x16x32_bf16 v[84:87], v[20:23], v[48:51], v[84:87]
    ds_read_b64_tr_b16 v[32:33], v1 offset:21120
    s_mov_b32 m0, 16896
    v_mfma_f32_16x16x32_bf16 v[88:91], v[24:27], v[48:51], v[88:91]
    buffer_load_dwordx4 v11, s[16:19], s35 offen  lds
    v_mfma_f32_16x16x32_bf16 v[92:95], v[28:31], v[48:51], v[92:95]
    ds_read_b64_tr_b16 v[34:35], v1 offset:21376
    ds_read_b128 v[48:51], v2 offset:192
    v_mfma_f32_16x16x32_bf16 v[96:99], v[16:19], v[52:55], v[96:99]
    s_waitcnt vmcnt(22)
    s_barrier
    v_mfma_f32_16x16x32_bf16 v[100:103], v[20:23], v[52:55], v[100:103]
    s_add_u32 m0, s39, 78336
    ds_read_b64_tr_b16 v[36:37], v1 offset:21152
    buffer_load_dwordx4 v9, s[12:15], s34 offen  lds
    v_mfma_f32_16x16x32_bf16 v[104:107], v[24:27], v[52:55], v[104:107]
    v_mfma_f32_16x16x32_bf16 v[108:111], v[28:31], v[52:55], v[108:111]
    ds_read_b64_tr_b16 v[38:39], v1 offset:21408
    ds_read_b128 v[52:55], v2 offset:4544
    s_mov_b32 m0, 17952
    v_mfma_f32_16x16x32_bf16 v[112:115], v[16:19], v[56:59], v[112:115]
    buffer_load_dwordx4 v12, s[16:19], s35 offen  lds
    v_mfma_f32_16x16x32_bf16 v[116:119], v[20:23], v[56:59], v[116:119]
    ds_read_b64_tr_b16 v[40:41], v1 offset:21184
    s_add_u32 m0, s39, 78240
    v_mfma_f32_16x16x32_bf16 v[120:123], v[24:27], v[56:59], v[120:123]
    buffer_load_dwordx4 v9, s[12:15], s34 offen offset:1152  lds
    v_mfma_f32_16x16x32_bf16 v[124:127], v[28:31], v[56:59], v[124:127]
    ds_read_b64_tr_b16 v[42:43], v1 offset:21440
    ds_read_b128 v[56:59], v2 offset:8896
    v_mfma_f32_16x16x32_bf16 v[128:131], v[16:19], v[60:63], v[128:131]
    v_mfma_f32_16x16x32_bf16 v[132:135], v[20:23], v[60:63], v[132:135]
    ds_read_b64_tr_b16 v[44:45], v1 offset:21216
    s_mov_b32 m0, 19008
    v_mfma_f32_16x16x32_bf16 v[136:139], v[24:27], v[60:63], v[136:139]
    buffer_load_dwordx4 v3, s[16:19], s35 offen  lds
    v_mfma_f32_16x16x32_bf16 v[140:143], v[28:31], v[60:63], v[140:143]
    ds_read_b64_tr_b16 v[46:47], v1 offset:21472
    ds_read_b128 v[60:63], v2 offset:13248
    s_waitcnt lgkmcnt(12)
    v_mfma_f32_16x16x32_bf16 v[144:147], v[16:19], v[64:67], v[144:147]
    s_add_u32 m0, s39, 87040
    s_sub_u32 s34, s34, 73600
    buffer_load_dwordx4 v9, s[12:15], s34 offen  lds
    v_mfma_f32_16x16x32_bf16 v[148:151], v[20:23], v[64:67], v[148:151]
    v_mfma_f32_16x16x32_bf16 v[152:155], v[24:27], v[64:67], v[152:155]
    v_mfma_f32_16x16x32_bf16 v[156:159], v[28:31], v[64:67], v[156:159]
    ds_read_b128 v[64:67], v2 offset:17600
    s_mov_b32 m0, 20064
    v_mfma_f32_16x16x32_bf16 v[160:163], v[16:19], v[68:71], v[160:163]
    buffer_load_dwordx4 v6, s[16:19], s35 offen  lds
    s_add_u32 s35, s35, 262144
    v_mfma_f32_16x16x32_bf16 v[164:167], v[20:23], v[68:71], v[164:167]
    s_add_u32 m0, s39, 86944
    v_mfma_f32_16x16x32_bf16 v[168:171], v[24:27], v[68:71], v[168:171]
    buffer_load_dwordx4 v9, s[12:15], s34 offen offset:1152  lds
    v_mfma_f32_16x16x32_bf16 v[172:175], v[28:31], v[68:71], v[172:175]
    ds_read_b128 v[68:71], v2 offset:21952
    s_waitcnt lgkmcnt(2)
    v_mfma_f32_16x16x32_bf16 v[80:83], v[32:35], v[48:51], v[80:83]
    s_waitcnt vmcnt(28)
    v_mfma_f32_16x16x32_bf16 v[84:87], v[36:39], v[48:51], v[84:87]
    ds_read_b64_tr_b16 v[16:17], v1 offset:0
    s_mov_b32 m0, 21120
    v_mfma_f32_16x16x32_bf16 v[88:91], v[40:43], v[48:51], v[88:91]
    buffer_load_dwordx4 v11, s[16:19], s35 offen  lds
    v_mfma_f32_16x16x32_bf16 v[92:95], v[44:47], v[48:51], v[92:95]
    ds_read_b64_tr_b16 v[18:19], v1 offset:256
    s_add_u32 m0, s39, 95744
    s_add_u32 s34, s34, 73728
    buffer_load_dwordx4 v8, s[8:11], s33 offen nt lds
    v_mfma_f32_16x16x32_bf16 v[96:99], v[32:35], v[52:55], v[96:99]
    v_mfma_f32_16x16x32_bf16 v[100:103], v[36:39], v[52:55], v[100:103]
    ds_read_b64_tr_b16 v[20:21], v1 offset:32
    v_mfma_f32_16x16x32_bf16 v[104:107], v[40:43], v[52:55], v[104:107]
    v_mfma_f32_16x16x32_bf16 v[108:111], v[44:47], v[52:55], v[108:111]
    ds_read_b64_tr_b16 v[22:23], v1 offset:288
    s_mov_b32 m0, 22176
    v_mfma_f32_16x16x32_bf16 v[112:115], v[32:35], v[56:59], v[112:115]
    buffer_load_dwordx4 v12, s[16:19], s35 offen  lds
    v_mfma_f32_16x16x32_bf16 v[116:119], v[36:39], v[56:59], v[116:119]
    s_add_u32 m0, s39, 96544
    ds_read_b64_tr_b16 v[24:25], v1 offset:64
    buffer_load_dwordx4 v8, s[8:11], s33 offen offset:256 nt lds
    s_add_u32 s33, s33, 8192
    v_mfma_f32_16x16x32_bf16 v[120:123], v[40:43], v[56:59], v[120:123]
    v_mfma_f32_16x16x32_bf16 v[124:127], v[44:47], v[56:59], v[124:127]
    ds_read_b64_tr_b16 v[26:27], v1 offset:320
    v_mfma_f32_16x16x32_bf16 v[128:131], v[32:35], v[60:63], v[128:131]
    v_mfma_f32_16x16x32_bf16 v[132:135], v[36:39], v[60:63], v[132:135]
    ds_read_b64_tr_b16 v[28:29], v1 offset:96
    s_mov_b32 m0, 23232
    v_mfma_f32_16x16x32_bf16 v[136:139], v[40:43], v[60:63], v[136:139]
    buffer_load_dwordx4 v3, s[16:19], s35 offen  lds
    v_mfma_f32_16x16x32_bf16 v[140:143], v[44:47], v[60:63], v[140:143]
    ds_read_b64_tr_b16 v[30:31], v1 offset:352
    s_waitcnt lgkmcnt(8)
    v_mfma_f32_16x16x32_bf16 v[144:147], v[32:35], v[64:67], v[144:147]
    v_mfma_f32_16x16x32_bf16 v[148:151], v[36:39], v[64:67], v[148:151]
    v_mfma_f32_16x16x32_bf16 v[152:155], v[40:43], v[64:67], v[152:155]
    v_mfma_f32_16x16x32_bf16 v[156:159], v[44:47], v[64:67], v[156:159]
    s_mov_b32 m0, 24288
    v_mfma_f32_16x16x32_bf16 v[160:163], v[32:35], v[68:71], v[160:163]
    buffer_load_dwordx4 v6, s[16:19], s35 offen  lds
    s_add_u32 s35, s35, 262144
    v_mfma_f32_16x16x32_bf16 v[164:167], v[36:39], v[68:71], v[164:167]
    v_mfma_f32_16x16x32_bf16 v[168:171], v[40:43], v[68:71], v[168:171]
    v_mfma_f32_16x16x32_bf16 v[172:175], v[44:47], v[68:71], v[172:175]
    v_add_u32 v5, s53, v4
    s_xor_b32 s53, s53, 4096
    v_mul_f32 v80, s47, v80
    v_mul_f32 v81, s47, v81
    v_mul_f32 v82, s47, v82
    v_mul_f32 v83, s47, v83
    v_mul_f32 v84, s47, v84
    v_mul_f32 v85, s47, v85
    v_mul_f32 v86, s47, v86
    v_mul_f32 v87, s47, v87
    v_cvt_pk_bf16_f32 v72, v80, v81
    v_cvt_pk_bf16_f32 v73, v82, v83
    v_cvt_pk_bf16_f32 v74, v84, v85
    v_cvt_pk_bf16_f32 v75, v86, v87
    ds_write_b64 v5, v[72:73] offset:0
    ds_write_b64 v5, v[74:75] offset:512
    v_mul_f32 v88, s47, v88
    v_mul_f32 v89, s47, v89
    v_mul_f32 v90, s47, v90
    v_mul_f32 v91, s47, v91
    v_mul_f32 v92, s47, v92
    v_mul_f32 v93, s47, v93
    v_mul_f32 v94, s47, v94
    v_mul_f32 v95, s47, v95
    v_cvt_pk_bf16_f32 v76, v88, v89
    v_cvt_pk_bf16_f32 v77, v90, v91
    v_cvt_pk_bf16_f32 v78, v92, v93
    v_cvt_pk_bf16_f32 v79, v94, v95
    ds_write_b64 v5, v[76:77] offset:2048
    ds_write_b64 v5, v[78:79] offset:2560
    s_waitcnt lgkmcnt(4)
    v_mfma_f32_16x16x32_bf16 v[80:83], v[16:19], a[0:3], 0
    s_waitcnt vmcnt(29)
    v_mul_f32 v96, s47, v96
    v_mul_f32 v97, s47, v97
    v_mul_f32 v98, s47, v98
    v_mul_f32 v99, s47, v99
    v_mul_f32 v100, s47, v100
    v_mul_f32 v101, s47, v101
    v_mul_f32 v102, s47, v102
    s_waitcnt vmcnt(20)
    s_barrier
    v_mfma_f32_16x16x32_bf16 v[84:87], v[20:23], a[0:3], 0
    ds_read_b64_tr_b16 v[32:33], v1 offset:4224
    v_mul_f32 v103, s47, v103
    v_cvt_pk_bf16_f32 v72, v96, v97
    v_cvt_pk_bf16_f32 v73, v98, v99
    v_cvt_pk_bf16_f32 v74, v100, v101
    v_cvt_pk_bf16_f32 v75, v102, v103
    ds_write_b64 v5, v[72:73] offset:1024
    s_add_u32 m0, s40, 104448
    ds_write_b64 v5, v[74:75] offset:1536
    buffer_load_dwordx4 v7, s[4:7], s32 offen nt lds
    v_mfma_f32_16x16x32_bf16 v[88:91], v[24:27], a[0:3], 0
    v_mul_f32 v104, s47, v104
    v_mul_f32 v105, s47, v105
    v_mul_f32 v106, s47, v106
    v_mul_f32 v107, s47, v107
    v_mul_f32 v108, s47, v108
    v_mul_f32 v109, s47, v109
    s_mov_b32 m0, 0
    v_mul_f32 v110, s47, v110
    buffer_load_dwordx4 v11, s[16:19], s35 offen  lds
    v_mfma_f32_16x16x32_bf16 v[92:95], v[28:31], a[0:3], 0
    ds_read_b64_tr_b16 v[34:35], v1 offset:4480
    v_mul_f32 v111, s47, v111
    v_cvt_pk_bf16_f32 v76, v104, v105
    v_cvt_pk_bf16_f32 v77, v106, v107
    v_cvt_pk_bf16_f32 v78, v108, v109
    v_cvt_pk_bf16_f32 v79, v110, v111
    ds_write_b64 v5, v[76:77] offset:3072
    s_add_u32 m0, s40, 104512
    ds_write_b64 v5, v[78:79] offset:3584
    buffer_load_dwordx4 v7, s[4:7], s32 offen offset:1024 nt lds
    v_mfma_f32_16x16x32_bf16 v[96:99], v[16:19], a[4:7], 0
    v_mul_f32 v112, s47, v112
    v_mul_f32 v113, s47, v113
    v_mul_f32 v114, s47, v114
    v_mul_f32 v115, s47, v115
    v_mul_f32 v116, s47, v116
    v_mul_f32 v117, s47, v117
    v_mul_f32 v118, s47, v118
    v_mfma_f32_16x16x32_bf16 v[100:103], v[20:23], a[4:7], 0
    ds_read_b64_tr_b16 v[36:37], v1 offset:4256
    v_mul_f32 v119, s47, v119
    v_cvt_pk_bf16_f32 v72, v112, v113
    v_cvt_pk_bf16_f32 v73, v114, v115
    v_cvt_pk_bf16_f32 v74, v116, v117
    v_cvt_pk_bf16_f32 v75, v118, v119
    ds_write_b64 v5, v[72:73] offset:8192
    ds_write_b64 v5, v[74:75] offset:8704
    v_mfma_f32_16x16x32_bf16 v[104:107], v[24:27], a[4:7], 0
    v_mul_f32 v120, s47, v120
    v_mul_f32 v121, s47, v121
    v_mul_f32 v122, s47, v122
    v_mul_f32 v123, s47, v123
    v_mul_f32 v124, s47, v124
    v_mul_f32 v125, s47, v125
    v_mul_f32 v126, s47, v126
    s_add_u32 m0, s39, 26112
    s_add_u32 s32, s32, 8192
    buffer_load_dwordx4 v9, s[12:15], s34 offen  lds
    v_mfma_f32_16x16x32_bf16 v[108:111], v[28:31], a[4:7], 0
    ds_read_b64_tr_b16 v[38:39], v1 offset:4512
    v_mul_f32 v127, s47, v127
    v_cvt_pk_bf16_f32 v76, v120, v121
    v_cvt_pk_bf16_f32 v77, v122, v123
    v_cvt_pk_bf16_f32 v78, v124, v125
    v_cvt_pk_bf16_f32 v79, v126, v127
    ds_write_b64 v5, v[76:77] offset:10240
    ds_write_b64 v5, v[78:79] offset:10752
    v_mfma_f32_16x16x32_bf16 v[112:115], v[16:19], a[8:11], 0
    v_mul_f32 v128, s47, v128
    v_mul_f32 v129, s47, v129
    v_mul_f32 v130, s47, v130
    v_mul_f32 v131, s47, v131
    v_mul_f32 v132, s47, v132
    v_mul_f32 v133, s47, v133
    s_mov_b32 m0, 1056
    v_mul_f32 v134, s47, v134
    buffer_load_dwordx4 v12, s[16:19], s35 offen  lds
    v_mfma_f32_16x16x32_bf16 v[116:119], v[20:23], a[8:11], 0
    ds_read_b64_tr_b16 v[40:41], v1 offset:4288
    v_mul_f32 v135, s47, v135
    v_cvt_pk_bf16_f32 v72, v128, v129
    v_cvt_pk_bf16_f32 v73, v130, v131
    v_cvt_pk_bf16_f32 v74, v132, v133
    v_cvt_pk_bf16_f32 v75, v134, v135
    ds_write_b64 v5, v[72:73] offset:9216
    s_add_u32 m0, s39, 26016
    ds_write_b64 v5, v[74:75] offset:9728
    buffer_load_dwordx4 v9, s[12:15], s34 offen offset:1152  lds
    v_mfma_f32_16x16x32_bf16 v[120:123], v[24:27], a[8:11], 0
    v_mul_f32 v136, s47, v136
    v_mul_f32 v137, s47, v137
    v_mul_f32 v138, s47, v138
    v_mul_f32 v139, s47, v139
    v_mul_f32 v140, s47, v140
    v_mul_f32 v141, s47, v141
    v_mul_f32 v142, s47, v142
    v_mfma_f32_16x16x32_bf16 v[124:127], v[28:31], a[8:11], 0
    ds_read_b64_tr_b16 v[42:43], v1 offset:4544
    v_mul_f32 v143, s47, v143
    v_cvt_pk_bf16_f32 v76, v136, v137
    v_cvt_pk_bf16_f32 v77, v138, v139
    v_cvt_pk_bf16_f32 v78, v140, v141
    v_cvt_pk_bf16_f32 v79, v142, v143
    ds_write_b64 v5, v[76:77] offset:11264
    ds_write_b64 v5, v[78:79] offset:11776
    s_add_u32 m0, s39, 34816
    s_sub_u32 s34, s34, 73600
    buffer_load_dwordx4 v8, s[8:11], s33 offen nt lds
    v_mfma_f32_16x16x32_bf16 v[128:131], v[16:19], a[12:15], 0
    v_mul_f32 v144, s47, v144
    v_mul_f32 v145, s47, v145
    v_mul_f32 v146, s47, v146
    v_mul_f32 v147, s47, v147
    v_mul_f32 v148, s47, v148
    v_mul_f32 v149, s47, v149
    v_mul_f32 v150, s47, v150
    v_mfma_f32_16x16x32_bf16 v[132:135], v[20:23], a[12:15], 0
    ds_read_b64_tr_b16 v[44:45], v1 offset:4320
    v_mul_f32 v151, s47, v151
    v_cvt_pk_bf16_f32 v72, v144, v145
    v_cvt_pk_bf16_f32 v73, v146, v147
    v_cvt_pk_bf16_f32 v74, v148, v149
    v_cvt_pk_bf16_f32 v75, v150, v151
    ds_write_b64 v5, v[72:73] offset:16384
    ds_write_b64 v5, v[74:75] offset:16896
    v_mfma_f32_16x16x32_bf16 v[136:139], v[24:27], a[12:15], 0
    v_mul_f32 v152, s47, v152
    v_mul_f32 v153, s47, v153
    v_mul_f32 v154, s47, v154
    v_mul_f32 v155, s47, v155
    v_mul_f32 v156, s47, v156
    v_mul_f32 v157, s47, v157
    s_add_u32 m0, s39, 35616
    v_mul_f32 v158, s47, v158
    buffer_load_dwordx4 v8, s[8:11], s33 offen offset:256 nt lds
    s_mov_b32 m0, 2112
    s_add_u32 s33, s33, 8192
    buffer_load_dwordx4 v3, s[16:19], s35 offen  lds
    v_mfma_f32_16x16x32_bf16 v[140:143], v[28:31], a[12:15], 0
    ds_read_b64_tr_b16 v[46:47], v1 offset:4576
    v_mul_f32 v159, s47, v159
    v_cvt_pk_bf16_f32 v76, v152, v153
    v_cvt_pk_bf16_f32 v77, v154, v155
    v_cvt_pk_bf16_f32 v78, v156, v157
    v_cvt_pk_bf16_f32 v79, v158, v159
    ds_write_b64 v5, v[76:77] offset:18432
    ds_write_b64 v5, v[78:79] offset:18944
    v_mfma_f32_16x16x32_bf16 v[144:147], v[16:19], a[16:19], 0
    v_mul_f32 v160, s47, v160
    v_mul_f32 v161, s47, v161
    v_mul_f32 v162, s47, v162
    v_mul_f32 v163, s47, v163
    v_mul_f32 v164, s47, v164
    v_mul_f32 v165, s47, v165
    v_mul_f32 v166, s47, v166
    v_mfma_f32_16x16x32_bf16 v[148:151], v[20:23], a[16:19], 0
    v_mul_f32 v167, s47, v167
    v_cvt_pk_bf16_f32 v72, v160, v161
    v_cvt_pk_bf16_f32 v73, v162, v163
    v_cvt_pk_bf16_f32 v74, v164, v165
    v_cvt_pk_bf16_f32 v75, v166, v167
    ds_write_b64 v5, v[72:73] offset:17408
    ds_write_b64 v5, v[74:75] offset:17920
    v_mfma_f32_16x16x32_bf16 v[152:155], v[24:27], a[16:19], 0
    v_mul_f32 v168, s47, v168
    v_mul_f32 v169, s47, v169
    v_mul_f32 v170, s47, v170
    v_mul_f32 v171, s47, v171
    v_mul_f32 v172, s47, v172
    v_mul_f32 v173, s47, v173
    v_mul_f32 v174, s47, v174
    v_mfma_f32_16x16x32_bf16 v[156:159], v[28:31], a[16:19], 0
    v_mul_f32 v175, s47, v175
    v_cvt_pk_bf16_f32 v76, v168, v169
    v_cvt_pk_bf16_f32 v77, v170, v171
    v_cvt_pk_bf16_f32 v78, v172, v173
    v_cvt_pk_bf16_f32 v79, v174, v175
    ds_write_b64 v5, v[76:77] offset:19456
    ds_write_b64 v5, v[78:79] offset:19968
    s_mov_b32 m0, 3168
    v_mfma_f32_16x16x32_bf16 v[160:163], v[16:19], a[20:23], 0
    buffer_load_dwordx4 v6, s[16:19], s35 offen  lds
    s_add_u32 s35, s35, 262144
    s_waitcnt vmcnt(12)
    s_barrier
    s_add_u32 m0, s40, 43520
    v_mfma_f32_16x16x32_bf16 v[164:167], v[20:23], a[20:23], 0
    buffer_load_dwordx4 v7, s[4:7], s32 offen nt lds
    v_mfma_f32_16x16x32_bf16 v[168:171], v[24:27], a[20:23], 0
    v_mfma_f32_16x16x32_bf16 v[172:175], v[28:31], a[20:23], 0
    s_waitcnt lgkmcnt(6)
    v_mfma_f32_16x16x32_bf16 v[80:83], v[32:35], a[24:27], v[80:83]
    s_nop 0
    v_mfma_f32_16x16x32_bf16 v[84:87], v[36:39], a[24:27], v[84:87]
    ds_read_b64_tr_b16 v[16:17], v1 offset:8448
    s_mov_b32 m0, 4224
    v_mfma_f32_16x16x32_bf16 v[88:91], v[40:43], a[24:27], v[88:91]
    buffer_load_dwordx4 v11, s[16:19], s35 offen  lds
    v_mfma_f32_16x16x32_bf16 v[92:95], v[44:47], a[24:27], v[92:95]
    ds_read_b64_tr_b16 v[18:19], v1 offset:8704
    v_mfma_f32_16x16x32_bf16 v[96:99], v[32:35], a[28:31], v[96:99]
    v_mfma_f32_16x16x32_bf16 v[100:103], v[36:39], a[28:31], v[100:103]
    s_add_u32 m0, s40, 43584
    ds_read_b64_tr_b16 v[20:21], v1 offset:8480
    buffer_load_dwordx4 v7, s[4:7], s32 offen offset:1024 nt lds
    v_mfma_f32_16x16x32_bf16 v[104:107], v[40:43], a[28:31], v[104:107]
    v_mfma_f32_16x16x32_bf16 v[108:111], v[44:47], a[28:31], v[108:111]
    ds_read_b64_tr_b16 v[22:23], v1 offset:8736
    s_mov_b32 m0, 5280
    v_mfma_f32_16x16x32_bf16 v[112:115], v[32:35], a[32:35], v[112:115]
    buffer_load_dwordx4 v12, s[16:19], s35 offen  lds
    v_mfma_f32_16x16x32_bf16 v[116:119], v[36:39], a[32:35], v[116:119]
    ds_read_b64_tr_b16 v[24:25], v1 offset:8512
    v_mfma_f32_16x16x32_bf16 v[120:123], v[40:43], a[32:35], v[120:123]
    v_mfma_f32_16x16x32_bf16 v[124:127], v[44:47], a[32:35], v[124:127]
    ds_read_b64_tr_b16 v[26:27], v1 offset:8768
    v_mfma_f32_16x16x32_bf16 v[128:131], v[32:35], a[36:39], v[128:131]
    v_mfma_f32_16x16x32_bf16 v[132:135], v[36:39], a[36:39], v[132:135]
    ds_read_b64_tr_b16 v[28:29], v1 offset:8544
    s_mov_b32 m0, 6336
    v_mfma_f32_16x16x32_bf16 v[136:139], v[40:43], a[36:39], v[136:139]
    buffer_load_dwordx4 v3, s[16:19], s35 offen  lds
    v_mfma_f32_16x16x32_bf16 v[140:143], v[44:47], a[36:39], v[140:143]
    ds_read_b64_tr_b16 v[30:31], v1 offset:8800
    s_add_u32 m0, s39, 52224
    s_add_u32 s32, s32, 8192
    buffer_load_dwordx4 v9, s[12:15], s34 offen  lds
    v_mfma_f32_16x16x32_bf16 v[144:147], v[32:35], a[40:43], v[144:147]
    v_mfma_f32_16x16x32_bf16 v[148:151], v[36:39], a[40:43], v[148:151]
    v_mfma_f32_16x16x32_bf16 v[152:155], v[40:43], a[40:43], v[152:155]
    v_mfma_f32_16x16x32_bf16 v[156:159], v[44:47], a[40:43], v[156:159]
    s_mov_b32 m0, 7392
    v_mfma_f32_16x16x32_bf16 v[160:163], v[32:35], a[44:47], v[160:163]
    buffer_load_dwordx4 v6, s[16:19], s35 offen  lds
    s_add_u32 s35, s35, 262144
    v_mfma_f32_16x16x32_bf16 v[164:167], v[36:39], a[44:47], v[164:167]
    v_mfma_f32_16x16x32_bf16 v[168:171], v[40:43], a[44:47], v[168:171]
    s_add_u32 m0, s39, 52128
    v_mfma_f32_16x16x32_bf16 v[172:175], v[44:47], a[44:47], v[172:175]
    buffer_load_dwordx4 v9, s[12:15], s34 offen offset:1152  lds
    s_waitcnt lgkmcnt(0)
    v_mfma_f32_16x16x32_bf16 v[80:83], v[16:19], a[48:51], v[80:83]
    s_nop 0
    v_mfma_f32_16x16x32_bf16 v[84:87], v[20:23], a[48:51], v[84:87]
    ds_read_b64_tr_b16 v[32:33], v1 offset:12672
    s_mov_b32 m0, 8448
    v_mfma_f32_16x16x32_bf16 v[88:91], v[24:27], a[48:51], v[88:91]
    buffer_load_dwordx4 v11, s[16:19], s35 offen  lds
    v_mfma_f32_16x16x32_bf16 v[92:95], v[28:31], a[48:51], v[92:95]
    ds_read_b64_tr_b16 v[34:35], v1 offset:12928
    v_mfma_f32_16x16x32_bf16 v[96:99], v[16:19], a[52:55], v[96:99]
    v_mfma_f32_16x16x32_bf16 v[100:103], v[20:23], a[52:55], v[100:103]
    ds_read_b64_tr_b16 v[36:37], v1 offset:12704
    v_mfma_f32_16x16x32_bf16 v[104:107], v[24:27], a[52:55], v[104:107]
    v_mfma_f32_16x16x32_bf16 v[108:111], v[28:31], a[52:55], v[108:111]
    ds_read_b64_tr_b16 v[38:39], v1 offset:12960
    s_mov_b32 m0, 9504
    v_mfma_f32_16x16x32_bf16 v[112:115], v[16:19], a[56:59], v[112:115]
    buffer_load_dwordx4 v12, s[16:19], s35 offen  lds
    v_mfma_f32_16x16x32_bf16 v[116:119], v[20:23], a[56:59], v[116:119]
    ds_read_b64_tr_b16 v[40:41], v1 offset:12736
    s_add_u32 m0, s39, 60928
    s_add_u32 s34, s34, 73728
    buffer_load_dwordx4 v8, s[8:11], s33 offen nt lds
    v_mfma_f32_16x16x32_bf16 v[120:123], v[24:27], a[56:59], v[120:123]
    v_mfma_f32_16x16x32_bf16 v[124:127], v[28:31], a[56:59], v[124:127]
    ds_read_b64_tr_b16 v[42:43], v1 offset:12992
    v_mfma_f32_16x16x32_bf16 v[128:131], v[16:19], a[60:63], v[128:131]
    v_mfma_f32_16x16x32_bf16 v[132:135], v[20:23], a[60:63], v[132:135]
    ds_read_b64_tr_b16 v[44:45], v1 offset:12768
    s_mov_b32 m0, 10560
    v_mfma_f32_16x16x32_bf16 v[136:139], v[24:27], a[60:63], v[136:139]
    buffer_load_dwordx4 v3, s[16:19], s35 offen  lds
    v_mfma_f32_16x16x32_bf16 v[140:143], v[28:31], a[60:63], v[140:143]
    ds_read_b64_tr_b16 v[46:47], v1 offset:13024
    v_mfma_f32_16x16x32_bf16 v[144:147], v[16:19], a[64:67], v[144:147]
    s_add_u32 m0, s39, 61728
    v_mfma_f32_16x16x32_bf16 v[148:151], v[20:23], a[64:67], v[148:151]
    buffer_load_dwordx4 v8, s[8:11], s33 offen offset:256 nt lds
    s_add_u32 s33, s33, 8192
    v_mfma_f32_16x16x32_bf16 v[152:155], v[24:27], a[64:67], v[152:155]
    v_mfma_f32_16x16x32_bf16 v[156:159], v[28:31], a[64:67], v[156:159]
    s_mov_b32 m0, 11616
    v_mfma_f32_16x16x32_bf16 v[160:163], v[16:19], a[68:71], v[160:163]
    buffer_load_dwordx4 v6, s[16:19], s35 offen  lds
    s_add_u32 s35, s35, 262144
    v_mfma_f32_16x16x32_bf16 v[164:167], v[20:23], a[68:71], v[164:167]
    v_mfma_f32_16x16x32_bf16 v[168:171], v[24:27], a[68:71], v[168:171]
    v_mfma_f32_16x16x32_bf16 v[172:175], v[28:31], a[68:71], v[172:175]
    s_waitcnt lgkmcnt(0)
    v_mfma_f32_16x16x32_bf16 v[80:83], v[32:35], a[72:75], v[80:83]
    s_nop 0
    v_mfma_f32_16x16x32_bf16 v[84:87], v[36:39], a[72:75], v[84:87]
    ds_read_b64_tr_b16 v[16:17], v1 offset:16896
    s_mov_b32 m0, 12672
    v_mfma_f32_16x16x32_bf16 v[88:91], v[40:43], a[72:75], v[88:91]
    buffer_load_dwordx4 v11, s[16:19], s35 offen  lds
    v_mfma_f32_16x16x32_bf16 v[92:95], v[44:47], a[72:75], v[92:95]
    ds_read_b64_tr_b16 v[18:19], v1 offset:17152
    v_mfma_f32_16x16x32_bf16 v[96:99], v[32:35], a[76:79], v[96:99]
    v_mfma_f32_16x16x32_bf16 v[100:103], v[36:39], a[76:79], v[100:103]
    ds_read_b64_tr_b16 v[20:21], v1 offset:16928
    v_mfma_f32_16x16x32_bf16 v[104:107], v[40:43], a[76:79], v[104:107]
    v_mfma_f32_16x16x32_bf16 v[108:111], v[44:47], a[76:79], v[108:111]
    ds_read_b64_tr_b16 v[22:23], v1 offset:17184
    s_mov_b32 m0, 13728
    v_mfma_f32_16x16x32_bf16 v[112:115], v[32:35], a[80:83], v[112:115]
    buffer_load_dwordx4 v12, s[16:19], s35 offen  lds
    v_mfma_f32_16x16x32_bf16 v[116:119], v[36:39], a[80:83], v[116:119]
    ds_read_b64_tr_b16 v[24:25], v1 offset:16960
    v_mfma_f32_16x16x32_bf16 v[120:123], v[40:43], a[80:83], v[120:123]
    v_mfma_f32_16x16x32_bf16 v[124:127], v[44:47], a[80:83], v[124:127]
    ds_read_b64_tr_b16 v[26:27], v1 offset:17216
    v_mfma_f32_16x16x32_bf16 v[128:131], v[32:35], a[84:87], v[128:131]
    v_mfma_f32_16x16x32_bf16 v[132:135], v[36:39], a[84:87], v[132:135]
    ds_read_b64_tr_b16 v[28:29], v1 offset:16992
    s_mov_b32 m0, 14784
    v_mfma_f32_16x16x32_bf16 v[136:139], v[40:43], a[84:87], v[136:139]
    buffer_load_dwordx4 v3, s[16:19], s35 offen  lds
    v_mfma_f32_16x16x32_bf16 v[140:143], v[44:47], a[84:87], v[140:143]
    ds_read_b64_tr_b16 v[30:31], v1 offset:17248
    v_mfma_f32_16x16x32_bf16 v[144:147], v[32:35], a[88:91], v[144:147]
    s_waitcnt vmcnt(19)
    s_barrier
    s_add_u32 m0, s40, 69632
    v_mfma_f32_16x16x32_bf16 v[148:151], v[36:39], a[88:91], v[148:151]
    buffer_load_dwordx4 v7, s[4:7], s32 offen nt lds
    v_mfma_f32_16x16x32_bf16 v[152:155], v[40:43], a[88:91], v[152:155]
    v_mfma_f32_16x16x32_bf16 v[156:159], v[44:47], a[88:91], v[156:159]
    s_mov_b32 m0, 15840
    v_mfma_f32_16x16x32_bf16 v[160:163], v[32:35], a[92:95], v[160:163]
    buffer_load_dwordx4 v6, s[16:19], s35 offen  lds
    s_add_u32 s35, s35, 262144
    v_mfma_f32_16x16x32_bf16 v[164:167], v[36:39], a[92:95], v[164:167]
    s_add_u32 m0, s40, 69696
    v_mfma_f32_16x16x32_bf16 v[168:171], v[40:43], a[92:95], v[168:171]
    buffer_load_dwordx4 v7, s[4:7], s32 offen offset:1024 nt lds
    v_mfma_f32_16x16x32_bf16 v[172:175], v[44:47], a[92:95], v[172:175]
    s_waitcnt lgkmcnt(0)
    v_mfma_f32_16x16x32_bf16 v[80:83], v[16:19], a[96:99], v[80:83]
    s_nop 0
    v_mfma_f32_16x16x32_bf16 v[84:87], v[20:23], a[96:99], v[84:87]
    ds_read_b64_tr_b16 v[32:33], v1 offset:21120
    s_mov_b32 m0, 16896
    v_mfma_f32_16x16x32_bf16 v[88:91], v[24:27], a[96:99], v[88:91]
    buffer_load_dwordx4 v11, s[16:19], s35 offen  lds
    v_mfma_f32_16x16x32_bf16 v[92:95], v[28:31], a[96:99], v[92:95]
    ds_read_b64_tr_b16 v[34:35], v1 offset:21376
    v_mfma_f32_16x16x32_bf16 v[96:99], v[16:19], a[100:103], v[96:99]
    s_add_u32 m0, s39, 78336
    s_add_u32 s32, s32, 8192
    buffer_load_dwordx4 v9, s[12:15], s34 offen  lds
    v_mfma_f32_16x16x32_bf16 v[100:103], v[20:23], a[100:103], v[100:103]
    ds_read_b64_tr_b16 v[36:37], v1 offset:21152
    v_mfma_f32_16x16x32_bf16 v[104:107], v[24:27], a[100:103], v[104:107]
    v_mfma_f32_16x16x32_bf16 v[108:111], v[28:31], a[100:103], v[108:111]
    ds_read_b64_tr_b16 v[38:39], v1 offset:21408
    s_mov_b32 m0, 17952
    v_mfma_f32_16x16x32_bf16 v[112:115], v[16:19], a[104:107], v[112:115]
    buffer_load_dwordx4 v12, s[16:19], s35 offen  lds
    v_mfma_f32_16x16x32_bf16 v[116:119], v[20:23], a[104:107], v[116:119]
    ds_read_b64_tr_b16 v[40:41], v1 offset:21184
    s_add_u32 m0, s39, 78240
    v_mfma_f32_16x16x32_bf16 v[120:123], v[24:27], a[104:107], v[120:123]
    buffer_load_dwordx4 v9, s[12:15], s34 offen offset:1152  lds
    v_mfma_f32_16x16x32_bf16 v[124:127], v[28:31], a[104:107], v[124:127]
    ds_read_b64_tr_b16 v[42:43], v1 offset:21440
    v_mfma_f32_16x16x32_bf16 v[128:131], v[16:19], a[108:111], v[128:131]
    v_mfma_f32_16x16x32_bf16 v[132:135], v[20:23], a[108:111], v[132:135]
    ds_read_b64_tr_b16 v[44:45], v1 offset:21216
    s_mov_b32 m0, 19008
    v_mfma_f32_16x16x32_bf16 v[136:139], v[24:27], a[108:111], v[136:139]
    buffer_load_dwordx4 v3, s[16:19], s35 offen  lds
    v_mfma_f32_16x16x32_bf16 v[140:143], v[28:31], a[108:111], v[140:143]
    ds_read_b64_tr_b16 v[46:47], v1 offset:21472
    v_mfma_f32_16x16x32_bf16 v[144:147], v[16:19], a[112:115], v[144:147]
    s_add_u32 m0, s39, 87040
    s_sub_u32 s34, s34, 73600
    buffer_load_dwordx4 v8, s[8:11], s33 offen nt lds
    v_mfma_f32_16x16x32_bf16 v[148:151], v[20:23], a[112:115], v[148:151]
    v_mfma_f32_16x16x32_bf16 v[152:155], v[24:27], a[112:115], v[152:155]
    v_mfma_f32_16x16x32_bf16 v[156:159], v[28:31], a[112:115], v[156:159]
    s_mov_b32 m0, 20064
    v_mfma_f32_16x16x32_bf16 v[160:163], v[16:19], a[116:119], v[160:163]
    buffer_load_dwordx4 v6, s[16:19], s35 offen  lds
    s_add_u32 s35, s35, 262144
    s_add_u32 m0, s39, 87840
    v_mfma_f32_16x16x32_bf16 v[164:167], v[20:23], a[116:119], v[164:167]
    buffer_load_dwordx4 v8, s[8:11], s33 offen offset:256 nt lds
    v_mfma_f32_16x16x32_bf16 v[168:171], v[24:27], a[116:119], v[168:171]
    v_mfma_f32_16x16x32_bf16 v[172:175], v[28:31], a[116:119], v[172:175]
    s_waitcnt lgkmcnt(0)
    v_mfma_f32_16x16x32_bf16 v[80:83], v[32:35], a[120:123], v[80:83]
    s_waitcnt vmcnt(28)
    v_mfma_f32_16x16x32_bf16 v[84:87], v[36:39], a[120:123], v[84:87]
    ds_read_b64_tr_b16 v[16:17], v1 offset:0
    s_mov_b32 m0, 21120
    v_mfma_f32_16x16x32_bf16 v[88:91], v[40:43], a[120:123], v[88:91]
    buffer_load_dwordx4 v11, s[16:19], s35 offen  lds
    v_mfma_f32_16x16x32_bf16 v[92:95], v[44:47], a[120:123], v[92:95]
    ds_read_b64_tr_b16 v[18:19], v1 offset:256
    s_add_u32 m0, s40, 95744
    s_add_u32 s33, s33, 8192
    buffer_load_dwordx4 v7, s[4:7], s32 offen nt lds
    v_mfma_f32_16x16x32_bf16 v[96:99], v[32:35], a[124:127], v[96:99]
    v_mfma_f32_16x16x32_bf16 v[100:103], v[36:39], a[124:127], v[100:103]
    ds_read_b64_tr_b16 v[20:21], v1 offset:32
    v_mfma_f32_16x16x32_bf16 v[104:107], v[40:43], a[124:127], v[104:107]
    v_mfma_f32_16x16x32_bf16 v[108:111], v[44:47], a[124:127], v[108:111]
    ds_read_b64_tr_b16 v[22:23], v1 offset:288
    s_mov_b32 m0, 22176
    v_mfma_f32_16x16x32_bf16 v[112:115], v[32:35], a[128:131], v[112:115]
    buffer_load_dwordx4 v12, s[16:19], s35 offen  lds
    v_mfma_f32_16x16x32_bf16 v[116:119], v[36:39], a[128:131], v[116:119]
    s_add_u32 m0, s40, 95808
    ds_read_b64_tr_b16 v[24:25], v1 offset:64
    buffer_load_dwordx4 v7, s[4:7], s32 offen offset:1024 nt lds
    s_add_u32 s32, s32, 8192
    v_mfma_f32_16x16x32_bf16 v[120:123], v[40:43], a[128:131], v[120:123]
    v_mfma_f32_16x16x32_bf16 v[124:127], v[44:47], a[128:131], v[124:127]
    ds_read_b64_tr_b16 v[26:27], v1 offset:320
    v_mfma_f32_16x16x32_bf16 v[128:131], v[32:35], a[132:135], v[128:131]
    v_mfma_f32_16x16x32_bf16 v[132:135], v[36:39], a[132:135], v[132:135]
    ds_read_b64_tr_b16 v[28:29], v1 offset:96
    s_mov_b32 m0, 23232
    v_mfma_f32_16x16x32_bf16 v[136:139], v[40:43], a[132:135], v[136:139]
    buffer_load_dwordx4 v3, s[16:19], s35 offen  lds
    v_mfma_f32_16x16x32_bf16 v[140:143], v[44:47], a[132:135], v[140:143]
    ds_read_b64_tr_b16 v[30:31], v1 offset:352
    v_mfma_f32_16x16x32_bf16 v[144:147], v[32:35], a[136:139], v[144:147]
    v_mfma_f32_16x16x32_bf16 v[148:151], v[36:39], a[136:139], v[148:151]
    v_mfma_f32_16x16x32_bf16 v[152:155], v[40:43], a[136:139], v[152:155]
    v_mfma_f32_16x16x32_bf16 v[156:159], v[44:47], a[136:139], v[156:159]
    s_mov_b32 m0, 24288
    v_mfma_f32_16x16x32_bf16 v[160:163], v[32:35], a[140:143], v[160:163]
    buffer_load_dwordx4 v6, s[16:19], s35 offen  lds
    s_add_u32 s35, s35, 262144
    v_mfma_f32_16x16x32_bf16 v[164:167], v[36:39], a[140:143], v[164:167]
    v_mfma_f32_16x16x32_bf16 v[168:171], v[40:43], a[140:143], v[168:171]
    v_mfma_f32_16x16x32_bf16 v[172:175], v[44:47], a[140:143], v[172:175]
    s_waitcnt lgkmcnt(0)
    v_mfma_f32_16x16x32_bf16 v[80:83], v[16:19], a[144:147], v[80:83]
    s_waitcnt vmcnt(27)
    v_mfma_f32_16x16x32_bf16 v[84:87], v[20:23], a[144:147], v[84:87]
    ds_read_b64_tr_b16 v[32:33], v1 offset:4224
    s_waitcnt vmcnt(21)
    s_barrier
    s_mov_b32 m0, 0
    v_mfma_f32_16x16x32_bf16 v[88:91], v[24:27], a[144:147], v[88:91]
    buffer_load_dwordx4 v11, s[16:19], s35 offen  lds
    v_mfma_f32_16x16x32_bf16 v[92:95], v[28:31], a[144:147], v[92:95]
    s_add_u32 m0, s39, 104448
    ds_read_b64_tr_b16 v[34:35], v1 offset:4480
    buffer_load_dwordx4 v9, s[12:15], s34 offen  lds
    v_mfma_f32_16x16x32_bf16 v[96:99], v[16:19], a[148:151], v[96:99]
    v_mfma_f32_16x16x32_bf16 v[100:103], v[20:23], a[148:151], v[100:103]
    ds_read_b64_tr_b16 v[36:37], v1 offset:4256
    v_mfma_f32_16x16x32_bf16 v[104:107], v[24:27], a[148:151], v[104:107]
    v_mfma_f32_16x16x32_bf16 v[108:111], v[28:31], a[148:151], v[108:111]
    ds_read_b64_tr_b16 v[38:39], v1 offset:4512
    s_mov_b32 m0, 1056
    v_mfma_f32_16x16x32_bf16 v[112:115], v[16:19], a[152:155], v[112:115]
    buffer_load_dwordx4 v12, s[16:19], s35 offen  lds
    v_mfma_f32_16x16x32_bf16 v[116:119], v[20:23], a[152:155], v[116:119]
    ds_read_b64_tr_b16 v[40:41], v1 offset:4288
    s_add_u32 m0, s39, 104352
    v_mfma_f32_16x16x32_bf16 v[120:123], v[24:27], a[152:155], v[120:123]
    buffer_load_dwordx4 v9, s[12:15], s34 offen offset:1152  lds
    v_mfma_f32_16x16x32_bf16 v[124:127], v[28:31], a[152:155], v[124:127]
    ds_read_b64_tr_b16 v[42:43], v1 offset:4544
    v_mfma_f32_16x16x32_bf16 v[128:131], v[16:19], a[156:159], v[128:131]
    v_mfma_f32_16x16x32_bf16 v[132:135], v[20:23], a[156:159], v[132:135]
    ds_read_b64_tr_b16 v[44:45], v1 offset:4320
    s_mov_b32 m0, 2112
    v_mfma_f32_16x16x32_bf16 v[136:139], v[24:27], a[156:159], v[136:139]
    buffer_load_dwordx4 v3, s[16:19], s35 offen  lds
    v_mfma_f32_16x16x32_bf16 v[140:143], v[28:31], a[156:159], v[140:143]
    ds_read_b64_tr_b16 v[46:47], v1 offset:4576
    v_mfma_f32_16x16x32_bf16 v[144:147], v[16:19], a[160:163], v[144:147]
    v_mfma_f32_16x16x32_bf16 v[148:151], v[20:23], a[160:163], v[148:151]
    s_add_u32 m0, s39, 26112
    s_add_u32 s34, s34, 73728
    buffer_load_dwordx4 v8, s[8:11], s33 offen nt lds
    v_mfma_f32_16x16x32_bf16 v[152:155], v[24:27], a[160:163], v[152:155]
    v_mfma_f32_16x16x32_bf16 v[156:159], v[28:31], a[160:163], v[156:159]
    s_mov_b32 m0, 3168
    v_mfma_f32_16x16x32_bf16 v[160:163], v[16:19], a[164:167], v[160:163]
    buffer_load_dwordx4 v6, s[16:19], s35 offen  lds
    s_add_u32 s35, s35, 262144
    v_mfma_f32_16x16x32_bf16 v[164:167], v[20:23], a[164:167], v[164:167]
    v_mfma_f32_16x16x32_bf16 v[168:171], v[24:27], a[164:167], v[168:171]
    v_mfma_f32_16x16x32_bf16 v[172:175], v[28:31], a[164:167], v[172:175]
    s_waitcnt lgkmcnt(0)
    v_mfma_f32_16x16x32_bf16 v[80:83], v[32:35], a[168:171], v[80:83]
    s_waitcnt vmcnt(27)
    s_add_u32 m0, s39, 26912
    s_nop 0
    buffer_load_dwordx4 v8, s[8:11], s33 offen offset:256 nt lds
    v_mfma_f32_16x16x32_bf16 v[84:87], v[36:39], a[168:171], v[84:87]
    ds_read_b64_tr_b16 v[16:17], v1 offset:8448
    s_mov_b32 m0, 4224
    v_mfma_f32_16x16x32_bf16 v[88:91], v[40:43], a[168:171], v[88:91]
    buffer_load_dwordx4 v11, s[16:19], s35 offen  lds
    v_mfma_f32_16x16x32_bf16 v[92:95], v[44:47], a[168:171], v[92:95]
    ds_read_b64_tr_b16 v[18:19], v1 offset:8704
    v_mfma_f32_16x16x32_bf16 v[96:99], v[32:35], a[172:175], v[96:99]
    v_mfma_f32_16x16x32_bf16 v[100:103], v[36:39], a[172:175], v[100:103]
    ds_read_b64_tr_b16 v[20:21], v1 offset:8480
    v_mfma_f32_16x16x32_bf16 v[104:107], v[40:43], a[172:175], v[104:107]
    v_mfma_f32_16x16x32_bf16 v[108:111], v[44:47], a[172:175], v[108:111]
    ds_read_b64_tr_b16 v[22:23], v1 offset:8736
    s_add_u32 m0, s40, 34816
    s_add_u32 s33, s33, 8192
    buffer_load_dwordx4 v7, s[4:7], s32 offen nt lds
    s_mov_b32 m0, 5280
    v_mfma_f32_16x16x32_bf16 v[112:115], v[32:35], a[176:179], v[112:115]
    buffer_load_dwordx4 v12, s[16:19], s35 offen  lds
    v_mfma_f32_16x16x32_bf16 v[116:119], v[36:39], a[176:179], v[116:119]
    ds_read_b64_tr_b16 v[24:25], v1 offset:8512
    v_mfma_f32_16x16x32_bf16 v[120:123], v[40:43], a[176:179], v[120:123]
    v_mfma_f32_16x16x32_bf16 v[124:127], v[44:47], a[176:179], v[124:127]
    ds_read_b64_tr_b16 v[26:27], v1 offset:8768
    v_mfma_f32_16x16x32_bf16 v[128:131], v[32:35], a[180:183], v[128:131]
    v_mfma_f32_16x16x32_bf16 v[132:135], v[36:39], a[180:183], v[132:135]
    ds_read_b64_tr_b16 v[28:29], v1 offset:8544
    s_mov_b32 m0, 6336
    v_mfma_f32_16x16x32_bf16 v[136:139], v[40:43], a[180:183], v[136:139]
    buffer_load_dwordx4 v3, s[16:19], s35 offen  lds
    v_mfma_f32_16x16x32_bf16 v[140:143], v[44:47], a[180:183], v[140:143]
    s_add_u32 m0, s40, 34880
    ds_read_b64_tr_b16 v[30:31], v1 offset:8800
    buffer_load_dwordx4 v7, s[4:7], s32 offen offset:1024 nt lds
    s_add_u32 s32, s32, 8192
    v_mfma_f32_16x16x32_bf16 v[144:147], v[32:35], a[184:187], v[144:147]
    v_mfma_f32_16x16x32_bf16 v[148:151], v[36:39], a[184:187], v[148:151]
    v_mfma_f32_16x16x32_bf16 v[152:155], v[40:43], a[184:187], v[152:155]
    v_mfma_f32_16x16x32_bf16 v[156:159], v[44:47], a[184:187], v[156:159]
    s_mov_b32 m0, 7392
    v_mfma_f32_16x16x32_bf16 v[160:163], v[32:35], a[188:191], v[160:163]
    buffer_load_dwordx4 v6, s[16:19], s35 offen  lds
    s_add_u32 s35, s35, 262144
    v_mfma_f32_16x16x32_bf16 v[164:167], v[36:39], a[188:191], v[164:167]
    v_mfma_f32_16x16x32_bf16 v[168:171], v[40:43], a[188:191], v[168:171]
    v_mfma_f32_16x16x32_bf16 v[172:175], v[44:47], a[188:191], v[172:175]
    s_waitcnt lgkmcnt(0)
    v_mfma_f32_16x16x32_bf16 v[80:83], v[16:19], a[192:195], v[80:83]
    s_waitcnt vmcnt(29)
    v_mfma_f32_16x16x32_bf16 v[84:87], v[20:23], a[192:195], v[84:87]
    ds_read_b64_tr_b16 v[32:33], v1 offset:12672
    s_mov_b32 m0, 8448
    v_mfma_f32_16x16x32_bf16 v[88:91], v[24:27], a[192:195], v[88:91]
    buffer_load_dwordx4 v11, s[16:19], s35 offen  lds
    v_mfma_f32_16x16x32_bf16 v[92:95], v[28:31], a[192:195], v[92:95]
    ds_read_b64_tr_b16 v[34:35], v1 offset:12928
    v_mfma_f32_16x16x32_bf16 v[96:99], v[16:19], a[196:199], v[96:99]
    v_mfma_f32_16x16x32_bf16 v[100:103], v[20:23], a[196:199], v[100:103]
    ds_read_b64_tr_b16 v[36:37], v1 offset:12704
    v_mfma_f32_16x16x32_bf16 v[104:107], v[24:27], a[196:199], v[104:107]
    v_mfma_f32_16x16x32_bf16 v[108:111], v[28:31], a[196:199], v[108:111]
    ds_read_b64_tr_b16 v[38:39], v1 offset:12960
    s_mov_b32 m0, 9504
    v_mfma_f32_16x16x32_bf16 v[112:115], v[16:19], a[200:203], v[112:115]
    buffer_load_dwordx4 v12, s[16:19], s35 offen  lds
    v_mfma_f32_16x16x32_bf16 v[116:119], v[20:23], a[200:203], v[116:119]
    ds_read_b64_tr_b16 v[40:41], v1 offset:12736
    s_waitcnt vmcnt(22)
    s_barrier
    s_add_u32 m0, s39, 43520
    v_mfma_f32_16x16x32_bf16 v[120:123], v[24:27], a[200:203], v[120:123]
    buffer_load_dwordx4 v9, s[12:15], s34 offen  lds
    v_mfma_f32_16x16x32_bf16 v[124:127], v[28:31], a[200:203], v[124:127]
    ds_read_b64_tr_b16 v[42:43], v1 offset:12992
    v_mfma_f32_16x16x32_bf16 v[128:131], v[16:19], a[204:207], v[128:131]
    v_mfma_f32_16x16x32_bf16 v[132:135], v[20:23], a[204:207], v[132:135]
    ds_read_b64_tr_b16 v[44:45], v1 offset:12768
    s_mov_b32 m0, 10560
    v_mfma_f32_16x16x32_bf16 v[136:139], v[24:27], a[204:207], v[136:139]
    buffer_load_dwordx4 v3, s[16:19], s35 offen  lds
    v_mfma_f32_16x16x32_bf16 v[140:143], v[28:31], a[204:207], v[140:143]
    ds_read_b64_tr_b16 v[46:47], v1 offset:13024
    v_mfma_f32_16x16x32_bf16 v[144:147], v[16:19], a[208:211], v[144:147]
    s_add_u32 m0, s39, 43424
    v_mfma_f32_16x16x32_bf16 v[148:151], v[20:23], a[208:211], v[148:151]
    buffer_load_dwordx4 v9, s[12:15], s34 offen offset:1152  lds
    v_mfma_f32_16x16x32_bf16 v[152:155], v[24:27], a[208:211], v[152:155]
    v_mfma_f32_16x16x32_bf16 v[156:159], v[28:31], a[208:211], v[156:159]
    s_mov_b32 m0, 11616
    v_mfma_f32_16x16x32_bf16 v[160:163], v[16:19], a[212:215], v[160:163]
    buffer_load_dwordx4 v6, s[16:19], s35 offen  lds
    s_add_u32 s35, s35, 262144
    v_mfma_f32_16x16x32_bf16 v[164:167], v[20:23], a[212:215], v[164:167]
    v_mfma_f32_16x16x32_bf16 v[168:171], v[24:27], a[212:215], v[168:171]
    v_mfma_f32_16x16x32_bf16 v[172:175], v[28:31], a[212:215], v[172:175]
    s_waitcnt lgkmcnt(0)
    v_mfma_f32_16x16x32_bf16 v[80:83], v[32:35], a[216:219], v[80:83]
    s_nop 0
    s_add_u32 m0, s39, 52224
    s_sub_u32 s34, s34, 73600
    buffer_load_dwordx4 v8, s[8:11], s33 offen nt lds
    v_mfma_f32_16x16x32_bf16 v[84:87], v[36:39], a[216:219], v[84:87]
    ds_read_b64_tr_b16 v[16:17], v1 offset:16896
    s_mov_b32 m0, 12672
    v_mfma_f32_16x16x32_bf16 v[88:91], v[40:43], a[216:219], v[88:91]
    buffer_load_dwordx4 v11, s[16:19], s35 offen  lds
    v_mfma_f32_16x16x32_bf16 v[92:95], v[44:47], a[216:219], v[92:95]
    ds_read_b64_tr_b16 v[18:19], v1 offset:17152
    v_mfma_f32_16x16x32_bf16 v[96:99], v[32:35], a[220:223], v[96:99]
    v_mfma_f32_16x16x32_bf16 v[100:103], v[36:39], a[220:223], v[100:103]
    ds_read_b64_tr_b16 v[20:21], v1 offset:16928
    v_mfma_f32_16x16x32_bf16 v[104:107], v[40:43], a[220:223], v[104:107]
    v_mfma_f32_16x16x32_bf16 v[108:111], v[44:47], a[220:223], v[108:111]
    s_add_u32 m0, s39, 53024
    ds_read_b64_tr_b16 v[22:23], v1 offset:17184
    buffer_load_dwordx4 v8, s[8:11], s33 offen offset:256 nt lds
    s_mov_b32 m0, 13728
    v_mfma_f32_16x16x32_bf16 v[112:115], v[32:35], a[224:227], v[112:115]
    buffer_load_dwordx4 v12, s[16:19], s35 offen  lds
    v_mfma_f32_16x16x32_bf16 v[116:119], v[36:39], a[224:227], v[116:119]
    ds_read_b64_tr_b16 v[24:25], v1 offset:16960
    v_mfma_f32_16x16x32_bf16 v[120:123], v[40:43], a[224:227], v[120:123]
    v_mfma_f32_16x16x32_bf16 v[124:127], v[44:47], a[224:227], v[124:127]
    ds_read_b64_tr_b16 v[26:27], v1 offset:17216
    v_mfma_f32_16x16x32_bf16 v[128:131], v[32:35], a[228:231], v[128:131]
    v_mfma_f32_16x16x32_bf16 v[132:135], v[36:39], a[228:231], v[132:135]
    ds_read_b64_tr_b16 v[28:29], v1 offset:16992
    s_mov_b32 m0, 14784
    v_mfma_f32_16x16x32_bf16 v[136:139], v[40:43], a[228:231], v[136:139]
    buffer_load_dwordx4 v3, s[16:19], s35 offen  lds
    v_mfma_f32_16x16x32_bf16 v[140:143], v[44:47], a[228:231], v[140:143]
    ds_read_b64_tr_b16 v[30:31], v1 offset:17248
    s_add_u32 m0, s40, 60928
    s_add_u32 s33, s33, 8192
    buffer_load_dwordx4 v7, s[4:7], s32 offen nt lds
    v_mfma_f32_16x16x32_bf16 v[144:147], v[32:35], a[232:235], v[144:147]
    v_mfma_f32_16x16x32_bf16 v[148:151], v[36:39], a[232:235], v[148:151]
    v_mfma_f32_16x16x32_bf16 v[152:155], v[40:43], a[232:235], v[152:155]
    v_mfma_f32_16x16x32_bf16 v[156:159], v[44:47], a[232:235], v[156:159]
    s_mov_b32 m0, 15840
    v_mfma_f32_16x16x32_bf16 v[160:163], v[32:35], a[236:239], v[160:163]
    buffer_load_dwordx4 v6, s[16:19], s35 offen  lds
    s_add_u32 s35, s35, 262144
    v_mfma_f32_16x16x32_bf16 v[164:167], v[36:39], a[236:239], v[164:167]
    s_add_u32 m0, s40, 60992
    v_mfma_f32_16x16x32_bf16 v[168:171], v[40:43], a[236:239], v[168:171]
    buffer_load_dwordx4 v7, s[4:7], s32 offen offset:1024 nt lds
    s_add_u32 s32, s32, 8192
    v_mfma_f32_16x16x32_bf16 v[172:175], v[44:47], a[236:239], v[172:175]
    s_waitcnt lgkmcnt(0)
    v_mfma_f32_16x16x32_bf16 v[80:83], v[16:19], a[240:243], v[80:83]
    s_waitcnt vmcnt(28)
    v_mfma_f32_16x16x32_bf16 v[84:87], v[20:23], a[240:243], v[84:87]
    ds_read_b64_tr_b16 v[32:33], v1 offset:21120
    s_mov_b32 m0, 16896
    v_mfma_f32_16x16x32_bf16 v[88:91], v[24:27], a[240:243], v[88:91]
    buffer_load_dwordx4 v11, s[16:19], s35 offen  lds
    v_mfma_f32_16x16x32_bf16 v[92:95], v[28:31], a[240:243], v[92:95]
    ds_read_b64_tr_b16 v[34:35], v1 offset:21376
    v_mfma_f32_16x16x32_bf16 v[96:99], v[16:19], a[244:247], v[96:99]
    v_mfma_f32_16x16x32_bf16 v[100:103], v[20:23], a[244:247], v[100:103]
    ds_read_b64_tr_b16 v[36:37], v1 offset:21152
    v_mfma_f32_16x16x32_bf16 v[104:107], v[24:27], a[244:247], v[104:107]
    v_mfma_f32_16x16x32_bf16 v[108:111], v[28:31], a[244:247], v[108:111]
    ds_read_b64_tr_b16 v[38:39], v1 offset:21408
    s_mov_b32 m0, 17952
    v_mfma_f32_16x16x32_bf16 v[112:115], v[16:19], a[248:251], v[112:115]
    buffer_load_dwordx4 v12, s[16:19], s35 offen  lds
    v_mfma_f32_16x16x32_bf16 v[116:119], v[20:23], a[248:251], v[116:119]
    ds_read_b64_tr_b16 v[40:41], v1 offset:21184
    v_mfma_f32_16x16x32_bf16 v[120:123], v[24:27], a[248:251], v[120:123]
    v_mfma_f32_16x16x32_bf16 v[124:127], v[28:31], a[248:251], v[124:127]
    ds_read_b64_tr_b16 v[42:43], v1 offset:21440
    v_mfma_f32_16x16x32_bf16 v[128:131], v[16:19], a[252:255], v[128:131]
    v_mfma_f32_16x16x32_bf16 v[132:135], v[20:23], a[252:255], v[132:135]
    ds_read_b64_tr_b16 v[44:45], v1 offset:21216
    s_mov_b32 m0, 19008
    v_mfma_f32_16x16x32_bf16 v[136:139], v[24:27], a[252:255], v[136:139]
    buffer_load_dwordx4 v3, s[16:19], s35 offen  lds
    v_mfma_f32_16x16x32_bf16 v[140:143], v[28:31], a[252:255], v[140:143]
    ds_read_b64_tr_b16 v[46:47], v1 offset:21472
    v_mfma_f32_16x16x32_bf16 v[144:147], v[16:19], v[176:179], v[144:147]
    v_mfma_f32_16x16x32_bf16 v[148:151], v[20:23], v[176:179], v[148:151]
    s_waitcnt vmcnt(23)
    s_barrier
    s_add_u32 m0, s39, 69632
    v_mfma_f32_16x16x32_bf16 v[152:155], v[24:27], v[176:179], v[152:155]
    buffer_load_dwordx4 v9, s[12:15], s34 offen  lds
    v_mfma_f32_16x16x32_bf16 v[156:159], v[28:31], v[176:179], v[156:159]
    s_mov_b32 m0, 20064
    v_mfma_f32_16x16x32_bf16 v[160:163], v[16:19], v[180:183], v[160:163]
    buffer_load_dwordx4 v6, s[16:19], s35 offen  lds
    s_add_u32 s35, s35, 262144
    v_mfma_f32_16x16x32_bf16 v[164:167], v[20:23], v[180:183], v[164:167]
    v_mfma_f32_16x16x32_bf16 v[168:171], v[24:27], v[180:183], v[168:171]
    v_mfma_f32_16x16x32_bf16 v[172:175], v[28:31], v[180:183], v[172:175]
    s_waitcnt lgkmcnt(0)
    v_mfma_f32_16x16x32_bf16 v[80:83], v[32:35], v[184:187], v[80:83]
    s_nop 0
    v_mfma_f32_16x16x32_bf16 v[84:87], v[36:39], v[184:187], v[84:87]
    s_add_u32 m0, s39, 69536
    ds_read_b64_tr_b16 v[16:17], v1 offset:0
    buffer_load_dwordx4 v9, s[12:15], s34 offen offset:1152  lds
    s_mov_b32 m0, 21120
    v_mfma_f32_16x16x32_bf16 v[88:91], v[40:43], v[184:187], v[88:91]
    buffer_load_dwordx4 v11, s[16:19], s35 offen  lds
    v_mfma_f32_16x16x32_bf16 v[92:95], v[44:47], v[184:187], v[92:95]
    ds_read_b64_tr_b16 v[18:19], v1 offset:256
    v_mfma_f32_16x16x32_bf16 v[96:99], v[32:35], v[188:191], v[96:99]
    v_mfma_f32_16x16x32_bf16 v[100:103], v[36:39], v[188:191], v[100:103]
    ds_read_b64_tr_b16 v[20:21], v1 offset:32
    v_mfma_f32_16x16x32_bf16 v[104:107], v[40:43], v[188:191], v[104:107]
    v_mfma_f32_16x16x32_bf16 v[108:111], v[44:47], v[188:191], v[108:111]
    ds_read_b64_tr_b16 v[22:23], v1 offset:288
    s_mov_b32 m0, 22176
    v_mfma_f32_16x16x32_bf16 v[112:115], v[32:35], v[192:195], v[112:115]
    buffer_load_dwordx4 v12, s[16:19], s35 offen  lds
    v_mfma_f32_16x16x32_bf16 v[116:119], v[36:39], v[192:195], v[116:119]
    ds_read_b64_tr_b16 v[24:25], v1 offset:64
    s_add_u32 m0, s39, 78336
    s_add_u32 s34, s34, 73728
    buffer_load_dwordx4 v8, s[8:11], s33 offen nt lds
    v_mfma_f32_16x16x32_bf16 v[120:123], v[40:43], v[192:195], v[120:123]
    v_mfma_f32_16x16x32_bf16 v[124:127], v[44:47], v[192:195], v[124:127]
    ds_read_b64_tr_b16 v[26:27], v1 offset:320
    v_mfma_f32_16x16x32_bf16 v[128:131], v[32:35], v[196:199], v[128:131]
    v_mfma_f32_16x16x32_bf16 v[132:135], v[36:39], v[196:199], v[132:135]
    ds_read_b64_tr_b16 v[28:29], v1 offset:96
    s_mov_b32 m0, 23232
    v_mfma_f32_16x16x32_bf16 v[136:139], v[40:43], v[196:199], v[136:139]
    buffer_load_dwordx4 v3, s[16:19], s35 offen  lds
    v_mfma_f32_16x16x32_bf16 v[140:143], v[44:47], v[196:199], v[140:143]
    ds_read_b64_tr_b16 v[30:31], v1 offset:352
    s_add_u32 m0, s39, 79136
    v_mfma_f32_16x16x32_bf16 v[144:147], v[32:35], v[200:203], v[144:147]
    buffer_load_dwordx4 v8, s[8:11], s33 offen offset:256 nt lds
    v_mfma_f32_16x16x32_bf16 v[148:151], v[36:39], v[200:203], v[148:151]
    v_mfma_f32_16x16x32_bf16 v[152:155], v[40:43], v[200:203], v[152:155]
    v_mfma_f32_16x16x32_bf16 v[156:159], v[44:47], v[200:203], v[156:159]
    s_mov_b32 m0, 24288
    v_mfma_f32_16x16x32_bf16 v[160:163], v[32:35], v[204:207], v[160:163]
    buffer_load_dwordx4 v6, s[16:19], s35 offen  lds
    s_add_u32 s35, s35, 262144
    v_mfma_f32_16x16x32_bf16 v[164:167], v[36:39], v[204:207], v[164:167]
    v_mfma_f32_16x16x32_bf16 v[168:171], v[40:43], v[204:207], v[168:171]
    v_mfma_f32_16x16x32_bf16 v[172:175], v[44:47], v[204:207], v[172:175]
    s_add_u32 m0, s40, 87040
    s_add_u32 s33, s33, 8192
    buffer_load_dwordx4 v7, s[4:7], s32 offen nt lds
    s_waitcnt lgkmcnt(0)
    v_mfma_f32_16x16x32_bf16 v[80:83], v[16:19], v[208:211], v[80:83]
    s_waitcnt vmcnt(27)
    v_mfma_f32_16x16x32_bf16 v[84:87], v[20:23], v[208:211], v[84:87]
    ds_read_b64_tr_b16 v[32:33], v1 offset:4224
    v_mfma_f32_16x16x32_bf16 v[88:91], v[24:27], v[208:211], v[88:91]
    s_add_u32 s51, s51, 1
    s_lshr_b32 s49, s51, 1
    s_lshl_b32 s48, s49, 2
    s_lshr_b32 s48, s41, s48
    s_and_b32 s48, s48, 3
    s_lshl_b32 s49, s44, 2
    s_add_u32 s48, s48, s49
    s_lshl_b32 s48, s48, 8
    s_xor_b32 s49, s51, s52
    s_and_b32 s49, s49, 1
    s_lshl_b32 s49, s49, 7
    s_add_u32 s35, s48, s49
    s_cmp_ge_u32 s51, 8
    s_cselect_b32 s18, 0, s18
    s_mov_b32 m0, 0
    s_nop 0
    buffer_load_dwordx4 v11, s[16:19], s35 offen  lds
    v_mfma_f32_16x16x32_bf16 v[92:95], v[28:31], v[208:211], v[92:95]
    ds_read_b64_tr_b16 v[34:35], v1 offset:4480
    v_mfma_f32_16x16x32_bf16 v[96:99], v[16:19], v[212:215], v[96:99]
    v_mfma_f32_16x16x32_bf16 v[100:103], v[20:23], v[212:215], v[100:103]
    ds_read_b64_tr_b16 v[36:37], v1 offset:4256
    s_add_u32 m0, s40, 87104
    v_mfma_f32_16x16x32_bf16 v[104:107], v[24:27], v[212:215], v[104:107]
    buffer_load_dwordx4 v7, s[4:7], s32 offen offset:1024 nt lds
    s_add_u32 s32, s32, 8192
    v_mfma_f32_16x16x32_bf16 v[108:111], v[28:31], v[212:215], v[108:111]
    ds_read_b64_tr_b16 v[38:39], v1 offset:4512
    s_mov_b32 m0, 1056
    v_mfma_f32_16x16x32_bf16 v[112:115], v[16:19], v[216:219], v[112:115]
    buffer_load_dwordx4 v12, s[16:19], s35 offen  lds
    v_mfma_f32_16x16x32_bf16 v[116:119], v[20:23], v[216:219], v[116:119]
    ds_read_b64_tr_b16 v[40:41], v1 offset:4288
    v_mfma_f32_16x16x32_bf16 v[120:123], v[24:27], v[216:219], v[120:123]
    v_mfma_f32_16x16x32_bf16 v[124:127], v[28:31], v[216:219], v[124:127]
    ds_read_b64_tr_b16 v[42:43], v1 offset:4544
    v_mfma_f32_16x16x32_bf16 v[128:131], v[16:19], v[220:223], v[128:131]
    v_mfma_f32_16x16x32_bf16 v[132:135], v[20:23], v[220:223], v[132:135]
    ds_read_b64_tr_b16 v[44:45], v1 offset:4320
    s_mov_b32 m0, 2112
    v_mfma_f32_16x16x32_bf16 v[136:139], v[24:27], v[220:223], v[136:139]
    buffer_load_dwordx4 v3, s[16:19], s35 offen  lds
    v_mfma_f32_16x16x32_bf16 v[140:143], v[28:31], v[220:223], v[140:143]
    ds_read_b64_tr_b16 v[46:47], v1 offset:4576
    v_mfma_f32_16x16x32_bf16 v[144:147], v[16:19], v[224:227], v[144:147]
    v_mfma_f32_16x16x32_bf16 v[148:151], v[20:23], v[224:227], v[148:151]
    v_mfma_f32_16x16x32_bf16 v[152:155], v[24:27], v[224:227], v[152:155]
    v_mfma_f32_16x16x32_bf16 v[156:159], v[28:31], v[224:227], v[156:159]
    s_mov_b32 m0, 3168
    v_mfma_f32_16x16x32_bf16 v[160:163], v[16:19], v[228:231], v[160:163]
    buffer_load_dwordx4 v6, s[16:19], s35 offen  lds
    s_add_u32 s35, s35, 262144
    v_mfma_f32_16x16x32_bf16 v[164:167], v[20:23], v[228:231], v[164:167]
    v_mfma_f32_16x16x32_bf16 v[168:171], v[24:27], v[228:231], v[168:171]
    v_mfma_f32_16x16x32_bf16 v[172:175], v[28:31], v[228:231], v[172:175]
    s_waitcnt lgkmcnt(0)
    v_mfma_f32_16x16x32_bf16 v[80:83], v[32:35], v[232:235], v[80:83]
    s_waitcnt vmcnt(26)
    v_mfma_f32_16x16x32_bf16 v[84:87], v[36:39], v[232:235], v[84:87]
    ds_read_b64_tr_b16 v[16:17], v1 offset:8448
    s_waitcnt vmcnt(23)
    s_barrier
    s_mov_b32 m0, 4224
    v_mfma_f32_16x16x32_bf16 v[88:91], v[40:43], v[232:235], v[88:91]
    buffer_load_dwordx4 v11, s[16:19], s35 offen  lds
    v_mfma_f32_16x16x32_bf16 v[92:95], v[44:47], v[232:235], v[92:95]
    ds_read_b64_tr_b16 v[18:19], v1 offset:8704
    s_add_u32 m0, s39, 95744
    ds_read_b128 v[48:51], v2 offset:0
    buffer_load_dwordx4 v9, s[12:15], s34 offen  lds
    v_mfma_f32_16x16x32_bf16 v[96:99], v[32:35], v[236:239], v[96:99]
    v_mfma_f32_16x16x32_bf16 v[100:103], v[36:39], v[236:239], v[100:103]
    ds_read_b64_tr_b16 v[20:21], v1 offset:8480
    v_mfma_f32_16x16x32_bf16 v[104:107], v[40:43], v[236:239], v[104:107]
    v_mfma_f32_16x16x32_bf16 v[108:111], v[44:47], v[236:239], v[108:111]
    ds_read_b64_tr_b16 v[22:23], v1 offset:8736
    ds_read_b128 v[52:55], v2 offset:4352
    s_mov_b32 m0, 5280
    v_mfma_f32_16x16x32_bf16 v[112:115], v[32:35], v[240:243], v[112:115]
    buffer_load_dwordx4 v12, s[16:19], s35 offen  lds
    v_mfma_f32_16x16x32_bf16 v[116:119], v[36:39], v[240:243], v[116:119]
    ds_read_b64_tr_b16 v[24:25], v1 offset:8512
    s_add_u32 m0, s39, 95648
    v_mfma_f32_16x16x32_bf16 v[120:123], v[40:43], v[240:243], v[120:123]
    buffer_load_dwordx4 v9, s[12:15], s34 offen offset:1152  lds
    v_mfma_f32_16x16x32_bf16 v[124:127], v[44:47], v[240:243], v[124:127]
    ds_read_b64_tr_b16 v[26:27], v1 offset:8768
    ds_read_b128 v[56:59], v2 offset:8704
    v_mfma_f32_16x16x32_bf16 v[128:131], v[32:35], v[244:247], v[128:131]
    v_mfma_f32_16x16x32_bf16 v[132:135], v[36:39], v[244:247], v[132:135]
    ds_read_b64_tr_b16 v[28:29], v1 offset:8544
    s_mov_b32 m0, 6336
    v_mfma_f32_16x16x32_bf16 v[136:139], v[40:43], v[244:247], v[136:139]
    buffer_load_dwordx4 v3, s[16:19], s35 offen  lds
    v_mfma_f32_16x16x32_bf16 v[140:143], v[44:47], v[244:247], v[140:143]
    ds_read_b64_tr_b16 v[30:31], v1 offset:8800
    ds_read_b128 v[60:63], v2 offset:13056
    v_mfma_f32_16x16x32_bf16 v[144:147], v[32:35], v[248:251], v[144:147]
    v_mfma_f32_16x16x32_bf16 v[148:151], v[36:39], v[248:251], v[148:151]
    v_mfma_f32_16x16x32_bf16 v[152:155], v[40:43], v[248:251], v[152:155]
    s_add_u32 m0, s39, 104448
    s_sub_u32 s34, s34, 73600
    buffer_load_dwordx4 v8, s[8:11], s33 offen nt lds
    v_mfma_f32_16x16x32_bf16 v[156:159], v[44:47], v[248:251], v[156:159]
    ds_read_b128 v[64:67], v2 offset:17408
    s_mov_b32 m0, 7392
    v_mfma_f32_16x16x32_bf16 v[160:163], v[32:35], v[252:255], v[160:163]
    buffer_load_dwordx4 v6, s[16:19], s35 offen  lds
    s_add_u32 s35, s35, 262144
    v_mfma_f32_16x16x32_bf16 v[164:167], v[36:39], v[252:255], v[164:167]
    v_mfma_f32_16x16x32_bf16 v[168:171], v[40:43], v[252:255], v[168:171]
    v_mfma_f32_16x16x32_bf16 v[172:175], v[44:47], v[252:255], v[172:175]
    ds_read_b128 v[68:71], v2 offset:21760
    s_waitcnt lgkmcnt(2)
    v_mfma_f32_16x16x32_bf16 v[80:83], v[16:19], v[48:51], v[80:83]
    s_waitcnt vmcnt(26)
    v_mfma_f32_16x16x32_bf16 v[84:87], v[20:23], v[48:51], v[84:87]
    s_add_u32 m0, s39, 105248
    ds_read_b64_tr_b16 v[32:33], v1 offset:12672
    buffer_load_dwordx4 v8, s[8:11], s33 offen offset:256 nt lds
    s_mov_b32 m0, 8448
    v_mfma_f32_16x16x32_bf16 v[88:91], v[24:27], v[48:51], v[88:91]
    buffer_load_dwordx4 v11, s[16:19], s35 offen  lds
    v_mfma_f32_16x16x32_bf16 v[92:95], v[28:31], v[48:51], v[92:95]
    ds_read_b64_tr_b16 v[34:35], v1 offset:12928
    ds_read_b128 v[48:51], v2 offset:64
    v_mfma_f32_16x16x32_bf16 v[96:99], v[16:19], v[52:55], v[96:99]
    v_mfma_f32_16x16x32_bf16 v[100:103], v[20:23], v[52:55], v[100:103]
    ds_read_b64_tr_b16 v[36:37], v1 offset:12704
    v_mfma_f32_16x16x32_bf16 v[104:107], v[24:27], v[52:55], v[104:107]
    v_mfma_f32_16x16x32_bf16 v[108:111], v[28:31], v[52:55], v[108:111]
    ds_read_b64_tr_b16 v[38:39], v1 offset:12960
    ds_read_b128 v[52:55], v2 offset:4416
    s_mov_b32 m0, 9504
    v_mfma_f32_16x16x32_bf16 v[112:115], v[16:19], v[56:59], v[112:115]
    buffer_load_dwordx4 v12, s[16:19], s35 offen  lds
    v_mfma_f32_16x16x32_bf16 v[116:119], v[20:23], v[56:59], v[116:119]
    ds_read_b64_tr_b16 v[40:41], v1 offset:12736
    v_mfma_f32_16x16x32_bf16 v[120:123], v[24:27], v[56:59], v[120:123]
    s_add_u32 s33, s33, 8192
    s_lshl_b32 s48, s30, 2
    s_lshr_b32 s48, s41, s48
    s_and_b32 s48, s48, 3
    s_lshl_b32 s49, s44, 2
    s_add_u32 s48, s48, s49
    s_lshl_b32 s49, s43, 5
    s_add_u32 s48, s48, s49
    s_lshl_b32 s74, s48, 17
    s_mov_b32 s32, s74
    s_add_u32 m0, s40, 26112
    s_add_u32 s30, s30, 1
    buffer_load_dwordx4 v7, s[4:7], s32 offen nt lds
    v_mfma_f32_16x16x32_bf16 v[124:127], v[28:31], v[56:59], v[124:127]
    ds_read_b64_tr_b16 v[42:43], v1 offset:12992
    ds_read_b128 v[56:59], v2 offset:8768
    v_mfma_f32_16x16x32_bf16 v[128:131], v[16:19], v[60:63], v[128:131]
    v_mfma_f32_16x16x32_bf16 v[132:135], v[20:23], v[60:63], v[132:135]
    ds_read_b64_tr_b16 v[44:45], v1 offset:12768
    s_mov_b32 m0, 10560
    v_mfma_f32_16x16x32_bf16 v[136:139], v[24:27], v[60:63], v[136:139]
    buffer_load_dwordx4 v3, s[16:19], s35 offen  lds
    v_mfma_f32_16x16x32_bf16 v[140:143], v[28:31], v[60:63], v[140:143]
    ds_read_b64_tr_b16 v[46:47], v1 offset:13024
    ds_read_b128 v[60:63], v2 offset:13120
    s_waitcnt lgkmcnt(12)
    v_mfma_f32_16x16x32_bf16 v[144:147], v[16:19], v[64:67], v[144:147]
    s_add_u32 m0, s40, 26176
    v_mfma_f32_16x16x32_bf16 v[148:151], v[20:23], v[64:67], v[148:151]
    buffer_load_dwordx4 v7, s[4:7], s32 offen offset:1024 nt lds
    s_add_u32 s32, s32, 8192
    v_mfma_f32_16x16x32_bf16 v[152:155], v[24:27], v[64:67], v[152:155]
    v_mfma_f32_16x16x32_bf16 v[156:159], v[28:31], v[64:67], v[156:159]
    ds_read_b128 v[64:67], v2 offset:17472
    s_mov_b32 m0, 11616
    v_mfma_f32_16x16x32_bf16 v[160:163], v[16:19], v[68:71], v[160:163]
    buffer_load_dwordx4 v6, s[16:19], s35 offen  lds
    s_add_u32 s35, s35, 262144
    v_mfma_f32_16x16x32_bf16 v[164:167], v[20:23], v[68:71], v[164:167]
    v_mfma_f32_16x16x32_bf16 v[168:171], v[24:27], v[68:71], v[168:171]
    v_mfma_f32_16x16x32_bf16 v[172:175], v[28:31], v[68:71], v[172:175]
    ds_read_b128 v[68:71], v2 offset:21824
    s_waitcnt lgkmcnt(2)
    v_mfma_f32_16x16x32_bf16 v[80:83], v[32:35], v[48:51], v[80:83]
    s_waitcnt vmcnt(27)
    v_mfma_f32_16x16x32_bf16 v[84:87], v[36:39], v[48:51], v[84:87]
    ds_read_b64_tr_b16 v[16:17], v1 offset:16896
    s_mov_b32 m0, 12672
    v_mfma_f32_16x16x32_bf16 v[88:91], v[40:43], v[48:51], v[88:91]
    buffer_load_dwordx4 v11, s[16:19], s35 offen  lds
    v_mfma_f32_16x16x32_bf16 v[92:95], v[44:47], v[48:51], v[92:95]
    ds_read_b64_tr_b16 v[18:19], v1 offset:17152
    ds_read_b128 v[48:51], v2 offset:128
    v_mfma_f32_16x16x32_bf16 v[96:99], v[32:35], v[52:55], v[96:99]
    v_mfma_f32_16x16x32_bf16 v[100:103], v[36:39], v[52:55], v[100:103]
    ds_read_b64_tr_b16 v[20:21], v1 offset:16928
    v_mfma_f32_16x16x32_bf16 v[104:107], v[40:43], v[52:55], v[104:107]
    v_mfma_f32_16x16x32_bf16 v[108:111], v[44:47], v[52:55], v[108:111]
    ds_read_b64_tr_b16 v[22:23], v1 offset:17184
    ds_read_b128 v[52:55], v2 offset:4480
    s_mov_b32 m0, 13728
    v_mfma_f32_16x16x32_bf16 v[112:115], v[32:35], v[56:59], v[112:115]
    buffer_load_dwordx4 v12, s[16:19], s35 offen  lds
    v_mfma_f32_16x16x32_bf16 v[116:119], v[36:39], v[56:59], v[116:119]
    ds_read_b64_tr_b16 v[24:25], v1 offset:16960
    v_mfma_f32_16x16x32_bf16 v[120:123], v[40:43], v[56:59], v[120:123]
    v_mfma_f32_16x16x32_bf16 v[124:127], v[44:47], v[56:59], v[124:127]
    ds_read_b64_tr_b16 v[26:27], v1 offset:17216
    ds_read_b128 v[56:59], v2 offset:8832
    v_mfma_f32_16x16x32_bf16 v[128:131], v[32:35], v[60:63], v[128:131]
    s_waitcnt vmcnt(23)
    s_barrier
    v_mfma_f32_16x16x32_bf16 v[132:135], v[36:39], v[60:63], v[132:135]
    s_add_u32 m0, s39, 34816
    ds_read_b64_tr_b16 v[28:29], v1 offset:16992
    buffer_load_dwordx4 v9, s[12:15], s34 offen  lds
    s_mov_b32 m0, 14784
    v_mfma_f32_16x16x32_bf16 v[136:139], v[40:43], v[60:63], v[136:139]
    buffer_load_dwordx4 v3, s[16:19], s35 offen  lds
    v_mfma_f32_16x16x32_bf16 v[140:143], v[44:47], v[60:63], v[140:143]
    ds_read_b64_tr_b16 v[30:31], v1 offset:17248
    ds_read_b128 v[60:63], v2 offset:13184
    s_waitcnt lgkmcnt(12)
    v_mfma_f32_16x16x32_bf16 v[144:147], v[32:35], v[64:67], v[144:147]
    v_mfma_f32_16x16x32_bf16 v[148:151], v[36:39], v[64:67], v[148:151]
    v_mfma_f32_16x16x32_bf16 v[152:155], v[40:43], v[64:67], v[152:155]
    v_mfma_f32_16x16x32_bf16 v[156:159], v[44:47], v[64:67], v[156:159]
    ds_read_b128 v[64:67], v2 offset:17536
    s_mov_b32 m0, 15840
    v_mfma_f32_16x16x32_bf16 v[160:163], v[32:35], v[68:71], v[160:163]
    buffer_load_dwordx4 v6, s[16:19], s35 offen  lds
    s_add_u32 s35, s35, 262144
    s_add_u32 m0, s39, 34720
    v_mfma_f32_16x16x32_bf16 v[164:167], v[36:39], v[68:71], v[164:167]
    buffer_load_dwordx4 v9, s[12:15], s34 offen offset:1152  lds
    v_mfma_f32_16x16x32_bf16 v[168:171], v[40:43], v[68:71], v[168:171]
    v_mfma_f32_16x16x32_bf16 v[172:175], v[44:47], v[68:71], v[172:175]
    ds_read_b128 v[68:71], v2 offset:21888
    s_waitcnt lgkmcnt(2)
    v_mfma_f32_16x16x32_bf16 v[80:83], v[16:19], v[48:51], v[80:83]
    s_waitcnt vmcnt(26)
    v_mfma_f32_16x16x32_bf16 v[84:87], v[20:23], v[48:51], v[84:87]
    ds_read_b64_tr_b16 v[32:33], v1 offset:21120
    s_mov_b32 m0, 16896
    v_mfma_f32_16x16x32_bf16 v[88:91], v[24:27], v[48:51], v[88:91]
    buffer_load_dwordx4 v11, s[16:19], s35 offen  lds
    v_mfma_f32_16x16x32_bf16 v[92:95], v[28:31], v[48:51], v[92:95]
    ds_read_b64_tr_b16 v[34:35], v1 offset:21376
    ds_read_b128 v[48:51], v2 offset:192
    v_mfma_f32_16x16x32_bf16 v[96:99], v[16:19], v[52:55], v[96:99]
    s_add_u32 m0, s39, 43520
    s_add_u32 s34, s34, 73728
    buffer_load_dwordx4 v8, s[8:11], s33 offen nt lds
    v_mfma_f32_16x16x32_bf16 v[100:103], v[20:23], v[52:55], v[100:103]
    ds_read_b64_tr_b16 v[36:37], v1 offset:21152
    v_mfma_f32_16x16x32_bf16 v[104:107], v[24:27], v[52:55], v[104:107]
    v_mfma_f32_16x16x32_bf16 v[108:111], v[28:31], v[52:55], v[108:111]
    ds_read_b64_tr_b16 v[38:39], v1 offset:21408
    ds_read_b128 v[52:55], v2 offset:4544
    s_mov_b32 m0, 17952
    v_mfma_f32_16x16x32_bf16 v[112:115], v[16:19], v[56:59], v[112:115]
    buffer_load_dwordx4 v12, s[16:19], s35 offen  lds
    v_mfma_f32_16x16x32_bf16 v[116:119], v[20:23], v[56:59], v[116:119]
    ds_read_b64_tr_b16 v[40:41], v1 offset:21184
    v_mfma_f32_16x16x32_bf16 v[120:123], v[24:27], v[56:59], v[120:123]
    v_mfma_f32_16x16x32_bf16 v[124:127], v[28:31], v[56:59], v[124:127]
    ds_read_b64_tr_b16 v[42:43], v1 offset:21440
    s_add_u32 m0, s39, 44320
    ds_read_b128 v[56:59], v2 offset:8896
    buffer_load_dwordx4 v8, s[8:11], s33 offen offset:256 nt lds
    v_mfma_f32_16x16x32_bf16 v[128:131], v[16:19], v[60:63], v[128:131]
    v_mfma_f32_16x16x32_bf16 v[132:135], v[20:23], v[60:63], v[132:135]
    ds_read_b64_tr_b16 v[44:45], v1 offset:21216
    s_mov_b32 m0, 19008
    v_mfma_f32_16x16x32_bf16 v[136:139], v[24:27], v[60:63], v[136:139]
    buffer_load_dwordx4 v3, s[16:19], s35 offen  lds
    v_mfma_f32_16x16x32_bf16 v[140:143], v[28:31], v[60:63], v[140:143]
    ds_read_b64_tr_b16 v[46:47], v1 offset:21472
    ds_read_b128 v[60:63], v2 offset:13248
    s_waitcnt lgkmcnt(12)
    v_mfma_f32_16x16x32_bf16 v[144:147], v[16:19], v[64:67], v[144:147]
    v_mfma_f32_16x16x32_bf16 v[148:151], v[20:23], v[64:67], v[148:151]
    v_mfma_f32_16x16x32_bf16 v[152:155], v[24:27], v[64:67], v[152:155]
    s_add_u32 m0, s40, 52224
    s_add_u32 s33, s33, 8192
    buffer_load_dwordx4 v7, s[4:7], s32 offen nt lds
    v_mfma_f32_16x16x32_bf16 v[156:159], v[28:31], v[64:67], v[156:159]
    ds_read_b128 v[64:67], v2 offset:17600
    s_mov_b32 m0, 20064
    v_mfma_f32_16x16x32_bf16 v[160:163], v[16:19], v[68:71], v[160:163]
    buffer_load_dwordx4 v6, s[16:19], s35 offen  lds
    s_add_u32 s35, s35, 262144
    v_mfma_f32_16x16x32_bf16 v[164:167], v[20:23], v[68:71], v[164:167]
    v_mfma_f32_16x16x32_bf16 v[168:171], v[24:27], v[68:71], v[168:171]
    v_mfma_f32_16x16x32_bf16 v[172:175], v[28:31], v[68:71], v[172:175]
    ds_read_b128 v[68:71], v2 offset:21952
    s_waitcnt lgkmcnt(2)
    v_mfma_f32_16x16x32_bf16 v[80:83], v[32:35], v[48:51], v[80:83]
    s_waitcnt vmcnt(27)
    v_mfma_f32_16x16x32_bf16 v[84:87], v[36:39], v[48:51], v[84:87]
    s_add_u32 m0, s40, 52288
    ds_read_b64_tr_b16 v[16:17], v1 offset:0
    buffer_load_dwordx4 v7, s[4:7], s32 offen offset:1024 nt lds
    s_add_u32 s32, s32, 8192
    s_mov_b32 m0, 21120
    v_mfma_f32_16x16x32_bf16 v[88:91], v[40:43], v[48:51], v[88:91]
    buffer_load_dwordx4 v11, s[16:19], s35 offen  lds
    v_mfma_f32_16x16x32_bf16 v[92:95], v[44:47], v[48:51], v[92:95]
    ds_read_b64_tr_b16 v[18:19], v1 offset:256
    v_mfma_f32_16x16x32_bf16 v[96:99], v[32:35], v[52:55], v[96:99]
    v_mfma_f32_16x16x32_bf16 v[100:103], v[36:39], v[52:55], v[100:103]
    ds_read_b64_tr_b16 v[20:21], v1 offset:32
    v_mfma_f32_16x16x32_bf16 v[104:107], v[40:43], v[52:55], v[104:107]
    v_mfma_f32_16x16x32_bf16 v[108:111], v[44:47], v[52:55], v[108:111]
    ds_read_b64_tr_b16 v[22:23], v1 offset:288
    s_mov_b32 m0, 22176
    v_mfma_f32_16x16x32_bf16 v[112:115], v[32:35], v[56:59], v[112:115]
    buffer_load_dwordx4 v12, s[16:19], s35 offen  lds
    v_mfma_f32_16x16x32_bf16 v[116:119], v[36:39], v[56:59], v[116:119]
    ds_read_b64_tr_b16 v[24:25], v1 offset:64
    v_mfma_f32_16x16x32_bf16 v[120:123], v[40:43], v[56:59], v[120:123]
    v_mfma_f32_16x16x32_bf16 v[124:127], v[44:47], v[56:59], v[124:127]
    ds_read_b64_tr_b16 v[26:27], v1 offset:320
    v_mfma_f32_16x16x32_bf16 v[128:131], v[32:35], v[60:63], v[128:131]
    v_mfma_f32_16x16x32_bf16 v[132:135], v[36:39], v[60:63], v[132:135]
    ds_read_b64_tr_b16 v[28:29], v1 offset:96
    s_mov_b32 m0, 23232
    v_mfma_f32_16x16x32_bf16 v[136:139], v[40:43], v[60:63], v[136:139]
    buffer_load_dwordx4 v3, s[16:19], s35 offen  lds
    v_mfma_f32_16x16x32_bf16 v[140:143], v[44:47], v[60:63], v[140:143]
    ds_read_b64_tr_b16 v[30:31], v1 offset:352
    s_waitcnt lgkmcnt(8)
    v_mfma_f32_16x16x32_bf16 v[144:147], v[32:35], v[64:67], v[144:147]
    v_mfma_f32_16x16x32_bf16 v[148:151], v[36:39], v[64:67], v[148:151]
    v_mfma_f32_16x16x32_bf16 v[152:155], v[40:43], v[64:67], v[152:155]
    v_mfma_f32_16x16x32_bf16 v[156:159], v[44:47], v[64:67], v[156:159]
    s_mov_b32 m0, 24288
    v_mfma_f32_16x16x32_bf16 v[160:163], v[32:35], v[68:71], v[160:163]
    buffer_load_dwordx4 v6, s[16:19], s35 offen  lds
    s_add_u32 s35, s35, 262144
    v_mfma_f32_16x16x32_bf16 v[164:167], v[36:39], v[68:71], v[164:167]
    s_waitcnt vmcnt(24)
    s_barrier
    s_add_u32 m0, s39, 60928
    v_mfma_f32_16x16x32_bf16 v[168:171], v[40:43], v[68:71], v[168:171]
    buffer_load_dwordx4 v9, s[12:15], s34 offen  lds
    s_add_u32 m0, s39, 60832
    s_nop 0
    buffer_load_dwordx4 v9, s[12:15], s34 offen offset:1152  lds
    s_sub_u32 s34, s34, 73600
    s_add_u32 m0, s39, 69632
    s_mov_b32 s33, s74
    buffer_load_dwordx4 v8, s[8:11], s33 offen nt lds
    s_add_u32 m0, s39, 70432
    s_nop 0
    buffer_load_dwordx4 v8, s[8:11], s33 offen offset:256 nt lds
    s_add_u32 m0, s40, 78336
    s_add_u32 s33, s33, 8192
    buffer_load_dwordx4 v7, s[4:7], s32 offen nt lds
    s_add_u32 m0, s40, 78400
    s_nop 0
    buffer_load_dwordx4 v7, s[4:7], s32 offen offset:1024 nt lds
    s_add_u32 s32, s32, 8192
    v_mfma_f32_16x16x32_bf16 v[172:175], v[44:47], v[68:71], v[172:175]
    v_add_u32 v5, s53, v4
    s_xor_b32 s53, s53, 4096
    v_mul_f32 v80, s47, v80
    v_mul_f32 v81, s47, v81
    v_mul_f32 v82, s47, v82
    v_mul_f32 v83, s47, v83
    v_mul_f32 v84, s47, v84
    v_mul_f32 v85, s47, v85
    v_mul_f32 v86, s47, v86
    v_mul_f32 v87, s47, v87
    v_cvt_pk_bf16_f32 v72, v80, v81
    v_cvt_pk_bf16_f32 v73, v82, v83
    v_cvt_pk_bf16_f32 v74, v84, v85
    v_cvt_pk_bf16_f32 v75, v86, v87
    ds_write_b64 v5, v[72:73] offset:0
    ds_write_b64 v5, v[74:75] offset:512
    v_mul_f32 v88, s47, v88
    v_mul_f32 v89, s47, v89
    v_mul_f32 v90, s47, v90
    v_mul_f32 v91, s47, v91
    v_mul_f32 v92, s47, v92
    v_mul_f32 v93, s47, v93
    v_mul_f32 v94, s47, v94
    v_mul_f32 v95, s47, v95
    v_cvt_pk_bf16_f32 v76, v88, v89
    v_cvt_pk_bf16_f32 v77, v90, v91
    v_cvt_pk_bf16_f32 v78, v92, v93
    v_cvt_pk_bf16_f32 v79, v94, v95
    ds_write_b64 v5, v[76:77] offset:2048
    ds_write_b64 v5, v[78:79] offset:2560
    v_mul_f32 v96, s47, v96
    v_mul_f32 v97, s47, v97
    v_mul_f32 v98, s47, v98
    v_mul_f32 v99, s47, v99
    v_mul_f32 v100, s47, v100
    v_mul_f32 v101, s47, v101
    v_mul_f32 v102, s47, v102
    v_mul_f32 v103, s47, v103
    v_cvt_pk_bf16_f32 v72, v96, v97
    v_cvt_pk_bf16_f32 v73, v98, v99
    v_cvt_pk_bf16_f32 v74, v100, v101
    v_cvt_pk_bf16_f32 v75, v102, v103
    ds_write_b64 v5, v[72:73] offset:1024
    ds_write_b64 v5, v[74:75] offset:1536
    v_mul_f32 v104, s47, v104
    v_mul_f32 v105, s47, v105
    v_mul_f32 v106, s47, v106
    v_mul_f32 v107, s47, v107
    v_mul_f32 v108, s47, v108
    v_mul_f32 v109, s47, v109
    v_mul_f32 v110, s47, v110
    v_mul_f32 v111, s47, v111
    v_cvt_pk_bf16_f32 v76, v104, v105
    v_cvt_pk_bf16_f32 v77, v106, v107
    v_cvt_pk_bf16_f32 v78, v108, v109
    v_cvt_pk_bf16_f32 v79, v110, v111
    ds_write_b64 v5, v[76:77] offset:3072
    ds_write_b64 v5, v[78:79] offset:3584
    v_mul_f32 v112, s47, v112
    v_mul_f32 v113, s47, v113
    v_mul_f32 v114, s47, v114
    v_mul_f32 v115, s47, v115
    v_mul_f32 v116, s47, v116
    v_mul_f32 v117, s47, v117
    v_mul_f32 v118, s47, v118
    v_mul_f32 v119, s47, v119
    v_cvt_pk_bf16_f32 v72, v112, v113
    v_cvt_pk_bf16_f32 v73, v114, v115
    v_cvt_pk_bf16_f32 v74, v116, v117
    v_cvt_pk_bf16_f32 v75, v118, v119
    ds_write_b64 v5, v[72:73] offset:8192
    ds_write_b64 v5, v[74:75] offset:8704
    v_mul_f32 v120, s47, v120
    v_mul_f32 v121, s47, v121
    v_mul_f32 v122, s47, v122
    v_mul_f32 v123, s47, v123
    v_mul_f32 v124, s47, v124
    v_mul_f32 v125, s47, v125
    v_mul_f32 v126, s47, v126
    v_mul_f32 v127, s47, v127
    v_cvt_pk_bf16_f32 v76, v120, v121
    v_cvt_pk_bf16_f32 v77, v122, v123
    v_cvt_pk_bf16_f32 v78, v124, v125
    v_cvt_pk_bf16_f32 v79, v126, v127
    ds_write_b64 v5, v[76:77] offset:10240
    ds_write_b64 v5, v[78:79] offset:10752
    v_mul_f32 v128, s47, v128
    v_mul_f32 v129, s47, v129
    v_mul_f32 v130, s47, v130
    v_mul_f32 v131, s47, v131
    v_mul_f32 v132, s47, v132
    v_mul_f32 v133, s47, v133
    v_mul_f32 v134, s47, v134
    v_mul_f32 v135, s47, v135
    v_cvt_pk_bf16_f32 v72, v128, v129
    v_cvt_pk_bf16_f32 v73, v130, v131
    v_cvt_pk_bf16_f32 v74, v132, v133
    v_cvt_pk_bf16_f32 v75, v134, v135
    ds_write_b64 v5, v[72:73] offset:9216
    ds_write_b64 v5, v[74:75] offset:9728
    v_mul_f32 v136, s47, v136
    v_mul_f32 v137, s47, v137
    v_mul_f32 v138, s47, v138
    v_mul_f32 v139, s47, v139
    v_mul_f32 v140, s47, v140
    v_mul_f32 v141, s47, v141
    v_mul_f32 v142, s47, v142
    v_mul_f32 v143, s47, v143
    v_cvt_pk_bf16_f32 v76, v136, v137
    v_cvt_pk_bf16_f32 v77, v138, v139
    v_cvt_pk_bf16_f32 v78, v140, v141
    v_cvt_pk_bf16_f32 v79, v142, v143
    ds_write_b64 v5, v[76:77] offset:11264
    ds_write_b64 v5, v[78:79] offset:11776
    v_mul_f32 v144, s47, v144
    v_mul_f32 v145, s47, v145
    v_mul_f32 v146, s47, v146
    v_mul_f32 v147, s47, v147
    v_mul_f32 v148, s47, v148
    v_mul_f32 v149, s47, v149
    v_mul_f32 v150, s47, v150
    v_mul_f32 v151, s47, v151
    v_cvt_pk_bf16_f32 v72, v144, v145
    v_cvt_pk_bf16_f32 v73, v146, v147
    v_cvt_pk_bf16_f32 v74, v148, v149
    v_cvt_pk_bf16_f32 v75, v150, v151
    ds_write_b64 v5, v[72:73] offset:16384
    ds_write_b64 v5, v[74:75] offset:16896
    v_mul_f32 v152, s47, v152
    v_mul_f32 v153, s47, v153
    v_mul_f32 v154, s47, v154
    v_mul_f32 v155, s47, v155
    v_mul_f32 v156, s47, v156
    v_mul_f32 v157, s47, v157
    v_mul_f32 v158, s47, v158
    v_mul_f32 v159, s47, v159
    v_cvt_pk_bf16_f32 v76, v152, v153
    v_cvt_pk_bf16_f32 v77, v154, v155
    v_cvt_pk_bf16_f32 v78, v156, v157
    v_cvt_pk_bf16_f32 v79, v158, v159
    ds_write_b64 v5, v[76:77] offset:18432
    ds_write_b64 v5, v[78:79] offset:18944
    v_mul_f32 v160, s47, v160
    v_mul_f32 v161, s47, v161
    v_mul_f32 v162, s47, v162
    v_mul_f32 v163, s47, v163
    v_mul_f32 v164, s47, v164
    v_mul_f32 v165, s47, v165
    v_mul_f32 v166, s47, v166
    v_mul_f32 v167, s47, v167
    v_cvt_pk_bf16_f32 v72, v160, v161
    v_cvt_pk_bf16_f32 v73, v162, v163
    v_cvt_pk_bf16_f32 v74, v164, v165
    v_cvt_pk_bf16_f32 v75, v166, v167
    ds_write_b64 v5, v[72:73] offset:17408
    ds_write_b64 v5, v[74:75] offset:17920
    v_mul_f32 v168, s47, v168
    v_mul_f32 v169, s47, v169
    v_mul_f32 v170, s47, v170
    v_mul_f32 v171, s47, v171
    v_mul_f32 v172, s47, v172
    v_mul_f32 v173, s47, v173
    v_mul_f32 v174, s47, v174
    v_mul_f32 v175, s47, v175
    v_cvt_pk_bf16_f32 v76, v168, v169
    v_cvt_pk_bf16_f32 v77, v170, v171
    v_cvt_pk_bf16_f32 v78, v172, v173
    v_cvt_pk_bf16_f32 v79, v174, v175
    ds_write_b64 v5, v[76:77] offset:19456
    ds_write_b64 v5, v[78:79] offset:19968
    s_add_u32 s28, s28, 1
    s_cmp_lt_u32 s28, 3
    s_cbranch_scc1 L_qround
    s_waitcnt vmcnt(14) lgkmcnt(0)
    s_barrier
    s_lshl_b32 s48, s73, 2
    s_lshr_b32 s48, s41, s48
    s_and_b32 s48, s48, 3
    s_lshl_b32 s49, s44, 2
    s_add_u32 s48, s48, s49
    s_mul_i32 s34, s48, 147456
    s_cmp_ge_i32 s73, 0
    s_cselect_b32 s14, 4718592, 0
    s_add_u32 m0, s39, 87040
    s_add_u32 s73, s73, 1
    buffer_load_dwordx4 v9, s[12:15], s34 offen  lds
    s_add_u32 m0, s39, 86944
    s_nop 0
    buffer_load_dwordx4 v9, s[12:15], s34 offen offset:1152  lds
    s_add_u32 m0, s39, 95744
    s_add_u32 s34, s34, 73728
    buffer_load_dwordx4 v8, s[8:11], s33 offen nt lds
    s_add_u32 m0, s39, 96544
    s_nop 0
    buffer_load_dwordx4 v8, s[8:11], s33 offen offset:256 nt lds
    s_add_u32 m0, s40, 104448
    s_add_u32 s33, s33, 8192
    buffer_load_dwordx4 v7, s[4:7], s32 offen nt lds
    s_add_u32 m0, s40, 104512
    s_nop 0
    buffer_load_dwordx4 v7, s[4:7], s32 offen offset:1024 nt lds
    s_add_u32 s32, s32, 8192
    s_waitcnt vmcnt(8)
    s_barrier
    s_add_u32 m0, s39, 26112
    s_nop 0
    buffer_load_dwordx4 v9, s[12:15], s34 offen  lds
    s_add_u32 m0, s39, 26016
    s_nop 0
    buffer_load_dwordx4 v9, s[12:15], s34 offen offset:1152  lds
    s_add_u32 m0, s39, 34816
    s_sub_u32 s34, s34, 73600
    buffer_load_dwordx4 v8, s[8:11], s33 offen nt lds
    s_add_u32 m0, s39, 35616
    s_nop 0
    buffer_load_dwordx4 v8, s[8:11], s33 offen offset:256 nt lds
    s_add_u32 m0, s40, 43520
    s_add_u32 s33, s33, 8192
    buffer_load_dwordx4 v7, s[4:7], s32 offen nt lds
    s_add_u32 m0, s40, 43584
    s_nop 0
    buffer_load_dwordx4 v7, s[4:7], s32 offen offset:1024 nt lds
    s_add_u32 s32, s32, 8192
    s_lshl_b32 s38, s55, 2
    v_mov_b32 v16, 0
    v_mov_b32 v17, 4
    v_mov_b32 v20, 1
    v_mbcnt_lo_u32_b32 v19, -1, 0
    v_mbcnt_hi_u32_b32 v19, -1, v19
    v_lshlrev_b32 v19, 8, v19
    s_lshl_b32 s48, s44, 2
    v_add_u32 v19, s48, v19
    buffer_load_dword v18, v16, s[60:63], s38 offen offset:128 sc1
    s_waitcnt vmcnt(9)
    s_barrier
    s_add_u32 m0, s39, 52224
    s_nop 0
    buffer_load_dwordx4 v9, s[12:15], s34 offen  lds
    s_add_u32 m0, s39, 52128
    s_nop 0
    buffer_load_dwordx4 v9, s[12:15], s34 offen offset:1152  lds
    s_add_u32 m0, s39, 60928
    s_add_u32 s34, s34, 73728
    buffer_load_dwordx4 v9, s[12:15], s34 offen  lds
    s_add_u32 m0, s39, 60832
    s_nop 0
    buffer_load_dwordx4 v9, s[12:15], s34 offen offset:1152  lds
    s_add_u32 m0, s39, 69632
    s_sub_u32 s34, s34, 73600
    buffer_load_dwordx4 v8, s[8:11], s33 offen nt lds
    s_add_u32 m0, s39, 70432
    s_nop 0
    buffer_load_dwordx4 v8, s[8:11], s33 offen offset:256 nt lds
    s_add_u32 s33, s33, 8192
    s_waitcnt vmcnt(9)
    s_barrier
    s_add_u32 m0, s40, 78336
    s_nop 0
    buffer_load_dwordx4 v7, s[4:7], s32 offen nt lds
    s_add_u32 m0, s40, 78400
    s_nop 0
    buffer_load_dwordx4 v7, s[4:7], s32 offen offset:1024 nt lds
    s_add_u32 m0, s39, 87040
    s_add_u32 s32, s32, 8192
    buffer_load_dwordx4 v9, s[12:15], s34 offen  lds
    s_add_u32 m0, s39, 86944
    s_nop 0
    buffer_load_dwordx4 v9, s[12:15], s34 offen offset:1152  lds
    s_add_u32 m0, s39, 95744
    s_add_u32 s34, s34, 73728
    buffer_load_dwordx4 v8, s[8:11], s33 offen nt lds
    s_add_u32 m0, s39, 96544
    s_nop 0
    buffer_load_dwordx4 v8, s[8:11], s33 offen offset:256 nt lds
    s_add_u32 s33, s33, 8192
    s_waitcnt vmcnt(6)
    s_barrier
    s_add_u32 m0, s40, 104448
    s_nop 0
    buffer_load_dwordx4 v7, s[4:7], s32 offen nt lds
    s_add_u32 m0, s40, 104512
    s_nop 0
    buffer_load_dwordx4 v7, s[4:7], s32 offen offset:1024 nt lds
    s_add_u32 m0, s39, 26112
    s_add_u32 s32, s32, 8192
    buffer_load_dwordx4 v9, s[12:15], s34 offen  lds
    s_add_u32 m0, s39, 26016
    s_nop 0
    buffer_load_dwordx4 v9, s[12:15], s34 offen offset:1152  lds
    s_add_u32 m0, s39, 34816
    s_sub_u32 s34, s34, 73600
    buffer_load_dwordx4 v8, s[8:11], s33 offen nt lds
    s_add_u32 m0, s39, 35616
    s_nop 0
    buffer_load_dwordx4 v8, s[8:11], s33 offen offset:256 nt lds
    s_add_u32 s33, s33, 8192
    s_waitcnt vmcnt(6)
    s_barrier
    s_add_u32 m0, s40, 43520
    s_nop 0
    buffer_load_dwordx4 v7, s[4:7], s32 offen nt lds
    s_add_u32 m0, s40, 43584
    s_nop 0
    buffer_load_dwordx4 v7, s[4:7], s32 offen offset:1024 nt lds
    s_add_u32 m0, s39, 52224
    s_add_u32 s32, s32, 8192
    buffer_load_dwordx4 v9, s[12:15], s34 offen  lds
    s_add_u32 m0, s39, 52128
    s_nop 0
    buffer_load_dwordx4 v9, s[12:15], s34 offen offset:1152  lds
    s_add_u32 m0, s39, 60928
    s_add_u32 s34, s34, 73728
    buffer_load_dwordx4 v8, s[8:11], s33 offen nt lds
    s_add_u32 m0, s39, 61728
    s_nop 0
    buffer_load_dwordx4 v8, s[8:11], s33 offen offset:256 nt lds
    s_add_u32 m0, s40, 69632
    s_add_u32 s33, s33, 8192
    buffer_load_dwordx4 v7, s[4:7], s32 offen nt lds
    s_add_u32 m0, s40, 69696
    s_nop 0
    buffer_load_dwordx4 v7, s[4:7], s32 offen offset:1024 nt lds
    s_add_u32 s32, s32, 8192
    s_waitcnt vmcnt(8)
    s_barrier
    s_add_u32 m0, s39, 78336
    s_nop 0
    buffer_load_dwordx4 v9, s[12:15], s34 offen  lds
    s_add_u32 m0, s39, 78240
    s_nop 0
    buffer_load_dwordx4 v9, s[12:15], s34 offen offset:1152  lds
    s_add_u32 m0, s39, 87040
    s_sub_u32 s34, s34, 73600
    buffer_load_dwordx4 v9, s[12:15], s34 offen  lds
    s_add_u32 m0, s39, 86944
    s_nop 0
    buffer_load_dwordx4 v9, s[12:15], s34 offen offset:1152  lds
    s_add_u32 m0, s39, 95744
    s_add_u32 s34, s34, 73728
    buffer_load_dwordx4 v8, s[8:11], s33 offen nt lds
    s_add_u32 m0, s39, 96544
    s_nop 0
    buffer_load_dwordx4 v8, s[8:11], s33 offen offset:256 nt lds
    s_add_u32 s33, s33, 8192
    s_nop 0
    s_mov_b32 s65, 0
L_rdy:
    v_readfirstlane_b32 s48, v18
    s_add_u32 s65, s65, 1
    s_and_b32 s48, s48, 458752
    s_cmp_eq_u32 s48, 0
    s_cbranch_scc1 L_rdyok
    buffer_load_dword v18, v16, s[60:63], s38 offen offset:128 sc1
    s_waitcnt vmcnt(0)
    s_cmp_lt_u32 s65, 1048576
    s_cbranch_scc1 L_rdy
L_rdyok:
    s_waitcnt vmcnt(8)
    s_barrier
    s_add_u32 m0, s40, 104448
    s_nop 0
    buffer_load_dwordx4 v7, s[4:7], s32 offen nt lds
    s_add_u32 m0, s40, 104512
    s_nop 0
    buffer_load_dwordx4 v7, s[4:7], s32 offen offset:1024 nt lds
    s_add_u32 m0, s39, 26112
    s_add_u32 s32, s32, 8192
    buffer_load_dwordx4 v9, s[12:15], s34 offen  lds
    s_add_u32 m0, s39, 26016
    s_nop 0
    buffer_load_dwordx4 v9, s[12:15], s34 offen offset:1152  lds
    s_add_u32 m0, s39, 34816
    s_sub_u32 s34, s34, 73600
    buffer_load_dwordx4 v8, s[8:11], s33 offen nt lds
    s_add_u32 m0, s39, 35616
    s_nop 0
    buffer_load_dwordx4 v8, s[8:11], s33 offen offset:256 nt lds
    s_add_u32 s33, s33, 8192
    s_waitcnt vmcnt(6)
    s_barrier
    s_add_u32 m0, s40, 43520
    s_nop 0
    buffer_load_dwordx4 v7, s[4:7], s32 offen nt lds
    s_add_u32 m0, s40, 43584
    s_nop 0
    buffer_load_dwordx4 v7, s[4:7], s32 offen offset:1024 nt lds
    s_add_u32 m0, s39, 52224
    s_add_u32 s32, s32, 8192
    buffer_load_dwordx4 v9, s[12:15], s34 offen  lds
    s_add_u32 m0, s39, 52128
    s_nop 0
    buffer_load_dwordx4 v9, s[12:15], s34 offen offset:1152  lds
    s_add_u32 m0, s39, 60928
    s_add_u32 s34, s34, 73728
    buffer_load_dwordx4 v8, s[8:11], s33 offen nt lds
    s_add_u32 m0, s39, 61728
    s_nop 0
    buffer_load_dwordx4 v8, s[8:11], s33 offen offset:256 nt lds
    s_add_u32 s33, s33, 8192
    s_waitcnt vmcnt(6)
    s_barrier
    s_add_u32 m0, s40, 69632
    s_nop 0
    buffer_load_dwordx4 v7, s[4:7], s32 offen nt lds
    s_add_u32 m0, s40, 69696
    s_nop 0
    buffer_load_dwordx4 v7, s[4:7], s32 offen offset:1024 nt lds
    s_add_u32 m0, s39, 78336
    s_add_u32 s32, s32, 8192
    buffer_load_dwordx4 v9, s[12:15], s34 offen  lds
    s_add_u32 m0, s39, 78240
    s_nop 0
    buffer_load_dwordx4 v9, s[12:15], s34 offen offset:1152  lds
    s_add_u32 m0, s39, 87040
    s_sub_u32 s34, s34, 73600
    buffer_load_dwordx4 v8, s[8:11], s33 offen nt lds
    s_add_u32 m0, s39, 87840
    s_nop 0
    buffer_load_dwordx4 v8, s[8:11], s33 offen offset:256 nt lds
    s_add_u32 m0, s40, 95744
    s_add_u32 s33, s33, 8192
    buffer_load_dwordx4 v7, s[4:7], s32 offen nt lds
    s_add_u32 m0, s40, 95808
    s_nop 0
    buffer_load_dwordx4 v7, s[4:7], s32 offen offset:1024 nt lds
    s_add_u32 s32, s32, 8192
    s_waitcnt vmcnt(8)
    s_barrier
    s_add_u32 m0, s39, 104448
    s_nop 0
    buffer_load_dwordx4 v9, s[12:15], s34 offen  lds
    s_add_u32 m0, s39, 104352
    s_nop 0
    buffer_load_dwordx4 v9, s[12:15], s34 offen offset:1152  lds
    s_add_u32 m0, s39, 26112
    s_add_u32 s34, s34, 73728
    buffer_load_dwordx4 v8, s[8:11], s33 offen nt lds
    s_add_u32 m0, s39, 26912
    s_nop 0
    buffer_load_dwordx4 v8, s[8:11], s33 offen offset:256 nt lds
    s_add_u32 m0, s40, 34816
    s_add_u32 s33, s33, 8192
    buffer_load_dwordx4 v7, s[4:7], s32 offen nt lds
    s_add_u32 m0, s40, 34880
    s_nop 0
    buffer_load_dwordx4 v7, s[4:7], s32 offen offset:1024 nt lds
    s_add_u32 s32, s32, 8192
    s_waitcnt vmcnt(8)
    s_barrier
    s_add_u32 m0, s39, 43520
    s_nop 0
    buffer_load_dwordx4 v9, s[12:15], s34 offen  lds
    s_add_u32 m0, s39, 43424
    s_nop 0
    buffer_load_dwordx4 v9, s[12:15], s34 offen offset:1152  lds
    s_add_u32 m0, s39, 52224
    s_sub_u32 s34, s34, 73600
    buffer_load_dwordx4 v8, s[8:11], s33 offen nt lds
    s_add_u32 m0, s39, 53024
    s_nop 0
    buffer_load_dwordx4 v8, s[8:11], s33 offen offset:256 nt lds
    s_add_u32 m0, s40, 60928
    s_add_u32 s33, s33, 8192
    buffer_load_dwordx4 v7, s[4:7], s32 offen nt lds
    s_add_u32 m0, s40, 60992
    s_nop 0
    buffer_load_dwordx4 v7, s[4:7], s32 offen offset:1024 nt lds
    s_add_u32 s32, s32, 8192
    s_waitcnt vmcnt(8)
    s_barrier
    s_add_u32 m0, s39, 69632
    s_nop 0
    buffer_load_dwordx4 v9, s[12:15], s34 offen  lds
    s_add_u32 m0, s39, 69536
    s_nop 0
    buffer_load_dwordx4 v9, s[12:15], s34 offen offset:1152  lds
    s_add_u32 m0, s39, 78336
    s_add_u32 s34, s34, 73728
    buffer_load_dwordx4 v8, s[8:11], s33 offen nt lds
    s_add_u32 m0, s39, 79136
    s_nop 0
    buffer_load_dwordx4 v8, s[8:11], s33 offen offset:256 nt lds
    s_add_u32 m0, s40, 87040
    s_add_u32 s33, s33, 8192
    buffer_load_dwordx4 v7, s[4:7], s32 offen nt lds
    s_add_u32 m0, s40, 87104
    s_nop 0
    buffer_load_dwordx4 v7, s[4:7], s32 offen offset:1024 nt lds
    s_add_u32 s32, s32, 8192
    s_waitcnt vmcnt(8)
    s_barrier
    s_add_u32 m0, s39, 95744
    s_nop 0
    buffer_load_dwordx4 v9, s[12:15], s34 offen  lds
    s_add_u32 m0, s39, 95648
    s_nop 0
    buffer_load_dwordx4 v9, s[12:15], s34 offen offset:1152  lds
    s_add_u32 m0, s39, 104448
    s_sub_u32 s34, s34, 73600
    buffer_load_dwordx4 v8, s[8:11], s33 offen nt lds
    s_add_u32 m0, s39, 105248
    s_nop 0
    buffer_load_dwordx4 v8, s[8:11], s33 offen offset:256 nt lds
    s_add_u32 m0, s39, 26112
    s_add_u32 s33, s33, 8192
    buffer_load_dwordx4 v9, s[12:15], s34 offen  lds
    s_add_u32 m0, s39, 26016
    s_nop 0
    buffer_load_dwordx4 v9, s[12:15], s34 offen offset:1152  lds
    s_add_u32 s34, s34, 73728
    s_waitcnt vmcnt(8)
    s_barrier
    s_add_u32 m0, s39, 34816
    s_nop 0
    buffer_load_dwordx4 v8, s[8:11], s33 offen nt lds
    s_add_u32 m0, s39, 35616
    s_nop 0
    buffer_load_dwordx4 v8, s[8:11], s33 offen offset:256 nt lds
    s_add_u32 m0, s39, 43520
    s_add_u32 s33, s33, 8192
    buffer_load_dwordx4 v9, s[12:15], s34 offen  lds
    s_add_u32 m0, s39, 43424
    s_nop 0
    buffer_load_dwordx4 v9, s[12:15], s34 offen offset:1152  lds
    s_sub_u32 s34, s34, 73600
    s_lshl_b32 s48, s73, 2
    s_lshr_b32 s48, s41, s48
    s_and_b32 s48, s48, 3
    s_lshl_b32 s49, s44, 2
    s_add_u32 s48, s48, s49
    s_mul_i32 s34, s48, 147456
    s_cmp_ge_i32 s73, 0
    s_cselect_b32 s14, 4718592, 0
    s_add_u32 s73, s73, 1
    v_subrev_u32 v15, 6912, v9
    s_mov_b32 m0, 52224
    s_add_u32 s50, s34, 0
    buffer_load_dwordx4 v15, s[12:15], s50 offen  lds
    s_mov_b32 m0, 53280
    s_add_u32 s50, s34, 1152
    buffer_load_dwordx4 v15, s[12:15], s50 offen  lds
    s_mov_b32 m0, 54336
    s_add_u32 s50, s34, 2304
    buffer_load_dwordx4 v15, s[12:15], s50 offen  lds
    s_mov_b32 m0, 55392
    s_add_u32 s50, s34, 3456
    buffer_load_dwordx4 v15, s[12:15], s50 offen  lds
    s_mov_b32 m0, 56448
    s_add_u32 s50, s34, 4608
    buffer_load_dwordx4 v15, s[12:15], s50 offen  lds
    s_mov_b32 m0, 57504
    s_add_u32 s50, s34, 5760
    buffer_load_dwordx4 v15, s[12:15], s50 offen  lds
    s_mov_b32 m0, 58560
    s_add_u32 s50, s34, 6912
    buffer_load_dwordx4 v15, s[12:15], s50 offen  lds
    s_mov_b32 m0, 59616
    s_add_u32 s50, s34, 8064
    buffer_load_dwordx4 v15, s[12:15], s50 offen  lds
    s_add_u32 s34, s34, 73728
    s_waitcnt vmcnt(14)
    s_barrier
    s_mov_b32 m0, 60928
    s_add_u32 s50, s34, 0
    buffer_load_dwordx4 v15, s[12:15], s50 offen  lds
    s_mov_b32 m0, 61984
    s_add_u32 s50, s34, 1152
    buffer_load_dwordx4 v15, s[12:15], s50 offen  lds
    s_mov_b32 m0, 63040
    s_add_u32 s50, s34, 2304
    buffer_load_dwordx4 v15, s[12:15], s50 offen  lds
    s_mov_b32 m0, 64096
    s_add_u32 s50, s34, 3456
    buffer_load_dwordx4 v15, s[12:15], s50 offen  lds
    s_mov_b32 m0, 65152
    s_add_u32 s50, s34, 4608
    buffer_load_dwordx4 v15, s[12:15], s50 offen  lds
    s_mov_b32 m0, 66208
    s_add_u32 s50, s34, 5760
    buffer_load_dwordx4 v15, s[12:15], s50 offen  lds
    s_mov_b32 m0, 67264
    s_add_u32 s50, s34, 6912
    buffer_load_dwordx4 v15, s[12:15], s50 offen  lds
    s_mov_b32 m0, 68320
    s_add_u32 s50, s34, 8064
    buffer_load_dwordx4 v15, s[12:15], s50 offen  lds
    s_sub_u32 s34, s34, 73600
    s_mov_b32 m0, 69632
    s_add_u32 s50, s34, 0
    buffer_load_dwordx4 v15, s[12:15], s50 offen  lds
    s_mov_b32 m0, 70688
    s_add_u32 s50, s34, 1152
    buffer_load_dwordx4 v15, s[12:15], s50 offen  lds
    s_mov_b32 m0, 71744
    s_add_u32 s50, s34, 2304
    buffer_load_dwordx4 v15, s[12:15], s50 offen  lds
    s_mov_b32 m0, 72800
    s_add_u32 s50, s34, 3456
    buffer_load_dwordx4 v15, s[12:15], s50 offen  lds
    s_mov_b32 m0, 73856
    s_add_u32 s50, s34, 4608
    buffer_load_dwordx4 v15, s[12:15], s50 offen  lds
    s_mov_b32 m0, 74912
    s_add_u32 s50, s34, 5760
    buffer_load_dwordx4 v15, s[12:15], s50 offen  lds
    s_mov_b32 m0, 75968
    s_add_u32 s50, s34, 6912
    buffer_load_dwordx4 v15, s[12:15], s50 offen  lds
    s_mov_b32 m0, 77024
    s_add_u32 s50, s34, 8064
    buffer_load_dwordx4 v15, s[12:15], s50 offen  lds
    s_add_u32 s34, s34, 73728
    s_mov_b32 m0, 78336
    s_add_u32 s50, s34, 0
    buffer_load_dwordx4 v15, s[12:15], s50 offen  lds
    s_mov_b32 m0, 79392
    s_add_u32 s50, s34, 1152
    buffer_load_dwordx4 v15, s[12:15], s50 offen  lds
    s_mov_b32 m0, 80448
    s_add_u32 s50, s34, 2304
    buffer_load_dwordx4 v15, s[12:15], s50 offen  lds
    s_mov_b32 m0, 81504
    s_add_u32 s50, s34, 3456
    buffer_load_dwordx4 v15, s[12:15], s50 offen  lds
    s_mov_b32 m0, 82560
    s_add_u32 s50, s34, 4608
    buffer_load_dwordx4 v15, s[12:15], s50 offen  lds
    s_mov_b32 m0, 83616
    s_add_u32 s50, s34, 5760
    buffer_load_dwordx4 v15, s[12:15], s50 offen  lds
    s_mov_b32 m0, 84672
    s_add_u32 s50, s34, 6912
    buffer_load_dwordx4 v15, s[12:15], s50 offen  lds
    s_mov_b32 m0, 85728
    s_add_u32 s50, s34, 8064
    buffer_load_dwordx4 v15, s[12:15], s50 offen  lds
    s_sub_u32 s34, s34, 73600
    s_mov_b64 exec, 1
    buffer_atomic_add v17, v16, s[60:63], s38 offen offset:128 sc0
    s_mov_b64 exec, -1
    s_waitcnt vmcnt(35)
    s_barrier
    s_mov_b32 m0, 87040
    s_add_u32 s50, s34, 0
    buffer_load_dwordx4 v15, s[12:15], s50 offen  lds
    s_mov_b32 m0, 88096
    s_add_u32 s50, s34, 1152
    buffer_load_dwordx4 v15, s[12:15], s50 offen  lds
    s_mov_b32 m0, 89152
    s_add_u32 s50, s34, 2304
    buffer_load_dwordx4 v15, s[12:15], s50 offen  lds
    s_mov_b32 m0, 90208
    s_add_u32 s50, s34, 3456
    buffer_load_dwordx4 v15, s[12:15], s50 offen  lds
    s_mov_b32 m0, 91264
    s_add_u32 s50, s34, 4608
    buffer_load_dwordx4 v15, s[12:15], s50 offen  lds
    s_mov_b32 m0, 92320
    s_add_u32 s50, s34, 5760
    buffer_load_dwordx4 v15, s[12:15], s50 offen  lds
    s_mov_b32 m0, 93376
    s_add_u32 s50, s34, 6912
    buffer_load_dwordx4 v15, s[12:15], s50 offen  lds
    s_mov_b32 m0, 94432
    s_add_u32 s50, s34, 8064
    buffer_load_dwordx4 v15, s[12:15], s50 offen  lds
    s_add_u32 s34, s34, 73728
    s_mov_b32 m0, 95744
    s_add_u32 s50, s34, 0
    buffer_load_dwordx4 v15, s[12:15], s50 offen  lds
    s_mov_b32 m0, 96800
    s_add_u32 s50, s34, 1152
    buffer_load_dwordx4 v15, s[12:15], s50 offen  lds
    s_mov_b32 m0, 97856
    s_add_u32 s50, s34, 2304
    buffer_load_dwordx4 v15, s[12:15], s50 offen  lds
    s_mov_b32 m0, 98912
    s_add_u32 s50, s34, 3456
    buffer_load_dwordx4 v15, s[12:15], s50 offen  lds
    s_mov_b32 m0, 99968
    s_add_u32 s50, s34, 4608
    buffer_load_dwordx4 v15, s[12:15], s50 offen  lds
    s_mov_b32 m0, 101024
    s_add_u32 s50, s34, 5760
    buffer_load_dwordx4 v15, s[12:15], s50 offen  lds
    s_mov_b32 m0, 102080
    s_add_u32 s50, s34, 6912
    buffer_load_dwordx4 v15, s[12:15], s50 offen  lds
    s_mov_b32 m0, 103136
    s_add_u32 s50, s34, 8064
    buffer_load_dwordx4 v15, s[12:15], s50 offen  lds
    s_sub_u32 s34, s34, 73600
    s_mov_b32 m0, 104448
    s_add_u32 s50, s34, 0
    buffer_load_dwordx4 v15, s[12:15], s50 offen  lds
    s_mov_b32 m0, 105504
    s_add_u32 s50, s34, 1152
    buffer_load_dwordx4 v15, s[12:15], s50 offen  lds
    s_mov_b32 m0, 106560
    s_add_u32 s50, s34, 2304
    buffer_load_dwordx4 v15, s[12:15], s50 offen  lds
    s_mov_b32 m0, 107616
    s_add_u32 s50, s34, 3456
    buffer_load_dwordx4 v15, s[12:15], s50 offen  lds
    s_mov_b32 m0, 108672
    s_add_u32 s50, s34, 4608
    buffer_load_dwordx4 v15, s[12:15], s50 offen  lds
    s_mov_b32 m0, 109728
    s_add_u32 s50, s34, 5760
    buffer_load_dwordx4 v15, s[12:15], s50 offen  lds
    s_mov_b32 m0, 110784
    s_add_u32 s50, s34, 6912
    buffer_load_dwordx4 v15, s[12:15], s50 offen  lds
    s_mov_b32 m0, 111840
    s_add_u32 s50, s34, 8064
    buffer_load_dwordx4 v15, s[12:15], s50 offen  lds
    s_add_u32 s34, s34, 73728
    s_waitcnt vmcnt(57)
    s_barrier
    s_mov_b32 m0, 26112
    s_add_u32 s50, s34, 0
    buffer_load_dwordx4 v15, s[12:15], s50 offen  lds
    s_mov_b32 m0, 27168
    s_add_u32 s50, s34, 1152
    buffer_load_dwordx4 v15, s[12:15], s50 offen  lds
    s_mov_b32 m0, 28224
    s_add_u32 s50, s34, 2304
    buffer_load_dwordx4 v15, s[12:15], s50 offen  lds
    s_mov_b32 m0, 29280
    s_add_u32 s50, s34, 3456
    buffer_load_dwordx4 v15, s[12:15], s50 offen  lds
    s_mov_b32 m0, 30336
    s_add_u32 s50, s34, 4608
    buffer_load_dwordx4 v15, s[12:15], s50 offen  lds
    s_mov_b32 m0, 31392
    s_add_u32 s50, s34, 5760
    buffer_load_dwordx4 v15, s[12:15], s50 offen  lds
    s_mov_b32 m0, 32448
    s_add_u32 s50, s34, 6912
    buffer_load_dwordx4 v15, s[12:15], s50 offen  lds
    s_mov_b32 m0, 33504
    s_add_u32 s50, s34, 8064
    buffer_load_dwordx4 v15, s[12:15], s50 offen  lds
    s_sub_u32 s34, s34, 73600
    s_mov_b32 m0, 34816
    s_add_u32 s50, s34, 0
    buffer_load_dwordx4 v15, s[12:15], s50 offen  lds
    s_mov_b32 m0, 35872
    s_add_u32 s50, s34, 1152
    buffer_load_dwordx4 v15, s[12:15], s50 offen  lds
    s_mov_b32 m0, 36928
    s_add_u32 s50, s34, 2304
    buffer_load_dwordx4 v15, s[12:15], s50 offen  lds
    s_mov_b32 m0, 37984
    s_add_u32 s50, s34, 3456
    buffer_load_dwordx4 v15, s[12:15], s50 offen  lds
    s_mov_b32 m0, 39040
    s_add_u32 s50, s34, 4608
    buffer_load_dwordx4 v15, s[12:15], s50 offen  lds
    s_mov_b32 m0, 40096
    s_add_u32 s50, s34, 5760
    buffer_load_dwordx4 v15, s[12:15], s50 offen  lds
    s_mov_b32 m0, 41152
    s_add_u32 s50, s34, 6912
    buffer_load_dwordx4 v15, s[12:15], s50 offen  lds
    s_mov_b32 m0, 42208
    s_add_u32 s50, s34, 8064
    buffer_load_dwordx4 v15, s[12:15], s50 offen  lds
    s_add_u32 s34, s34, 73728
    s_waitcnt vmcnt(40)
    s_mov_b64 exec, 1
    v_mov_b32 v16, 130560
    ds_write_b32 v16, v17
    s_mov_b64 exec, -1
    s_waitcnt lgkmcnt(0)
    s_barrier
    s_mov_b32 m0, 43520
    s_add_u32 s50, s34, 0
    buffer_load_dwordx4 v15, s[12:15], s50 offen  lds
    s_mov_b32 m0, 44576
    s_add_u32 s50, s34, 1152
    buffer_load_dwordx4 v15, s[12:15], s50 offen  lds
    s_mov_b32 m0, 45632
    s_add_u32 s50, s34, 2304
    buffer_load_dwordx4 v15, s[12:15], s50 offen  lds
    s_mov_b32 m0, 46688
    s_add_u32 s50, s34, 3456
    buffer_load_dwordx4 v15, s[12:15], s50 offen  lds
    s_mov_b32 m0, 47744
    s_add_u32 s50, s34, 4608
    buffer_load_dwordx4 v15, s[12:15], s50 offen  lds
    s_mov_b32 m0, 48800
    s_add_u32 s50, s34, 5760
    buffer_load_dwordx4 v15, s[12:15], s50 offen  lds
    s_mov_b32 m0, 49856
    s_add_u32 s50, s34, 6912
    buffer_load_dwordx4 v15, s[12:15], s50 offen  lds
    s_mov_b32 m0, 50912
    s_add_u32 s50, s34, 8064
    buffer_load_dwordx4 v15, s[12:15], s50 offen  lds
    s_sub_u32 s34, s34, 73600
    s_waitcnt vmcnt(32)
    s_barrier
    s_mov_b32 m0, 52224
    s_add_u32 s50, s34, 0
    buffer_load_dwordx4 v15, s[12:15], s50 offen  lds
    s_mov_b32 m0, 53280
    s_add_u32 s50, s34, 1152
    buffer_load_dwordx4 v15, s[12:15], s50 offen  lds
    s_mov_b32 m0, 54336
    s_add_u32 s50, s34, 2304
    buffer_load_dwordx4 v15, s[12:15], s50 offen  lds
    s_mov_b32 m0, 55392
    s_add_u32 s50, s34, 3456
    buffer_load_dwordx4 v15, s[12:15], s50 offen  lds
    s_mov_b32 m0, 56448
    s_add_u32 s50, s34, 4608
    buffer_load_dwordx4 v15, s[12:15], s50 offen  lds
    s_mov_b32 m0, 57504
    s_add_u32 s50, s34, 5760
    buffer_load_dwordx4 v15, s[12:15], s50 offen  lds
    s_mov_b32 m0, 58560
    s_add_u32 s50, s34, 6912
    buffer_load_dwordx4 v15, s[12:15], s50 offen  lds
    s_mov_b32 m0, 59616
    s_add_u32 s50, s34, 8064
    buffer_load_dwordx4 v15, s[12:15], s50 offen  lds
    s_add_u32 s34, s34, 73728
    s_mov_b32 m0, 60928
    s_add_u32 s50, s34, 0
    buffer_load_dwordx4 v15, s[12:15], s50 offen  lds
    s_mov_b32 m0, 61984
    s_add_u32 s50, s34, 1152
    buffer_load_dwordx4 v15, s[12:15], s50 offen  lds
    s_mov_b32 m0, 63040
    s_add_u32 s50, s34, 2304
    buffer_load_dwordx4 v15, s[12:15], s50 offen  lds
    s_mov_b32 m0, 64096
    s_add_u32 s50, s34, 3456
    buffer_load_dwordx4 v15, s[12:15], s50 offen  lds
    s_mov_b32 m0, 65152
    s_add_u32 s50, s34, 4608
    buffer_load_dwordx4 v15, s[12:15], s50 offen  lds
    s_mov_b32 m0, 66208
    s_add_u32 s50, s34, 5760
    buffer_load_dwordx4 v15, s[12:15], s50 offen  lds
    s_mov_b32 m0, 67264
    s_add_u32 s50, s34, 6912
    buffer_load_dwordx4 v15, s[12:15], s50 offen  lds
    s_mov_b32 m0, 68320
    s_add_u32 s50, s34, 8064
    buffer_load_dwordx4 v15, s[12:15], s50 offen  lds
    s_sub_u32 s34, s34, 73600
    s_mov_b32 m0, 69632
    s_add_u32 s50, s34, 0
    buffer_load_dwordx4 v15, s[12:15], s50 offen  lds
    s_mov_b32 m0, 70688
    s_add_u32 s50, s34, 1152
    buffer_load_dwordx4 v15, s[12:15], s50 offen  lds
    s_mov_b32 m0, 71744
    s_add_u32 s50, s34, 2304
    buffer_load_dwordx4 v15, s[12:15], s50 offen  lds
    s_mov_b32 m0, 72800
    s_add_u32 s50, s34, 3456
    buffer_load_dwordx4 v15, s[12:15], s50 offen  lds
    s_mov_b32 m0, 73856
    s_add_u32 s50, s34, 4608
    buffer_load_dwordx4 v15, s[12:15], s50 offen  lds
    s_mov_b32 m0, 74912
    s_add_u32 s50, s34, 5760
    buffer_load_dwordx4 v15, s[12:15], s50 offen  lds
    s_mov_b32 m0, 75968
    s_add_u32 s50, s34, 6912
    buffer_load_dwordx4 v15, s[12:15], s50 offen  lds
    s_mov_b32 m0, 77024
    s_add_u32 s50, s34, 8064
    buffer_load_dwordx4 v15, s[12:15], s50 offen  lds
    s_add_u32 s34, s34, 73728
    s_waitcnt vmcnt(32)
    s_barrier
    s_mov_b32 m0, 78336
    s_add_u32 s50, s34, 0
    buffer_load_dwordx4 v15, s[12:15], s50 offen  lds
    s_mov_b32 m0, 79392
    s_add_u32 s50, s34, 1152
    buffer_load_dwordx4 v15, s[12:15], s50 offen  lds
    s_mov_b32 m0, 80448
    s_add_u32 s50, s34, 2304
    buffer_load_dwordx4 v15, s[12:15], s50 offen  lds
    s_mov_b32 m0, 81504
    s_add_u32 s50, s34, 3456
    buffer_load_dwordx4 v15, s[12:15], s50 offen  lds
    s_mov_b32 m0, 82560
    s_add_u32 s50, s34, 4608
    buffer_load_dwordx4 v15, s[12:15], s50 offen  lds
    s_mov_b32 m0, 83616
    s_add_u32 s50, s34, 5760
    buffer_load_dwordx4 v15, s[12:15], s50 offen  lds
    s_mov_b32 m0, 84672
    s_add_u32 s50, s34, 6912
    buffer_load_dwordx4 v15, s[12:15], s50 offen  lds
    s_mov_b32 m0, 85728
    s_add_u32 s50, s34, 8064
    buffer_load_dwordx4 v15, s[12:15], s50 offen  lds
    s_sub_u32 s34, s34, 73600
    s_mov_b32 m0, 87040
    s_add_u32 s50, s34, 0
    buffer_load_dwordx4 v15, s[12:15], s50 offen  lds
    s_mov_b32 m0, 88096
    s_add_u32 s50, s34, 1152
    buffer_load_dwordx4 v15, s[12:15], s50 offen  lds
    s_mov_b32 m0, 89152
    s_add_u32 s50, s34, 2304
    buffer_load_dwordx4 v15, s[12:15], s50 offen  lds
    s_mov_b32 m0, 90208
    s_add_u32 s50, s34, 3456
    buffer_load_dwordx4 v15, s[12:15], s50 offen  lds
    s_mov_b32 m0, 91264
    s_add_u32 s50, s34, 4608
    buffer_load_dwordx4 v15, s[12:15], s50 offen  lds
    s_mov_b32 m0, 92320
    s_add_u32 s50, s34, 5760
    buffer_load_dwordx4 v15, s[12:15], s50 offen  lds
    s_mov_b32 m0, 93376
    s_add_u32 s50, s34, 6912
    buffer_load_dwordx4 v15, s[12:15], s50 offen  lds
    s_mov_b32 m0, 94432
    s_add_u32 s50, s34, 8064
    buffer_load_dwordx4 v15, s[12:15], s50 offen  lds
    s_add_u32 s34, s34, 73728
    s_mov_b32 m0, 95744
    s_add_u32 s50, s34, 0
    buffer_load_dwordx4 v15, s[12:15], s50 offen  lds
    s_mov_b32 m0, 96800
    s_add_u32 s50, s34, 1152
    buffer_load_dwordx4 v15, s[12:15], s50 offen  lds
    s_mov_b32 m0, 97856
    s_add_u32 s50, s34, 2304
    buffer_load_dwordx4 v15, s[12:15], s50 offen  lds
    s_mov_b32 m0, 98912
    s_add_u32 s50, s34, 3456
    buffer_load_dwordx4 v15, s[12:15], s50 offen  lds
    s_mov_b32 m0, 99968
    s_add_u32 s50, s34, 4608
    buffer_load_dwordx4 v15, s[12:15], s50 offen  lds
    s_mov_b32 m0, 101024
    s_add_u32 s50, s34, 5760
    buffer_load_dwordx4 v15, s[12:15], s50 offen  lds
    s_mov_b32 m0, 102080
    s_add_u32 s50, s34, 6912
    buffer_load_dwordx4 v15, s[12:15], s50 offen  lds
    s_mov_b32 m0, 103136
    s_add_u32 s50, s34, 8064
    buffer_load_dwordx4 v15, s[12:15], s50 offen  lds
    s_sub_u32 s34, s34, 73600
    s_waitcnt vmcnt(32)
    s_barrier
    s_mov_b32 m0, 104448
    s_add_u32 s50, s34, 0
    buffer_load_dwordx4 v15, s[12:15], s50 offen  lds
    s_mov_b32 m0, 105504
    s_add_u32 s50, s34, 1152
    buffer_load_dwordx4 v15, s[12:15], s50 offen  lds
    s_mov_b32 m0, 106560
    s_add_u32 s50, s34, 2304
    buffer_load_dwordx4 v15, s[12:15], s50 offen  lds
    s_mov_b32 m0, 107616
    s_add_u32 s50, s34, 3456
    buffer_load_dwordx4 v15, s[12:15], s50 offen  lds
    s_mov_b32 m0, 108672
    s_add_u32 s50, s34, 4608
    buffer_load_dwordx4 v15, s[12:15], s50 offen  lds
    s_mov_b32 m0, 109728
    s_add_u32 s50, s34, 5760
    buffer_load_dwordx4 v15, s[12:15], s50 offen  lds
    s_mov_b32 m0, 110784
    s_add_u32 s50, s34, 6912
    buffer_load_dwordx4 v15, s[12:15], s50 offen  lds
    s_mov_b32 m0, 111840
    s_add_u32 s50, s34, 8064
    buffer_load_dwordx4 v15, s[12:15], s50 offen  lds
    s_add_u32 s34, s34, 73728
    s_mov_b32 m0, 26112
    s_add_u32 s50, s34, 0
    buffer_load_dwordx4 v15, s[12:15], s50 offen  lds
    s_mov_b32 m0, 27168
    s_add_u32 s50, s34, 1152
    buffer_load_dwordx4 v15, s[12:15], s50 offen  lds
    s_mov_b32 m0, 28224
    s_add_u32 s50, s34, 2304
    buffer_load_dwordx4 v15, s[12:15], s50 offen  lds
    s_mov_b32 m0, 29280
    s_add_u32 s50, s34, 3456
    buffer_load_dwordx4 v15, s[12:15], s50 offen  lds
    s_mov_b32 m0, 30336
    s_add_u32 s50, s34, 4608
    buffer_load_dwordx4 v15, s[12:15], s50 offen  lds
    s_mov_b32 m0, 31392
    s_add_u32 s50, s34, 5760
    buffer_load_dwordx4 v15, s[12:15], s50 offen  lds
    s_mov_b32 m0, 32448
    s_add_u32 s50, s34, 6912
    buffer_load_dwordx4 v15, s[12:15], s50 offen  lds
    s_mov_b32 m0, 33504
    s_add_u32 s50, s34, 8064
    buffer_load_dwordx4 v15, s[12:15], s50 offen  lds
    s_sub_u32 s34, s34, 73600
    s_waitcnt vmcnt(24)
    s_barrier
    s_waitcnt vmcnt(0)
    s_barrier
    v_mbcnt_lo_u32_b32 v21, -1, 0
    v_mbcnt_hi_u32_b32 v21, -1, v21
    v_lshlrev_b32 v21, 2, v21
    s_mov_b64 exec, 255
    buffer_load_dword v22, v21, s[20:23], s54 offen sc1
    s_waitcnt vmcnt(0)
    buffer_load_dword v22, v21, s[20:23], s54 offen sc1
    s_waitcnt vmcnt(0)
    v_cmp_eq_u32 vcc, 1, v22
    s_mov_b64 exec, 1
    v_mov_b32 v21, 130564
    s_nop 0
    v_mov_b32 v22, vcc_lo
    ds_write_b32 v21, v22
    s_mov_b64 exec, -1
    s_waitcnt lgkmcnt(0)
    s_and_b32 s48, s54, 0xfffff800
    s_waitcnt vmcnt(0)
    s_barrier
    s_mov_b64 exec, 255
    buffer_store_dword v20, v19, s[20:23], s48 offen sc1
    s_mov_b64 exec, -1
    s_branch L_reduce
L_exit:
    s_endpgm
.section .rodata,"a"
.p2align 6
.amdhsa_kernel concat_heads__mha_block_cached__gqa_block_cached__near_ridge_kernel
  .amdhsa_next_free_vgpr 512
  .amdhsa_next_free_sgpr 102
  .amdhsa_accum_offset 256
  .amdhsa_group_segment_fixed_size 0
  .amdhsa_kernarg_size 104
  .amdhsa_user_sgpr_count 2
  .amdhsa_user_sgpr_kernarg_segment_ptr 1
  .amdhsa_system_sgpr_workgroup_id_x 1
  .amdhsa_float_denorm_mode_32 3
.end_amdhsa_kernel
.text
```
